```python
import torch

def _softmax(x, axis=-1):
    return torch.softmax(x, dim=axis)

def _gelu(x):
    return torch.nn.functional.gelu(x, approximate='tanh')

def _silu(x):
    return torch.nn.functional.silu(x)

def _sigmoid(x):
    return torch.sigmoid(x)

def _layernorm(x, axis=-1, eps=1e-05):
    m = x.mean(dim=axis, keepdim=True)
    v = x.var(dim=axis, keepdim=True, unbiased=False)
    return (x - m) / torch.sqrt(v + eps)

def _scatter_add(tgt, idx, src, axis=0):
    return tgt.clone().index_add_(axis, idx, src)

def _segment_sum(src, seg, n):
    out = torch.zeros((n,) + src.shape[1:], dtype=src.dtype)
    return out.index_add_(0, seg, src)

def _pad(x, pw):
    flat = tuple((v for pair in reversed(pw) for v in pair))
    return torch.nn.functional.pad(x, flat)
kernel_name = 'interleave_layers__memory_aug_recurrent_mem_tr__grouped_kv_mqa__prompt'

def setup_inputs():

    _w = lambda a: (lambda t: t.to(torch.bfloat16) if t.is_floating_point() else t)(torch.as_tensor(a))

    def _A_setup():
        B, S, Dm = (1, 2048, 448)
        H, Dh = (16, 256)
        M, seg = (8, 32)
        seg = min(seg, S)
        S = S // seg * seg
        return {'x': _w((lambda *s: torch.randn(*s, dtype=torch.bfloat16) * 0.05)(B, S, Dm)), 'mem0': _w((lambda *s: torch.randn(*s, dtype=torch.bfloat16) * 0.2)(B, M, Dm)), 'Wq': _w((lambda *s: torch.randn(*s, dtype=torch.bfloat16) * 1.6)(Dm, H, Dh) * Dm ** (-0.5)), 'Wk': _w((lambda *s: torch.randn(*s, dtype=torch.bfloat16) * 1.6)(Dm, H, Dh) * Dm ** (-0.5)), 'Wv': _w((lambda *s: torch.randn(*s, dtype=torch.bfloat16) * 0.2)(Dm, H, Dh) * Dm ** (-0.5)), 'Wo': _w((lambda *s: torch.randn(*s, dtype=torch.bfloat16) * 0.2)(H, Dh, Dm) * (H * Dh) ** (-0.5)), 'seg_len': seg}
    _A_in = _A_setup()

    def _B_setup():
        B, S, D, H = (1, 2048, 448, 16)
        Dh = D // H
        return {'x': _w((lambda *s: torch.randn(*s, dtype=torch.bfloat16) * 0.05)(B, S, D)), 'wq': _w((lambda *s: torch.randn(*s, dtype=torch.bfloat16) * 0.05)(D, H * Dh)), 'wk': _w((lambda *s: torch.randn(*s, dtype=torch.bfloat16) * 0.05)(D, Dh)), 'wv': _w((lambda *s: torch.randn(*s, dtype=torch.bfloat16) * 0.05)(D, Dh)), 'wo': _w((lambda *s: torch.randn(*s, dtype=torch.bfloat16) * 0.05)(H * Dh, D))}
    _B_in = _B_setup()
    return {'A_x': _A_in['x'], 'A_mem0': _A_in['mem0'], 'A_Wq': _A_in['Wq'], 'A_Wk': _A_in['Wk'], 'A_Wv': _A_in['Wv'], 'A_Wo': _A_in['Wo'], 'A_seg_len': _A_in['seg_len'], 'B_x': _B_in['x'], 'B_wq': _B_in['wq'], 'B_wk': _B_in['wk'], 'B_wv': _B_in['wv'], 'B_wo': _B_in['wo']}

def reference(A_x, A_mem0, A_Wq, A_Wk, A_Wv, A_Wo, A_seg_len, B_x, B_wq, B_wk, B_wv, B_wo):

    def _A_ref(x, mem0, Wq, Wk, Wv, Wo, seg_len):
        B, S, Dm = x.shape
        H, Dh = (Wq.shape[1], Wq.shape[2])
        M = mem0.shape[1]
        scale = Dh ** (-0.5)
        n_seg = S // seg_len
        L = M + seg_len
        idx = torch.arange(L)
        mask = (idx[:, None] < M) | (idx[:, None] >= idx[None, :])
        mem = mem0
        outs = []
        for s in range(n_seg):
            xs = x[:, s * seg_len:(s + 1) * seg_len, :].clone()
            h = torch.concatenate([mem, xs], axis=1)
            q = torch.einsum('btd,dhe->bhte', h, Wq)
            k = torch.einsum('btd,dhe->bhte', h, Wk)
            v = torch.einsum('btd,dhe->bhte', h, Wv)
            scores = torch.einsum('bhqe,bhke->bhqk', q, k) * scale
            scores = torch.where(mask[None, None], scores, -1000000000.0)
            p = _softmax(scores, axis=-1)
            o = torch.einsum('bhqk,bhke->bhqe', p, v)
            o = torch.einsum('bhte,hed->btd', o, Wo)
            mem = o[:, :M, :].clone()
            outs.append(o[:, M:, :])
        return torch.concatenate(outs, axis=1)

    def _B_ref(x, wq, wk, wv, wo):
        B, S, D = x.shape
        H = 16
        Dh = D // H
        q = (lambda x, *d: x.permute(*d))((x @ wq).reshape(B, S, H, Dh), 0, 2, 1, 3)
        k = x @ wk
        v = x @ wv
        scores = torch.einsum('bhqd,bkd->bhqk', q, k) * Dh ** (-0.5)
        p = _softmax(scores, axis=-1)
        o = torch.einsum('bhqk,bkd->bhqd', p, v)
        return (lambda x, *d: x.permute(*d))(o, 0, 2, 1, 3).reshape(B, S, H * Dh) @ wo
    x = A_x
    x = x + _A_ref(_layernorm(x, axis=-1), A_mem0, A_Wq, A_Wk, A_Wv, A_Wo, A_seg_len)
    x = x + _B_ref(_layernorm(x, axis=-1), B_wq, B_wk, B_wv, B_wo)
    x = x + _A_ref(_layernorm(x, axis=-1), A_mem0, A_Wq, A_Wk, A_Wv, A_Wo, A_seg_len)
    x = x + _B_ref(_layernorm(x, axis=-1), B_wq, B_wk, B_wv, B_wo)
    return x
```

```asm
; @launch kernel=main_kernel grid=(256,1,1) block=(256,1,1) lds=155648
.amdgcn_target "amdgcn-amd-amdhsa--gfx950"
.text
.globl main_kernel
.p2align 8
.type main_kernel,@function
main_kernel:
    s_cmp_lt_u32 s2, 256
    s_cbranch_scc1 Lgo_main_kernel
    s_endpgm
Lgo_main_kernel:
    s_load_dwordx16 s[16:31], s[0:1], 0
    s_load_dwordx8 s[32:39], s[0:1], 64
    s_load_dwordx4 s[40:43], s[0:1], 96
    s_load_dwordx2 s[44:45], s[0:1], 112
    v_lshrrev_b32 v1, 6, v0
    s_nop 0
    v_readfirstlane_b32 s3, v1
    v_and_b32 v0, 63, v0
    s_waitcnt lgkmcnt(0)
    s_mov_b32 s4, s44
    s_and_b32 s5, s45, 0xffff
    s_mov_b32 s6, 0x10000000
    s_mov_b32 s7, 0x20000
    s_mov_b32 s12, s44
    s_and_b32 s13, s45, 0xffff
    s_mov_b32 s14, 0x10000000
    s_mov_b32 s15, 0x20000
    s_mov_b32 s0, 0
    s_and_b32 s46, s2, 7
    s_lshr_b32 s59, s2, 3
    s_cmp_lg_u32 s46, 0
    s_cbranch_scc1 Lbulk_main_kernel_1
    s_getreg_b32 s58, hwreg(HW_REG_XCC_ID)
    s_and_b32 s58, s58, 15
    s_add_u32 s58, s58, 1
    v_and_b32 v2, 15, v0
    v_lshrrev_b32 v3, 4, v0
    v_lshrrev_b32 v4, 2, v2
    v_lshlrev_b32 v4, 3, v4
    v_and_b32 v5, 3, v2
    v_add_u32 v4, v4, v5
    v_lshlrev_b32 v6, 4, v0
    s_mov_b32 s8, s16
    s_and_b32 s9, s17, 0xffff
    s_mov_b32 s10, 0x1c0000
    s_mov_b32 s11, 0x20000
    s_lshl_b32 s47, s59, 2
    s_add_u32 s47, s47, s3
    v_mul_u32_u24 v8, 896, v2
    v_lshl_add_u32 v8, v3, 4, v8
    s_mul_i32 s48, s47, 14336
    s_mov_b32 s49, s48
    v_lshlrev_b32 v9, 7, v0
    s_lshl_b32 s48, s47, 10
    v_add_u32 v9, s48, v9
    v_mov_b64 v[12:13], 0
    v_mov_b64 v[14:15], 0
    s_mov_b64 exec, 0xff
    s_mov_b32 s53, 97640448
    buffer_store_dwordx4 v[12:15], v9, s[4:7], s53 offen sc1
    s_mov_b32 s53, 179822592
    buffer_store_dwordx4 v[12:15], v9, s[4:7], s53 offen sc1
    s_mov_b64 exec, -1
    s_waitcnt vmcnt(0)
    buffer_load_dwordx4 v[16:19], v8, s[8:11], s49 offen offset:0
    buffer_load_dwordx4 v[20:23], v8, s[8:11], s49 offen offset:64
    buffer_load_dwordx4 v[24:27], v8, s[8:11], s49 offen offset:128
    buffer_load_dwordx4 v[28:31], v8, s[8:11], s49 offen offset:192
    buffer_load_dwordx4 v[32:35], v8, s[8:11], s49 offen offset:256
    buffer_load_dwordx4 v[36:39], v8, s[8:11], s49 offen offset:320
    buffer_load_dwordx4 v[40:43], v8, s[8:11], s49 offen offset:384
    buffer_load_dwordx4 v[44:47], v8, s[8:11], s49 offen offset:448
    buffer_load_dwordx4 v[48:51], v8, s[8:11], s49 offen offset:512
    buffer_load_dwordx4 v[52:55], v8, s[8:11], s49 offen offset:576
    buffer_load_dwordx4 v[56:59], v8, s[8:11], s49 offen offset:640
    buffer_load_dwordx4 v[60:63], v8, s[8:11], s49 offen offset:704
    buffer_load_dwordx4 v[64:67], v8, s[8:11], s49 offen offset:768
    buffer_load_dwordx4 v[68:71], v8, s[8:11], s49 offen offset:832
    s_barrier
    s_mov_b32 s64, s42
    s_and_b32 s65, s43, 0xffff
    s_mov_b32 s66, 0x100
    s_mov_b32 s67, 0x20000
    s_cmp_lg_u32 s3, 0
    s_cbranch_scc1 L_main_kernel_3
    v_mov_b32 v12, 64
    v_mov_b32 v13, 1
    s_mov_b64 exec, 1
    buffer_atomic_add v13, v12, s[64:67], 0 offen sc1
    s_mov_b64 exec, -1
L_main_kernel_3:
    s_cmp_lg_u32 s59, 31
    s_cbranch_scc1 L_main_kernel_4
    s_mov_b32 s8, s18
    s_and_b32 s9, s19, 0xffff
    s_mov_b32 s10, 0x1c00
    s_mov_b32 s11, 0x20000
    s_lshl_b32 s48, s3, 6
    v_add_u32 v8, s48, v0
    v_and_b32 v9, 3, v8
    v_bfe_u32 v10, v8, 2, 3
    v_bfe_u32 v11, v8, 5, 1
    v_lshrrev_b32 v12, 6, v8
    v_mul_u32_u24 v10, 896, v10
    v_lshl_add_u32 v10, v12, 5, v10
    v_lshl_add_u32 v10, v9, 3, v10
    v_lshl_add_u32 v10, v11, 2, v10
    v_lshlrev_b32 v13, 2, v8
    buffer_load_dword v76, v10, s[8:11], 0 offen offset:0
    buffer_load_dword v77, v10, s[8:11], 0 offen offset:128
    buffer_load_dword v78, v10, s[8:11], 0 offen offset:256
    buffer_load_dword v79, v10, s[8:11], 0 offen offset:384
    buffer_load_dword v80, v10, s[8:11], 0 offen offset:512
    buffer_load_dword v81, v10, s[8:11], 0 offen offset:640
    buffer_load_dword v82, v10, s[8:11], 0 offen offset:768
    v_and_b32 v9, 7, v8
    v_mul_u32_u24 v9, 896, v9
    v_lshrrev_b32 v11, 3, v8
    v_lshl_add_u32 v9, v11, 4, v9
    v_lshlrev_b32 v14, 4, v8
    buffer_load_dwordx4 v[84:87], v9, s[8:11], 0 offen
    buffer_load_dwordx4 v[88:91], v9, s[8:11], 0 offen offset:512
    v_add_u32 v15, 4096, v14
    v_cmp_gt_u32 vcc, 7168, v15
    v_mov_b32 v11, 0x7fffffff
    s_nop 0
    v_cndmask_b32 v15, v11, v15, vcc
    s_waitcnt vmcnt(0)
    v_min_u32 v76, -2, v76
    v_min_u32 v77, -2, v77
    v_min_u32 v78, -2, v78
    v_min_u32 v79, -2, v79
    v_min_u32 v80, -2, v80
    v_min_u32 v81, -2, v81
    v_min_u32 v82, -2, v82
    v_min_u32 v84, -2, v84
    v_min_u32 v85, -2, v85
    v_min_u32 v86, -2, v86
    v_min_u32 v87, -2, v87
    v_min_u32 v88, -2, v88
    v_min_u32 v89, -2, v89
    v_min_u32 v90, -2, v90
    v_min_u32 v91, -2, v91
    s_mov_b32 s48, 79822848
    buffer_store_dword v76, v13, s[4:7], s48 offen offset:0 sc1
    buffer_store_dword v77, v13, s[4:7], s48 offen offset:1024 sc1
    buffer_store_dword v78, v13, s[4:7], s48 offen offset:2048 sc1
    buffer_store_dword v79, v13, s[4:7], s48 offen offset:3072 sc1
    s_add_u32 s48, s48, 4096
    buffer_store_dword v80, v13, s[4:7], s48 offen offset:0 sc1
    buffer_store_dword v81, v13, s[4:7], s48 offen offset:1024 sc1
    buffer_store_dword v82, v13, s[4:7], s48 offen offset:2048 sc1
    s_mov_b32 s48, 80945152
    buffer_store_dwordx4 v[84:87], v14, s[4:7], s48 offen sc1
    buffer_store_dwordx4 v[88:91], v15, s[4:7], s48 offen sc1
    s_mov_b32 s48, 162004992
    buffer_store_dword v76, v13, s[4:7], s48 offen offset:0 sc1
    buffer_store_dword v77, v13, s[4:7], s48 offen offset:1024 sc1
    buffer_store_dword v78, v13, s[4:7], s48 offen offset:2048 sc1
    buffer_store_dword v79, v13, s[4:7], s48 offen offset:3072 sc1
    s_add_u32 s48, s48, 4096
    buffer_store_dword v80, v13, s[4:7], s48 offen offset:0 sc1
    buffer_store_dword v81, v13, s[4:7], s48 offen offset:1024 sc1
    buffer_store_dword v82, v13, s[4:7], s48 offen offset:2048 sc1
    s_mov_b32 s48, 163127296
    buffer_store_dwordx4 v[84:87], v14, s[4:7], s48 offen sc1
    buffer_store_dwordx4 v[88:91], v15, s[4:7], s48 offen sc1
L_main_kernel_4:
    s_waitcnt vmcnt(0)
    s_barrier
    v_mov_b32 v12, s58
    s_lshl_b32 s46, s59, 2
    v_mov_b32 v13, s46
    buffer_store_dword v12, v13, s[64:67], 0 offen offset:128 sc1
    v_lshlrev_b32 v72, 16, v16
    v_and_b32 v73, 0xffff0000, v16
    v_lshlrev_b32 v74, 16, v17
    v_and_b32 v75, 0xffff0000, v17
    v_lshlrev_b32 v76, 16, v18
    v_and_b32 v77, 0xffff0000, v18
    v_lshlrev_b32 v78, 16, v19
    v_and_b32 v79, 0xffff0000, v19
    v_lshlrev_b32 v80, 16, v20
    v_and_b32 v81, 0xffff0000, v20
    v_lshlrev_b32 v82, 16, v21
    v_and_b32 v83, 0xffff0000, v21
    v_lshlrev_b32 v84, 16, v22
    v_and_b32 v85, 0xffff0000, v22
    v_lshlrev_b32 v86, 16, v23
    v_and_b32 v87, 0xffff0000, v23
    v_lshlrev_b32 v88, 16, v24
    v_and_b32 v89, 0xffff0000, v24
    v_lshlrev_b32 v90, 16, v25
    v_and_b32 v91, 0xffff0000, v25
    v_lshlrev_b32 v92, 16, v26
    v_and_b32 v93, 0xffff0000, v26
    v_lshlrev_b32 v94, 16, v27
    v_and_b32 v95, 0xffff0000, v27
    v_lshlrev_b32 v96, 16, v28
    v_and_b32 v97, 0xffff0000, v28
    v_lshlrev_b32 v98, 16, v29
    v_and_b32 v99, 0xffff0000, v29
    v_lshlrev_b32 v100, 16, v30
    v_and_b32 v101, 0xffff0000, v30
    v_lshlrev_b32 v102, 16, v31
    v_and_b32 v103, 0xffff0000, v31
    v_lshlrev_b32 v104, 16, v32
    v_and_b32 v105, 0xffff0000, v32
    v_lshlrev_b32 v106, 16, v33
    v_and_b32 v107, 0xffff0000, v33
    v_lshlrev_b32 v108, 16, v34
    v_and_b32 v109, 0xffff0000, v34
    v_lshlrev_b32 v110, 16, v35
    v_and_b32 v111, 0xffff0000, v35
    v_lshlrev_b32 v112, 16, v36
    v_and_b32 v113, 0xffff0000, v36
    v_lshlrev_b32 v114, 16, v37
    v_and_b32 v115, 0xffff0000, v37
    v_lshlrev_b32 v116, 16, v38
    v_and_b32 v117, 0xffff0000, v38
    v_lshlrev_b32 v118, 16, v39
    v_and_b32 v119, 0xffff0000, v39
    v_lshlrev_b32 v120, 16, v40
    v_and_b32 v121, 0xffff0000, v40
    v_lshlrev_b32 v122, 16, v41
    v_and_b32 v123, 0xffff0000, v41
    v_lshlrev_b32 v124, 16, v42
    v_and_b32 v125, 0xffff0000, v42
    v_lshlrev_b32 v126, 16, v43
    v_and_b32 v127, 0xffff0000, v43
    v_lshlrev_b32 v128, 16, v44
    v_and_b32 v129, 0xffff0000, v44
    v_lshlrev_b32 v130, 16, v45
    v_and_b32 v131, 0xffff0000, v45
    v_lshlrev_b32 v132, 16, v46
    v_and_b32 v133, 0xffff0000, v46
    v_lshlrev_b32 v134, 16, v47
    v_and_b32 v135, 0xffff0000, v47
    v_lshlrev_b32 v136, 16, v48
    v_and_b32 v137, 0xffff0000, v48
    v_lshlrev_b32 v138, 16, v49
    v_and_b32 v139, 0xffff0000, v49
    v_lshlrev_b32 v140, 16, v50
    v_and_b32 v141, 0xffff0000, v50
    v_lshlrev_b32 v142, 16, v51
    v_and_b32 v143, 0xffff0000, v51
    v_lshlrev_b32 v144, 16, v52
    v_and_b32 v145, 0xffff0000, v52
    v_lshlrev_b32 v146, 16, v53
    v_and_b32 v147, 0xffff0000, v53
    v_lshlrev_b32 v148, 16, v54
    v_and_b32 v149, 0xffff0000, v54
    v_lshlrev_b32 v150, 16, v55
    v_and_b32 v151, 0xffff0000, v55
    v_lshlrev_b32 v152, 16, v56
    v_and_b32 v153, 0xffff0000, v56
    v_lshlrev_b32 v154, 16, v57
    v_and_b32 v155, 0xffff0000, v57
    v_lshlrev_b32 v156, 16, v58
    v_and_b32 v157, 0xffff0000, v58
    v_lshlrev_b32 v158, 16, v59
    v_and_b32 v159, 0xffff0000, v59
    v_lshlrev_b32 v160, 16, v60
    v_and_b32 v161, 0xffff0000, v60
    v_lshlrev_b32 v162, 16, v61
    v_and_b32 v163, 0xffff0000, v61
    v_lshlrev_b32 v164, 16, v62
    v_and_b32 v165, 0xffff0000, v62
    v_lshlrev_b32 v166, 16, v63
    v_and_b32 v167, 0xffff0000, v63
    v_lshlrev_b32 v168, 16, v64
    v_and_b32 v169, 0xffff0000, v64
    v_lshlrev_b32 v170, 16, v65
    v_and_b32 v171, 0xffff0000, v65
    v_lshlrev_b32 v172, 16, v66
    v_and_b32 v173, 0xffff0000, v66
    v_lshlrev_b32 v174, 16, v67
    v_and_b32 v175, 0xffff0000, v67
    v_lshlrev_b32 v176, 16, v68
    v_and_b32 v177, 0xffff0000, v68
    v_lshlrev_b32 v178, 16, v69
    v_and_b32 v179, 0xffff0000, v69
    v_lshlrev_b32 v180, 16, v70
    v_and_b32 v181, 0xffff0000, v70
    v_lshlrev_b32 v182, 16, v71
    v_and_b32 v183, 0xffff0000, v71
    v_add_f32 v9, v72, v73
    v_add_f32 v10, v74, v75
    v_add_f32 v9, v9, v76
    v_add_f32 v10, v10, v77
    v_add_f32 v9, v9, v78
    v_add_f32 v10, v10, v79
    v_add_f32 v9, v9, v80
    v_add_f32 v10, v10, v81
    v_add_f32 v9, v9, v82
    v_add_f32 v10, v10, v83
    v_add_f32 v9, v9, v84
    v_add_f32 v10, v10, v85
    v_add_f32 v9, v9, v86
    v_add_f32 v10, v10, v87
    v_add_f32 v9, v9, v88
    v_add_f32 v10, v10, v89
    v_add_f32 v9, v9, v90
    v_add_f32 v10, v10, v91
    v_add_f32 v9, v9, v92
    v_add_f32 v10, v10, v93
    v_add_f32 v9, v9, v94
    v_add_f32 v10, v10, v95
    v_add_f32 v9, v9, v96
    v_add_f32 v10, v10, v97
    v_add_f32 v9, v9, v98
    v_add_f32 v10, v10, v99
    v_add_f32 v9, v9, v100
    v_add_f32 v10, v10, v101
    v_add_f32 v9, v9, v102
    v_add_f32 v10, v10, v103
    v_add_f32 v9, v9, v104
    v_add_f32 v10, v10, v105
    v_add_f32 v9, v9, v106
    v_add_f32 v10, v10, v107
    v_add_f32 v9, v9, v108
    v_add_f32 v10, v10, v109
    v_add_f32 v9, v9, v110
    v_add_f32 v10, v10, v111
    v_add_f32 v9, v9, v112
    v_add_f32 v10, v10, v113
    v_add_f32 v9, v9, v114
    v_add_f32 v10, v10, v115
    v_add_f32 v9, v9, v116
    v_add_f32 v10, v10, v117
    v_add_f32 v9, v9, v118
    v_add_f32 v10, v10, v119
    v_add_f32 v9, v9, v120
    v_add_f32 v10, v10, v121
    v_add_f32 v9, v9, v122
    v_add_f32 v10, v10, v123
    v_add_f32 v9, v9, v124
    v_add_f32 v10, v10, v125
    v_add_f32 v9, v9, v126
    v_add_f32 v10, v10, v127
    v_add_f32 v9, v9, v128
    v_add_f32 v10, v10, v129
    v_add_f32 v9, v9, v130
    v_add_f32 v10, v10, v131
    v_add_f32 v9, v9, v132
    v_add_f32 v10, v10, v133
    v_add_f32 v9, v9, v134
    v_add_f32 v10, v10, v135
    v_add_f32 v9, v9, v136
    v_add_f32 v10, v10, v137
    v_add_f32 v9, v9, v138
    v_add_f32 v10, v10, v139
    v_add_f32 v9, v9, v140
    v_add_f32 v10, v10, v141
    v_add_f32 v9, v9, v142
    v_add_f32 v10, v10, v143
    v_add_f32 v9, v9, v144
    v_add_f32 v10, v10, v145
    v_add_f32 v9, v9, v146
    v_add_f32 v10, v10, v147
    v_add_f32 v9, v9, v148
    v_add_f32 v10, v10, v149
    v_add_f32 v9, v9, v150
    v_add_f32 v10, v10, v151
    v_add_f32 v9, v9, v152
    v_add_f32 v10, v10, v153
    v_add_f32 v9, v9, v154
    v_add_f32 v10, v10, v155
    v_add_f32 v9, v9, v156
    v_add_f32 v10, v10, v157
    v_add_f32 v9, v9, v158
    v_add_f32 v10, v10, v159
    v_add_f32 v9, v9, v160
    v_add_f32 v10, v10, v161
    v_add_f32 v9, v9, v162
    v_add_f32 v10, v10, v163
    v_add_f32 v9, v9, v164
    v_add_f32 v10, v10, v165
    v_add_f32 v9, v9, v166
    v_add_f32 v10, v10, v167
    v_add_f32 v9, v9, v168
    v_add_f32 v10, v10, v169
    v_add_f32 v9, v9, v170
    v_add_f32 v10, v10, v171
    v_add_f32 v9, v9, v172
    v_add_f32 v10, v10, v173
    v_add_f32 v9, v9, v174
    v_add_f32 v10, v10, v175
    v_add_f32 v9, v9, v176
    v_add_f32 v10, v10, v177
    v_add_f32 v9, v9, v178
    v_add_f32 v10, v10, v179
    v_add_f32 v9, v9, v180
    v_add_f32 v10, v10, v181
    v_add_f32 v9, v9, v182
    v_add_f32 v10, v10, v183
    v_add_f32 v9, v9, v10
    v_mov_b32 v10, v9
    s_nop 1
    v_permlane16_swap_b32 v9, v10
    s_nop 0
    v_add_f32 v9, v9, v10
    v_mov_b32 v10, v9
    s_nop 1
    v_permlane32_swap_b32 v9, v10
    s_nop 0
    v_add_f32 v9, v9, v10
    v_mul_f32 v9, 0x3b124925, v9
    v_sub_f32 v72, v72, v9
    v_sub_f32 v73, v73, v9
    v_sub_f32 v74, v74, v9
    v_sub_f32 v75, v75, v9
    v_sub_f32 v76, v76, v9
    v_sub_f32 v77, v77, v9
    v_sub_f32 v78, v78, v9
    v_sub_f32 v79, v79, v9
    v_sub_f32 v80, v80, v9
    v_sub_f32 v81, v81, v9
    v_sub_f32 v82, v82, v9
    v_sub_f32 v83, v83, v9
    v_sub_f32 v84, v84, v9
    v_sub_f32 v85, v85, v9
    v_sub_f32 v86, v86, v9
    v_sub_f32 v87, v87, v9
    v_sub_f32 v88, v88, v9
    v_sub_f32 v89, v89, v9
    v_sub_f32 v90, v90, v9
    v_sub_f32 v91, v91, v9
    v_sub_f32 v92, v92, v9
    v_sub_f32 v93, v93, v9
    v_sub_f32 v94, v94, v9
    v_sub_f32 v95, v95, v9
    v_sub_f32 v96, v96, v9
    v_sub_f32 v97, v97, v9
    v_sub_f32 v98, v98, v9
    v_sub_f32 v99, v99, v9
    v_sub_f32 v100, v100, v9
    v_sub_f32 v101, v101, v9
    v_sub_f32 v102, v102, v9
    v_sub_f32 v103, v103, v9
    v_sub_f32 v104, v104, v9
    v_sub_f32 v105, v105, v9
    v_sub_f32 v106, v106, v9
    v_sub_f32 v107, v107, v9
    v_sub_f32 v108, v108, v9
    v_sub_f32 v109, v109, v9
    v_sub_f32 v110, v110, v9
    v_sub_f32 v111, v111, v9
    v_sub_f32 v112, v112, v9
    v_sub_f32 v113, v113, v9
    v_sub_f32 v114, v114, v9
    v_sub_f32 v115, v115, v9
    v_sub_f32 v116, v116, v9
    v_sub_f32 v117, v117, v9
    v_sub_f32 v118, v118, v9
    v_sub_f32 v119, v119, v9
    v_sub_f32 v120, v120, v9
    v_sub_f32 v121, v121, v9
    v_sub_f32 v122, v122, v9
    v_sub_f32 v123, v123, v9
    v_sub_f32 v124, v124, v9
    v_sub_f32 v125, v125, v9
    v_sub_f32 v126, v126, v9
    v_sub_f32 v127, v127, v9
    v_sub_f32 v128, v128, v9
    v_sub_f32 v129, v129, v9
    v_sub_f32 v130, v130, v9
    v_sub_f32 v131, v131, v9
    v_sub_f32 v132, v132, v9
    v_sub_f32 v133, v133, v9
    v_sub_f32 v134, v134, v9
    v_sub_f32 v135, v135, v9
    v_sub_f32 v136, v136, v9
    v_sub_f32 v137, v137, v9
    v_sub_f32 v138, v138, v9
    v_sub_f32 v139, v139, v9
    v_sub_f32 v140, v140, v9
    v_sub_f32 v141, v141, v9
    v_sub_f32 v142, v142, v9
    v_sub_f32 v143, v143, v9
    v_sub_f32 v144, v144, v9
    v_sub_f32 v145, v145, v9
    v_sub_f32 v146, v146, v9
    v_sub_f32 v147, v147, v9
    v_sub_f32 v148, v148, v9
    v_sub_f32 v149, v149, v9
    v_sub_f32 v150, v150, v9
    v_sub_f32 v151, v151, v9
    v_sub_f32 v152, v152, v9
    v_sub_f32 v153, v153, v9
    v_sub_f32 v154, v154, v9
    v_sub_f32 v155, v155, v9
    v_sub_f32 v156, v156, v9
    v_sub_f32 v157, v157, v9
    v_sub_f32 v158, v158, v9
    v_sub_f32 v159, v159, v9
    v_sub_f32 v160, v160, v9
    v_sub_f32 v161, v161, v9
    v_sub_f32 v162, v162, v9
    v_sub_f32 v163, v163, v9
    v_sub_f32 v164, v164, v9
    v_sub_f32 v165, v165, v9
    v_sub_f32 v166, v166, v9
    v_sub_f32 v167, v167, v9
    v_sub_f32 v168, v168, v9
    v_sub_f32 v169, v169, v9
    v_sub_f32 v170, v170, v9
    v_sub_f32 v171, v171, v9
    v_sub_f32 v172, v172, v9
    v_sub_f32 v173, v173, v9
    v_sub_f32 v174, v174, v9
    v_sub_f32 v175, v175, v9
    v_sub_f32 v176, v176, v9
    v_sub_f32 v177, v177, v9
    v_sub_f32 v178, v178, v9
    v_sub_f32 v179, v179, v9
    v_sub_f32 v180, v180, v9
    v_sub_f32 v181, v181, v9
    v_sub_f32 v182, v182, v9
    v_sub_f32 v183, v183, v9
    v_mul_f32 v10, v72, v72
    v_mul_f32 v11, v73, v73
    v_fmac_f32 v10, v74, v74
    v_fmac_f32 v11, v75, v75
    v_fmac_f32 v10, v76, v76
    v_fmac_f32 v11, v77, v77
    v_fmac_f32 v10, v78, v78
    v_fmac_f32 v11, v79, v79
    v_fmac_f32 v10, v80, v80
    v_fmac_f32 v11, v81, v81
    v_fmac_f32 v10, v82, v82
    v_fmac_f32 v11, v83, v83
    v_fmac_f32 v10, v84, v84
    v_fmac_f32 v11, v85, v85
    v_fmac_f32 v10, v86, v86
    v_fmac_f32 v11, v87, v87
    v_fmac_f32 v10, v88, v88
    v_fmac_f32 v11, v89, v89
    v_fmac_f32 v10, v90, v90
    v_fmac_f32 v11, v91, v91
    v_fmac_f32 v10, v92, v92
    v_fmac_f32 v11, v93, v93
    v_fmac_f32 v10, v94, v94
    v_fmac_f32 v11, v95, v95
    v_fmac_f32 v10, v96, v96
    v_fmac_f32 v11, v97, v97
    v_fmac_f32 v10, v98, v98
    v_fmac_f32 v11, v99, v99
    v_fmac_f32 v10, v100, v100
    v_fmac_f32 v11, v101, v101
    v_fmac_f32 v10, v102, v102
    v_fmac_f32 v11, v103, v103
    v_fmac_f32 v10, v104, v104
    v_fmac_f32 v11, v105, v105
    v_fmac_f32 v10, v106, v106
    v_fmac_f32 v11, v107, v107
    v_fmac_f32 v10, v108, v108
    v_fmac_f32 v11, v109, v109
    v_fmac_f32 v10, v110, v110
    v_fmac_f32 v11, v111, v111
    v_fmac_f32 v10, v112, v112
    v_fmac_f32 v11, v113, v113
    v_fmac_f32 v10, v114, v114
    v_fmac_f32 v11, v115, v115
    v_fmac_f32 v10, v116, v116
    v_fmac_f32 v11, v117, v117
    v_fmac_f32 v10, v118, v118
    v_fmac_f32 v11, v119, v119
    v_fmac_f32 v10, v120, v120
    v_fmac_f32 v11, v121, v121
    v_fmac_f32 v10, v122, v122
    v_fmac_f32 v11, v123, v123
    v_fmac_f32 v10, v124, v124
    v_fmac_f32 v11, v125, v125
    v_fmac_f32 v10, v126, v126
    v_fmac_f32 v11, v127, v127
    v_fmac_f32 v10, v128, v128
    v_fmac_f32 v11, v129, v129
    v_fmac_f32 v10, v130, v130
    v_fmac_f32 v11, v131, v131
    v_fmac_f32 v10, v132, v132
    v_fmac_f32 v11, v133, v133
    v_fmac_f32 v10, v134, v134
    v_fmac_f32 v11, v135, v135
    v_fmac_f32 v10, v136, v136
    v_fmac_f32 v11, v137, v137
    v_fmac_f32 v10, v138, v138
    v_fmac_f32 v11, v139, v139
    v_fmac_f32 v10, v140, v140
    v_fmac_f32 v11, v141, v141
    v_fmac_f32 v10, v142, v142
    v_fmac_f32 v11, v143, v143
    v_fmac_f32 v10, v144, v144
    v_fmac_f32 v11, v145, v145
    v_fmac_f32 v10, v146, v146
    v_fmac_f32 v11, v147, v147
    v_fmac_f32 v10, v148, v148
    v_fmac_f32 v11, v149, v149
    v_fmac_f32 v10, v150, v150
    v_fmac_f32 v11, v151, v151
    v_fmac_f32 v10, v152, v152
    v_fmac_f32 v11, v153, v153
    v_fmac_f32 v10, v154, v154
    v_fmac_f32 v11, v155, v155
    v_fmac_f32 v10, v156, v156
    v_fmac_f32 v11, v157, v157
    v_fmac_f32 v10, v158, v158
    v_fmac_f32 v11, v159, v159
    v_fmac_f32 v10, v160, v160
    v_fmac_f32 v11, v161, v161
    v_fmac_f32 v10, v162, v162
    v_fmac_f32 v11, v163, v163
    v_fmac_f32 v10, v164, v164
    v_fmac_f32 v11, v165, v165
    v_fmac_f32 v10, v166, v166
    v_fmac_f32 v11, v167, v167
    v_fmac_f32 v10, v168, v168
    v_fmac_f32 v11, v169, v169
    v_fmac_f32 v10, v170, v170
    v_fmac_f32 v11, v171, v171
    v_fmac_f32 v10, v172, v172
    v_fmac_f32 v11, v173, v173
    v_fmac_f32 v10, v174, v174
    v_fmac_f32 v11, v175, v175
    v_fmac_f32 v10, v176, v176
    v_fmac_f32 v11, v177, v177
    v_fmac_f32 v10, v178, v178
    v_fmac_f32 v11, v179, v179
    v_fmac_f32 v10, v180, v180
    v_fmac_f32 v11, v181, v181
    v_fmac_f32 v10, v182, v182
    v_fmac_f32 v11, v183, v183
    v_add_f32 v10, v10, v11
    v_mov_b32 v11, v10
    s_nop 1
    v_permlane16_swap_b32 v10, v11
    s_nop 0
    v_add_f32 v10, v10, v11
    v_mov_b32 v11, v10
    s_nop 1
    v_permlane32_swap_b32 v10, v11
    s_nop 0
    v_add_f32 v10, v10, v11
    v_mov_b32 v11, 0x3727c5ac
    v_fmac_f32 v11, 0x3b124925, v10
    v_rsq_f32 v11, v11
    s_nop 0
    v_mul_f32 v72, v72, v11
    v_mul_f32 v73, v73, v11
    v_mul_f32 v74, v74, v11
    v_mul_f32 v75, v75, v11
    v_mul_f32 v76, v76, v11
    v_mul_f32 v77, v77, v11
    v_mul_f32 v78, v78, v11
    v_mul_f32 v79, v79, v11
    v_mul_f32 v80, v80, v11
    v_mul_f32 v81, v81, v11
    v_mul_f32 v82, v82, v11
    v_mul_f32 v83, v83, v11
    v_mul_f32 v84, v84, v11
    v_mul_f32 v85, v85, v11
    v_mul_f32 v86, v86, v11
    v_mul_f32 v87, v87, v11
    v_mul_f32 v88, v88, v11
    v_mul_f32 v89, v89, v11
    v_mul_f32 v90, v90, v11
    v_mul_f32 v91, v91, v11
    v_mul_f32 v92, v92, v11
    v_mul_f32 v93, v93, v11
    v_mul_f32 v94, v94, v11
    v_mul_f32 v95, v95, v11
    v_mul_f32 v96, v96, v11
    v_mul_f32 v97, v97, v11
    v_mul_f32 v98, v98, v11
    v_mul_f32 v99, v99, v11
    v_mul_f32 v100, v100, v11
    v_mul_f32 v101, v101, v11
    v_mul_f32 v102, v102, v11
    v_mul_f32 v103, v103, v11
    v_mul_f32 v104, v104, v11
    v_mul_f32 v105, v105, v11
    v_mul_f32 v106, v106, v11
    v_mul_f32 v107, v107, v11
    v_mul_f32 v108, v108, v11
    v_mul_f32 v109, v109, v11
    v_mul_f32 v110, v110, v11
    v_mul_f32 v111, v111, v11
    v_mul_f32 v112, v112, v11
    v_mul_f32 v113, v113, v11
    v_mul_f32 v114, v114, v11
    v_mul_f32 v115, v115, v11
    v_mul_f32 v116, v116, v11
    v_mul_f32 v117, v117, v11
    v_mul_f32 v118, v118, v11
    v_mul_f32 v119, v119, v11
    v_mul_f32 v120, v120, v11
    v_mul_f32 v121, v121, v11
    v_mul_f32 v122, v122, v11
    v_mul_f32 v123, v123, v11
    v_mul_f32 v124, v124, v11
    v_mul_f32 v125, v125, v11
    v_mul_f32 v126, v126, v11
    v_mul_f32 v127, v127, v11
    v_mul_f32 v128, v128, v11
    v_mul_f32 v129, v129, v11
    v_mul_f32 v130, v130, v11
    v_mul_f32 v131, v131, v11
    v_mul_f32 v132, v132, v11
    v_mul_f32 v133, v133, v11
    v_mul_f32 v134, v134, v11
    v_mul_f32 v135, v135, v11
    v_mul_f32 v136, v136, v11
    v_mul_f32 v137, v137, v11
    v_mul_f32 v138, v138, v11
    v_mul_f32 v139, v139, v11
    v_mul_f32 v140, v140, v11
    v_mul_f32 v141, v141, v11
    v_mul_f32 v142, v142, v11
    v_mul_f32 v143, v143, v11
    v_mul_f32 v144, v144, v11
    v_mul_f32 v145, v145, v11
    v_mul_f32 v146, v146, v11
    v_mul_f32 v147, v147, v11
    v_mul_f32 v148, v148, v11
    v_mul_f32 v149, v149, v11
    v_mul_f32 v150, v150, v11
    v_mul_f32 v151, v151, v11
    v_mul_f32 v152, v152, v11
    v_mul_f32 v153, v153, v11
    v_mul_f32 v154, v154, v11
    v_mul_f32 v155, v155, v11
    v_mul_f32 v156, v156, v11
    v_mul_f32 v157, v157, v11
    v_mul_f32 v158, v158, v11
    v_mul_f32 v159, v159, v11
    v_mul_f32 v160, v160, v11
    v_mul_f32 v161, v161, v11
    v_mul_f32 v162, v162, v11
    v_mul_f32 v163, v163, v11
    v_mul_f32 v164, v164, v11
    v_mul_f32 v165, v165, v11
    v_mul_f32 v166, v166, v11
    v_mul_f32 v167, v167, v11
    v_mul_f32 v168, v168, v11
    v_mul_f32 v169, v169, v11
    v_mul_f32 v170, v170, v11
    v_mul_f32 v171, v171, v11
    v_mul_f32 v172, v172, v11
    v_mul_f32 v173, v173, v11
    v_mul_f32 v174, v174, v11
    v_mul_f32 v175, v175, v11
    v_mul_f32 v176, v176, v11
    v_mul_f32 v177, v177, v11
    v_mul_f32 v178, v178, v11
    v_mul_f32 v179, v179, v11
    v_mul_f32 v180, v180, v11
    v_mul_f32 v181, v181, v11
    v_mul_f32 v182, v182, v11
    v_mul_f32 v183, v183, v11
    v_cvt_pk_bf16_f32 v16, v72, v73
    v_cvt_pk_bf16_f32 v17, v74, v75
    v_cvt_pk_bf16_f32 v18, v76, v77
    v_cvt_pk_bf16_f32 v19, v78, v79
    v_cvt_pk_bf16_f32 v20, v80, v81
    v_cvt_pk_bf16_f32 v21, v82, v83
    v_cvt_pk_bf16_f32 v22, v84, v85
    v_cvt_pk_bf16_f32 v23, v86, v87
    v_cvt_pk_bf16_f32 v24, v88, v89
    v_cvt_pk_bf16_f32 v25, v90, v91
    v_cvt_pk_bf16_f32 v26, v92, v93
    v_cvt_pk_bf16_f32 v27, v94, v95
    v_cvt_pk_bf16_f32 v28, v96, v97
    v_cvt_pk_bf16_f32 v29, v98, v99
    v_cvt_pk_bf16_f32 v30, v100, v101
    v_cvt_pk_bf16_f32 v31, v102, v103
    v_cvt_pk_bf16_f32 v32, v104, v105
    v_cvt_pk_bf16_f32 v33, v106, v107
    v_cvt_pk_bf16_f32 v34, v108, v109
    v_cvt_pk_bf16_f32 v35, v110, v111
    v_cvt_pk_bf16_f32 v36, v112, v113
    v_cvt_pk_bf16_f32 v37, v114, v115
    v_cvt_pk_bf16_f32 v38, v116, v117
    v_cvt_pk_bf16_f32 v39, v118, v119
    v_cvt_pk_bf16_f32 v40, v120, v121
    v_cvt_pk_bf16_f32 v41, v122, v123
    v_cvt_pk_bf16_f32 v42, v124, v125
    v_cvt_pk_bf16_f32 v43, v126, v127
    v_cvt_pk_bf16_f32 v44, v128, v129
    v_cvt_pk_bf16_f32 v45, v130, v131
    v_cvt_pk_bf16_f32 v46, v132, v133
    v_cvt_pk_bf16_f32 v47, v134, v135
    v_cvt_pk_bf16_f32 v48, v136, v137
    v_cvt_pk_bf16_f32 v49, v138, v139
    v_cvt_pk_bf16_f32 v50, v140, v141
    v_cvt_pk_bf16_f32 v51, v142, v143
    v_cvt_pk_bf16_f32 v52, v144, v145
    v_cvt_pk_bf16_f32 v53, v146, v147
    v_cvt_pk_bf16_f32 v54, v148, v149
    v_cvt_pk_bf16_f32 v55, v150, v151
    v_cvt_pk_bf16_f32 v56, v152, v153
    v_cvt_pk_bf16_f32 v57, v154, v155
    v_cvt_pk_bf16_f32 v58, v156, v157
    v_cvt_pk_bf16_f32 v59, v158, v159
    v_cvt_pk_bf16_f32 v60, v160, v161
    v_cvt_pk_bf16_f32 v61, v162, v163
    v_cvt_pk_bf16_f32 v62, v164, v165
    v_cvt_pk_bf16_f32 v63, v166, v167
    v_cvt_pk_bf16_f32 v64, v168, v169
    v_cvt_pk_bf16_f32 v65, v170, v171
    v_cvt_pk_bf16_f32 v66, v172, v173
    v_cvt_pk_bf16_f32 v67, v174, v175
    v_cvt_pk_bf16_f32 v68, v176, v177
    v_cvt_pk_bf16_f32 v69, v178, v179
    v_cvt_pk_bf16_f32 v70, v180, v181
    v_cvt_pk_bf16_f32 v71, v182, v183
    s_mul_i32 s48, s47, 14336
    s_add_u32 s48, s48, 15597568
    buffer_store_dwordx4 v[16:19], v6, s[4:7], s48 offen offset:0 sc1
    buffer_store_dwordx4 v[20:23], v6, s[4:7], s48 offen offset:1024 sc1
    buffer_store_dwordx4 v[24:27], v6, s[4:7], s48 offen offset:2048 sc1
    buffer_store_dwordx4 v[28:31], v6, s[4:7], s48 offen offset:3072 sc1
    s_add_u32 s48, s48, 4096
    buffer_store_dwordx4 v[32:35], v6, s[4:7], s48 offen offset:0 sc1
    buffer_store_dwordx4 v[36:39], v6, s[4:7], s48 offen offset:1024 sc1
    buffer_store_dwordx4 v[40:43], v6, s[4:7], s48 offen offset:2048 sc1
    buffer_store_dwordx4 v[44:47], v6, s[4:7], s48 offen offset:3072 sc1
    s_add_u32 s48, s48, 4096
    buffer_store_dwordx4 v[48:51], v6, s[4:7], s48 offen offset:0 sc1
    buffer_store_dwordx4 v[52:55], v6, s[4:7], s48 offen offset:1024 sc1
    buffer_store_dwordx4 v[56:59], v6, s[4:7], s48 offen offset:2048 sc1
    buffer_store_dwordx4 v[60:63], v6, s[4:7], s48 offen offset:3072 sc1
    s_add_u32 s48, s48, 4096
    buffer_store_dwordx4 v[64:67], v6, s[4:7], s48 offen offset:0 sc1
    buffer_store_dwordx4 v[68:71], v6, s[4:7], s48 offen offset:1024 sc1
    s_waitcnt vmcnt(0)
    s_mov_b32 s48, s47
    s_mov_b32 s8, s42
    s_and_b32 s9, s43, 0xffff
    s_mov_b32 s10, 0x100
    s_mov_b32 s11, 0x20000
    v_mov_b32 v12, 64
    s_cmp_lg_u32 s3, 0
    s_cbranch_scc1 Lwo_main_kernel_6
    s_mov_b32 s47, 2097152
Lwc_main_kernel_5:
    buffer_load_dword v13, v12, s[8:11], 0 offen sc1
    s_sub_u32 s47, s47, 1
    s_cbranch_scc1 Lexit_team
    s_waitcnt vmcnt(0)
    v_cmp_ne_u32 vcc, 32, v13
    s_cbranch_vccz Lwo_main_kernel_6
    s_sleep 1
    s_branch Lwc_main_kernel_5
Lwo_main_kernel_6:
    s_barrier
    s_lshr_b32 s46, s48, 1
    s_lshl_b32 s46, s46, 7
    s_add_u32 s46, s46, 97722368
    v_mov_b32 v12, 0
    v_mov_b32 v13, 16
    s_mov_b64 exec, 1
    buffer_atomic_add v13, v12, s[4:7], s46 offen sc1
    s_mov_b64 exec, -1
    s_cmp_ge_u32 s59, 30
    s_cbranch_scc1 LroleP_main_kernel_2
    s_cmp_ge_u32 s59, 16
    s_cbranch_scc1 LroleB_main_kernel_7
    s_mov_b32 s60, s59
    v_lshlrev_b32 v16, 7, v0
    s_getpc_b64 s[82:83]
Lpc_main_kernel_10:
    s_add_u32 s82, s82, LA0_main_kernel_8-Lpc_main_kernel_10
    s_addc_u32 s83, s83, 0
    global_load_dword v17, v16, s[82:83]
    s_add_u32 s82, s82, 8192
    s_addc_u32 s83, s83, 0
    global_load_dword v17, v16, s[82:83]
    v_lshlrev_b32 v1, 4, v0
    v_and_b32 v2, 8, v0
    v_cmp_eq_u32 vcc, 0, v2
    v_mov_b32 v2, 0xeeee
    v_mov_b32 v3, 0x4444
    v_cndmask_b32 v2, v2, v3, vcc
    s_lshl_b32 s46, s3, 11
    s_mov_b32 m0, s46
    v_add_u32 v3, s46, v1
    s_cmp_eq_u32 s3, 3
    s_cselect_b32 s47, 7, 15
    v_and_b32 v4, s47, v0
    v_lshlrev_b32 v4, 7, v4
    v_add_u32 v4, s46, v4
    s_cmp_eq_u32 s3, 3
    s_cselect_b32 s46, 0, 1024
    v_add_u32 v4, s46, v3
    s_cselect_b64 vcc, -1, 0
    v_cndmask_b32 v4, v4, v1, vcc
    s_lshr_b32 s46, s3, 1
    s_mul_i32 s46, s46, 7
    s_and_b32 s69, s3, 1
    s_lshl_b32 s66, s69, 2
    s_add_u32 s66, s66, s46
    s_add_u32 s68, s46, 3
    v_min_u32 v16, 27, v0
    v_lshrrev_b32 v17, 2, v16
    v_and_b32 v16, 3, v16
    v_lshlrev_b32 v16, 2, v16
    v_lshl_add_u32 v16, v17, 7, v16
    s_mul_i32 s54, s60, 896
    s_add_u32 s54, s54, 97738752
    s_mov_b32 s55, 0
    s_mul_i32 s47, s60, 28
    s_lshl_b32 s48, s66, 1
    s_add_u32 s48, s48, s47
    s_mul_i32 s48, s48, 14336
    s_add_u32 s48, s48, 0
    s_lshl_b32 s49, s68, 1
    s_add_u32 s49, s49, s69
    s_add_u32 s49, s49, s47
    s_mul_i32 s49, s49, 14336
    s_add_u32 s49, s49, 0
    v_lshrrev_b32 v18, 5, v0
    v_mul_u32_u24 v18, 14336, v18
    v_and_b32 v19, 31, v0
    v_lshl_add_u32 v18, v19, 7, v18
    s_cmp_gt_u32 s55, 0
    s_cbranch_scc1 Lsr_main_kernel_11
    s_mov_b32 s70, 2097152
Lsl_main_kernel_12:
    buffer_load_dword v17, v16, s[4:7], s54 offen sc1
    s_sub_u32 s70, s70, 1
    s_cbranch_scc1 Lexit_team
    s_waitcnt vmcnt(0)
    v_cmp_gt_u32 vcc, 4, v17
    s_nop 0
    s_cmp_eq_u64 vcc, 0
    s_cselect_b32 s55, 4, s55
    v_cmp_ge_u32 vcc, 0, v17
    s_cbranch_vccz Lsr_main_kernel_11
    s_sleep 2
    s_branch Lsl_main_kernel_12
Lsr_main_kernel_11:
    s_add_u32 s50, s48, 0
    buffer_load_dwordx4 a[0:3], v1, s[4:7], s50 offen offset:0 sc1
    buffer_load_dwordx4 a[4:7], v1, s[4:7], s50 offen offset:1024 sc1
    buffer_load_dwordx4 a[8:11], v1, s[4:7], s50 offen offset:2048 sc1
    buffer_load_dwordx4 a[12:15], v1, s[4:7], s50 offen offset:3072 sc1
    s_add_u32 s50, s48, 14336
    buffer_load_dwordx4 a[56:59], v1, s[4:7], s50 offen offset:0 sc1
    buffer_load_dwordx4 a[60:63], v1, s[4:7], s50 offen offset:1024 sc1
    buffer_load_dwordx4 a[64:67], v1, s[4:7], s50 offen offset:2048 sc1
    buffer_load_dwordx4 a[68:71], v1, s[4:7], s50 offen offset:3072 sc1
    s_add_u32 s50, s48, 28672
    buffer_load_dwordx4 a[112:115], v1, s[4:7], s50 offen offset:0 sc1
    buffer_load_dwordx4 a[116:119], v1, s[4:7], s50 offen offset:1024 sc1
    buffer_load_dwordx4 a[120:123], v1, s[4:7], s50 offen offset:2048 sc1
    buffer_load_dwordx4 a[124:127], v1, s[4:7], s50 offen offset:3072 sc1
    s_add_u32 s50, s48, 43008
    buffer_load_dwordx4 a[168:171], v1, s[4:7], s50 offen offset:0 sc1
    buffer_load_dwordx4 a[172:175], v1, s[4:7], s50 offen offset:1024 sc1
    buffer_load_dwordx4 a[176:179], v1, s[4:7], s50 offen offset:2048 sc1
    buffer_load_dwordx4 a[180:183], v1, s[4:7], s50 offen offset:3072 sc1
    s_add_u32 s50, s48, 57344
    buffer_load_dwordx4 a[224:227], v1, s[4:7], s50 offen offset:0 sc1
    buffer_load_dwordx4 a[228:231], v1, s[4:7], s50 offen offset:1024 sc1
    buffer_load_dwordx4 a[232:235], v1, s[4:7], s50 offen offset:2048 sc1
    buffer_load_dwordx4 a[236:239], v1, s[4:7], s50 offen offset:3072 sc1
    s_add_u32 s50, s48, 71680
    buffer_load_dwordx4 v[144:147], v1, s[4:7], s50 offen offset:0 sc1
    buffer_load_dwordx4 v[148:151], v1, s[4:7], s50 offen offset:1024 sc1
    buffer_load_dwordx4 v[152:155], v1, s[4:7], s50 offen offset:2048 sc1
    buffer_load_dwordx4 v[156:159], v1, s[4:7], s50 offen offset:3072 sc1
    s_add_u32 s50, s49, 0
    buffer_load_dwordx4 v[200:203], v1, s[4:7], s50 offen offset:0 sc1
    buffer_load_dwordx4 v[204:207], v1, s[4:7], s50 offen offset:1024 sc1
    buffer_load_dwordx4 v[208:211], v1, s[4:7], s50 offen offset:2048 sc1
    buffer_load_dwordx4 v[212:215], v1, s[4:7], s50 offen offset:3072 sc1
    s_cmp_gt_u32 s55, 1
    s_cbranch_scc1 Lsr_main_kernel_13
    s_mov_b32 s70, 2097152
Lsl_main_kernel_14:
    buffer_load_dword v17, v16, s[4:7], s54 offen sc1
    s_sub_u32 s70, s70, 1
    s_cbranch_scc1 Lexit_team
    s_waitcnt vmcnt(0)
    v_cmp_gt_u32 vcc, 4, v17
    s_nop 0
    s_cmp_eq_u64 vcc, 0
    s_cselect_b32 s55, 4, s55
    v_cmp_ge_u32 vcc, 1, v17
    s_cbranch_vccz Lsr_main_kernel_13
    s_sleep 2
    s_branch Lsl_main_kernel_14
Lsr_main_kernel_13:
    s_add_u32 s50, s48, 4096
    buffer_load_dwordx4 a[16:19], v1, s[4:7], s50 offen offset:0 sc1
    buffer_load_dwordx4 a[20:23], v1, s[4:7], s50 offen offset:1024 sc1
    buffer_load_dwordx4 a[24:27], v1, s[4:7], s50 offen offset:2048 sc1
    buffer_load_dwordx4 a[28:31], v1, s[4:7], s50 offen offset:3072 sc1
    s_add_u32 s50, s48, 18432
    buffer_load_dwordx4 a[72:75], v1, s[4:7], s50 offen offset:0 sc1
    buffer_load_dwordx4 a[76:79], v1, s[4:7], s50 offen offset:1024 sc1
    buffer_load_dwordx4 a[80:83], v1, s[4:7], s50 offen offset:2048 sc1
    buffer_load_dwordx4 a[84:87], v1, s[4:7], s50 offen offset:3072 sc1
    s_add_u32 s50, s48, 32768
    buffer_load_dwordx4 a[128:131], v1, s[4:7], s50 offen offset:0 sc1
    buffer_load_dwordx4 a[132:135], v1, s[4:7], s50 offen offset:1024 sc1
    buffer_load_dwordx4 a[136:139], v1, s[4:7], s50 offen offset:2048 sc1
    buffer_load_dwordx4 a[140:143], v1, s[4:7], s50 offen offset:3072 sc1
    s_add_u32 s50, s48, 47104
    buffer_load_dwordx4 a[184:187], v1, s[4:7], s50 offen offset:0 sc1
    buffer_load_dwordx4 a[188:191], v1, s[4:7], s50 offen offset:1024 sc1
    buffer_load_dwordx4 a[192:195], v1, s[4:7], s50 offen offset:2048 sc1
    buffer_load_dwordx4 a[196:199], v1, s[4:7], s50 offen offset:3072 sc1
    s_add_u32 s50, s48, 61440
    buffer_load_dwordx4 a[240:243], v1, s[4:7], s50 offen offset:0 sc1
    buffer_load_dwordx4 a[244:247], v1, s[4:7], s50 offen offset:1024 sc1
    buffer_load_dwordx4 a[248:251], v1, s[4:7], s50 offen offset:2048 sc1
    buffer_load_dwordx4 a[252:255], v1, s[4:7], s50 offen offset:3072 sc1
    s_add_u32 s50, s48, 75776
    buffer_load_dwordx4 v[160:163], v1, s[4:7], s50 offen offset:0 sc1
    buffer_load_dwordx4 v[164:167], v1, s[4:7], s50 offen offset:1024 sc1
    buffer_load_dwordx4 v[168:171], v1, s[4:7], s50 offen offset:2048 sc1
    buffer_load_dwordx4 v[172:175], v1, s[4:7], s50 offen offset:3072 sc1
    s_add_u32 s50, s49, 4096
    buffer_load_dwordx4 v[216:219], v1, s[4:7], s50 offen offset:0 sc1
    buffer_load_dwordx4 v[220:223], v1, s[4:7], s50 offen offset:1024 sc1
    buffer_load_dwordx4 v[224:227], v1, s[4:7], s50 offen offset:2048 sc1
    buffer_load_dwordx4 v[228:231], v1, s[4:7], s50 offen offset:3072 sc1
    s_cmp_gt_u32 s55, 2
    s_cbranch_scc1 Lsr_main_kernel_15
    s_mov_b32 s70, 2097152
Lsl_main_kernel_16:
    buffer_load_dword v17, v16, s[4:7], s54 offen sc1
    s_sub_u32 s70, s70, 1
    s_cbranch_scc1 Lexit_team
    s_waitcnt vmcnt(0)
    v_cmp_gt_u32 vcc, 4, v17
    s_nop 0
    s_cmp_eq_u64 vcc, 0
    s_cselect_b32 s55, 4, s55
    v_cmp_ge_u32 vcc, 2, v17
    s_cbranch_vccz Lsr_main_kernel_15
    s_sleep 2
    s_branch Lsl_main_kernel_16
Lsr_main_kernel_15:
    s_add_u32 s50, s48, 8192
    buffer_load_dwordx4 a[32:35], v1, s[4:7], s50 offen offset:0 sc1
    buffer_load_dwordx4 a[36:39], v1, s[4:7], s50 offen offset:1024 sc1
    buffer_load_dwordx4 a[40:43], v1, s[4:7], s50 offen offset:2048 sc1
    buffer_load_dwordx4 a[44:47], v1, s[4:7], s50 offen offset:3072 sc1
    s_add_u32 s50, s48, 22528
    buffer_load_dwordx4 a[88:91], v1, s[4:7], s50 offen offset:0 sc1
    buffer_load_dwordx4 a[92:95], v1, s[4:7], s50 offen offset:1024 sc1
    buffer_load_dwordx4 a[96:99], v1, s[4:7], s50 offen offset:2048 sc1
    buffer_load_dwordx4 a[100:103], v1, s[4:7], s50 offen offset:3072 sc1
    s_add_u32 s50, s48, 36864
    buffer_load_dwordx4 a[144:147], v1, s[4:7], s50 offen offset:0 sc1
    buffer_load_dwordx4 a[148:151], v1, s[4:7], s50 offen offset:1024 sc1
    buffer_load_dwordx4 a[152:155], v1, s[4:7], s50 offen offset:2048 sc1
    buffer_load_dwordx4 a[156:159], v1, s[4:7], s50 offen offset:3072 sc1
    s_add_u32 s50, s48, 51200
    buffer_load_dwordx4 a[200:203], v1, s[4:7], s50 offen offset:0 sc1
    buffer_load_dwordx4 a[204:207], v1, s[4:7], s50 offen offset:1024 sc1
    buffer_load_dwordx4 a[208:211], v1, s[4:7], s50 offen offset:2048 sc1
    buffer_load_dwordx4 a[212:215], v1, s[4:7], s50 offen offset:3072 sc1
    s_add_u32 s50, s48, 65536
    buffer_load_dwordx4 v[120:123], v1, s[4:7], s50 offen offset:0 sc1
    buffer_load_dwordx4 v[124:127], v1, s[4:7], s50 offen offset:1024 sc1
    buffer_load_dwordx4 v[128:131], v1, s[4:7], s50 offen offset:2048 sc1
    buffer_load_dwordx4 v[132:135], v1, s[4:7], s50 offen offset:3072 sc1
    s_add_u32 s50, s48, 79872
    buffer_load_dwordx4 v[176:179], v1, s[4:7], s50 offen offset:0 sc1
    buffer_load_dwordx4 v[180:183], v1, s[4:7], s50 offen offset:1024 sc1
    buffer_load_dwordx4 v[184:187], v1, s[4:7], s50 offen offset:2048 sc1
    buffer_load_dwordx4 v[188:191], v1, s[4:7], s50 offen offset:3072 sc1
    s_add_u32 s50, s49, 8192
    buffer_load_dwordx4 v[232:235], v1, s[4:7], s50 offen offset:0 sc1
    buffer_load_dwordx4 v[236:239], v1, s[4:7], s50 offen offset:1024 sc1
    buffer_load_dwordx4 v[240:243], v1, s[4:7], s50 offen offset:2048 sc1
    buffer_load_dwordx4 v[244:247], v1, s[4:7], s50 offen offset:3072 sc1
    s_cmp_gt_u32 s55, 3
    s_cbranch_scc1 Lsr_main_kernel_17
    s_mov_b32 s70, 2097152
Lsl_main_kernel_18:
    buffer_load_dword v17, v16, s[4:7], s54 offen sc1
    s_sub_u32 s70, s70, 1
    s_cbranch_scc1 Lexit_team
    s_waitcnt vmcnt(0)
    v_cmp_gt_u32 vcc, 4, v17
    s_nop 0
    s_cmp_eq_u64 vcc, 0
    s_cselect_b32 s55, 4, s55
    v_cmp_ge_u32 vcc, 3, v17
    s_cbranch_vccz Lsr_main_kernel_17
    s_sleep 2
    s_branch Lsl_main_kernel_18
Lsr_main_kernel_17:
    s_add_u32 s50, s48, 12288
    buffer_load_dwordx4 a[48:51], v1, s[4:7], s50 offen offset:0 sc1
    buffer_load_dwordx4 a[52:55], v1, s[4:7], s50 offen offset:1024 sc1
    s_add_u32 s50, s48, 26624
    buffer_load_dwordx4 a[104:107], v1, s[4:7], s50 offen offset:0 sc1
    buffer_load_dwordx4 a[108:111], v1, s[4:7], s50 offen offset:1024 sc1
    s_add_u32 s50, s48, 40960
    buffer_load_dwordx4 a[160:163], v1, s[4:7], s50 offen offset:0 sc1
    buffer_load_dwordx4 a[164:167], v1, s[4:7], s50 offen offset:1024 sc1
    s_add_u32 s50, s48, 55296
    buffer_load_dwordx4 a[216:219], v1, s[4:7], s50 offen offset:0 sc1
    buffer_load_dwordx4 a[220:223], v1, s[4:7], s50 offen offset:1024 sc1
    s_add_u32 s50, s48, 69632
    buffer_load_dwordx4 v[136:139], v1, s[4:7], s50 offen offset:0 sc1
    buffer_load_dwordx4 v[140:143], v1, s[4:7], s50 offen offset:1024 sc1
    s_add_u32 s50, s48, 83968
    buffer_load_dwordx4 v[192:195], v1, s[4:7], s50 offen offset:0 sc1
    buffer_load_dwordx4 v[196:199], v1, s[4:7], s50 offen offset:1024 sc1
    s_add_u32 s50, s49, 12288
    buffer_load_dwordx4 v[248:251], v1, s[4:7], s50 offen offset:0 sc1
    buffer_load_dwordx4 v[252:255], v1, s[4:7], s50 offen offset:1024 sc1
    v_and_b32 v16, 15, v0
    v_lshrrev_b32 v17, 4, v0
    v_bfe_u32 v18, v0, 1, 1
    v_lshlrev_b32 v18, 2, v18
    v_bfe_u32 v19, v0, 2, 1
    v_lshl_add_u32 v18, v19, 1, v18
    v_and_b32 v19, 1, v0
    v_add_u32 v18, v18, v19
    v_lshlrev_b32 v18, 4, v18
    v_lshrrev_b32 v19, 1, v17
    v_lshl_add_u32 v18, v19, 8, v18
    v_and_b32 v19, 1, v17
    v_lshl_add_u32 v18, v19, 3, v18
    s_lshl_b32 s46, s66, 9
    v_add_u32 v7, s46, v18
    v_add_u32 v15, 1024, v7
    s_lshl_b32 s46, s68, 9
    s_lshl_b32 s47, s69, 2
    s_add_u32 s46, s46, s47
    v_add_u32 v5, s46, v18
    s_mul_i32 s46, s3, 3584
    s_add_u32 s46, s46, 8192
    v_lshlrev_b32 v8, 5, v16
    v_lshl_add_u32 v8, v17, 3, v8
    v_add_u32 v8, s46, v8
    v_lshlrev_b32 v9, 3, v0
    v_add_u32 v9, s46, v9
    s_mul_i32 s46, s3, 1408
    s_add_u32 s46, s46, 22528
    v_and_b32 v19, 7, v0
    v_mul_u32_u24 v18, 176, v19
    v_add_u32 v18, s46, v18
    v_lshrrev_b32 v19, 3, v16
    v_lshl_add_u32 v10, v17, 5, v18
    v_lshl_add_u32 v10, v19, 4, v10
    v_and_b32 v20, 1, v17
    v_lshl_add_u32 v11, v20, 4, v18
    v_lshrrev_b32 v20, 1, v17
    v_lshl_add_u32 v11, v20, 3, v11
    v_lshl_add_u32 v11, v19, 2, v11
    v_add_u32 v11, 128, v11
    v_mov_b32 v20, 0xf149f2ca
    v_mov_b32 v21, v20
    ds_write_b64 v18, v[20:21] offset:160
    v_and_b32 v19, 31, v0
    v_lshrrev_b32 v20, 5, v0
    s_lshl_b32 s46, s3, 1
    v_add_u32 v20, s46, v20
    v_lshlrev_b32 v21, 3, v19
    v_cmp_gt_u32 vcc, 20, v19
    v_mov_b32 v22, 160
    s_nop 0
    v_cndmask_b32 v21, v22, v21, vcc
    v_mul_u32_u24 v22, 176, v20
    v_add_u32 v12, v21, v22
    v_add_u32 v12, 22528, v12
    v_lshrrev_b32 v21, 2, v19
    v_lshl_add_u32 v21, v21, 3, v20
    v_lshlrev_b32 v21, 4, v21
    v_and_b32 v22, 3, v19
    v_lshl_add_u32 v21, v22, 2, v21
    v_mov_b32 v22, 0x7fffffff
    v_cndmask_b32 v13, v22, v21, vcc
    s_lshl_b32 s46, s68, 10
    s_lshl_b32 s47, s69, 3
    s_add_u32 s46, s46, s47
    v_add_u32 v14, s46, v1
    s_lshl_b32 s46, s66, 10
    v_add_u32 v6, s46, v1
    s_mov_b32 s56, 0x21800000
    v_mov_b32 v0, 0x5d800000
    s_waitcnt vmcnt(0) lgkmcnt(0)
    v_lshrrev_b32 v16, 2, v1
    v_min_u32 v16, 124, v16
    s_mov_b32 s70, 2097152
Lx_main_kernel_20:
    buffer_load_dword v17, v16, s[8:11], 0 offen offset:128 sc1
    s_sub_u32 s70, s70, 1
    s_cbranch_scc1 Lexit_team
    s_waitcnt vmcnt(0)
    v_cmp_eq_u32 vcc, 0, v17
    s_cbranch_vccnz Lx_main_kernel_20
    v_cmp_ne_u32 vcc, s58, v17
    s_nop 0
    s_cmp_lg_u64 vcc, 0
    s_cselect_b32 s1, 1, 0
LA0_main_kernel_8:
    s_cmp_eq_u32 s3, 1
    s_cbranch_scc1 LAw_main_kernel_22
    s_cmp_eq_u32 s3, 2
    s_cbranch_scc1 LAw_main_kernel_23
    s_cmp_eq_u32 s3, 3
    s_cbranch_scc1 LAw_main_kernel_24
LAw_main_kernel_21:
Ltop_main_kernel_25:
    s_mov_b32 s61, 79822848
    s_mul_i32 s65, s60, 640
    s_add_u32 s65, s65, 80288768
    s_mov_b32 s62, 15597568
    s_mov_b32 s96, 0
    s_mov_b32 s98, 0
    s_cmp_lt_u32 s98, s96
    s_cbranch_scc1 Lgo_main_kernel_27
    s_mov_b32 s70, 2097152
Lgl_main_kernel_28:
    v_lshlrev_b32 v16, 3, v1
    v_and_b32 v17, 0x780, v16
    v_lshrrev_b32 v16, 11, v16
    v_lshl_add_u32 v16, v16, 13, v17
    s_min_u32 s96, s96, 48
    s_lshl_b32 s97, s96, 7
    s_add_u32 s97, s97, 97640448
    buffer_load_dword v17, v16, s[12:15], s97 offen sc1
    s_sub_u32 s70, s70, 1
    s_cbranch_scc1 Lexit_team
    s_waitcnt vmcnt(0)
    v_cmp_ne_u32 vcc, 28, v17
    s_nop 0
    s_or_b32 s97, vcc_lo, vcc_hi
    s_lshr_b32 vcc_lo, s97, 16
    s_or_b32 s97, s97, vcc_lo
    s_or_b32 s97, s97, 0x10000
    s_ff1_i32_b32 s97, s97
    s_add_u32 s96, s96, s97
    s_cmp_ge_u32 s96, 64
    s_cselect_b32 s96, 0x100, s96
    s_cmp_lt_u32 s98, s96
    s_cbranch_scc0 Lgl_main_kernel_28
Lgo_main_kernel_27:
    buffer_load_dwordx4 v[72:75], v6, s[12:15], s62 offen offset:0 sc1
    buffer_load_dwordx4 v[80:83], v6, s[12:15], s62 offen offset:1024 sc1
    buffer_load_dwordx4 v[88:91], v6, s[12:15], s62 offen offset:2048 sc1
    buffer_load_dwordx2 v[96:97], v14, s[12:15], s62 offen sc1
    s_add_u32 s64, s62, 14336
    buffer_load_dwordx4 v[76:79], v6, s[12:15], s64 offen offset:0 sc1
    buffer_load_dwordx4 v[84:87], v6, s[12:15], s64 offen offset:1024 sc1
    buffer_load_dwordx4 v[92:95], v6, s[12:15], s64 offen offset:2048 sc1
    buffer_load_dwordx2 v[98:99], v14, s[12:15], s64 offen sc1
    s_add_u32 s62, s62, 28672
    s_mov_b32 s67, 63
    v_mov_b64 v[56:57], 0
    v_mov_b64 v[58:59], 0
LA_main_kernel_26:
    s_mov_b32 s70, 2097152
    buffer_load_dwordx4 v[44:47], v3, s[12:15], s61 offen sc1
    buffer_load_dwordx4 v[48:51], v4, s[12:15], s61 offen sc1
    v_mov_b64 v[52:53], 0
    v_mov_b64 v[54:55], 0
    v_mov_b64 v[56:57], 0
    v_mov_b64 v[58:59], 0
    v_mov_b64 v[60:61], 0
    v_mov_b64 v[62:63], 0
    v_mov_b64 v[64:65], 0
    v_mov_b64 v[66:67], 0
    v_mov_b64 v[116:117], 0
    v_mov_b64 v[118:119], 0
Lpm_main_kernel_30:
    buffer_load_dwordx4 v[100:103], v3, s[12:15], s61 offen sc1
    buffer_load_dwordx4 v[104:107], v4, s[12:15], s61 offen sc1
    s_sub_u32 s70, s70, 1
    s_cbranch_scc1 Lexit_team
    s_waitcnt vmcnt(2)
    v_max_u32 v114, v44, v48
    v_cmp_eq_u32 vcc, -1, v114
    s_cbranch_vccz Lpg_main_kernel_31
    buffer_load_dwordx4 v[44:47], v3, s[12:15], s61 offen sc1
    buffer_load_dwordx4 v[48:51], v4, s[12:15], s61 offen sc1
    s_waitcnt vmcnt(2)
    v_max_u32 v114, v100, v104
    v_cmp_eq_u32 vcc, -1, v114
    s_cbranch_vccnz Lpm_main_kernel_30
Lpg_main_kernel_32:
    ds_write_b128 v3, v[100:103]
    ds_write_b128 v4, v[104:107]
    v_smfmac_f32_16x16x64_bf16 v[52:55], v[100:103], a[0:7], v2
    v_smfmac_f32_16x16x64_bf16 v[52:55], v[104:107], a[8:15], v2
    v_smfmac_f32_16x16x64_bf16 v[56:59], v[100:103], a[56:63], v2
    v_smfmac_f32_16x16x64_bf16 v[56:59], v[104:107], a[64:71], v2
    s_waitcnt lgkmcnt(0)
    s_barrier
    ds_read_b128 v[24:27], v1 offset:2048
    ds_read_b128 v[28:31], v1 offset:3072
    ds_read_b128 v[32:35], v1 offset:4096
    ds_read_b128 v[36:39], v1 offset:5120
    ds_read_b128 v[40:43], v1 offset:6144
    v_smfmac_f32_16x16x64_bf16 v[60:63], v[100:103], a[112:119], v2
    v_smfmac_f32_16x16x64_bf16 v[60:63], v[104:107], a[120:127], v2
    v_smfmac_f32_16x16x64_bf16 v[64:67], v[100:103], a[168:175], v2
    v_smfmac_f32_16x16x64_bf16 v[64:67], v[104:107], a[176:183], v2
    v_smfmac_f32_16x16x64_bf16 v[116:119], v[100:103], a[224:231], v2
    v_smfmac_f32_16x16x64_bf16 v[116:119], v[104:107], a[232:239], v2
    s_branch Lpj_main_kernel_33
Lpg_main_kernel_31:
    ds_write_b128 v3, v[44:47]
    ds_write_b128 v4, v[48:51]
    v_smfmac_f32_16x16x64_bf16 v[52:55], v[44:47], a[0:7], v2
    v_smfmac_f32_16x16x64_bf16 v[52:55], v[48:51], a[8:15], v2
    v_smfmac_f32_16x16x64_bf16 v[56:59], v[44:47], a[56:63], v2
    v_smfmac_f32_16x16x64_bf16 v[56:59], v[48:51], a[64:71], v2
    s_waitcnt lgkmcnt(0)
    s_barrier
    ds_read_b128 v[24:27], v1 offset:2048
    ds_read_b128 v[28:31], v1 offset:3072
    ds_read_b128 v[32:35], v1 offset:4096
    ds_read_b128 v[36:39], v1 offset:5120
    ds_read_b128 v[40:43], v1 offset:6144
    v_smfmac_f32_16x16x64_bf16 v[60:63], v[44:47], a[112:119], v2
    v_smfmac_f32_16x16x64_bf16 v[60:63], v[48:51], a[120:127], v2
    v_smfmac_f32_16x16x64_bf16 v[64:67], v[44:47], a[168:175], v2
    v_smfmac_f32_16x16x64_bf16 v[64:67], v[48:51], a[176:183], v2
    v_smfmac_f32_16x16x64_bf16 v[116:119], v[44:47], a[224:231], v2
    v_smfmac_f32_16x16x64_bf16 v[116:119], v[48:51], a[232:239], v2
Lpj_main_kernel_33:
    s_waitcnt lgkmcnt(4)
    v_smfmac_f32_16x16x64_bf16 v[52:55], v[24:27], a[16:23], v2
    s_waitcnt lgkmcnt(3)
    v_smfmac_f32_16x16x64_bf16 v[52:55], v[28:31], a[24:31], v2
    s_waitcnt lgkmcnt(2)
    v_smfmac_f32_16x16x64_bf16 v[52:55], v[32:35], a[32:39], v2
    s_waitcnt lgkmcnt(1)
    v_smfmac_f32_16x16x64_bf16 v[52:55], v[36:39], a[40:47], v2
    s_waitcnt lgkmcnt(0)
    v_smfmac_f32_16x16x64_bf16 v[52:55], v[40:43], a[48:55], v2
    v_smfmac_f32_16x16x64_bf16 v[56:59], v[24:27], a[72:79], v2
    ds_read_b128 v[16:19], v1 offset:0
    v_smfmac_f32_16x16x64_bf16 v[56:59], v[28:31], a[80:87], v2
    ds_read_b128 v[20:23], v1 offset:1024
    v_smfmac_f32_16x16x64_bf16 v[56:59], v[32:35], a[88:95], v2
    v_cvt_pk_bf16_f32 v114, v52, v53
    v_smfmac_f32_16x16x64_bf16 v[56:59], v[36:39], a[96:103], v2
    v_cvt_pk_bf16_f32 v115, v54, v55
    v_smfmac_f32_16x16x64_bf16 v[56:59], v[40:43], a[104:111], v2
    ds_write_b64 v8, v[114:115] offset:0
    v_smfmac_f32_16x16x64_bf16 v[60:63], v[24:27], a[128:135], v2
    v_mov_b64 v[52:53], 0
    v_smfmac_f32_16x16x64_bf16 v[60:63], v[28:31], a[136:143], v2
    v_mov_b64 v[54:55], 0
    v_smfmac_f32_16x16x64_bf16 v[60:63], v[32:35], a[144:151], v2
    v_cvt_pk_bf16_f32 v114, v56, v57
    v_smfmac_f32_16x16x64_bf16 v[60:63], v[36:39], a[152:159], v2
    v_cvt_pk_bf16_f32 v115, v58, v59
    v_smfmac_f32_16x16x64_bf16 v[60:63], v[40:43], a[160:167], v2
    ds_write_b64 v8, v[114:115] offset:512
    v_smfmac_f32_16x16x64_bf16 v[64:67], v[24:27], a[184:191], v2
    ds_read2_b32 v[112:113], v5 offset0:0 offset1:32
    v_mov_b64 v[56:57], 0
    v_smfmac_f32_16x16x64_bf16 v[64:67], v[28:31], a[192:199], v2
    ds_read2_b32 v[110:111], v15 offset0:1 offset1:33
    v_mov_b64 v[58:59], 0
    v_smfmac_f32_16x16x64_bf16 v[64:67], v[32:35], a[200:207], v2
    v_cvt_pk_bf16_f32 v114, v60, v61
    v_smfmac_f32_16x16x64_bf16 v[64:67], v[36:39], a[208:215], v2
    v_cvt_pk_bf16_f32 v115, v62, v63
    v_smfmac_f32_16x16x64_bf16 v[64:67], v[40:43], a[216:223], v2
    ds_write_b64 v8, v[114:115] offset:1024
    v_smfmac_f32_16x16x64_bf16 v[116:119], v[24:27], a[240:247], v2
    ds_read_b64_tr_b16 v[68:69], v9 offset:1024
    v_smfmac_f32_16x16x64_bf16 v[116:119], v[28:31], a[248:255], v2
    s_waitcnt vmcnt(0)
    ds_read2_b32 v[100:101], v7 offset0:0 offset1:32
    v_smfmac_f32_16x16x64_bf16 v[116:119], v[32:35], v[120:127], v2
    ds_read2_b32 v[102:103], v7 offset0:1 offset1:33
    v_cvt_pk_bf16_f32 v114, v64, v65
    v_smfmac_f32_16x16x64_bf16 v[116:119], v[36:39], v[128:135], v2
    ds_read2_b32 v[104:105], v7 offset0:128 offset1:160
    v_cvt_pk_bf16_f32 v115, v66, v67
    v_smfmac_f32_16x16x64_bf16 v[116:119], v[40:43], v[136:143], v2
    ds_write_b64 v8, v[114:115] offset:1536
    v_smfmac_f32_16x16x64_bf16 v[52:55], v[24:27], v[160:167], v2
    ds_read_b64_tr_b16 v[70:71], v9 offset:1536
    v_smfmac_f32_16x16x64_bf16 v[52:55], v[28:31], v[168:175], v2
    ds_read2_b32 v[106:107], v7 offset0:129 offset1:161
    v_smfmac_f32_16x16x64_bf16 v[52:55], v[32:35], v[176:183], v2
    ds_read2_b32 v[108:109], v15 offset0:0 offset1:32
    v_cvt_pk_bf16_f32 v114, v116, v117
    v_smfmac_f32_16x16x64_bf16 v[52:55], v[36:39], v[184:191], v2
    v_cvt_pk_bf16_f32 v115, v118, v119
    v_smfmac_f32_16x16x64_bf16 v[52:55], v[40:43], v[192:199], v2
    ds_write_b64 v8, v[114:115] offset:2048
    s_waitcnt lgkmcnt(6)
    v_smfmac_f32_16x16x64_bf16 v[52:55], v[16:19], v[144:151], v2
    ds_read_b64_tr_b16 v[64:65], v9 offset:2048
    v_smfmac_f32_16x16x64_bf16 v[52:55], v[20:23], v[152:159], v2
    ds_read_b64_tr_b16 v[60:61], v9
    v_smfmac_f32_16x16x64_bf16 v[56:59], v[24:27], v[216:223], v2
    ds_read_b64_tr_b16 v[62:63], v9 offset:512
    v_smfmac_f32_16x16x64_bf16 v[56:59], v[28:31], v[224:231], v2
    v_smfmac_f32_16x16x64_bf16 v[56:59], v[32:35], v[232:239], v2
    v_cvt_pk_bf16_f32 v114, v52, v53
    v_smfmac_f32_16x16x64_bf16 v[56:59], v[36:39], v[240:247], v2
    v_cvt_pk_bf16_f32 v115, v54, v55
    v_smfmac_f32_16x16x64_bf16 v[56:59], v[40:43], v[248:255], v2
    ds_write_b64 v8, v[114:115] offset:2560
    v_smfmac_f32_16x16x64_bf16 v[56:59], v[16:19], v[200:207], v2
    ds_read_b64_tr_b16 v[66:67], v9 offset:2560
    v_smfmac_f32_16x16x64_bf16 v[56:59], v[20:23], v[208:215], v2
    s_waitcnt lgkmcnt(2)
    v_mfma_f32_16x16x32_bf16 v[44:47], v[80:83], v[68:71], 0
    v_mfma_f32_16x16x32_bf16 v[48:51], v[84:87], v[68:71], 0
    s_nop 1
    v_cvt_pk_bf16_f32 v114, v56, v57
    v_cvt_pk_bf16_f32 v115, v58, v59
    v_mfma_f32_16x16x32_bf16 v[116:119], v[104:107], v[68:71], 0
    ds_write_b64 v8, v[114:115] offset:3072
    ds_read_b64_tr_b16 v[114:115], v9 offset:3072
    v_mfma_f32_16x16x32_bf16 v[44:47], v[72:75], v[60:63], v[44:47]
    v_max3_u32 v56, v16, v17, v18
    v_max3_u32 v56, v56, v19, v20
    v_mfma_f32_16x16x32_bf16 v[48:51], v[76:79], v[60:63], v[48:51]
    v_max3_u32 v56, v56, v21, v22
    v_max3_u32 v56, v56, v23, v24
    v_mfma_f32_16x16x32_bf16 v[116:119], v[100:103], v[60:63], v[116:119]
    v_max3_u32 v56, v56, v25, v26
    v_max3_u32 v56, v56, v27, v28
    s_waitcnt lgkmcnt(2)
    v_mfma_f32_16x16x32_bf16 v[44:47], v[88:91], v[64:67], v[44:47]
    v_max3_u32 v56, v56, v29, v30
    v_max3_u32 v56, v56, v31, v32
    v_mfma_f32_16x16x32_bf16 v[48:51], v[92:95], v[64:67], v[48:51]
    v_max3_u32 v56, v56, v33, v34
    v_max3_u32 v56, v56, v35, v36
    v_mfma_f32_16x16x32_bf16 v[116:119], v[108:111], v[64:67], v[116:119]
    v_max3_u32 v56, v56, v37, v38
    v_max3_u32 v56, v56, v39, v40
    s_waitcnt lgkmcnt(0)
    v_mfma_f32_16x16x16_bf16 v[44:47], v[96:97], v[114:115], v[44:47]
    v_mfma_f32_16x16x16_bf16 v[48:51], v[98:99], v[114:115], v[48:51]
    v_max3_u32 v56, v56, v41, v42
    v_mfma_f32_16x16x16_bf16 v[116:119], v[112:113], v[114:115], v[116:119]
    v_max_u32 v56, v56, v43
    v_cmp_eq_u32 vcc, -1, v56
    v_add_f32_dpp v64, v44, v44 row_ror:8 row_mask:0xf bank_mask:0x3
    v_add_f32_dpp v65, v45, v45 row_ror:8 row_mask:0xf bank_mask:0x3
    v_add_f32_dpp v66, v46, v46 row_ror:8 row_mask:0xf bank_mask:0x3
    v_add_f32_dpp v67, v47, v47 row_ror:8 row_mask:0xf bank_mask:0x3
    v_add_f32_dpp v64, v48, v48 row_ror:8 row_mask:0xf bank_mask:0xc
    v_add_f32_dpp v65, v49, v49 row_ror:8 row_mask:0xf bank_mask:0xc
    v_add_f32_dpp v66, v50, v50 row_ror:8 row_mask:0xf bank_mask:0xc
    v_add_f32_dpp v67, v51, v51 row_ror:8 row_mask:0xf bank_mask:0xc
    ds_write_b128 v10, v[64:67]
    v_add_f32_dpp v68, v116, v116 row_ror:8 row_mask:0x3 bank_mask:0x3
    v_add_f32_dpp v68, v117, v117 row_ror:8 row_mask:0x3 bank_mask:0xc
    v_add_f32_dpp v68, v118, v118 row_ror:8 row_mask:0xc bank_mask:0x3
    v_add_f32_dpp v68, v119, v119 row_ror:8 row_mask:0xc bank_mask:0xc
    ds_write_b32 v11, v68
    s_cbranch_vccnz LAr_main_kernel_29
    s_waitcnt lgkmcnt(0)
    s_barrier
    ds_read_b64 v[16:17], v12 offset:0
    ds_read_b64 v[18:19], v12 offset:1408
    ds_read_b64 v[20:21], v12 offset:2816
    ds_read_b64 v[22:23], v12 offset:4224
    s_waitcnt lgkmcnt(2)
    v_pk_add_f32 v[16:17], v[16:17], v[18:19]
    s_waitcnt lgkmcnt(0)
    v_pk_add_f32 v[20:21], v[20:21], v[22:23]
    v_pk_add_f32 v[16:17], v[16:17], v[20:21]
    v_exp_f32 v20, v16
    v_exp_f32 v21, v17
    s_nop 0
    v_add_f32 v18, v20, v21
    s_nop 1
    v_add_f32_dpp v18, v18, v18 row_ror:8 row_mask:0xf bank_mask:0xf
    s_nop 1
    v_add_f32_dpp v18, v18, v18 row_ror:4 row_mask:0xf bank_mask:0xf
    s_nop 1
    v_add_f32_dpp v18, v18, v18 row_ror:2 row_mask:0xf bank_mask:0xf
    s_nop 1
    v_add_f32_dpp v18, v18, v18 row_ror:1 row_mask:0xf bank_mask:0xf
    v_mov_b32 v19, v18
    s_nop 1
    v_permlane16_swap_b32 v18, v19
    s_nop 0
    v_add_f32 v18, v18, v19
    v_med3_f32 v19, v18, s56, v0
    v_cmp_neq_f32 vcc, v19, v18
    v_rcp_f32 v18, v18
    s_nop 0
    v_mul_f32 v20, v20, v18
    v_mul_f32 v21, v21, v18
    v_cvt_pk_bf16_f32 v20, v20, v21
    v_min_u32 v20, -2, v20
    s_cbranch_vccnz LAm_main_kernel_34
LAp_main_kernel_35:
    buffer_store_dword v20, v13, s[12:15], s65 offen
    s_cmp_eq_u32 s1, 0
    s_cbranch_scc1 Lpub_main_kernel_36
    buffer_store_dword v20, v13, s[12:15], s65 offen sc1
Lpub_main_kernel_36:
    s_barrier
    s_add_u32 s98, s98, 1
    s_cmp_lt_u32 s98, s96
    s_cbranch_scc1 Lgo_main_kernel_37
    s_mov_b32 s70, 2097152
Lgl_main_kernel_38:
    v_lshlrev_b32 v24, 3, v1
    v_and_b32 v25, 0x780, v24
    v_lshrrev_b32 v24, 11, v24
    v_lshl_add_u32 v24, v24, 13, v25
    s_min_u32 s96, s96, 48
    s_lshl_b32 s97, s96, 7
    s_add_u32 s97, s97, 97640448
    buffer_load_dword v25, v24, s[12:15], s97 offen sc1
    s_sub_u32 s70, s70, 1
    s_cbranch_scc1 Lexit_team
    s_waitcnt vmcnt(0)
    v_cmp_ne_u32 vcc, 28, v25
    s_nop 0
    s_or_b32 s97, vcc_lo, vcc_hi
    s_lshr_b32 vcc_lo, s97, 16
    s_or_b32 s97, s97, vcc_lo
    s_or_b32 s97, s97, 0x10000
    s_ff1_i32_b32 s97, s97
    s_add_u32 s96, s96, s97
    s_cmp_ge_u32 s96, 64
    s_cselect_b32 s96, 0x100, s96
    s_cmp_lt_u32 s98, s96
    s_cbranch_scc0 Lgl_main_kernel_38
Lgo_main_kernel_37:
    buffer_load_dwordx4 v[72:75], v6, s[12:15], s62 offen offset:0 sc1
    buffer_load_dwordx4 v[80:83], v6, s[12:15], s62 offen offset:1024 sc1
    buffer_load_dwordx4 v[88:91], v6, s[12:15], s62 offen offset:2048 sc1
    buffer_load_dwordx2 v[96:97], v14, s[12:15], s62 offen sc1
    s_add_u32 s64, s62, 14336
    buffer_load_dwordx4 v[76:79], v6, s[12:15], s64 offen offset:0 sc1
    buffer_load_dwordx4 v[84:87], v6, s[12:15], s64 offen offset:1024 sc1
    buffer_load_dwordx4 v[92:95], v6, s[12:15], s64 offen offset:2048 sc1
    buffer_load_dwordx2 v[98:99], v14, s[12:15], s64 offen sc1
    s_add_u32 s62, s62, 28672
    s_add_u32 s65, s65, 10240
    s_add_u32 s61, s61, 7168
    s_sub_u32 s67, s67, 1
    s_cmp_lg_u32 s67, 0
    s_cbranch_scc1 LA_main_kernel_26
    s_branch LAo_main_kernel_39
LAm_main_kernel_34:
    v_max_f32 v18, v16, v17
    s_nop 1
    v_max_f32_dpp v18, v18, v18 row_ror:8 row_mask:0xf bank_mask:0xf
    s_nop 1
    v_max_f32_dpp v18, v18, v18 row_ror:4 row_mask:0xf bank_mask:0xf
    s_nop 1
    v_max_f32_dpp v18, v18, v18 row_ror:2 row_mask:0xf bank_mask:0xf
    s_nop 1
    v_max_f32_dpp v18, v18, v18 row_ror:1 row_mask:0xf bank_mask:0xf
    v_mov_b32 v19, v18
    s_nop 1
    v_permlane16_swap_b32 v18, v19
    s_nop 0
    v_max_f32 v18, v18, v19
    v_sub_f32 v16, v16, v18
    v_sub_f32 v17, v17, v18
    v_exp_f32 v20, v16
    v_exp_f32 v21, v17
    s_nop 0
    v_add_f32 v18, v20, v21
    s_nop 1
    v_add_f32_dpp v18, v18, v18 row_ror:8 row_mask:0xf bank_mask:0xf
    s_nop 1
    v_add_f32_dpp v18, v18, v18 row_ror:4 row_mask:0xf bank_mask:0xf
    s_nop 1
    v_add_f32_dpp v18, v18, v18 row_ror:2 row_mask:0xf bank_mask:0xf
    s_nop 1
    v_add_f32_dpp v18, v18, v18 row_ror:1 row_mask:0xf bank_mask:0xf
    v_mov_b32 v19, v18
    s_nop 1
    v_permlane16_swap_b32 v18, v19
    s_nop 0
    v_add_f32 v18, v18, v19
    v_rcp_f32 v18, v18
    s_nop 0
    v_mul_f32 v20, v20, v18
    v_mul_f32 v21, v21, v18
    v_cvt_pk_bf16_f32 v20, v20, v21
    v_min_u32 v20, -2, v20
    s_branch LAp_main_kernel_35
LAr_main_kernel_29:
    s_waitcnt lgkmcnt(0)
    s_barrier
    s_branch LA_main_kernel_26
LAo_main_kernel_39:
    s_add_u32 s12, s44, 82182144
    s_addc_u32 s13, s45, 0
    s_and_b32 s13, s13, 0xffff
    s_mov_b32 s14, 186253312
    s_add_u32 s0, s0, 1
    s_cmp_lt_u32 s0, 2
    s_cbranch_scc1 Ltop_main_kernel_25
    s_endpgm
LAw_main_kernel_22:
Ltop_main_kernel_40:
    s_mov_b32 s61, 79822848
    s_mul_i32 s65, s60, 640
    s_add_u32 s65, s65, 80288768
    s_mov_b32 s62, 15597568
    s_mov_b32 s96, 0
    s_mov_b32 s98, 0
    s_cmp_lt_u32 s98, s96
    s_cbranch_scc1 Lgo_main_kernel_42
    s_mov_b32 s70, 2097152
Lgl_main_kernel_43:
    v_lshlrev_b32 v16, 3, v1
    v_and_b32 v17, 0x780, v16
    v_lshrrev_b32 v16, 11, v16
    v_lshl_add_u32 v16, v16, 13, v17
    s_min_u32 s96, s96, 48
    s_lshl_b32 s97, s96, 7
    s_add_u32 s97, s97, 97640448
    buffer_load_dword v17, v16, s[12:15], s97 offen sc1
    s_sub_u32 s70, s70, 1
    s_cbranch_scc1 Lexit_team
    s_waitcnt vmcnt(0)
    v_cmp_ne_u32 vcc, 28, v17
    s_nop 0
    s_or_b32 s97, vcc_lo, vcc_hi
    s_lshr_b32 vcc_lo, s97, 16
    s_or_b32 s97, s97, vcc_lo
    s_or_b32 s97, s97, 0x10000
    s_ff1_i32_b32 s97, s97
    s_add_u32 s96, s96, s97
    s_cmp_ge_u32 s96, 64
    s_cselect_b32 s96, 0x100, s96
    s_cmp_lt_u32 s98, s96
    s_cbranch_scc0 Lgl_main_kernel_43
Lgo_main_kernel_42:
    buffer_load_dwordx4 v[72:75], v6, s[12:15], s62 offen offset:0 sc1
    buffer_load_dwordx4 v[80:83], v6, s[12:15], s62 offen offset:1024 sc1
    buffer_load_dwordx4 v[88:91], v6, s[12:15], s62 offen offset:2048 sc1
    buffer_load_dwordx2 v[96:97], v14, s[12:15], s62 offen sc1
    s_add_u32 s64, s62, 14336
    buffer_load_dwordx4 v[76:79], v6, s[12:15], s64 offen offset:0 sc1
    buffer_load_dwordx4 v[84:87], v6, s[12:15], s64 offen offset:1024 sc1
    buffer_load_dwordx4 v[92:95], v6, s[12:15], s64 offen offset:2048 sc1
    buffer_load_dwordx2 v[98:99], v14, s[12:15], s64 offen sc1
    s_add_u32 s62, s62, 28672
    s_mov_b32 s67, 63
    v_mov_b64 v[56:57], 0
    v_mov_b64 v[58:59], 0
LA_main_kernel_41:
    s_mov_b32 s70, 2097152
    buffer_load_dwordx4 v[44:47], v3, s[12:15], s61 offen sc1
    buffer_load_dwordx4 v[48:51], v4, s[12:15], s61 offen sc1
    v_mov_b64 v[52:53], 0
    v_mov_b64 v[54:55], 0
    v_mov_b64 v[56:57], 0
    v_mov_b64 v[58:59], 0
    v_mov_b64 v[60:61], 0
    v_mov_b64 v[62:63], 0
    v_mov_b64 v[64:65], 0
    v_mov_b64 v[66:67], 0
    v_mov_b64 v[116:117], 0
    v_mov_b64 v[118:119], 0
Lpm_main_kernel_45:
    buffer_load_dwordx4 v[100:103], v3, s[12:15], s61 offen sc1
    buffer_load_dwordx4 v[104:107], v4, s[12:15], s61 offen sc1
    s_sub_u32 s70, s70, 1
    s_cbranch_scc1 Lexit_team
    s_waitcnt vmcnt(2)
    v_max_u32 v114, v44, v48
    v_cmp_eq_u32 vcc, -1, v114
    s_cbranch_vccz Lpg_main_kernel_46
    buffer_load_dwordx4 v[44:47], v3, s[12:15], s61 offen sc1
    buffer_load_dwordx4 v[48:51], v4, s[12:15], s61 offen sc1
    s_waitcnt vmcnt(2)
    v_max_u32 v114, v100, v104
    v_cmp_eq_u32 vcc, -1, v114
    s_cbranch_vccnz Lpm_main_kernel_45
Lpg_main_kernel_47:
    ds_write_b128 v3, v[100:103]
    ds_write_b128 v4, v[104:107]
    v_smfmac_f32_16x16x64_bf16 v[52:55], v[100:103], a[16:23], v2
    v_smfmac_f32_16x16x64_bf16 v[52:55], v[104:107], a[24:31], v2
    v_smfmac_f32_16x16x64_bf16 v[56:59], v[100:103], a[72:79], v2
    v_smfmac_f32_16x16x64_bf16 v[56:59], v[104:107], a[80:87], v2
    s_waitcnt lgkmcnt(0)
    s_barrier
    ds_read_b128 v[16:19], v1 offset:0
    ds_read_b128 v[20:23], v1 offset:1024
    ds_read_b128 v[32:35], v1 offset:4096
    ds_read_b128 v[36:39], v1 offset:5120
    ds_read_b128 v[40:43], v1 offset:6144
    v_smfmac_f32_16x16x64_bf16 v[60:63], v[100:103], a[128:135], v2
    v_smfmac_f32_16x16x64_bf16 v[60:63], v[104:107], a[136:143], v2
    v_smfmac_f32_16x16x64_bf16 v[64:67], v[100:103], a[184:191], v2
    v_smfmac_f32_16x16x64_bf16 v[64:67], v[104:107], a[192:199], v2
    v_smfmac_f32_16x16x64_bf16 v[116:119], v[100:103], a[240:247], v2
    v_smfmac_f32_16x16x64_bf16 v[116:119], v[104:107], a[248:255], v2
    s_branch Lpj_main_kernel_48
Lpg_main_kernel_46:
    ds_write_b128 v3, v[44:47]
    ds_write_b128 v4, v[48:51]
    v_smfmac_f32_16x16x64_bf16 v[52:55], v[44:47], a[16:23], v2
    v_smfmac_f32_16x16x64_bf16 v[52:55], v[48:51], a[24:31], v2
    v_smfmac_f32_16x16x64_bf16 v[56:59], v[44:47], a[72:79], v2
    v_smfmac_f32_16x16x64_bf16 v[56:59], v[48:51], a[80:87], v2
    s_waitcnt lgkmcnt(0)
    s_barrier
    ds_read_b128 v[16:19], v1 offset:0
    ds_read_b128 v[20:23], v1 offset:1024
    ds_read_b128 v[32:35], v1 offset:4096
    ds_read_b128 v[36:39], v1 offset:5120
    ds_read_b128 v[40:43], v1 offset:6144
    v_smfmac_f32_16x16x64_bf16 v[60:63], v[44:47], a[128:135], v2
    v_smfmac_f32_16x16x64_bf16 v[60:63], v[48:51], a[136:143], v2
    v_smfmac_f32_16x16x64_bf16 v[64:67], v[44:47], a[184:191], v2
    v_smfmac_f32_16x16x64_bf16 v[64:67], v[48:51], a[192:199], v2
    v_smfmac_f32_16x16x64_bf16 v[116:119], v[44:47], a[240:247], v2
    v_smfmac_f32_16x16x64_bf16 v[116:119], v[48:51], a[248:255], v2
Lpj_main_kernel_48:
    s_waitcnt lgkmcnt(4)
    v_smfmac_f32_16x16x64_bf16 v[52:55], v[16:19], a[0:7], v2
    s_waitcnt lgkmcnt(3)
    v_smfmac_f32_16x16x64_bf16 v[52:55], v[20:23], a[8:15], v2
    s_waitcnt lgkmcnt(2)
    v_smfmac_f32_16x16x64_bf16 v[52:55], v[32:35], a[32:39], v2
    s_waitcnt lgkmcnt(1)
    v_smfmac_f32_16x16x64_bf16 v[52:55], v[36:39], a[40:47], v2
    s_waitcnt lgkmcnt(0)
    v_smfmac_f32_16x16x64_bf16 v[52:55], v[40:43], a[48:55], v2
    v_smfmac_f32_16x16x64_bf16 v[56:59], v[16:19], a[56:63], v2
    ds_read_b128 v[24:27], v1 offset:2048
    v_smfmac_f32_16x16x64_bf16 v[56:59], v[20:23], a[64:71], v2
    ds_read_b128 v[28:31], v1 offset:3072
    v_smfmac_f32_16x16x64_bf16 v[56:59], v[32:35], a[88:95], v2
    v_cvt_pk_bf16_f32 v114, v52, v53
    v_smfmac_f32_16x16x64_bf16 v[56:59], v[36:39], a[96:103], v2
    v_cvt_pk_bf16_f32 v115, v54, v55
    v_smfmac_f32_16x16x64_bf16 v[56:59], v[40:43], a[104:111], v2
    ds_write_b64 v8, v[114:115] offset:0
    v_smfmac_f32_16x16x64_bf16 v[60:63], v[16:19], a[112:119], v2
    v_mov_b64 v[52:53], 0
    v_smfmac_f32_16x16x64_bf16 v[60:63], v[20:23], a[120:127], v2
    v_mov_b64 v[54:55], 0
    v_smfmac_f32_16x16x64_bf16 v[60:63], v[32:35], a[144:151], v2
    v_cvt_pk_bf16_f32 v114, v56, v57
    v_smfmac_f32_16x16x64_bf16 v[60:63], v[36:39], a[152:159], v2
    v_cvt_pk_bf16_f32 v115, v58, v59
    v_smfmac_f32_16x16x64_bf16 v[60:63], v[40:43], a[160:167], v2
    ds_write_b64 v8, v[114:115] offset:512
    v_smfmac_f32_16x16x64_bf16 v[64:67], v[16:19], a[168:175], v2
    ds_read2_b32 v[112:113], v5 offset0:0 offset1:32
    v_mov_b64 v[56:57], 0
    v_smfmac_f32_16x16x64_bf16 v[64:67], v[20:23], a[176:183], v2
    ds_read2_b32 v[110:111], v15 offset0:1 offset1:33
    v_mov_b64 v[58:59], 0
    v_smfmac_f32_16x16x64_bf16 v[64:67], v[32:35], a[200:207], v2
    v_cvt_pk_bf16_f32 v114, v60, v61
    v_smfmac_f32_16x16x64_bf16 v[64:67], v[36:39], a[208:215], v2
    v_cvt_pk_bf16_f32 v115, v62, v63
    v_smfmac_f32_16x16x64_bf16 v[64:67], v[40:43], a[216:223], v2
    ds_write_b64 v8, v[114:115] offset:1024
    v_smfmac_f32_16x16x64_bf16 v[116:119], v[16:19], a[224:231], v2
    ds_read_b64_tr_b16 v[68:69], v9 offset:1024
    v_smfmac_f32_16x16x64_bf16 v[116:119], v[20:23], a[232:239], v2
    s_waitcnt vmcnt(0)
    ds_read2_b32 v[100:101], v7 offset0:0 offset1:32
    v_smfmac_f32_16x16x64_bf16 v[116:119], v[32:35], v[120:127], v2
    ds_read2_b32 v[102:103], v7 offset0:1 offset1:33
    v_cvt_pk_bf16_f32 v114, v64, v65
    v_smfmac_f32_16x16x64_bf16 v[116:119], v[36:39], v[128:135], v2
    ds_read2_b32 v[104:105], v7 offset0:128 offset1:160
    v_cvt_pk_bf16_f32 v115, v66, v67
    v_smfmac_f32_16x16x64_bf16 v[116:119], v[40:43], v[136:143], v2
    ds_write_b64 v8, v[114:115] offset:1536
    v_smfmac_f32_16x16x64_bf16 v[52:55], v[16:19], v[144:151], v2
    ds_read_b64_tr_b16 v[70:71], v9 offset:1536
    v_smfmac_f32_16x16x64_bf16 v[52:55], v[20:23], v[152:159], v2
    ds_read2_b32 v[106:107], v7 offset0:129 offset1:161
    v_smfmac_f32_16x16x64_bf16 v[52:55], v[32:35], v[176:183], v2
    ds_read2_b32 v[108:109], v15 offset0:0 offset1:32
    v_cvt_pk_bf16_f32 v114, v116, v117
    v_smfmac_f32_16x16x64_bf16 v[52:55], v[36:39], v[184:191], v2
    v_cvt_pk_bf16_f32 v115, v118, v119
    v_smfmac_f32_16x16x64_bf16 v[52:55], v[40:43], v[192:199], v2
    ds_write_b64 v8, v[114:115] offset:2048
    s_waitcnt lgkmcnt(6)
    v_smfmac_f32_16x16x64_bf16 v[52:55], v[24:27], v[160:167], v2
    ds_read_b64_tr_b16 v[64:65], v9 offset:2048
    v_smfmac_f32_16x16x64_bf16 v[52:55], v[28:31], v[168:175], v2
    ds_read_b64_tr_b16 v[60:61], v9
    v_smfmac_f32_16x16x64_bf16 v[56:59], v[16:19], v[200:207], v2
    ds_read_b64_tr_b16 v[62:63], v9 offset:512
    v_smfmac_f32_16x16x64_bf16 v[56:59], v[20:23], v[208:215], v2
    v_smfmac_f32_16x16x64_bf16 v[56:59], v[32:35], v[232:239], v2
    v_cvt_pk_bf16_f32 v114, v52, v53
    v_smfmac_f32_16x16x64_bf16 v[56:59], v[36:39], v[240:247], v2
    v_cvt_pk_bf16_f32 v115, v54, v55
    v_smfmac_f32_16x16x64_bf16 v[56:59], v[40:43], v[248:255], v2
    ds_write_b64 v8, v[114:115] offset:2560
    v_smfmac_f32_16x16x64_bf16 v[56:59], v[24:27], v[216:223], v2
    ds_read_b64_tr_b16 v[66:67], v9 offset:2560
    v_smfmac_f32_16x16x64_bf16 v[56:59], v[28:31], v[224:231], v2
    s_waitcnt lgkmcnt(2)
    v_mfma_f32_16x16x32_bf16 v[44:47], v[80:83], v[68:71], 0
    v_mfma_f32_16x16x32_bf16 v[48:51], v[84:87], v[68:71], 0
    s_nop 1
    v_cvt_pk_bf16_f32 v114, v56, v57
    v_cvt_pk_bf16_f32 v115, v58, v59
    v_mfma_f32_16x16x32_bf16 v[116:119], v[104:107], v[68:71], 0
    ds_write_b64 v8, v[114:115] offset:3072
    ds_read_b64_tr_b16 v[114:115], v9 offset:3072
    v_mfma_f32_16x16x32_bf16 v[44:47], v[72:75], v[60:63], v[44:47]
    v_max3_u32 v56, v16, v17, v18
    v_max3_u32 v56, v56, v19, v20
    v_mfma_f32_16x16x32_bf16 v[48:51], v[76:79], v[60:63], v[48:51]
    v_max3_u32 v56, v56, v21, v22
    v_max3_u32 v56, v56, v23, v24
    v_mfma_f32_16x16x32_bf16 v[116:119], v[100:103], v[60:63], v[116:119]
    v_max3_u32 v56, v56, v25, v26
    v_max3_u32 v56, v56, v27, v28
    s_waitcnt lgkmcnt(2)
    v_mfma_f32_16x16x32_bf16 v[44:47], v[88:91], v[64:67], v[44:47]
    v_max3_u32 v56, v56, v29, v30
    v_max3_u32 v56, v56, v31, v32
    v_mfma_f32_16x16x32_bf16 v[48:51], v[92:95], v[64:67], v[48:51]
    v_max3_u32 v56, v56, v33, v34
    v_max3_u32 v56, v56, v35, v36
    v_mfma_f32_16x16x32_bf16 v[116:119], v[108:111], v[64:67], v[116:119]
    v_max3_u32 v56, v56, v37, v38
    v_max3_u32 v56, v56, v39, v40
    s_waitcnt lgkmcnt(0)
    v_mfma_f32_16x16x16_bf16 v[44:47], v[96:97], v[114:115], v[44:47]
    v_mfma_f32_16x16x16_bf16 v[48:51], v[98:99], v[114:115], v[48:51]
    v_max3_u32 v56, v56, v41, v42
    v_mfma_f32_16x16x16_bf16 v[116:119], v[112:113], v[114:115], v[116:119]
    v_max_u32 v56, v56, v43
    v_cmp_eq_u32 vcc, -1, v56
    v_add_f32_dpp v64, v44, v44 row_ror:8 row_mask:0xf bank_mask:0x3
    v_add_f32_dpp v65, v45, v45 row_ror:8 row_mask:0xf bank_mask:0x3
    v_add_f32_dpp v66, v46, v46 row_ror:8 row_mask:0xf bank_mask:0x3
    v_add_f32_dpp v67, v47, v47 row_ror:8 row_mask:0xf bank_mask:0x3
    v_add_f32_dpp v64, v48, v48 row_ror:8 row_mask:0xf bank_mask:0xc
    v_add_f32_dpp v65, v49, v49 row_ror:8 row_mask:0xf bank_mask:0xc
    v_add_f32_dpp v66, v50, v50 row_ror:8 row_mask:0xf bank_mask:0xc
    v_add_f32_dpp v67, v51, v51 row_ror:8 row_mask:0xf bank_mask:0xc
    ds_write_b128 v10, v[64:67]
    v_add_f32_dpp v68, v116, v116 row_ror:8 row_mask:0x3 bank_mask:0x3
    v_add_f32_dpp v68, v117, v117 row_ror:8 row_mask:0x3 bank_mask:0xc
    v_add_f32_dpp v68, v118, v118 row_ror:8 row_mask:0xc bank_mask:0x3
    v_add_f32_dpp v68, v119, v119 row_ror:8 row_mask:0xc bank_mask:0xc
    ds_write_b32 v11, v68
    s_cbranch_vccnz LAr_main_kernel_44
    s_waitcnt lgkmcnt(0)
    s_barrier
    ds_read_b64 v[16:17], v12 offset:0
    ds_read_b64 v[18:19], v12 offset:1408
    ds_read_b64 v[20:21], v12 offset:2816
    ds_read_b64 v[22:23], v12 offset:4224
    s_waitcnt lgkmcnt(2)
    v_pk_add_f32 v[16:17], v[16:17], v[18:19]
    s_waitcnt lgkmcnt(0)
    v_pk_add_f32 v[20:21], v[20:21], v[22:23]
    v_pk_add_f32 v[16:17], v[16:17], v[20:21]
    v_exp_f32 v20, v16
    v_exp_f32 v21, v17
    s_nop 0
    v_add_f32 v18, v20, v21
    s_nop 1
    v_add_f32_dpp v18, v18, v18 row_ror:8 row_mask:0xf bank_mask:0xf
    s_nop 1
    v_add_f32_dpp v18, v18, v18 row_ror:4 row_mask:0xf bank_mask:0xf
    s_nop 1
    v_add_f32_dpp v18, v18, v18 row_ror:2 row_mask:0xf bank_mask:0xf
    s_nop 1
    v_add_f32_dpp v18, v18, v18 row_ror:1 row_mask:0xf bank_mask:0xf
    v_mov_b32 v19, v18
    s_nop 1
    v_permlane16_swap_b32 v18, v19
    s_nop 0
    v_add_f32 v18, v18, v19
    v_med3_f32 v19, v18, s56, v0
    v_cmp_neq_f32 vcc, v19, v18
    v_rcp_f32 v18, v18
    s_nop 0
    v_mul_f32 v20, v20, v18
    v_mul_f32 v21, v21, v18
    v_cvt_pk_bf16_f32 v20, v20, v21
    v_min_u32 v20, -2, v20
    s_cbranch_vccnz LAm_main_kernel_49
LAp_main_kernel_50:
    buffer_store_dword v20, v13, s[12:15], s65 offen
    s_cmp_eq_u32 s1, 0
    s_cbranch_scc1 Lpub_main_kernel_51
    buffer_store_dword v20, v13, s[12:15], s65 offen sc1
Lpub_main_kernel_51:
    s_barrier
    s_add_u32 s98, s98, 1
    s_cmp_lt_u32 s98, s96
    s_cbranch_scc1 Lgo_main_kernel_52
    s_mov_b32 s70, 2097152
Lgl_main_kernel_53:
    v_lshlrev_b32 v24, 3, v1
    v_and_b32 v25, 0x780, v24
    v_lshrrev_b32 v24, 11, v24
    v_lshl_add_u32 v24, v24, 13, v25
    s_min_u32 s96, s96, 48
    s_lshl_b32 s97, s96, 7
    s_add_u32 s97, s97, 97640448
    buffer_load_dword v25, v24, s[12:15], s97 offen sc1
    s_sub_u32 s70, s70, 1
    s_cbranch_scc1 Lexit_team
    s_waitcnt vmcnt(0)
    v_cmp_ne_u32 vcc, 28, v25
    s_nop 0
    s_or_b32 s97, vcc_lo, vcc_hi
    s_lshr_b32 vcc_lo, s97, 16
    s_or_b32 s97, s97, vcc_lo
    s_or_b32 s97, s97, 0x10000
    s_ff1_i32_b32 s97, s97
    s_add_u32 s96, s96, s97
    s_cmp_ge_u32 s96, 64
    s_cselect_b32 s96, 0x100, s96
    s_cmp_lt_u32 s98, s96
    s_cbranch_scc0 Lgl_main_kernel_53
Lgo_main_kernel_52:
    buffer_load_dwordx4 v[72:75], v6, s[12:15], s62 offen offset:0 sc1
    buffer_load_dwordx4 v[80:83], v6, s[12:15], s62 offen offset:1024 sc1
    buffer_load_dwordx4 v[88:91], v6, s[12:15], s62 offen offset:2048 sc1
    buffer_load_dwordx2 v[96:97], v14, s[12:15], s62 offen sc1
    s_add_u32 s64, s62, 14336
    buffer_load_dwordx4 v[76:79], v6, s[12:15], s64 offen offset:0 sc1
    buffer_load_dwordx4 v[84:87], v6, s[12:15], s64 offen offset:1024 sc1
    buffer_load_dwordx4 v[92:95], v6, s[12:15], s64 offen offset:2048 sc1
    buffer_load_dwordx2 v[98:99], v14, s[12:15], s64 offen sc1
    s_add_u32 s62, s62, 28672
    s_add_u32 s65, s65, 10240
    s_add_u32 s61, s61, 7168
    s_sub_u32 s67, s67, 1
    s_cmp_lg_u32 s67, 0
    s_cbranch_scc1 LA_main_kernel_41
    s_branch LAo_main_kernel_54
LAm_main_kernel_49:
    v_max_f32 v18, v16, v17
    s_nop 1
    v_max_f32_dpp v18, v18, v18 row_ror:8 row_mask:0xf bank_mask:0xf
    s_nop 1
    v_max_f32_dpp v18, v18, v18 row_ror:4 row_mask:0xf bank_mask:0xf
    s_nop 1
    v_max_f32_dpp v18, v18, v18 row_ror:2 row_mask:0xf bank_mask:0xf
    s_nop 1
    v_max_f32_dpp v18, v18, v18 row_ror:1 row_mask:0xf bank_mask:0xf
    v_mov_b32 v19, v18
    s_nop 1
    v_permlane16_swap_b32 v18, v19
    s_nop 0
    v_max_f32 v18, v18, v19
    v_sub_f32 v16, v16, v18
    v_sub_f32 v17, v17, v18
    v_exp_f32 v20, v16
    v_exp_f32 v21, v17
    s_nop 0
    v_add_f32 v18, v20, v21
    s_nop 1
    v_add_f32_dpp v18, v18, v18 row_ror:8 row_mask:0xf bank_mask:0xf
    s_nop 1
    v_add_f32_dpp v18, v18, v18 row_ror:4 row_mask:0xf bank_mask:0xf
    s_nop 1
    v_add_f32_dpp v18, v18, v18 row_ror:2 row_mask:0xf bank_mask:0xf
    s_nop 1
    v_add_f32_dpp v18, v18, v18 row_ror:1 row_mask:0xf bank_mask:0xf
    v_mov_b32 v19, v18
    s_nop 1
    v_permlane16_swap_b32 v18, v19
    s_nop 0
    v_add_f32 v18, v18, v19
    v_rcp_f32 v18, v18
    s_nop 0
    v_mul_f32 v20, v20, v18
    v_mul_f32 v21, v21, v18
    v_cvt_pk_bf16_f32 v20, v20, v21
    v_min_u32 v20, -2, v20
    s_branch LAp_main_kernel_50
LAr_main_kernel_44:
    s_waitcnt lgkmcnt(0)
    s_barrier
    s_branch LA_main_kernel_41
LAo_main_kernel_54:
    s_add_u32 s12, s44, 82182144
    s_addc_u32 s13, s45, 0
    s_and_b32 s13, s13, 0xffff
    s_mov_b32 s14, 186253312
    s_add_u32 s0, s0, 1
    s_cmp_lt_u32 s0, 2
    s_cbranch_scc1 Ltop_main_kernel_40
    s_endpgm
LAw_main_kernel_23:
Ltop_main_kernel_55:
    s_mov_b32 s61, 79822848
    s_mul_i32 s65, s60, 640
    s_add_u32 s65, s65, 80288768
    s_mov_b32 s62, 15597568
    s_mov_b32 s96, 0
    s_mov_b32 s98, 0
    s_cmp_lt_u32 s98, s96
    s_cbranch_scc1 Lgo_main_kernel_57
    s_mov_b32 s70, 2097152
Lgl_main_kernel_58:
    v_lshlrev_b32 v16, 3, v1
    v_and_b32 v17, 0x780, v16
    v_lshrrev_b32 v16, 11, v16
    v_lshl_add_u32 v16, v16, 13, v17
    s_min_u32 s96, s96, 48
    s_lshl_b32 s97, s96, 7
    s_add_u32 s97, s97, 97640448
    buffer_load_dword v17, v16, s[12:15], s97 offen sc1
    s_sub_u32 s70, s70, 1
    s_cbranch_scc1 Lexit_team
    s_waitcnt vmcnt(0)
    v_cmp_ne_u32 vcc, 28, v17
    s_nop 0
    s_or_b32 s97, vcc_lo, vcc_hi
    s_lshr_b32 vcc_lo, s97, 16
    s_or_b32 s97, s97, vcc_lo
    s_or_b32 s97, s97, 0x10000
    s_ff1_i32_b32 s97, s97
    s_add_u32 s96, s96, s97
    s_cmp_ge_u32 s96, 64
    s_cselect_b32 s96, 0x100, s96
    s_cmp_lt_u32 s98, s96
    s_cbranch_scc0 Lgl_main_kernel_58
Lgo_main_kernel_57:
    buffer_load_dwordx4 v[72:75], v6, s[12:15], s62 offen offset:0 sc1
    buffer_load_dwordx4 v[80:83], v6, s[12:15], s62 offen offset:1024 sc1
    buffer_load_dwordx4 v[88:91], v6, s[12:15], s62 offen offset:2048 sc1
    buffer_load_dwordx2 v[96:97], v14, s[12:15], s62 offen sc1
    s_add_u32 s64, s62, 14336
    buffer_load_dwordx4 v[76:79], v6, s[12:15], s64 offen offset:0 sc1
    buffer_load_dwordx4 v[84:87], v6, s[12:15], s64 offen offset:1024 sc1
    buffer_load_dwordx4 v[92:95], v6, s[12:15], s64 offen offset:2048 sc1
    buffer_load_dwordx2 v[98:99], v14, s[12:15], s64 offen sc1
    s_add_u32 s62, s62, 28672
    s_mov_b32 s67, 63
    v_mov_b64 v[56:57], 0
    v_mov_b64 v[58:59], 0
LA_main_kernel_56:
    s_mov_b32 s70, 2097152
    buffer_load_dwordx4 v[44:47], v3, s[12:15], s61 offen sc1
    buffer_load_dwordx4 v[48:51], v4, s[12:15], s61 offen sc1
    v_mov_b64 v[52:53], 0
    v_mov_b64 v[54:55], 0
    v_mov_b64 v[56:57], 0
    v_mov_b64 v[58:59], 0
    v_mov_b64 v[60:61], 0
    v_mov_b64 v[62:63], 0
    v_mov_b64 v[64:65], 0
    v_mov_b64 v[66:67], 0
    v_mov_b64 v[116:117], 0
    v_mov_b64 v[118:119], 0
Lpm_main_kernel_60:
    buffer_load_dwordx4 v[100:103], v3, s[12:15], s61 offen sc1
    buffer_load_dwordx4 v[104:107], v4, s[12:15], s61 offen sc1
    s_sub_u32 s70, s70, 1
    s_cbranch_scc1 Lexit_team
    s_waitcnt vmcnt(2)
    v_max_u32 v114, v44, v48
    v_cmp_eq_u32 vcc, -1, v114
    s_cbranch_vccz Lpg_main_kernel_61
    buffer_load_dwordx4 v[44:47], v3, s[12:15], s61 offen sc1
    buffer_load_dwordx4 v[48:51], v4, s[12:15], s61 offen sc1
    s_waitcnt vmcnt(2)
    v_max_u32 v114, v100, v104
    v_cmp_eq_u32 vcc, -1, v114
    s_cbranch_vccnz Lpm_main_kernel_60
Lpg_main_kernel_62:
    ds_write_b128 v3, v[100:103]
    ds_write_b128 v4, v[104:107]
    v_smfmac_f32_16x16x64_bf16 v[52:55], v[100:103], a[32:39], v2
    v_smfmac_f32_16x16x64_bf16 v[52:55], v[104:107], a[40:47], v2
    v_smfmac_f32_16x16x64_bf16 v[56:59], v[100:103], a[88:95], v2
    v_smfmac_f32_16x16x64_bf16 v[56:59], v[104:107], a[96:103], v2
    s_waitcnt lgkmcnt(0)
    s_barrier
    ds_read_b128 v[16:19], v1 offset:0
    ds_read_b128 v[20:23], v1 offset:1024
    ds_read_b128 v[24:27], v1 offset:2048
    ds_read_b128 v[28:31], v1 offset:3072
    ds_read_b128 v[40:43], v1 offset:6144
    v_smfmac_f32_16x16x64_bf16 v[60:63], v[100:103], a[144:151], v2
    v_smfmac_f32_16x16x64_bf16 v[60:63], v[104:107], a[152:159], v2
    v_smfmac_f32_16x16x64_bf16 v[64:67], v[100:103], a[200:207], v2
    v_smfmac_f32_16x16x64_bf16 v[64:67], v[104:107], a[208:215], v2
    v_smfmac_f32_16x16x64_bf16 v[116:119], v[100:103], v[120:127], v2
    v_smfmac_f32_16x16x64_bf16 v[116:119], v[104:107], v[128:135], v2
    s_branch Lpj_main_kernel_63
Lpg_main_kernel_61:
    ds_write_b128 v3, v[44:47]
    ds_write_b128 v4, v[48:51]
    v_smfmac_f32_16x16x64_bf16 v[52:55], v[44:47], a[32:39], v2
    v_smfmac_f32_16x16x64_bf16 v[52:55], v[48:51], a[40:47], v2
    v_smfmac_f32_16x16x64_bf16 v[56:59], v[44:47], a[88:95], v2
    v_smfmac_f32_16x16x64_bf16 v[56:59], v[48:51], a[96:103], v2
    s_waitcnt lgkmcnt(0)
    s_barrier
    ds_read_b128 v[16:19], v1 offset:0
    ds_read_b128 v[20:23], v1 offset:1024
    ds_read_b128 v[24:27], v1 offset:2048
    ds_read_b128 v[28:31], v1 offset:3072
    ds_read_b128 v[40:43], v1 offset:6144
    v_smfmac_f32_16x16x64_bf16 v[60:63], v[44:47], a[144:151], v2
    v_smfmac_f32_16x16x64_bf16 v[60:63], v[48:51], a[152:159], v2
    v_smfmac_f32_16x16x64_bf16 v[64:67], v[44:47], a[200:207], v2
    v_smfmac_f32_16x16x64_bf16 v[64:67], v[48:51], a[208:215], v2
    v_smfmac_f32_16x16x64_bf16 v[116:119], v[44:47], v[120:127], v2
    v_smfmac_f32_16x16x64_bf16 v[116:119], v[48:51], v[128:135], v2
Lpj_main_kernel_63:
    s_waitcnt lgkmcnt(4)
    v_smfmac_f32_16x16x64_bf16 v[52:55], v[16:19], a[0:7], v2
    s_waitcnt lgkmcnt(3)
    v_smfmac_f32_16x16x64_bf16 v[52:55], v[20:23], a[8:15], v2
    s_waitcnt lgkmcnt(2)
    v_smfmac_f32_16x16x64_bf16 v[52:55], v[24:27], a[16:23], v2
    s_waitcnt lgkmcnt(1)
    v_smfmac_f32_16x16x64_bf16 v[52:55], v[28:31], a[24:31], v2
    s_waitcnt lgkmcnt(0)
    v_smfmac_f32_16x16x64_bf16 v[52:55], v[40:43], a[48:55], v2
    v_smfmac_f32_16x16x64_bf16 v[56:59], v[16:19], a[56:63], v2
    ds_read_b128 v[32:35], v1 offset:4096
    v_smfmac_f32_16x16x64_bf16 v[56:59], v[20:23], a[64:71], v2
    ds_read_b128 v[36:39], v1 offset:5120
    v_smfmac_f32_16x16x64_bf16 v[56:59], v[24:27], a[72:79], v2
    v_cvt_pk_bf16_f32 v114, v52, v53
    v_smfmac_f32_16x16x64_bf16 v[56:59], v[28:31], a[80:87], v2
    v_cvt_pk_bf16_f32 v115, v54, v55
    v_smfmac_f32_16x16x64_bf16 v[56:59], v[40:43], a[104:111], v2
    ds_write_b64 v8, v[114:115] offset:0
    v_smfmac_f32_16x16x64_bf16 v[60:63], v[16:19], a[112:119], v2
    v_mov_b64 v[52:53], 0
    v_smfmac_f32_16x16x64_bf16 v[60:63], v[20:23], a[120:127], v2
    v_mov_b64 v[54:55], 0
    v_smfmac_f32_16x16x64_bf16 v[60:63], v[24:27], a[128:135], v2
    v_cvt_pk_bf16_f32 v114, v56, v57
    v_smfmac_f32_16x16x64_bf16 v[60:63], v[28:31], a[136:143], v2
    v_cvt_pk_bf16_f32 v115, v58, v59
    v_smfmac_f32_16x16x64_bf16 v[60:63], v[40:43], a[160:167], v2
    ds_write_b64 v8, v[114:115] offset:512
    v_smfmac_f32_16x16x64_bf16 v[64:67], v[16:19], a[168:175], v2
    ds_read2_b32 v[112:113], v5 offset0:0 offset1:32
    v_mov_b64 v[56:57], 0
    v_smfmac_f32_16x16x64_bf16 v[64:67], v[20:23], a[176:183], v2
    ds_read2_b32 v[110:111], v15 offset0:1 offset1:33
    v_mov_b64 v[58:59], 0
    v_smfmac_f32_16x16x64_bf16 v[64:67], v[24:27], a[184:191], v2
    v_cvt_pk_bf16_f32 v114, v60, v61
    v_smfmac_f32_16x16x64_bf16 v[64:67], v[28:31], a[192:199], v2
    v_cvt_pk_bf16_f32 v115, v62, v63
    v_smfmac_f32_16x16x64_bf16 v[64:67], v[40:43], a[216:223], v2
    ds_write_b64 v8, v[114:115] offset:1024
    v_smfmac_f32_16x16x64_bf16 v[116:119], v[16:19], a[224:231], v2
    ds_read_b64_tr_b16 v[68:69], v9 offset:1024
    v_smfmac_f32_16x16x64_bf16 v[116:119], v[20:23], a[232:239], v2
    s_waitcnt vmcnt(0)
    ds_read2_b32 v[100:101], v7 offset0:0 offset1:32
    v_smfmac_f32_16x16x64_bf16 v[116:119], v[24:27], a[240:247], v2
    ds_read2_b32 v[102:103], v7 offset0:1 offset1:33
    v_cvt_pk_bf16_f32 v114, v64, v65
    v_smfmac_f32_16x16x64_bf16 v[116:119], v[28:31], a[248:255], v2
    ds_read2_b32 v[104:105], v7 offset0:128 offset1:160
    v_cvt_pk_bf16_f32 v115, v66, v67
    v_smfmac_f32_16x16x64_bf16 v[116:119], v[40:43], v[136:143], v2
    ds_write_b64 v8, v[114:115] offset:1536
    v_smfmac_f32_16x16x64_bf16 v[52:55], v[16:19], v[144:151], v2
    ds_read_b64_tr_b16 v[70:71], v9 offset:1536
    v_smfmac_f32_16x16x64_bf16 v[52:55], v[20:23], v[152:159], v2
    ds_read2_b32 v[106:107], v7 offset0:129 offset1:161
    v_smfmac_f32_16x16x64_bf16 v[52:55], v[24:27], v[160:167], v2
    ds_read2_b32 v[108:109], v15 offset0:0 offset1:32
    v_cvt_pk_bf16_f32 v114, v116, v117
    v_smfmac_f32_16x16x64_bf16 v[52:55], v[28:31], v[168:175], v2
    v_cvt_pk_bf16_f32 v115, v118, v119
    v_smfmac_f32_16x16x64_bf16 v[52:55], v[40:43], v[192:199], v2
    ds_write_b64 v8, v[114:115] offset:2048
    s_waitcnt lgkmcnt(6)
    v_smfmac_f32_16x16x64_bf16 v[52:55], v[32:35], v[176:183], v2
    ds_read_b64_tr_b16 v[64:65], v9 offset:2048
    v_smfmac_f32_16x16x64_bf16 v[52:55], v[36:39], v[184:191], v2
    ds_read_b64_tr_b16 v[60:61], v9
    v_smfmac_f32_16x16x64_bf16 v[56:59], v[16:19], v[200:207], v2
    ds_read_b64_tr_b16 v[62:63], v9 offset:512
    v_smfmac_f32_16x16x64_bf16 v[56:59], v[20:23], v[208:215], v2
    v_smfmac_f32_16x16x64_bf16 v[56:59], v[24:27], v[216:223], v2
    v_cvt_pk_bf16_f32 v114, v52, v53
    v_smfmac_f32_16x16x64_bf16 v[56:59], v[28:31], v[224:231], v2
    v_cvt_pk_bf16_f32 v115, v54, v55
    v_smfmac_f32_16x16x64_bf16 v[56:59], v[40:43], v[248:255], v2
    ds_write_b64 v8, v[114:115] offset:2560
    v_smfmac_f32_16x16x64_bf16 v[56:59], v[32:35], v[232:239], v2
    ds_read_b64_tr_b16 v[66:67], v9 offset:2560
    v_smfmac_f32_16x16x64_bf16 v[56:59], v[36:39], v[240:247], v2
    s_waitcnt lgkmcnt(2)
    v_mfma_f32_16x16x32_bf16 v[44:47], v[80:83], v[68:71], 0
    v_mfma_f32_16x16x32_bf16 v[48:51], v[84:87], v[68:71], 0
    s_nop 1
    v_cvt_pk_bf16_f32 v114, v56, v57
    v_cvt_pk_bf16_f32 v115, v58, v59
    v_mfma_f32_16x16x32_bf16 v[116:119], v[104:107], v[68:71], 0
    ds_write_b64 v8, v[114:115] offset:3072
    ds_read_b64_tr_b16 v[114:115], v9 offset:3072
    v_mfma_f32_16x16x32_bf16 v[44:47], v[72:75], v[60:63], v[44:47]
    v_max3_u32 v56, v16, v17, v18
    v_max3_u32 v56, v56, v19, v20
    v_mfma_f32_16x16x32_bf16 v[48:51], v[76:79], v[60:63], v[48:51]
    v_max3_u32 v56, v56, v21, v22
    v_max3_u32 v56, v56, v23, v24
    v_mfma_f32_16x16x32_bf16 v[116:119], v[100:103], v[60:63], v[116:119]
    v_max3_u32 v56, v56, v25, v26
    v_max3_u32 v56, v56, v27, v28
    s_waitcnt lgkmcnt(2)
    v_mfma_f32_16x16x32_bf16 v[44:47], v[88:91], v[64:67], v[44:47]
    v_max3_u32 v56, v56, v29, v30
    v_max3_u32 v56, v56, v31, v32
    v_mfma_f32_16x16x32_bf16 v[48:51], v[92:95], v[64:67], v[48:51]
    v_max3_u32 v56, v56, v33, v34
    v_max3_u32 v56, v56, v35, v36
    v_mfma_f32_16x16x32_bf16 v[116:119], v[108:111], v[64:67], v[116:119]
    v_max3_u32 v56, v56, v37, v38
    v_max3_u32 v56, v56, v39, v40
    s_waitcnt lgkmcnt(0)
    v_mfma_f32_16x16x16_bf16 v[44:47], v[96:97], v[114:115], v[44:47]
    v_mfma_f32_16x16x16_bf16 v[48:51], v[98:99], v[114:115], v[48:51]
    v_max3_u32 v56, v56, v41, v42
    v_mfma_f32_16x16x16_bf16 v[116:119], v[112:113], v[114:115], v[116:119]
    v_max_u32 v56, v56, v43
    v_cmp_eq_u32 vcc, -1, v56
    v_add_f32_dpp v64, v44, v44 row_ror:8 row_mask:0xf bank_mask:0x3
    v_add_f32_dpp v65, v45, v45 row_ror:8 row_mask:0xf bank_mask:0x3
    v_add_f32_dpp v66, v46, v46 row_ror:8 row_mask:0xf bank_mask:0x3
    v_add_f32_dpp v67, v47, v47 row_ror:8 row_mask:0xf bank_mask:0x3
    v_add_f32_dpp v64, v48, v48 row_ror:8 row_mask:0xf bank_mask:0xc
    v_add_f32_dpp v65, v49, v49 row_ror:8 row_mask:0xf bank_mask:0xc
    v_add_f32_dpp v66, v50, v50 row_ror:8 row_mask:0xf bank_mask:0xc
    v_add_f32_dpp v67, v51, v51 row_ror:8 row_mask:0xf bank_mask:0xc
    ds_write_b128 v10, v[64:67]
    v_add_f32_dpp v68, v116, v116 row_ror:8 row_mask:0x3 bank_mask:0x3
    v_add_f32_dpp v68, v117, v117 row_ror:8 row_mask:0x3 bank_mask:0xc
    v_add_f32_dpp v68, v118, v118 row_ror:8 row_mask:0xc bank_mask:0x3
    v_add_f32_dpp v68, v119, v119 row_ror:8 row_mask:0xc bank_mask:0xc
    ds_write_b32 v11, v68
    s_cbranch_vccnz LAr_main_kernel_59
    s_waitcnt lgkmcnt(0)
    s_barrier
    ds_read_b64 v[16:17], v12 offset:0
    ds_read_b64 v[18:19], v12 offset:1408
    ds_read_b64 v[20:21], v12 offset:2816
    ds_read_b64 v[22:23], v12 offset:4224
    s_waitcnt lgkmcnt(2)
    v_pk_add_f32 v[16:17], v[16:17], v[18:19]
    s_waitcnt lgkmcnt(0)
    v_pk_add_f32 v[20:21], v[20:21], v[22:23]
    v_pk_add_f32 v[16:17], v[16:17], v[20:21]
    v_exp_f32 v20, v16
    v_exp_f32 v21, v17
    s_nop 0
    v_add_f32 v18, v20, v21
    s_nop 1
    v_add_f32_dpp v18, v18, v18 row_ror:8 row_mask:0xf bank_mask:0xf
    s_nop 1
    v_add_f32_dpp v18, v18, v18 row_ror:4 row_mask:0xf bank_mask:0xf
    s_nop 1
    v_add_f32_dpp v18, v18, v18 row_ror:2 row_mask:0xf bank_mask:0xf
    s_nop 1
    v_add_f32_dpp v18, v18, v18 row_ror:1 row_mask:0xf bank_mask:0xf
    v_mov_b32 v19, v18
    s_nop 1
    v_permlane16_swap_b32 v18, v19
    s_nop 0
    v_add_f32 v18, v18, v19
    v_med3_f32 v19, v18, s56, v0
    v_cmp_neq_f32 vcc, v19, v18
    v_rcp_f32 v18, v18
    s_nop 0
    v_mul_f32 v20, v20, v18
    v_mul_f32 v21, v21, v18
    v_cvt_pk_bf16_f32 v20, v20, v21
    v_min_u32 v20, -2, v20
    s_cbranch_vccnz LAm_main_kernel_64
LAp_main_kernel_65:
    buffer_store_dword v20, v13, s[12:15], s65 offen
    s_cmp_eq_u32 s1, 0
    s_cbranch_scc1 Lpub_main_kernel_66
    buffer_store_dword v20, v13, s[12:15], s65 offen sc1
Lpub_main_kernel_66:
    s_barrier
    s_add_u32 s98, s98, 1
    s_cmp_lt_u32 s98, s96
    s_cbranch_scc1 Lgo_main_kernel_67
    s_mov_b32 s70, 2097152
Lgl_main_kernel_68:
    v_lshlrev_b32 v24, 3, v1
    v_and_b32 v25, 0x780, v24
    v_lshrrev_b32 v24, 11, v24
    v_lshl_add_u32 v24, v24, 13, v25
    s_min_u32 s96, s96, 48
    s_lshl_b32 s97, s96, 7
    s_add_u32 s97, s97, 97640448
    buffer_load_dword v25, v24, s[12:15], s97 offen sc1
    s_sub_u32 s70, s70, 1
    s_cbranch_scc1 Lexit_team
    s_waitcnt vmcnt(0)
    v_cmp_ne_u32 vcc, 28, v25
    s_nop 0
    s_or_b32 s97, vcc_lo, vcc_hi
    s_lshr_b32 vcc_lo, s97, 16
    s_or_b32 s97, s97, vcc_lo
    s_or_b32 s97, s97, 0x10000
    s_ff1_i32_b32 s97, s97
    s_add_u32 s96, s96, s97
    s_cmp_ge_u32 s96, 64
    s_cselect_b32 s96, 0x100, s96
    s_cmp_lt_u32 s98, s96
    s_cbranch_scc0 Lgl_main_kernel_68
Lgo_main_kernel_67:
    buffer_load_dwordx4 v[72:75], v6, s[12:15], s62 offen offset:0 sc1
    buffer_load_dwordx4 v[80:83], v6, s[12:15], s62 offen offset:1024 sc1
    buffer_load_dwordx4 v[88:91], v6, s[12:15], s62 offen offset:2048 sc1
    buffer_load_dwordx2 v[96:97], v14, s[12:15], s62 offen sc1
    s_add_u32 s64, s62, 14336
    buffer_load_dwordx4 v[76:79], v6, s[12:15], s64 offen offset:0 sc1
    buffer_load_dwordx4 v[84:87], v6, s[12:15], s64 offen offset:1024 sc1
    buffer_load_dwordx4 v[92:95], v6, s[12:15], s64 offen offset:2048 sc1
    buffer_load_dwordx2 v[98:99], v14, s[12:15], s64 offen sc1
    s_add_u32 s62, s62, 28672
    s_add_u32 s65, s65, 10240
    s_add_u32 s61, s61, 7168
    s_sub_u32 s67, s67, 1
    s_cmp_lg_u32 s67, 0
    s_cbranch_scc1 LA_main_kernel_56
    s_branch LAo_main_kernel_69
LAm_main_kernel_64:
    v_max_f32 v18, v16, v17
    s_nop 1
    v_max_f32_dpp v18, v18, v18 row_ror:8 row_mask:0xf bank_mask:0xf
    s_nop 1
    v_max_f32_dpp v18, v18, v18 row_ror:4 row_mask:0xf bank_mask:0xf
    s_nop 1
    v_max_f32_dpp v18, v18, v18 row_ror:2 row_mask:0xf bank_mask:0xf
    s_nop 1
    v_max_f32_dpp v18, v18, v18 row_ror:1 row_mask:0xf bank_mask:0xf
    v_mov_b32 v19, v18
    s_nop 1
    v_permlane16_swap_b32 v18, v19
    s_nop 0
    v_max_f32 v18, v18, v19
    v_sub_f32 v16, v16, v18
    v_sub_f32 v17, v17, v18
    v_exp_f32 v20, v16
    v_exp_f32 v21, v17
    s_nop 0
    v_add_f32 v18, v20, v21
    s_nop 1
    v_add_f32_dpp v18, v18, v18 row_ror:8 row_mask:0xf bank_mask:0xf
    s_nop 1
    v_add_f32_dpp v18, v18, v18 row_ror:4 row_mask:0xf bank_mask:0xf
    s_nop 1
    v_add_f32_dpp v18, v18, v18 row_ror:2 row_mask:0xf bank_mask:0xf
    s_nop 1
    v_add_f32_dpp v18, v18, v18 row_ror:1 row_mask:0xf bank_mask:0xf
    v_mov_b32 v19, v18
    s_nop 1
    v_permlane16_swap_b32 v18, v19
    s_nop 0
    v_add_f32 v18, v18, v19
    v_rcp_f32 v18, v18
    s_nop 0
    v_mul_f32 v20, v20, v18
    v_mul_f32 v21, v21, v18
    v_cvt_pk_bf16_f32 v20, v20, v21
    v_min_u32 v20, -2, v20
    s_branch LAp_main_kernel_65
LAr_main_kernel_59:
    s_waitcnt lgkmcnt(0)
    s_barrier
    s_branch LA_main_kernel_56
LAo_main_kernel_69:
    s_add_u32 s12, s44, 82182144
    s_addc_u32 s13, s45, 0
    s_and_b32 s13, s13, 0xffff
    s_mov_b32 s14, 186253312
    s_add_u32 s0, s0, 1
    s_cmp_lt_u32 s0, 2
    s_cbranch_scc1 Ltop_main_kernel_55
    s_endpgm
LAw_main_kernel_24:
Ltop_main_kernel_70:
    s_mov_b32 s61, 79822848
    s_mul_i32 s65, s60, 640
    s_add_u32 s65, s65, 80288768
    s_mov_b32 s62, 15597568
    s_mov_b32 s96, 0
    s_mov_b32 s98, 0
    s_cmp_lt_u32 s98, s96
    s_cbranch_scc1 Lgo_main_kernel_72
    s_mov_b32 s70, 2097152
Lgl_main_kernel_73:
    v_lshlrev_b32 v16, 3, v1
    v_and_b32 v17, 0x780, v16
    v_lshrrev_b32 v16, 11, v16
    v_lshl_add_u32 v16, v16, 13, v17
    s_min_u32 s96, s96, 48
    s_lshl_b32 s97, s96, 7
    s_add_u32 s97, s97, 97640448
    buffer_load_dword v17, v16, s[12:15], s97 offen sc1
    s_sub_u32 s70, s70, 1
    s_cbranch_scc1 Lexit_team
    s_waitcnt vmcnt(0)
    v_cmp_ne_u32 vcc, 28, v17
    s_nop 0
    s_or_b32 s97, vcc_lo, vcc_hi
    s_lshr_b32 vcc_lo, s97, 16
    s_or_b32 s97, s97, vcc_lo
    s_or_b32 s97, s97, 0x10000
    s_ff1_i32_b32 s97, s97
    s_add_u32 s96, s96, s97
    s_cmp_ge_u32 s96, 64
    s_cselect_b32 s96, 0x100, s96
    s_cmp_lt_u32 s98, s96
    s_cbranch_scc0 Lgl_main_kernel_73
Lgo_main_kernel_72:
    buffer_load_dwordx4 v[72:75], v6, s[12:15], s62 offen offset:0 sc1
    buffer_load_dwordx4 v[80:83], v6, s[12:15], s62 offen offset:1024 sc1
    buffer_load_dwordx4 v[88:91], v6, s[12:15], s62 offen offset:2048 sc1
    buffer_load_dwordx2 v[96:97], v14, s[12:15], s62 offen sc1
    s_add_u32 s64, s62, 14336
    buffer_load_dwordx4 v[76:79], v6, s[12:15], s64 offen offset:0 sc1
    buffer_load_dwordx4 v[84:87], v6, s[12:15], s64 offen offset:1024 sc1
    buffer_load_dwordx4 v[92:95], v6, s[12:15], s64 offen offset:2048 sc1
    buffer_load_dwordx2 v[98:99], v14, s[12:15], s64 offen sc1
    s_add_u32 s62, s62, 28672
    s_mov_b32 s67, 63
    v_mov_b64 v[56:57], 0
    v_mov_b64 v[58:59], 0
LA_main_kernel_71:
    s_mov_b32 s70, 2097152
    buffer_load_dwordx4 v[44:47], v3, s[12:15], s61 offen sc1
    buffer_load_dwordx4 v[48:51], v4, s[12:15], s61 offen sc1
    v_mov_b64 v[52:53], 0
    v_mov_b64 v[54:55], 0
    v_mov_b64 v[56:57], 0
    v_mov_b64 v[58:59], 0
    v_mov_b64 v[60:61], 0
    v_mov_b64 v[62:63], 0
    v_mov_b64 v[64:65], 0
    v_mov_b64 v[66:67], 0
    v_mov_b64 v[116:117], 0
    v_mov_b64 v[118:119], 0
Lpm_main_kernel_75:
    buffer_load_dwordx4 v[100:103], v3, s[12:15], s61 offen sc1
    buffer_load_dwordx4 v[104:107], v4, s[12:15], s61 offen sc1
    s_sub_u32 s70, s70, 1
    s_cbranch_scc1 Lexit_team
    s_waitcnt vmcnt(2)
    v_max3_u32 v114, v44, v48, v49
    v_max3_u32 v114, v114, v50, v51
    v_cmp_eq_u32 vcc, -1, v114
    s_cbranch_vccz Lpg_main_kernel_76
    buffer_load_dwordx4 v[44:47], v3, s[12:15], s61 offen sc1
    buffer_load_dwordx4 v[48:51], v4, s[12:15], s61 offen sc1
    s_waitcnt vmcnt(2)
    v_max3_u32 v114, v100, v104, v105
    v_max3_u32 v114, v114, v106, v107
    v_cmp_eq_u32 vcc, -1, v114
    s_cbranch_vccnz Lpm_main_kernel_75
Lpg_main_kernel_77:
    ds_write_b128 v3, v[100:103]
    v_smfmac_f32_16x16x64_bf16 v[52:55], v[100:103], a[48:55], v2
    v_smfmac_f32_16x16x64_bf16 v[52:55], v[104:107], a[0:7], v2
    v_smfmac_f32_16x16x64_bf16 v[56:59], v[100:103], a[104:111], v2
    v_smfmac_f32_16x16x64_bf16 v[56:59], v[104:107], a[56:63], v2
    s_waitcnt lgkmcnt(0)
    s_barrier
    ds_read_b128 v[20:23], v1 offset:1024
    ds_read_b128 v[24:27], v1 offset:2048
    ds_read_b128 v[28:31], v1 offset:3072
    ds_read_b128 v[32:35], v1 offset:4096
    ds_read_b128 v[36:39], v1 offset:5120
    v_smfmac_f32_16x16x64_bf16 v[60:63], v[100:103], a[160:167], v2
    v_smfmac_f32_16x16x64_bf16 v[60:63], v[104:107], a[112:119], v2
    v_smfmac_f32_16x16x64_bf16 v[64:67], v[100:103], a[216:223], v2
    v_smfmac_f32_16x16x64_bf16 v[64:67], v[104:107], a[168:175], v2
    v_smfmac_f32_16x16x64_bf16 v[116:119], v[100:103], v[136:143], v2
    v_smfmac_f32_16x16x64_bf16 v[116:119], v[104:107], a[224:231], v2
    s_branch Lpj_main_kernel_78
Lpg_main_kernel_76:
    ds_write_b128 v3, v[44:47]
    v_smfmac_f32_16x16x64_bf16 v[52:55], v[44:47], a[48:55], v2
    v_smfmac_f32_16x16x64_bf16 v[52:55], v[48:51], a[0:7], v2
    v_smfmac_f32_16x16x64_bf16 v[56:59], v[44:47], a[104:111], v2
    v_smfmac_f32_16x16x64_bf16 v[56:59], v[48:51], a[56:63], v2
    s_waitcnt lgkmcnt(0)
    s_barrier
    ds_read_b128 v[20:23], v1 offset:1024
    ds_read_b128 v[24:27], v1 offset:2048
    ds_read_b128 v[28:31], v1 offset:3072
    ds_read_b128 v[32:35], v1 offset:4096
    ds_read_b128 v[36:39], v1 offset:5120
    v_smfmac_f32_16x16x64_bf16 v[60:63], v[44:47], a[160:167], v2
    v_smfmac_f32_16x16x64_bf16 v[60:63], v[48:51], a[112:119], v2
    v_smfmac_f32_16x16x64_bf16 v[64:67], v[44:47], a[216:223], v2
    v_smfmac_f32_16x16x64_bf16 v[64:67], v[48:51], a[168:175], v2
    v_smfmac_f32_16x16x64_bf16 v[116:119], v[44:47], v[136:143], v2
    v_smfmac_f32_16x16x64_bf16 v[116:119], v[48:51], a[224:231], v2
Lpj_main_kernel_78:
    s_waitcnt lgkmcnt(4)
    v_smfmac_f32_16x16x64_bf16 v[52:55], v[20:23], a[8:15], v2
    s_waitcnt lgkmcnt(3)
    v_smfmac_f32_16x16x64_bf16 v[52:55], v[24:27], a[16:23], v2
    s_waitcnt lgkmcnt(2)
    v_smfmac_f32_16x16x64_bf16 v[52:55], v[28:31], a[24:31], v2
    s_waitcnt lgkmcnt(1)
    v_smfmac_f32_16x16x64_bf16 v[52:55], v[32:35], a[32:39], v2
    s_waitcnt lgkmcnt(0)
    v_smfmac_f32_16x16x64_bf16 v[52:55], v[36:39], a[40:47], v2
    v_smfmac_f32_16x16x64_bf16 v[56:59], v[20:23], a[64:71], v2
    ds_read_b128 v[40:43], v1 offset:6144
    v_smfmac_f32_16x16x64_bf16 v[56:59], v[24:27], a[72:79], v2
    ds_read_b128 v[16:19], v1 offset:0
    v_smfmac_f32_16x16x64_bf16 v[56:59], v[28:31], a[80:87], v2
    v_cvt_pk_bf16_f32 v114, v52, v53
    v_smfmac_f32_16x16x64_bf16 v[56:59], v[32:35], a[88:95], v2
    v_cvt_pk_bf16_f32 v115, v54, v55
    v_smfmac_f32_16x16x64_bf16 v[56:59], v[36:39], a[96:103], v2
    ds_write_b64 v8, v[114:115] offset:0
    v_smfmac_f32_16x16x64_bf16 v[60:63], v[20:23], a[120:127], v2
    v_mov_b64 v[52:53], 0
    v_smfmac_f32_16x16x64_bf16 v[60:63], v[24:27], a[128:135], v2
    v_mov_b64 v[54:55], 0
    v_smfmac_f32_16x16x64_bf16 v[60:63], v[28:31], a[136:143], v2
    v_cvt_pk_bf16_f32 v114, v56, v57
    v_smfmac_f32_16x16x64_bf16 v[60:63], v[32:35], a[144:151], v2
    v_cvt_pk_bf16_f32 v115, v58, v59
    v_smfmac_f32_16x16x64_bf16 v[60:63], v[36:39], a[152:159], v2
    ds_write_b64 v8, v[114:115] offset:512
    v_smfmac_f32_16x16x64_bf16 v[64:67], v[20:23], a[176:183], v2
    ds_read2_b32 v[112:113], v5 offset0:0 offset1:32
    v_mov_b64 v[56:57], 0
    v_smfmac_f32_16x16x64_bf16 v[64:67], v[24:27], a[184:191], v2
    ds_read2_b32 v[110:111], v15 offset0:1 offset1:33
    v_mov_b64 v[58:59], 0
    v_smfmac_f32_16x16x64_bf16 v[64:67], v[28:31], a[192:199], v2
    v_cvt_pk_bf16_f32 v114, v60, v61
    v_smfmac_f32_16x16x64_bf16 v[64:67], v[32:35], a[200:207], v2
    v_cvt_pk_bf16_f32 v115, v62, v63
    v_smfmac_f32_16x16x64_bf16 v[64:67], v[36:39], a[208:215], v2
    ds_write_b64 v8, v[114:115] offset:1024
    v_smfmac_f32_16x16x64_bf16 v[116:119], v[20:23], a[232:239], v2
    ds_read_b64_tr_b16 v[68:69], v9 offset:1024
    v_smfmac_f32_16x16x64_bf16 v[116:119], v[24:27], a[240:247], v2
    s_waitcnt vmcnt(0)
    ds_read2_b32 v[100:101], v7 offset0:0 offset1:32
    v_smfmac_f32_16x16x64_bf16 v[116:119], v[28:31], a[248:255], v2
    ds_read2_b32 v[102:103], v7 offset0:1 offset1:33
    v_cvt_pk_bf16_f32 v114, v64, v65
    v_smfmac_f32_16x16x64_bf16 v[116:119], v[32:35], v[120:127], v2
    ds_read2_b32 v[104:105], v7 offset0:128 offset1:160
    v_cvt_pk_bf16_f32 v115, v66, v67
    v_smfmac_f32_16x16x64_bf16 v[116:119], v[36:39], v[128:135], v2
    ds_write_b64 v8, v[114:115] offset:1536
    v_smfmac_f32_16x16x64_bf16 v[52:55], v[20:23], v[152:159], v2
    ds_read_b64_tr_b16 v[70:71], v9 offset:1536
    v_smfmac_f32_16x16x64_bf16 v[52:55], v[24:27], v[160:167], v2
    ds_read2_b32 v[106:107], v7 offset0:129 offset1:161
    v_smfmac_f32_16x16x64_bf16 v[52:55], v[28:31], v[168:175], v2
    ds_read2_b32 v[108:109], v15 offset0:0 offset1:32
    v_cvt_pk_bf16_f32 v114, v116, v117
    v_smfmac_f32_16x16x64_bf16 v[52:55], v[32:35], v[176:183], v2
    v_cvt_pk_bf16_f32 v115, v118, v119
    v_smfmac_f32_16x16x64_bf16 v[52:55], v[36:39], v[184:191], v2
    ds_write_b64 v8, v[114:115] offset:2048
    s_waitcnt lgkmcnt(6)
    v_smfmac_f32_16x16x64_bf16 v[52:55], v[40:43], v[192:199], v2
    ds_read_b64_tr_b16 v[64:65], v9 offset:2048
    v_smfmac_f32_16x16x64_bf16 v[52:55], v[16:19], v[144:151], v2
    ds_read_b64_tr_b16 v[60:61], v9
    v_smfmac_f32_16x16x64_bf16 v[56:59], v[20:23], v[208:215], v2
    ds_read_b64_tr_b16 v[62:63], v9 offset:512
    v_smfmac_f32_16x16x64_bf16 v[56:59], v[24:27], v[216:223], v2
    v_smfmac_f32_16x16x64_bf16 v[56:59], v[28:31], v[224:231], v2
    v_cvt_pk_bf16_f32 v114, v52, v53
    v_smfmac_f32_16x16x64_bf16 v[56:59], v[32:35], v[232:239], v2
    v_cvt_pk_bf16_f32 v115, v54, v55
    v_smfmac_f32_16x16x64_bf16 v[56:59], v[36:39], v[240:247], v2
    ds_write_b64 v8, v[114:115] offset:2560
    v_smfmac_f32_16x16x64_bf16 v[56:59], v[40:43], v[248:255], v2
    ds_read_b64_tr_b16 v[66:67], v9 offset:2560
    v_smfmac_f32_16x16x64_bf16 v[56:59], v[16:19], v[200:207], v2
    s_waitcnt lgkmcnt(2)
    v_mfma_f32_16x16x32_bf16 v[44:47], v[80:83], v[68:71], 0
    v_mfma_f32_16x16x32_bf16 v[48:51], v[84:87], v[68:71], 0
    s_nop 1
    v_cvt_pk_bf16_f32 v114, v56, v57
    v_cvt_pk_bf16_f32 v115, v58, v59
    v_mfma_f32_16x16x32_bf16 v[116:119], v[104:107], v[68:71], 0
    ds_write_b64 v8, v[114:115] offset:3072
    ds_read_b64_tr_b16 v[114:115], v9 offset:3072
    v_mfma_f32_16x16x32_bf16 v[44:47], v[72:75], v[60:63], v[44:47]
    v_max3_u32 v56, v16, v17, v18
    v_max3_u32 v56, v56, v19, v20
    v_mfma_f32_16x16x32_bf16 v[48:51], v[76:79], v[60:63], v[48:51]
    v_max3_u32 v56, v56, v21, v22
    v_max3_u32 v56, v56, v23, v24
    v_mfma_f32_16x16x32_bf16 v[116:119], v[100:103], v[60:63], v[116:119]
    v_max3_u32 v56, v56, v25, v26
    v_max3_u32 v56, v56, v27, v28
    s_waitcnt lgkmcnt(2)
    v_mfma_f32_16x16x32_bf16 v[44:47], v[88:91], v[64:67], v[44:47]
    v_max3_u32 v56, v56, v29, v30
    v_max3_u32 v56, v56, v31, v32
    v_mfma_f32_16x16x32_bf16 v[48:51], v[92:95], v[64:67], v[48:51]
    v_max3_u32 v56, v56, v33, v34
    v_max3_u32 v56, v56, v35, v36
    v_mfma_f32_16x16x32_bf16 v[116:119], v[108:111], v[64:67], v[116:119]
    v_max3_u32 v56, v56, v37, v38
    v_max3_u32 v56, v56, v39, v40
    s_waitcnt lgkmcnt(0)
    v_mfma_f32_16x16x16_bf16 v[44:47], v[96:97], v[114:115], v[44:47]
    v_mfma_f32_16x16x16_bf16 v[48:51], v[98:99], v[114:115], v[48:51]
    v_max3_u32 v56, v56, v41, v42
    v_mfma_f32_16x16x16_bf16 v[116:119], v[112:113], v[114:115], v[116:119]
    v_max_u32 v56, v56, v43
    v_cmp_eq_u32 vcc, -1, v56
    v_add_f32_dpp v64, v44, v44 row_ror:8 row_mask:0xf bank_mask:0x3
    v_add_f32_dpp v65, v45, v45 row_ror:8 row_mask:0xf bank_mask:0x3
    v_add_f32_dpp v66, v46, v46 row_ror:8 row_mask:0xf bank_mask:0x3
    v_add_f32_dpp v67, v47, v47 row_ror:8 row_mask:0xf bank_mask:0x3
    v_add_f32_dpp v64, v48, v48 row_ror:8 row_mask:0xf bank_mask:0xc
    v_add_f32_dpp v65, v49, v49 row_ror:8 row_mask:0xf bank_mask:0xc
    v_add_f32_dpp v66, v50, v50 row_ror:8 row_mask:0xf bank_mask:0xc
    v_add_f32_dpp v67, v51, v51 row_ror:8 row_mask:0xf bank_mask:0xc
    ds_write_b128 v10, v[64:67]
    v_add_f32_dpp v68, v116, v116 row_ror:8 row_mask:0x3 bank_mask:0x3
    v_add_f32_dpp v68, v117, v117 row_ror:8 row_mask:0x3 bank_mask:0xc
    v_add_f32_dpp v68, v118, v118 row_ror:8 row_mask:0xc bank_mask:0x3
    v_add_f32_dpp v68, v119, v119 row_ror:8 row_mask:0xc bank_mask:0xc
    ds_write_b32 v11, v68
    s_cbranch_vccnz LAr_main_kernel_74
    s_waitcnt lgkmcnt(0)
    s_barrier
    ds_read_b64 v[16:17], v12 offset:0
    ds_read_b64 v[18:19], v12 offset:1408
    ds_read_b64 v[20:21], v12 offset:2816
    ds_read_b64 v[22:23], v12 offset:4224
    s_waitcnt lgkmcnt(2)
    v_pk_add_f32 v[16:17], v[16:17], v[18:19]
    s_waitcnt lgkmcnt(0)
    v_pk_add_f32 v[20:21], v[20:21], v[22:23]
    v_pk_add_f32 v[16:17], v[16:17], v[20:21]
    v_exp_f32 v20, v16
    v_exp_f32 v21, v17
    s_nop 0
    v_add_f32 v18, v20, v21
    s_nop 1
    v_add_f32_dpp v18, v18, v18 row_ror:8 row_mask:0xf bank_mask:0xf
    s_nop 1
    v_add_f32_dpp v18, v18, v18 row_ror:4 row_mask:0xf bank_mask:0xf
    s_nop 1
    v_add_f32_dpp v18, v18, v18 row_ror:2 row_mask:0xf bank_mask:0xf
    s_nop 1
    v_add_f32_dpp v18, v18, v18 row_ror:1 row_mask:0xf bank_mask:0xf
    v_mov_b32 v19, v18
    s_nop 1
    v_permlane16_swap_b32 v18, v19
    s_nop 0
    v_add_f32 v18, v18, v19
    v_med3_f32 v19, v18, s56, v0
    v_cmp_neq_f32 vcc, v19, v18
    v_rcp_f32 v18, v18
    s_nop 0
    v_mul_f32 v20, v20, v18
    v_mul_f32 v21, v21, v18
    v_cvt_pk_bf16_f32 v20, v20, v21
    v_min_u32 v20, -2, v20
    s_cbranch_vccnz LAm_main_kernel_79
LAp_main_kernel_80:
    buffer_store_dword v20, v13, s[12:15], s65 offen
    s_cmp_eq_u32 s1, 0
    s_cbranch_scc1 Lpub_main_kernel_81
    buffer_store_dword v20, v13, s[12:15], s65 offen sc1
Lpub_main_kernel_81:
    s_barrier
    s_add_u32 s98, s98, 1
    s_cmp_lt_u32 s98, s96
    s_cbranch_scc1 Lgo_main_kernel_82
    s_mov_b32 s70, 2097152
Lgl_main_kernel_83:
    v_lshlrev_b32 v24, 3, v1
    v_and_b32 v25, 0x780, v24
    v_lshrrev_b32 v24, 11, v24
    v_lshl_add_u32 v24, v24, 13, v25
    s_min_u32 s96, s96, 48
    s_lshl_b32 s97, s96, 7
    s_add_u32 s97, s97, 97640448
    buffer_load_dword v25, v24, s[12:15], s97 offen sc1
    s_sub_u32 s70, s70, 1
    s_cbranch_scc1 Lexit_team
    s_waitcnt vmcnt(0)
    v_cmp_ne_u32 vcc, 28, v25
    s_nop 0
    s_or_b32 s97, vcc_lo, vcc_hi
    s_lshr_b32 vcc_lo, s97, 16
    s_or_b32 s97, s97, vcc_lo
    s_or_b32 s97, s97, 0x10000
    s_ff1_i32_b32 s97, s97
    s_add_u32 s96, s96, s97
    s_cmp_ge_u32 s96, 64
    s_cselect_b32 s96, 0x100, s96
    s_cmp_lt_u32 s98, s96
    s_cbranch_scc0 Lgl_main_kernel_83
Lgo_main_kernel_82:
    buffer_load_dwordx4 v[72:75], v6, s[12:15], s62 offen offset:0 sc1
    buffer_load_dwordx4 v[80:83], v6, s[12:15], s62 offen offset:1024 sc1
    buffer_load_dwordx4 v[88:91], v6, s[12:15], s62 offen offset:2048 sc1
    buffer_load_dwordx2 v[96:97], v14, s[12:15], s62 offen sc1
    s_add_u32 s64, s62, 14336
    buffer_load_dwordx4 v[76:79], v6, s[12:15], s64 offen offset:0 sc1
    buffer_load_dwordx4 v[84:87], v6, s[12:15], s64 offen offset:1024 sc1
    buffer_load_dwordx4 v[92:95], v6, s[12:15], s64 offen offset:2048 sc1
    buffer_load_dwordx2 v[98:99], v14, s[12:15], s64 offen sc1
    s_add_u32 s62, s62, 28672
    s_add_u32 s65, s65, 10240
    s_add_u32 s61, s61, 7168
    s_sub_u32 s67, s67, 1
    s_cmp_lg_u32 s67, 0
    s_cbranch_scc1 LA_main_kernel_71
    s_branch LAo_main_kernel_84
LAm_main_kernel_79:
    v_max_f32 v18, v16, v17
    s_nop 1
    v_max_f32_dpp v18, v18, v18 row_ror:8 row_mask:0xf bank_mask:0xf
    s_nop 1
    v_max_f32_dpp v18, v18, v18 row_ror:4 row_mask:0xf bank_mask:0xf
    s_nop 1
    v_max_f32_dpp v18, v18, v18 row_ror:2 row_mask:0xf bank_mask:0xf
    s_nop 1
    v_max_f32_dpp v18, v18, v18 row_ror:1 row_mask:0xf bank_mask:0xf
    v_mov_b32 v19, v18
    s_nop 1
    v_permlane16_swap_b32 v18, v19
    s_nop 0
    v_max_f32 v18, v18, v19
    v_sub_f32 v16, v16, v18
    v_sub_f32 v17, v17, v18
    v_exp_f32 v20, v16
    v_exp_f32 v21, v17
    s_nop 0
    v_add_f32 v18, v20, v21
    s_nop 1
    v_add_f32_dpp v18, v18, v18 row_ror:8 row_mask:0xf bank_mask:0xf
    s_nop 1
    v_add_f32_dpp v18, v18, v18 row_ror:4 row_mask:0xf bank_mask:0xf
    s_nop 1
    v_add_f32_dpp v18, v18, v18 row_ror:2 row_mask:0xf bank_mask:0xf
    s_nop 1
    v_add_f32_dpp v18, v18, v18 row_ror:1 row_mask:0xf bank_mask:0xf
    v_mov_b32 v19, v18
    s_nop 1
    v_permlane16_swap_b32 v18, v19
    s_nop 0
    v_add_f32 v18, v18, v19
    v_rcp_f32 v18, v18
    s_nop 0
    v_mul_f32 v20, v20, v18
    v_mul_f32 v21, v21, v18
    v_cvt_pk_bf16_f32 v20, v20, v21
    v_min_u32 v20, -2, v20
    s_branch LAp_main_kernel_80
LAr_main_kernel_74:
    s_waitcnt lgkmcnt(0)
    s_barrier
    s_branch LA_main_kernel_71
LAo_main_kernel_84:
    s_add_u32 s12, s44, 82182144
    s_addc_u32 s13, s45, 0
    s_and_b32 s13, s13, 0xffff
    s_mov_b32 s14, 186253312
    s_add_u32 s0, s0, 1
    s_cmp_lt_u32 s0, 2
    s_cbranch_scc1 Ltop_main_kernel_70
    s_endpgm
LroleB_main_kernel_7:
    s_sub_u32 s60, s59, 16
    v_lshlrev_b32 v132, 7, v0
    s_getpc_b64 s[82:83]
Lpc_main_kernel_85:
    s_add_u32 s82, s82, LB0_main_kernel_9-Lpc_main_kernel_85
    s_addc_u32 s83, s83, 0
    global_load_dword v133, v132, s[82:83]
    v_lshlrev_b32 v1, 4, v0
    v_and_b32 v2, 8, v0
    v_cmp_eq_u32 vcc, 0, v2
    v_mov_b32 v2, 0xeeee
    v_mov_b32 v3, 0x4444
    v_cndmask_b32 v2, v2, v3, vcc
    s_lshl_b32 s46, s3, 11
    s_mov_b32 m0, s46
    v_add_u32 v3, s46, v1
    s_cmp_eq_u32 s3, 3
    s_cselect_b32 s47, 7, 15
    v_and_b32 v4, s47, v0
    v_lshlrev_b32 v4, 7, v4
    v_add_u32 v4, s46, v4
    v_lshrrev_b32 v131, 2, v0
    v_mul_u32_u24 v131, 896, v131
    v_and_b32 v130, 3, v0
    v_lshl_add_u32 v130, v130, 2, v131
    s_lshr_b32 s54, s60, 1
    s_lshl_b32 s54, s54, 7
    s_add_u32 s54, s54, 97753088
    s_mov_b32 s55, 0
    s_lshl_b32 s46, s3, 2
    s_mul_i32 s46, s46, 28
    s_lshl_b32 s47, s60, 1
    s_add_u32 s46, s46, s47
    s_mul_i32 s46, s46, 14336
    s_add_u32 s46, s46, 6422528
    s_mul_i32 s47, s3, 28672
    s_add_u32 s47, s47, 24576
    v_add_u32 v15, s47, v1
    v_lshrrev_b32 v134, 5, v0
    v_mul_u32_u24 v134, 14336, v134
    v_and_b32 v135, 31, v0
    v_lshl_add_u32 v134, v135, 7, v134
    s_cmp_gt_u32 s55, 0
    s_cbranch_scc1 Lsr_main_kernel_86
    s_mov_b32 s70, 2097152
Lsl_main_kernel_87:
    buffer_load_dword v131, v130, s[4:7], s54 offen sc1
    s_sub_u32 s70, s70, 1
    s_cbranch_scc1 Lexit_team
    s_waitcnt vmcnt(0)
    v_cmp_gt_u32 vcc, 4, v131
    s_nop 0
    s_cmp_eq_u64 vcc, 0
    s_cselect_b32 s55, 4, s55
    v_cmp_ge_u32 vcc, 0, v131
    s_cbranch_vccz Lsr_main_kernel_86
    s_sleep 2
    s_branch Lsl_main_kernel_87
Lsr_main_kernel_86:
    s_add_u32 s48, s46, 0
    buffer_load_dwordx4 a[0:3], v1, s[4:7], s48 offen offset:0 sc1
    buffer_load_dwordx4 a[4:7], v1, s[4:7], s48 offen offset:1024 sc1
    buffer_load_dwordx4 a[8:11], v1, s[4:7], s48 offen offset:2048 sc1
    buffer_load_dwordx4 a[12:15], v1, s[4:7], s48 offen offset:3072 sc1
    s_add_u32 s48, s46, 14336
    buffer_load_dwordx4 a[56:59], v1, s[4:7], s48 offen offset:0 sc1
    buffer_load_dwordx4 a[60:63], v1, s[4:7], s48 offen offset:1024 sc1
    buffer_load_dwordx4 a[64:67], v1, s[4:7], s48 offen offset:2048 sc1
    buffer_load_dwordx4 a[68:71], v1, s[4:7], s48 offen offset:3072 sc1
    s_add_u32 s48, s46, 401408
    buffer_load_dwordx4 a[112:115], v1, s[4:7], s48 offen offset:0 sc1
    buffer_load_dwordx4 a[116:119], v1, s[4:7], s48 offen offset:1024 sc1
    buffer_load_dwordx4 a[120:123], v1, s[4:7], s48 offen offset:2048 sc1
    buffer_load_dwordx4 a[124:127], v1, s[4:7], s48 offen offset:3072 sc1
    s_add_u32 s48, s46, 415744
    buffer_load_dwordx4 a[168:171], v1, s[4:7], s48 offen offset:0 sc1
    buffer_load_dwordx4 a[172:175], v1, s[4:7], s48 offen offset:1024 sc1
    buffer_load_dwordx4 a[176:179], v1, s[4:7], s48 offen offset:2048 sc1
    buffer_load_dwordx4 a[180:183], v1, s[4:7], s48 offen offset:3072 sc1
    s_add_u32 s48, s46, 802816
    buffer_load_dwordx4 a[224:227], v1, s[4:7], s48 offen offset:0 sc1
    buffer_load_dwordx4 a[228:231], v1, s[4:7], s48 offen offset:1024 sc1
    buffer_load_dwordx4 a[232:235], v1, s[4:7], s48 offen offset:2048 sc1
    buffer_load_dwordx4 a[236:239], v1, s[4:7], s48 offen offset:3072 sc1
    s_add_u32 s48, s46, 817152
    buffer_load_dwordx4 v[200:203], v1, s[4:7], s48 offen offset:0 sc1
    buffer_load_dwordx4 v[204:207], v1, s[4:7], s48 offen offset:1024 sc1
    buffer_load_dwordx4 v[208:211], v1, s[4:7], s48 offen offset:2048 sc1
    buffer_load_dwordx4 v[212:215], v1, s[4:7], s48 offen offset:3072 sc1
    s_add_u32 s48, s46, 1204224
    buffer_load_dwordx4 v[16:19], v1, s[4:7], s48 offen offset:0 sc1
    buffer_load_dwordx4 v[20:23], v1, s[4:7], s48 offen offset:1024 sc1
    buffer_load_dwordx4 v[24:27], v1, s[4:7], s48 offen offset:2048 sc1
    buffer_load_dwordx4 v[28:31], v1, s[4:7], s48 offen offset:3072 sc1
    s_add_u32 s48, s46, 1218560
    buffer_load_dwordx4 v[72:75], v1, s[4:7], s48 offen offset:0 sc1
    buffer_load_dwordx4 v[76:79], v1, s[4:7], s48 offen offset:1024 sc1
    buffer_load_dwordx4 v[80:83], v1, s[4:7], s48 offen offset:2048 sc1
    buffer_load_dwordx4 v[84:87], v1, s[4:7], s48 offen offset:3072 sc1
    s_cmp_gt_u32 s55, 1
    s_cbranch_scc1 Lsr_main_kernel_88
    s_mov_b32 s70, 2097152
Lsl_main_kernel_89:
    buffer_load_dword v131, v130, s[4:7], s54 offen sc1
    s_sub_u32 s70, s70, 1
    s_cbranch_scc1 Lexit_team
    s_waitcnt vmcnt(0)
    v_cmp_gt_u32 vcc, 4, v131
    s_nop 0
    s_cmp_eq_u64 vcc, 0
    s_cselect_b32 s55, 4, s55
    v_cmp_ge_u32 vcc, 1, v131
    s_cbranch_vccz Lsr_main_kernel_88
    s_sleep 2
    s_branch Lsl_main_kernel_89
Lsr_main_kernel_88:
    s_add_u32 s48, s46, 4096
    buffer_load_dwordx4 a[16:19], v1, s[4:7], s48 offen offset:0 sc1
    buffer_load_dwordx4 a[20:23], v1, s[4:7], s48 offen offset:1024 sc1
    buffer_load_dwordx4 a[24:27], v1, s[4:7], s48 offen offset:2048 sc1
    buffer_load_dwordx4 a[28:31], v1, s[4:7], s48 offen offset:3072 sc1
    s_add_u32 s48, s46, 18432
    buffer_load_dwordx4 a[72:75], v1, s[4:7], s48 offen offset:0 sc1
    buffer_load_dwordx4 a[76:79], v1, s[4:7], s48 offen offset:1024 sc1
    buffer_load_dwordx4 a[80:83], v1, s[4:7], s48 offen offset:2048 sc1
    buffer_load_dwordx4 a[84:87], v1, s[4:7], s48 offen offset:3072 sc1
    s_add_u32 s48, s46, 405504
    buffer_load_dwordx4 a[128:131], v1, s[4:7], s48 offen offset:0 sc1
    buffer_load_dwordx4 a[132:135], v1, s[4:7], s48 offen offset:1024 sc1
    buffer_load_dwordx4 a[136:139], v1, s[4:7], s48 offen offset:2048 sc1
    buffer_load_dwordx4 a[140:143], v1, s[4:7], s48 offen offset:3072 sc1
    s_add_u32 s48, s46, 419840
    buffer_load_dwordx4 a[184:187], v1, s[4:7], s48 offen offset:0 sc1
    buffer_load_dwordx4 a[188:191], v1, s[4:7], s48 offen offset:1024 sc1
    buffer_load_dwordx4 a[192:195], v1, s[4:7], s48 offen offset:2048 sc1
    buffer_load_dwordx4 a[196:199], v1, s[4:7], s48 offen offset:3072 sc1
    s_add_u32 s48, s46, 806912
    buffer_load_dwordx4 a[240:243], v1, s[4:7], s48 offen offset:0 sc1
    buffer_load_dwordx4 a[244:247], v1, s[4:7], s48 offen offset:1024 sc1
    buffer_load_dwordx4 a[248:251], v1, s[4:7], s48 offen offset:2048 sc1
    buffer_load_dwordx4 a[252:255], v1, s[4:7], s48 offen offset:3072 sc1
    s_add_u32 s48, s46, 821248
    buffer_load_dwordx4 v[216:219], v1, s[4:7], s48 offen offset:0 sc1
    buffer_load_dwordx4 v[220:223], v1, s[4:7], s48 offen offset:1024 sc1
    buffer_load_dwordx4 v[224:227], v1, s[4:7], s48 offen offset:2048 sc1
    buffer_load_dwordx4 v[228:231], v1, s[4:7], s48 offen offset:3072 sc1
    s_add_u32 s48, s46, 1208320
    buffer_load_dwordx4 v[32:35], v1, s[4:7], s48 offen offset:0 sc1
    buffer_load_dwordx4 v[36:39], v1, s[4:7], s48 offen offset:1024 sc1
    buffer_load_dwordx4 v[40:43], v1, s[4:7], s48 offen offset:2048 sc1
    buffer_load_dwordx4 v[44:47], v1, s[4:7], s48 offen offset:3072 sc1
    s_add_u32 s48, s46, 1222656
    buffer_load_dwordx4 v[88:91], v1, s[4:7], s48 offen offset:0 sc1
    buffer_load_dwordx4 v[92:95], v1, s[4:7], s48 offen offset:1024 sc1
    buffer_load_dwordx4 v[96:99], v1, s[4:7], s48 offen offset:2048 sc1
    buffer_load_dwordx4 v[100:103], v1, s[4:7], s48 offen offset:3072 sc1
    s_cmp_gt_u32 s55, 2
    s_cbranch_scc1 Lsr_main_kernel_90
    s_mov_b32 s70, 2097152
Lsl_main_kernel_91:
    buffer_load_dword v131, v130, s[4:7], s54 offen sc1
    s_sub_u32 s70, s70, 1
    s_cbranch_scc1 Lexit_team
    s_waitcnt vmcnt(0)
    v_cmp_gt_u32 vcc, 4, v131
    s_nop 0
    s_cmp_eq_u64 vcc, 0
    s_cselect_b32 s55, 4, s55
    v_cmp_ge_u32 vcc, 2, v131
    s_cbranch_vccz Lsr_main_kernel_90
    s_sleep 2
    s_branch Lsl_main_kernel_91
Lsr_main_kernel_90:
    s_add_u32 s48, s46, 8192
    buffer_load_dwordx4 a[32:35], v1, s[4:7], s48 offen offset:0 sc1
    buffer_load_dwordx4 a[36:39], v1, s[4:7], s48 offen offset:1024 sc1
    buffer_load_dwordx4 a[40:43], v1, s[4:7], s48 offen offset:2048 sc1
    buffer_load_dwordx4 a[44:47], v1, s[4:7], s48 offen offset:3072 sc1
    s_add_u32 s48, s46, 22528
    buffer_load_dwordx4 a[88:91], v1, s[4:7], s48 offen offset:0 sc1
    buffer_load_dwordx4 a[92:95], v1, s[4:7], s48 offen offset:1024 sc1
    buffer_load_dwordx4 a[96:99], v1, s[4:7], s48 offen offset:2048 sc1
    buffer_load_dwordx4 a[100:103], v1, s[4:7], s48 offen offset:3072 sc1
    s_add_u32 s48, s46, 409600
    buffer_load_dwordx4 a[144:147], v1, s[4:7], s48 offen offset:0 sc1
    buffer_load_dwordx4 a[148:151], v1, s[4:7], s48 offen offset:1024 sc1
    buffer_load_dwordx4 a[152:155], v1, s[4:7], s48 offen offset:2048 sc1
    buffer_load_dwordx4 a[156:159], v1, s[4:7], s48 offen offset:3072 sc1
    s_add_u32 s48, s46, 423936
    buffer_load_dwordx4 a[200:203], v1, s[4:7], s48 offen offset:0 sc1
    buffer_load_dwordx4 a[204:207], v1, s[4:7], s48 offen offset:1024 sc1
    buffer_load_dwordx4 a[208:211], v1, s[4:7], s48 offen offset:2048 sc1
    buffer_load_dwordx4 a[212:215], v1, s[4:7], s48 offen offset:3072 sc1
    s_add_u32 s48, s46, 811008
    buffer_load_dwordx4 v[176:179], v1, s[4:7], s48 offen offset:0 sc1
    buffer_load_dwordx4 v[180:183], v1, s[4:7], s48 offen offset:1024 sc1
    buffer_load_dwordx4 v[184:187], v1, s[4:7], s48 offen offset:2048 sc1
    buffer_load_dwordx4 v[188:191], v1, s[4:7], s48 offen offset:3072 sc1
    s_add_u32 s48, s46, 825344
    buffer_load_dwordx4 v[232:235], v1, s[4:7], s48 offen offset:0 sc1
    buffer_load_dwordx4 v[236:239], v1, s[4:7], s48 offen offset:1024 sc1
    buffer_load_dwordx4 v[240:243], v1, s[4:7], s48 offen offset:2048 sc1
    buffer_load_dwordx4 v[244:247], v1, s[4:7], s48 offen offset:3072 sc1
    s_add_u32 s48, s46, 1212416
    buffer_load_dwordx4 v[48:51], v1, s[4:7], s48 offen offset:0 sc1
    buffer_load_dwordx4 v[52:55], v1, s[4:7], s48 offen offset:1024 sc1
    buffer_load_dwordx4 v[56:59], v1, s[4:7], s48 offen offset:2048 sc1
    buffer_load_dwordx4 v[60:63], v1, s[4:7], s48 offen offset:3072 sc1
    s_add_u32 s48, s46, 1226752
    buffer_load_dwordx4 v[104:107], v1, s[4:7], s48 offen offset:0 sc1
    buffer_load_dwordx4 v[108:111], v1, s[4:7], s48 offen offset:1024 sc1
    buffer_load_dwordx4 v[112:115], v1, s[4:7], s48 offen offset:2048 sc1
    buffer_load_dwordx4 v[116:119], v1, s[4:7], s48 offen offset:3072 sc1
    s_cmp_gt_u32 s55, 3
    s_cbranch_scc1 Lsr_main_kernel_92
    s_mov_b32 s70, 2097152
Lsl_main_kernel_93:
    buffer_load_dword v131, v130, s[4:7], s54 offen sc1
    s_sub_u32 s70, s70, 1
    s_cbranch_scc1 Lexit_team
    s_waitcnt vmcnt(0)
    v_cmp_gt_u32 vcc, 4, v131
    s_nop 0
    s_cmp_eq_u64 vcc, 0
    s_cselect_b32 s55, 4, s55
    v_cmp_ge_u32 vcc, 3, v131
    s_cbranch_vccz Lsr_main_kernel_92
    s_sleep 2
    s_branch Lsl_main_kernel_93
Lsr_main_kernel_92:
    s_add_u32 s48, s46, 12288
    buffer_load_dwordx4 a[48:51], v1, s[4:7], s48 offen offset:0 sc1
    buffer_load_dwordx4 a[52:55], v1, s[4:7], s48 offen offset:1024 sc1
    s_add_u32 s48, s46, 26624
    buffer_load_dwordx4 a[104:107], v1, s[4:7], s48 offen offset:0 sc1
    buffer_load_dwordx4 a[108:111], v1, s[4:7], s48 offen offset:1024 sc1
    s_add_u32 s48, s46, 413696
    buffer_load_dwordx4 a[160:163], v1, s[4:7], s48 offen offset:0 sc1
    buffer_load_dwordx4 a[164:167], v1, s[4:7], s48 offen offset:1024 sc1
    s_add_u32 s48, s46, 428032
    buffer_load_dwordx4 a[216:219], v1, s[4:7], s48 offen offset:0 sc1
    buffer_load_dwordx4 a[220:223], v1, s[4:7], s48 offen offset:1024 sc1
    s_add_u32 s48, s46, 815104
    buffer_load_dwordx4 v[192:195], v1, s[4:7], s48 offen offset:0 sc1
    buffer_load_dwordx4 v[196:199], v1, s[4:7], s48 offen offset:1024 sc1
    s_add_u32 s48, s46, 829440
    buffer_load_dwordx4 v[248:251], v1, s[4:7], s48 offen offset:0 sc1
    buffer_load_dwordx4 v[252:255], v1, s[4:7], s48 offen offset:1024 sc1
    s_add_u32 s48, s46, 1216512
    buffer_load_dwordx4 v[64:67], v1, s[4:7], s48 offen offset:0 sc1
    buffer_load_dwordx4 v[68:71], v1, s[4:7], s48 offen offset:1024 sc1
    s_add_u32 s48, s46, 1230848
    buffer_load_dwordx4 v[120:123], v1, s[4:7], s48 offen offset:0 sc1
    buffer_load_dwordx4 v[124:127], v1, s[4:7], s48 offen offset:1024 sc1
    s_mov_b32 s96, 0
    v_lshlrev_b32 v130, 3, v1
    v_and_b32 v131, 0x780, v130
    v_lshrrev_b32 v130, 11, v130
    v_lshl_add_u32 v130, v130, 13, v131
    s_min_u32 s96, s96, 48
    s_lshl_b32 s97, s96, 7
    s_add_u32 s97, s97, 97640448
    buffer_load_dword v131, v130, s[12:15], s97 offen sc1
    s_mov_b32 s48, 79822848
    buffer_load_dword v132, v4, s[12:15], s48 offen sc1
    s_waitcnt vmcnt(0)
    v_cmp_ne_u32 vcc, 28, v131
    s_nop 0
    s_or_b32 s97, vcc_lo, vcc_hi
    s_lshr_b32 vcc_lo, s97, 16
    s_or_b32 s97, s97, vcc_lo
    s_or_b32 s97, s97, 0x10000
    s_ff1_i32_b32 s97, s97
    s_add_u32 s96, s96, s97
    s_cmp_ge_u32 s96, 64
    s_cselect_b32 s96, 0x100, s96
    ds_write_b128 v15, v[16:19] offset:0
    ds_write_b128 v15, v[20:23] offset:1024
    ds_write_b128 v15, v[24:27] offset:2048
    ds_write_b128 v15, v[28:31] offset:3072
    ds_write_b128 v15, v[32:35] offset:4096
    ds_write_b128 v15, v[36:39] offset:5120
    ds_write_b128 v15, v[40:43] offset:6144
    ds_write_b128 v15, v[44:47] offset:7168
    ds_write_b128 v15, v[48:51] offset:8192
    ds_write_b128 v15, v[52:55] offset:9216
    ds_write_b128 v15, v[56:59] offset:10240
    ds_write_b128 v15, v[60:63] offset:11264
    ds_write_b128 v15, v[64:67] offset:12288
    ds_write_b128 v15, v[68:71] offset:13312
    ds_write_b128 v15, v[72:75] offset:14336
    ds_write_b128 v15, v[76:79] offset:15360
    ds_write_b128 v15, v[80:83] offset:16384
    ds_write_b128 v15, v[84:87] offset:17408
    ds_write_b128 v15, v[88:91] offset:18432
    ds_write_b128 v15, v[92:95] offset:19456
    ds_write_b128 v15, v[96:99] offset:20480
    ds_write_b128 v15, v[100:103] offset:21504
    ds_write_b128 v15, v[104:107] offset:22528
    ds_write_b128 v15, v[108:111] offset:23552
    ds_write_b128 v15, v[112:115] offset:24576
    ds_write_b128 v15, v[116:119] offset:25600
    ds_write_b128 v15, v[120:123] offset:26624
    ds_write_b128 v15, v[124:127] offset:27648
    s_waitcnt lgkmcnt(0)
    v_and_b32 v16, 15, v0
    v_lshrrev_b32 v17, 4, v0
    v_and_b32 v18, 7, v0
    s_mul_i32 s46, s3, 2560
    v_lshl_add_u32 v7, v17, 3, v18
    v_lshlrev_b32 v7, 4, v7
    v_add_u32 v7, s46, v7
    v_lshrrev_b32 v19, 3, v16
    v_mul_u32_u24 v19, 640, v19
    v_add_u32 v7, v7, v19
    v_mul_u32_u24 v8, 640, v17
    v_lshl_add_u32 v8, v18, 4, v8
    v_add_u32 v8, s46, v8
    v_add_u32 v8, 512, v8
    v_mul_u32_u24 v19, 28672, v17
    v_lshl_add_u32 v19, v16, 7, v19
    v_mov_b32 v20, 0x7fffffff
    v_cmp_gt_u32 vcc, 9, v16
    s_nop 1
    v_cndmask_b32 v5, v20, v19, vcc
    s_lshl_b32 s46, s3, 11
    s_add_u32 s47, s46, 8192
    v_lshlrev_b32 v9, 4, v16
    v_lshl_add_u32 v9, v17, 2, v9
    v_add_u32 v9, s47, v9
    v_add_u32 v10, s47, v1
    s_lshl_b32 s46, s3, 10
    s_add_u32 s47, s46, 16384
    v_add_u32 v11, s47, v1
    v_bfe_u32 v19, v0, 2, 3
    v_lshrrev_b32 v20, 5, v0
    v_bfe_u32 v21, v0, 1, 1
    v_and_b32 v22, 1, v0
    s_lshl_b32 s46, s3, 1
    s_and_b32 s46, s46, 2
    v_add_u32 v21, s46, v21
    v_lshl_add_u32 v12, v21, 4, v19
    v_lshlrev_b32 v12, 4, v12
    v_lshl_add_u32 v12, v22, 7, v12
    v_lshl_add_u32 v12, v20, 3, v12
    v_add_u32 v12, 16384, v12
    s_lshl_b32 s47, s60, 9
    s_lshl_b32 s48, s46, 7
    s_add_u32 s48, s48, s47
    v_lshlrev_b32 v13, 2, v0
    v_add_u32 v13, s48, v13
    v_lshlrev_b32 v14, 7, v21
    v_lshl_add_u32 v14, v19, 4, v14
    v_lshl_add_u32 v14, v22, 3, v14
    v_lshl_add_u32 v14, v20, 2, v14
    v_add_u32 v14, s47, v14
    v_mov_b32 v19, 0x7fffffff
    s_cmp_ge_u32 s3, 2
    s_cselect_b64 vcc, -1, 0
    v_cndmask_b32 v14, v14, v19, vcc
    v_cndmask_b32 v13, v13, v19, vcc
    v_mov_b32 v6, 0
    v_mov_b32 v19, 1
    v_mov_b32 v0, 1
    s_waitcnt vmcnt(0)
    v_lshrrev_b32 v16, 2, v1
    v_min_u32 v16, 124, v16
    s_mov_b32 s70, 2097152
Lx_main_kernel_95:
    buffer_load_dword v17, v16, s[8:11], 0 offen offset:128 sc1
    s_sub_u32 s70, s70, 1
    s_cbranch_scc1 Lexit_team
    s_waitcnt vmcnt(0)
    v_cmp_eq_u32 vcc, 0, v17
    s_cbranch_vccnz Lx_main_kernel_95
    v_cmp_ne_u32 vcc, s58, v17
    s_nop 0
    s_cmp_lg_u64 vcc, 0
    s_cselect_b32 s1, 1, 0
LB0_main_kernel_9:
Ltop_main_kernel_96:
    s_mov_b32 s61, 79822848
    s_mov_b32 s65, 80288768
    s_lshl_b32 s62, s3, 2
    s_mul_i32 s62, s62, 28
    s_lshl_b32 s46, s60, 1
    s_add_u32 s62, s62, s46
    s_lshl_b32 s62, s62, 10
    s_add_u32 s62, s62, 50462720
    s_mul_i32 s63, s3, 28
    s_add_u32 s63, s63, s46
    s_lshl_b32 s63, s63, 10
    s_add_u32 s63, s63, 81289216
    s_mov_b32 s66, 80945152
    s_mov_b32 s67, 0
    v_mov_b64 v[56:57], 0
    v_mov_b64 v[58:59], 0
    v_mov_b64 v[60:61], 0
    v_mov_b64 v[62:63], 0
    v_mov_b64 v[164:165], 0
    v_mov_b64 v[166:167], 0
    v_mov_b64 v[168:169], 0
    v_mov_b64 v[170:171], 0
    v_mov_b64 v[172:173], 0
    v_mov_b64 v[174:175], 0
    v_mov_b64 v[44:45], 0
    v_mov_b64 v[46:47], 0
    v_mov_b64 v[48:49], 0
    v_mov_b64 v[50:51], 0
LB_main_kernel_97:
    s_add_u32 s98, s67, 1
    s_cmp_lt_u32 s98, s96
    s_cbranch_scc1 Lgo_main_kernel_101
    s_mov_b32 s70, 2097152
Lgl_main_kernel_102:
    v_lshlrev_b32 v108, 3, v1
    v_and_b32 v109, 0x780, v108
    v_lshrrev_b32 v108, 11, v108
    v_lshl_add_u32 v108, v108, 13, v109
    s_min_u32 s96, s96, 48
    s_lshl_b32 s97, s96, 7
    s_add_u32 s97, s97, 97640448
    buffer_load_dword v109, v108, s[12:15], s97 offen sc1
    s_sub_u32 s70, s70, 1
    s_cbranch_scc1 Lexit_team
    s_waitcnt vmcnt(0)
    v_cmp_ne_u32 vcc, 28, v109
    s_nop 0
    s_or_b32 s97, vcc_lo, vcc_hi
    s_lshr_b32 vcc_lo, s97, 16
    s_or_b32 s97, s97, vcc_lo
    s_or_b32 s97, s97, 0x10000
    s_ff1_i32_b32 s97, s97
    s_add_u32 s96, s96, s97
    s_cmp_ge_u32 s96, 64
    s_cselect_b32 s96, 0x100, s96
    s_cmp_lt_u32 s98, s96
    s_cbranch_scc0 Lgl_main_kernel_102
Lgo_main_kernel_101:
    s_cmp_eq_u32 s67, 0
    s_cselect_b32 s57, 97402880, s63
    s_cselect_b32 s58, 97402880, s66
LBa_main_kernel_103:
    s_mov_b32 s70, 2097152
Lpm_main_kernel_104:
    buffer_load_dword v64, v4, s[12:15], s61 offen sc1
    buffer_load_dwordx4 v3, s[12:15], s61 offen sc1 lds
    buffer_load_dwordx4 v3, s[12:15], s61 offen offset:1024 sc1 lds
    s_sub_u32 s70, s70, 1
    s_cbranch_scc1 Lexit_team
    v_mov_b64 v[52:53], 0
    v_mov_b64 v[54:55], 0
    s_waitcnt vmcnt(2)
    v_cmp_eq_u32 vcc, -1, v64
    s_cbranch_vccnz Lpm_main_kernel_104
    s_waitcnt vmcnt(0)
    s_barrier
    ds_read_b128 v[16:19], v1 offset:0
    ds_read_b128 v[20:23], v1 offset:1024
    ds_read_b128 v[24:27], v1 offset:2048
    ds_read_b128 v[28:31], v1 offset:3072
    ds_read_b128 v[32:35], v1 offset:4096
    ds_read_b128 v[36:39], v1 offset:5120
    ds_read_b128 v[40:43], v1 offset:6144
    s_add_u32 s64, s62, 458752
    buffer_load_dword v66, v5, s[12:15], s64 offen sc1
    s_waitcnt lgkmcnt(6)
    v_smfmac_f32_16x16x64_bf16 v[52:55], v[16:19], a[0:7], v2
    ds_read_b128 v[108:111], v15 offset:0
    s_waitcnt lgkmcnt(6)
    v_smfmac_f32_16x16x64_bf16 v[52:55], v[20:23], a[8:15], v2
    ds_read_b128 v[112:115], v15 offset:1024
    s_waitcnt lgkmcnt(6)
    v_smfmac_f32_16x16x64_bf16 v[52:55], v[24:27], a[16:23], v2
    ds_read_b128 v[116:119], v15 offset:2048
    s_waitcnt lgkmcnt(6)
    v_smfmac_f32_16x16x64_bf16 v[52:55], v[28:31], a[24:31], v2
    ds_read_b128 v[120:123], v15 offset:3072
    s_waitcnt lgkmcnt(6)
    v_smfmac_f32_16x16x64_bf16 v[52:55], v[32:35], a[32:39], v2
    ds_read_b128 v[124:127], v15 offset:4096
    s_waitcnt lgkmcnt(6)
    v_smfmac_f32_16x16x64_bf16 v[52:55], v[36:39], a[40:47], v2
    ds_read_b128 v[128:131], v15 offset:5120
    s_waitcnt lgkmcnt(6)
    v_smfmac_f32_16x16x64_bf16 v[52:55], v[40:43], a[48:55], v2
    ds_read_b128 v[132:135], v15 offset:6144
    v_smfmac_f32_16x16x64_bf16 v[56:59], v[16:19], a[56:63], v2
    ds_read_b128 v[136:139], v15 offset:7168
    v_smfmac_f32_16x16x64_bf16 v[56:59], v[20:23], a[64:71], v2
    buffer_store_dwordx4 v[68:71], v1, s[12:15], s57 offen sc1
    v_smfmac_f32_16x16x64_bf16 v[56:59], v[24:27], a[72:79], v2
    ds_read_b128 v[140:143], v15 offset:8192
    v_permlane32_swap_b32 v52, v54
    v_smfmac_f32_16x16x64_bf16 v[56:59], v[28:31], a[80:87], v2
    ds_read_b128 v[144:147], v15 offset:9216
    v_permlane32_swap_b32 v53, v55
    v_smfmac_f32_16x16x64_bf16 v[56:59], v[32:35], a[88:95], v2
    ds_read_b128 v[148:151], v15 offset:10240
    v_add_f32 v52, v52, v54
    v_smfmac_f32_16x16x64_bf16 v[56:59], v[36:39], a[96:103], v2
    ds_read_b128 v[152:155], v15 offset:11264
    v_add_f32 v53, v53, v55
    v_smfmac_f32_16x16x64_bf16 v[56:59], v[40:43], a[104:111], v2
    buffer_store_dwordx4 v[72:75], v1, s[12:15], s57 offen offset:1024 sc1
    v_cvt_pk_bf16_f32 v52, v52, v53
    v_smfmac_f32_16x16x64_bf16 v[60:63], v[16:19], a[112:119], v2
    v_min_u32 v52, -2, v52
    ds_write_b32 v9, v52 offset:0
    v_smfmac_f32_16x16x64_bf16 v[60:63], v[20:23], a[120:127], v2
    buffer_store_dword v67, v14, s[12:15], s58 offen sc1
    v_smfmac_f32_16x16x64_bf16 v[60:63], v[24:27], a[128:135], v2
    ds_read_b128 v[156:159], v15 offset:12288
    v_permlane32_swap_b32 v56, v58
    v_smfmac_f32_16x16x64_bf16 v[60:63], v[28:31], a[136:143], v2
    ds_read_b128 v[160:163], v15 offset:13312
    v_permlane32_swap_b32 v57, v59
    v_smfmac_f32_16x16x64_bf16 v[60:63], v[32:35], a[144:151], v2
    v_add_f32 v56, v56, v58
    v_smfmac_f32_16x16x64_bf16 v[60:63], v[36:39], a[152:159], v2
    buffer_load_dwordx4 v[76:79], v1, s[12:15], s62 offen offset:0 sc1
    v_add_f32 v57, v57, v59
    v_smfmac_f32_16x16x64_bf16 v[60:63], v[40:43], a[160:167], v2
    v_cvt_pk_bf16_f32 v56, v56, v57
    s_waitcnt lgkmcnt(0)
    v_smfmac_f32_16x16x64_bf16 v[164:167], v[16:19], v[108:115], v2
    v_min_u32 v56, -2, v56
    ds_write_b32 v9, v56 offset:1024
    v_smfmac_f32_16x16x64_bf16 v[164:167], v[20:23], v[116:123], v2
    buffer_load_dwordx4 v[80:83], v1, s[12:15], s62 offen offset:1024 sc1
    v_smfmac_f32_16x16x64_bf16 v[164:167], v[24:27], v[124:131], v2
    v_permlane32_swap_b32 v60, v62
    v_smfmac_f32_16x16x64_bf16 v[164:167], v[28:31], v[132:139], v2
    v_permlane32_swap_b32 v61, v63
    v_smfmac_f32_16x16x64_bf16 v[164:167], v[32:35], v[140:147], v2
    s_add_u32 s64, s62, 28672
    buffer_load_dwordx4 v[84:87], v1, s[12:15], s64 offen offset:0 sc1
    v_add_f32 v60, v60, v62
    v_smfmac_f32_16x16x64_bf16 v[164:167], v[36:39], v[148:155], v2
    v_add_f32 v61, v61, v63
    v_smfmac_f32_16x16x64_bf16 v[164:167], v[40:43], v[156:163], v2
    v_cvt_pk_bf16_f32 v60, v60, v61
    v_smfmac_f32_16x16x64_bf16 v[168:171], v[16:19], a[168:175], v2
    v_min_u32 v60, -2, v60
    ds_write_b32 v9, v60 offset:256
    v_smfmac_f32_16x16x64_bf16 v[168:171], v[20:23], a[176:183], v2
    buffer_load_dwordx4 v[88:91], v1, s[12:15], s64 offen offset:1024 sc1
    v_smfmac_f32_16x16x64_bf16 v[168:171], v[24:27], a[184:191], v2
    ds_read_b128 v[108:111], v15 offset:14336
    v_permlane32_swap_b32 v164, v166
    v_smfmac_f32_16x16x64_bf16 v[168:171], v[28:31], a[192:199], v2
    ds_read_b128 v[112:115], v15 offset:15360
    v_permlane32_swap_b32 v165, v167
    v_smfmac_f32_16x16x64_bf16 v[168:171], v[32:35], a[200:207], v2
    ds_read_b128 v[116:119], v15 offset:16384
    v_add_f32 v164, v164, v166
    v_smfmac_f32_16x16x64_bf16 v[168:171], v[36:39], a[208:215], v2
    ds_read_b128 v[120:123], v15 offset:17408
    v_add_f32 v165, v165, v167
    v_smfmac_f32_16x16x64_bf16 v[168:171], v[40:43], a[216:223], v2
    ds_read_b128 v[124:127], v15 offset:18432
    v_cvt_pk_bf16_f32 v164, v164, v165
    v_smfmac_f32_16x16x64_bf16 v[172:175], v[16:19], a[224:231], v2
    v_min_u32 v164, -2, v164
    ds_write_b32 v9, v164 offset:768
    v_smfmac_f32_16x16x64_bf16 v[172:175], v[20:23], a[232:239], v2
    s_add_u32 s64, s62, 57344
    buffer_load_dwordx4 v[92:95], v1, s[12:15], s64 offen offset:0 sc1
    v_smfmac_f32_16x16x64_bf16 v[172:175], v[24:27], a[240:247], v2
    ds_read_b128 v[128:131], v15 offset:19456
    v_permlane32_swap_b32 v168, v170
    v_smfmac_f32_16x16x64_bf16 v[172:175], v[28:31], a[248:255], v2
    ds_read_b128 v[132:135], v15 offset:20480
    v_permlane32_swap_b32 v169, v171
    v_smfmac_f32_16x16x64_bf16 v[172:175], v[32:35], v[176:183], v2
    ds_read_b128 v[136:139], v15 offset:21504
    v_add_f32 v168, v168, v170
    v_smfmac_f32_16x16x64_bf16 v[172:175], v[36:39], v[184:191], v2
    ds_read_b128 v[140:143], v15 offset:22528
    v_add_f32 v169, v169, v171
    v_smfmac_f32_16x16x64_bf16 v[172:175], v[40:43], v[192:199], v2
    ds_read_b128 v[144:147], v15 offset:23552
    v_cvt_pk_bf16_f32 v168, v168, v169
    v_smfmac_f32_16x16x64_bf16 v[44:47], v[16:19], v[200:207], v2
    v_min_u32 v168, -2, v168
    ds_write_b32 v9, v168 offset:1280
    v_smfmac_f32_16x16x64_bf16 v[44:47], v[20:23], v[208:215], v2
    buffer_load_dwordx4 v[96:99], v1, s[12:15], s64 offen offset:1024 sc1
    v_smfmac_f32_16x16x64_bf16 v[44:47], v[24:27], v[216:223], v2
    ds_read_b128 v[148:151], v15 offset:24576
    v_permlane32_swap_b32 v172, v174
    v_smfmac_f32_16x16x64_bf16 v[44:47], v[28:31], v[224:231], v2
    ds_read_b128 v[152:155], v15 offset:25600
    v_permlane32_swap_b32 v173, v175
    v_smfmac_f32_16x16x64_bf16 v[44:47], v[32:35], v[232:239], v2
    ds_read_b128 v[156:159], v15 offset:26624
    v_add_f32 v172, v172, v174
    v_smfmac_f32_16x16x64_bf16 v[44:47], v[36:39], v[240:247], v2
    ds_read_b128 v[160:163], v15 offset:27648
    v_add_f32 v173, v173, v175
    v_smfmac_f32_16x16x64_bf16 v[44:47], v[40:43], v[248:255], v2
    s_add_u32 s64, s62, 86016
    buffer_load_dwordx4 v[100:103], v1, s[12:15], s64 offen offset:0 sc1
    v_cvt_pk_bf16_f32 v172, v172, v173
    s_waitcnt lgkmcnt(0)
    v_smfmac_f32_16x16x64_bf16 v[48:51], v[16:19], v[108:115], v2
    v_min_u32 v172, -2, v172
    ds_write_b32 v9, v172 offset:512
    v_smfmac_f32_16x16x64_bf16 v[48:51], v[20:23], v[116:123], v2
    buffer_load_dwordx4 v[104:107], v1, s[12:15], s64 offen offset:1024 sc1
    v_smfmac_f32_16x16x64_bf16 v[48:51], v[24:27], v[124:131], v2
    v_permlane32_swap_b32 v44, v46
    v_smfmac_f32_16x16x64_bf16 v[48:51], v[28:31], v[132:139], v2
    v_permlane32_swap_b32 v45, v47
    v_smfmac_f32_16x16x64_bf16 v[48:51], v[32:35], v[140:147], v2
    v_add_f32 v44, v44, v46
    v_smfmac_f32_16x16x64_bf16 v[48:51], v[36:39], v[148:155], v2
    v_add_f32 v45, v45, v47
    v_smfmac_f32_16x16x64_bf16 v[48:51], v[40:43], v[156:163], v2
    v_cvt_pk_bf16_f32 v44, v44, v45
    v_min_u32 v44, -2, v44
    ds_write_b32 v9, v44 offset:1536
    v_max3_u32 v64, v16, v17, v18
    v_max3_u32 v64, v64, v19, v20
    v_max3_u32 v64, v64, v21, v22
    v_max3_u32 v64, v64, v23, v24
    v_max3_u32 v64, v64, v25, v26
    v_max3_u32 v64, v64, v27, v28
    v_permlane32_swap_b32 v48, v50
    v_permlane32_swap_b32 v49, v51
    v_add_f32 v48, v48, v50
    v_add_f32 v49, v49, v51
    v_cvt_pk_bf16_f32 v48, v48, v49
    v_min_u32 v48, -2, v48
    ds_write_b32 v9, v48 offset:1792
    ds_read_b128 v[68:71], v10
    ds_read_b128 v[72:75], v10 offset:1024
    v_max3_u32 v64, v64, v29, v30
    v_max3_u32 v64, v64, v31, v32
    v_max3_u32 v64, v64, v33, v34
    v_max3_u32 v64, v64, v35, v36
    v_max3_u32 v64, v64, v37, v38
    v_max3_u32 v64, v64, v39, v40
    v_max3_u32 v64, v64, v41, v42
    v_max_u32 v64, v64, v43
    v_cmp_eq_u32 vcc, -1, v64
    s_cbranch_vccnz LBr_main_kernel_105
    s_add_u32 s62, s62, 458752
    s_add_u32 s61, s61, 7168
    s_add_u32 s63, s63, 114688
    s_add_u32 s66, s66, 7168
    s_cmp_eq_u32 s67, 63
    s_cbranch_scc1 LBd_main_kernel_98
    s_waitcnt lgkmcnt(0)
    s_mov_b32 s70, 2097152
    v_mov_b64 v[56:57], 0
    v_mov_b64 v[58:59], 0
    v_mov_b64 v[60:61], 0
    v_mov_b64 v[62:63], 0
    v_mov_b64 v[164:165], 0
    v_mov_b64 v[166:167], 0
    v_mov_b64 v[168:169], 0
    v_mov_b64 v[170:171], 0
    v_mov_b64 v[172:173], 0
    v_mov_b64 v[174:175], 0
    v_mov_b64 v[44:45], 0
    v_mov_b64 v[46:47], 0
    v_mov_b64 v[48:49], 0
    v_mov_b64 v[50:51], 0
Lpp_main_kernel_106:
    v_mov_b64 v[132:133], 0
    v_mov_b64 v[134:135], 0
    v_mov_b64 v[136:137], 0
    v_mov_b64 v[138:139], 0
    v_mov_b64 v[140:141], 0
    v_mov_b64 v[142:143], 0
    v_mov_b64 v[144:145], 0
    v_mov_b64 v[146:147], 0
    v_mov_b32 v65, 0
    s_mov_b32 s70, 2097152
    buffer_load_dwordx4 v[108:111], v7, s[12:15], s65 offen sc1
    buffer_load_dwordx4 v[112:115], v7, s[12:15], s65 offen offset:1280 sc1
    buffer_load_dwordx4 v[116:119], v8, s[12:15], s65 offen sc1
Lr_main_kernel_108:
    s_waitcnt vmcnt(2)
    v_cmp_eq_u32 vcc, -1, v108
    s_cbranch_vccz Lr_main_kernel_109
    buffer_load_dwordx4 v[108:111], v7, s[12:15], s65 offen sc1
Lr_main_kernel_110:
    s_waitcnt vmcnt(2)
    v_cmp_eq_u32 vcc, -1, v112
    s_cbranch_vccz Lr_main_kernel_111
    buffer_load_dwordx4 v[112:115], v7, s[12:15], s65 offen offset:1280 sc1
Lr_main_kernel_112:
    s_waitcnt vmcnt(2)
    v_cmp_eq_u32 vcc, -1, v116
    s_cbranch_vccz Lr_main_kernel_113
    buffer_load_dwordx4 v[116:119], v8, s[12:15], s65 offen sc1
    s_sub_u32 s70, s70, 1
    s_cbranch_scc0 Lr_main_kernel_108
    s_branch Lexit_team
Lr_main_kernel_109:
    v_mfma_f32_16x16x32_bf16 v[132:135], v[76:79], v[108:111], v[132:135]
    v_max3_u32 v65, v65, v109, v110
    v_mfma_f32_16x16x32_bf16 v[136:139], v[80:83], v[108:111], v[136:139]
    v_max_u32 v65, v65, v111
    v_mfma_f32_16x16x32_bf16 v[140:143], v[84:87], v[108:111], v[140:143]
    v_mfma_f32_16x16x32_bf16 v[144:147], v[88:91], v[108:111], v[144:147]
    s_waitcnt vmcnt(1)
    v_cmp_eq_u32 vcc, -1, v112
    s_cbranch_vccnz Lr_main_kernel_114
    v_mfma_f32_16x16x32_bf16 v[132:135], v[92:95], v[112:115], v[132:135]
    v_max3_u32 v65, v65, v113, v114
    v_mfma_f32_16x16x32_bf16 v[136:139], v[96:99], v[112:115], v[136:139]
    v_max_u32 v65, v65, v115
    v_mfma_f32_16x16x32_bf16 v[140:143], v[100:103], v[112:115], v[140:143]
    v_mfma_f32_16x16x32_bf16 v[144:147], v[104:107], v[112:115], v[144:147]
    s_waitcnt vmcnt(0)
    v_cmp_eq_u32 vcc, -1, v116
    s_cbranch_vccnz Lr_main_kernel_115
    v_mfma_f32_16x16x32_bf16 v[132:135], v[68:71], v[116:119], v[132:135]
    v_max3_u32 v65, v65, v117, v118
    v_mfma_f32_16x16x32_bf16 v[136:139], v[72:75], v[116:119], v[136:139]
    v_max_u32 v65, v65, v119
    s_nop 1
    s_branch Lrd_main_kernel_107
Lr_main_kernel_111:
    v_mfma_f32_16x16x32_bf16 v[132:135], v[92:95], v[112:115], v[132:135]
    v_max3_u32 v65, v65, v113, v114
    v_mfma_f32_16x16x32_bf16 v[136:139], v[96:99], v[112:115], v[136:139]
    v_max_u32 v65, v65, v115
    v_mfma_f32_16x16x32_bf16 v[140:143], v[100:103], v[112:115], v[140:143]
    v_mfma_f32_16x16x32_bf16 v[144:147], v[104:107], v[112:115], v[144:147]
    s_waitcnt vmcnt(1)
    v_cmp_eq_u32 vcc, -1, v116
    s_cbranch_vccnz Lr_main_kernel_116
    v_mfma_f32_16x16x32_bf16 v[132:135], v[68:71], v[116:119], v[132:135]
    v_max3_u32 v65, v65, v117, v118
    v_mfma_f32_16x16x32_bf16 v[136:139], v[72:75], v[116:119], v[136:139]
    v_max_u32 v65, v65, v119
    s_waitcnt vmcnt(0)
    v_cmp_eq_u32 vcc, -1, v108
    s_cbranch_vccnz Lr_main_kernel_117
    v_mfma_f32_16x16x32_bf16 v[132:135], v[76:79], v[108:111], v[132:135]
    v_max3_u32 v65, v65, v109, v110
    v_mfma_f32_16x16x32_bf16 v[136:139], v[80:83], v[108:111], v[136:139]
    v_max_u32 v65, v65, v111
    v_mfma_f32_16x16x32_bf16 v[140:143], v[84:87], v[108:111], v[140:143]
    v_mfma_f32_16x16x32_bf16 v[144:147], v[88:91], v[108:111], v[144:147]
    s_nop 2
    s_branch Lrd_main_kernel_107
Lr_main_kernel_113:
    v_mfma_f32_16x16x32_bf16 v[132:135], v[68:71], v[116:119], v[132:135]
    v_max3_u32 v65, v65, v117, v118
    v_mfma_f32_16x16x32_bf16 v[136:139], v[72:75], v[116:119], v[136:139]
    v_max_u32 v65, v65, v119
    s_waitcnt vmcnt(1)
    v_cmp_eq_u32 vcc, -1, v108
    s_cbranch_vccnz Lr_main_kernel_118
    v_mfma_f32_16x16x32_bf16 v[132:135], v[76:79], v[108:111], v[132:135]
    v_max3_u32 v65, v65, v109, v110
    v_mfma_f32_16x16x32_bf16 v[136:139], v[80:83], v[108:111], v[136:139]
    v_max_u32 v65, v65, v111
    v_mfma_f32_16x16x32_bf16 v[140:143], v[84:87], v[108:111], v[140:143]
    v_mfma_f32_16x16x32_bf16 v[144:147], v[88:91], v[108:111], v[144:147]
    s_waitcnt vmcnt(0)
    v_cmp_eq_u32 vcc, -1, v112
    s_cbranch_vccnz Lr_main_kernel_119
    v_mfma_f32_16x16x32_bf16 v[132:135], v[92:95], v[112:115], v[132:135]
    v_max3_u32 v65, v65, v113, v114
    v_mfma_f32_16x16x32_bf16 v[136:139], v[96:99], v[112:115], v[136:139]
    v_max_u32 v65, v65, v115
    v_mfma_f32_16x16x32_bf16 v[140:143], v[100:103], v[112:115], v[140:143]
    v_mfma_f32_16x16x32_bf16 v[144:147], v[104:107], v[112:115], v[144:147]
    s_nop 2
    s_branch Lrd_main_kernel_107
Lr_main_kernel_114:
    buffer_load_dwordx4 v[112:115], v7, s[12:15], s65 offen offset:1280 sc1
Lr_main_kernel_120:
    s_waitcnt vmcnt(1)
    v_cmp_eq_u32 vcc, -1, v116
    s_cbranch_vccz Lr_main_kernel_121
    buffer_load_dwordx4 v[116:119], v8, s[12:15], s65 offen sc1
Lr_main_kernel_122:
    s_waitcnt vmcnt(1)
    v_cmp_eq_u32 vcc, -1, v112
    s_cbranch_vccz Lr_main_kernel_123
    buffer_load_dwordx4 v[112:115], v7, s[12:15], s65 offen offset:1280 sc1
    s_sub_u32 s70, s70, 1
    s_cbranch_scc0 Lr_main_kernel_120
    s_branch Lexit_team
Lr_main_kernel_115:
    buffer_load_dwordx4 v[116:119], v8, s[12:15], s65 offen sc1
Lr_main_kernel_124:
    s_waitcnt vmcnt(0)
    v_cmp_eq_u32 vcc, -1, v116
    s_cbranch_vccz Lr_main_kernel_125
    buffer_load_dwordx4 v[116:119], v8, s[12:15], s65 offen sc1
    s_sub_u32 s70, s70, 1
    s_cbranch_scc0 Lr_main_kernel_124
    s_branch Lexit_team
Lr_main_kernel_116:
    buffer_load_dwordx4 v[116:119], v8, s[12:15], s65 offen sc1
Lr_main_kernel_126:
    s_waitcnt vmcnt(1)
    v_cmp_eq_u32 vcc, -1, v108
    s_cbranch_vccz Lr_main_kernel_127
    buffer_load_dwordx4 v[108:111], v7, s[12:15], s65 offen sc1
Lr_main_kernel_128:
    s_waitcnt vmcnt(1)
    v_cmp_eq_u32 vcc, -1, v116
    s_cbranch_vccz Lr_main_kernel_129
    buffer_load_dwordx4 v[116:119], v8, s[12:15], s65 offen sc1
    s_sub_u32 s70, s70, 1
    s_cbranch_scc0 Lr_main_kernel_126
    s_branch Lexit_team
Lr_main_kernel_117:
    buffer_load_dwordx4 v[108:111], v7, s[12:15], s65 offen sc1
Lr_main_kernel_130:
    s_waitcnt vmcnt(0)
    v_cmp_eq_u32 vcc, -1, v108
    s_cbranch_vccz Lr_main_kernel_131
    buffer_load_dwordx4 v[108:111], v7, s[12:15], s65 offen sc1
    s_sub_u32 s70, s70, 1
    s_cbranch_scc0 Lr_main_kernel_130
    s_branch Lexit_team
Lr_main_kernel_118:
    buffer_load_dwordx4 v[108:111], v7, s[12:15], s65 offen sc1
Lr_main_kernel_132:
    s_waitcnt vmcnt(1)
    v_cmp_eq_u32 vcc, -1, v112
    s_cbranch_vccz Lr_main_kernel_133
    buffer_load_dwordx4 v[112:115], v7, s[12:15], s65 offen offset:1280 sc1
Lr_main_kernel_134:
    s_waitcnt vmcnt(1)
    v_cmp_eq_u32 vcc, -1, v108
    s_cbranch_vccz Lr_main_kernel_135
    buffer_load_dwordx4 v[108:111], v7, s[12:15], s65 offen sc1
    s_sub_u32 s70, s70, 1
    s_cbranch_scc0 Lr_main_kernel_132
    s_branch Lexit_team
Lr_main_kernel_119:
    buffer_load_dwordx4 v[112:115], v7, s[12:15], s65 offen offset:1280 sc1
Lr_main_kernel_136:
    s_waitcnt vmcnt(0)
    v_cmp_eq_u32 vcc, -1, v112
    s_cbranch_vccz Lr_main_kernel_137
    buffer_load_dwordx4 v[112:115], v7, s[12:15], s65 offen offset:1280 sc1
    s_sub_u32 s70, s70, 1
    s_cbranch_scc0 Lr_main_kernel_136
    s_branch Lexit_team
Lr_main_kernel_121:
    v_mfma_f32_16x16x32_bf16 v[132:135], v[68:71], v[116:119], v[132:135]
    v_max3_u32 v65, v65, v117, v118
    v_mfma_f32_16x16x32_bf16 v[136:139], v[72:75], v[116:119], v[136:139]
    v_max_u32 v65, v65, v119
    s_waitcnt vmcnt(0)
    v_cmp_eq_u32 vcc, -1, v112
    s_cbranch_vccnz Lr_main_kernel_119
    v_mfma_f32_16x16x32_bf16 v[132:135], v[92:95], v[112:115], v[132:135]
    v_max3_u32 v65, v65, v113, v114
    v_mfma_f32_16x16x32_bf16 v[136:139], v[96:99], v[112:115], v[136:139]
    v_max_u32 v65, v65, v115
    v_mfma_f32_16x16x32_bf16 v[140:143], v[100:103], v[112:115], v[140:143]
    v_mfma_f32_16x16x32_bf16 v[144:147], v[104:107], v[112:115], v[144:147]
    s_nop 2
    s_branch Lrd_main_kernel_107
Lr_main_kernel_123:
    v_mfma_f32_16x16x32_bf16 v[132:135], v[92:95], v[112:115], v[132:135]
    v_max3_u32 v65, v65, v113, v114
    v_mfma_f32_16x16x32_bf16 v[136:139], v[96:99], v[112:115], v[136:139]
    v_max_u32 v65, v65, v115
    v_mfma_f32_16x16x32_bf16 v[140:143], v[100:103], v[112:115], v[140:143]
    v_mfma_f32_16x16x32_bf16 v[144:147], v[104:107], v[112:115], v[144:147]
    s_waitcnt vmcnt(0)
    v_cmp_eq_u32 vcc, -1, v116
    s_cbranch_vccnz Lr_main_kernel_115
    v_mfma_f32_16x16x32_bf16 v[132:135], v[68:71], v[116:119], v[132:135]
    v_max3_u32 v65, v65, v117, v118
    v_mfma_f32_16x16x32_bf16 v[136:139], v[72:75], v[116:119], v[136:139]
    v_max_u32 v65, v65, v119
    s_nop 1
    s_branch Lrd_main_kernel_107
Lr_main_kernel_125:
    v_mfma_f32_16x16x32_bf16 v[132:135], v[68:71], v[116:119], v[132:135]
    v_max3_u32 v65, v65, v117, v118
    v_mfma_f32_16x16x32_bf16 v[136:139], v[72:75], v[116:119], v[136:139]
    v_max_u32 v65, v65, v119
    s_nop 1
    s_branch Lrd_main_kernel_107
Lr_main_kernel_127:
    v_mfma_f32_16x16x32_bf16 v[132:135], v[76:79], v[108:111], v[132:135]
    v_max3_u32 v65, v65, v109, v110
    v_mfma_f32_16x16x32_bf16 v[136:139], v[80:83], v[108:111], v[136:139]
    v_max_u32 v65, v65, v111
    v_mfma_f32_16x16x32_bf16 v[140:143], v[84:87], v[108:111], v[140:143]
    v_mfma_f32_16x16x32_bf16 v[144:147], v[88:91], v[108:111], v[144:147]
    s_waitcnt vmcnt(0)
    v_cmp_eq_u32 vcc, -1, v116
    s_cbranch_vccnz Lr_main_kernel_115
    v_mfma_f32_16x16x32_bf16 v[132:135], v[68:71], v[116:119], v[132:135]
    v_max3_u32 v65, v65, v117, v118
    v_mfma_f32_16x16x32_bf16 v[136:139], v[72:75], v[116:119], v[136:139]
    v_max_u32 v65, v65, v119
    s_nop 1
    s_branch Lrd_main_kernel_107
Lr_main_kernel_129:
    v_mfma_f32_16x16x32_bf16 v[132:135], v[68:71], v[116:119], v[132:135]
    v_max3_u32 v65, v65, v117, v118
    v_mfma_f32_16x16x32_bf16 v[136:139], v[72:75], v[116:119], v[136:139]
    v_max_u32 v65, v65, v119
    s_waitcnt vmcnt(0)
    v_cmp_eq_u32 vcc, -1, v108
    s_cbranch_vccnz Lr_main_kernel_117
    v_mfma_f32_16x16x32_bf16 v[132:135], v[76:79], v[108:111], v[132:135]
    v_max3_u32 v65, v65, v109, v110
    v_mfma_f32_16x16x32_bf16 v[136:139], v[80:83], v[108:111], v[136:139]
    v_max_u32 v65, v65, v111
    v_mfma_f32_16x16x32_bf16 v[140:143], v[84:87], v[108:111], v[140:143]
    v_mfma_f32_16x16x32_bf16 v[144:147], v[88:91], v[108:111], v[144:147]
    s_nop 2
    s_branch Lrd_main_kernel_107
Lr_main_kernel_131:
    v_mfma_f32_16x16x32_bf16 v[132:135], v[76:79], v[108:111], v[132:135]
    v_max3_u32 v65, v65, v109, v110
    v_mfma_f32_16x16x32_bf16 v[136:139], v[80:83], v[108:111], v[136:139]
    v_max_u32 v65, v65, v111
    v_mfma_f32_16x16x32_bf16 v[140:143], v[84:87], v[108:111], v[140:143]
    v_mfma_f32_16x16x32_bf16 v[144:147], v[88:91], v[108:111], v[144:147]
    s_nop 2
    s_branch Lrd_main_kernel_107
Lr_main_kernel_133:
    v_mfma_f32_16x16x32_bf16 v[132:135], v[92:95], v[112:115], v[132:135]
    v_max3_u32 v65, v65, v113, v114
    v_mfma_f32_16x16x32_bf16 v[136:139], v[96:99], v[112:115], v[136:139]
    v_max_u32 v65, v65, v115
    v_mfma_f32_16x16x32_bf16 v[140:143], v[100:103], v[112:115], v[140:143]
    v_mfma_f32_16x16x32_bf16 v[144:147], v[104:107], v[112:115], v[144:147]
    s_waitcnt vmcnt(0)
    v_cmp_eq_u32 vcc, -1, v108
    s_cbranch_vccnz Lr_main_kernel_117
    v_mfma_f32_16x16x32_bf16 v[132:135], v[76:79], v[108:111], v[132:135]
    v_max3_u32 v65, v65, v109, v110
    v_mfma_f32_16x16x32_bf16 v[136:139], v[80:83], v[108:111], v[136:139]
    v_max_u32 v65, v65, v111
    v_mfma_f32_16x16x32_bf16 v[140:143], v[84:87], v[108:111], v[140:143]
    v_mfma_f32_16x16x32_bf16 v[144:147], v[88:91], v[108:111], v[144:147]
    s_nop 2
    s_branch Lrd_main_kernel_107
Lr_main_kernel_135:
    v_mfma_f32_16x16x32_bf16 v[132:135], v[76:79], v[108:111], v[132:135]
    v_max3_u32 v65, v65, v109, v110
    v_mfma_f32_16x16x32_bf16 v[136:139], v[80:83], v[108:111], v[136:139]
    v_max_u32 v65, v65, v111
    v_mfma_f32_16x16x32_bf16 v[140:143], v[84:87], v[108:111], v[140:143]
    v_mfma_f32_16x16x32_bf16 v[144:147], v[88:91], v[108:111], v[144:147]
    s_waitcnt vmcnt(0)
    v_cmp_eq_u32 vcc, -1, v112
    s_cbranch_vccnz Lr_main_kernel_119
    v_mfma_f32_16x16x32_bf16 v[132:135], v[92:95], v[112:115], v[132:135]
    v_max3_u32 v65, v65, v113, v114
    v_mfma_f32_16x16x32_bf16 v[136:139], v[96:99], v[112:115], v[136:139]
    v_max_u32 v65, v65, v115
    v_mfma_f32_16x16x32_bf16 v[140:143], v[100:103], v[112:115], v[140:143]
    v_mfma_f32_16x16x32_bf16 v[144:147], v[104:107], v[112:115], v[144:147]
    s_nop 2
    s_branch Lrd_main_kernel_107
Lr_main_kernel_137:
    v_mfma_f32_16x16x32_bf16 v[132:135], v[92:95], v[112:115], v[132:135]
    v_max3_u32 v65, v65, v113, v114
    v_mfma_f32_16x16x32_bf16 v[136:139], v[96:99], v[112:115], v[136:139]
    v_max_u32 v65, v65, v115
    v_mfma_f32_16x16x32_bf16 v[140:143], v[100:103], v[112:115], v[140:143]
    v_mfma_f32_16x16x32_bf16 v[144:147], v[104:107], v[112:115], v[144:147]
    s_nop 2
    s_branch Lrd_main_kernel_107
Lrd_main_kernel_107:
    v_cmp_eq_u32 vcc, -1, v65
    v_add_f32_dpp v52, v140, v132 row_ror:8 row_mask:0xf bank_mask:0x3
    v_add_f32_dpp v53, v141, v133 row_ror:8 row_mask:0xf bank_mask:0x3
    v_add_f32_dpp v54, v142, v134 row_ror:8 row_mask:0xf bank_mask:0x3
    v_add_f32_dpp v55, v143, v135 row_ror:8 row_mask:0xf bank_mask:0x3
    v_add_f32_dpp v52, v136, v144 row_ror:8 row_mask:0xf bank_mask:0xc
    v_add_f32_dpp v53, v137, v145 row_ror:8 row_mask:0xf bank_mask:0xc
    v_add_f32_dpp v54, v138, v146 row_ror:8 row_mask:0xf bank_mask:0xc
    v_add_f32_dpp v55, v139, v147 row_ror:8 row_mask:0xf bank_mask:0xc
    ds_write_b128 v11, v[52:55]
    s_cbranch_vccnz Lpp_main_kernel_106
    s_add_u32 s65, s65, 10240
    s_add_u32 s67, s67, 1
    s_waitcnt lgkmcnt(0)
    s_barrier
    ds_read_b64 v[76:77], v12 offset:0
    ds_read_b64 v[78:79], v12 offset:1024
    ds_read_b64 v[80:81], v12 offset:2048
    ds_read_b64 v[82:83], v12 offset:3072
    s_waitcnt lgkmcnt(2)
    v_pk_add_f32 v[76:77], v[76:77], v[78:79]
    s_waitcnt lgkmcnt(0)
    v_pk_add_f32 v[80:81], v[80:81], v[82:83]
    v_pk_add_f32 v[76:77], v[76:77], v[80:81]
    v_cvt_pk_bf16_f32 v67, v76, v77
    v_min_u32 v67, -2, v67
    buffer_store_dword v67, v13, s[12:15], s61 offen
    s_cmp_eq_u32 s1, 0
    s_cbranch_scc1 Lpub_main_kernel_138
    buffer_store_dword v67, v13, s[12:15], s61 offen sc1
Lpub_main_kernel_138:
    s_cmp_lg_u32 s67, 63
    s_cbranch_scc1 LBn_main_kernel_100
    buffer_store_dword v67, v14, s[12:15], s66 offen sc1
LBn_main_kernel_100:
    s_branch LB_main_kernel_97
LBr_main_kernel_105:
    s_waitcnt vmcnt(0) lgkmcnt(0)
    s_barrier
    s_mov_b32 s57, 97402880
    s_mov_b32 s58, s57
    v_mov_b64 v[56:57], 0
    v_mov_b64 v[58:59], 0
    v_mov_b64 v[60:61], 0
    v_mov_b64 v[62:63], 0
    v_mov_b64 v[164:165], 0
    v_mov_b64 v[166:167], 0
    v_mov_b64 v[168:169], 0
    v_mov_b64 v[170:171], 0
    v_mov_b64 v[172:173], 0
    v_mov_b64 v[174:175], 0
    v_mov_b64 v[44:45], 0
    v_mov_b64 v[46:47], 0
    v_mov_b64 v[48:49], 0
    v_mov_b64 v[50:51], 0
    s_branch LBa_main_kernel_103
LBd_main_kernel_98:
    s_waitcnt lgkmcnt(0)
    buffer_store_dwordx4 v[68:71], v1, s[12:15], s63 offen sc1
    buffer_store_dwordx4 v[72:75], v1, s[12:15], s63 offen offset:1024 sc1
    s_mov_b32 s96, 0
    s_add_u32 s12, s44, 82182144
    s_addc_u32 s13, s45, 0
    s_and_b32 s13, s13, 0xffff
    s_mov_b32 s14, 186253312
    s_add_u32 s0, s0, 1
    s_cmp_lt_u32 s0, 2
    s_cbranch_scc1 Ltop_main_kernel_96
    s_endpgm
LroleP_main_kernel_2:
    s_sub_u32 s60, s59, 30
Ltop_main_kernel_139:
    s_lshl_b32 s46, s60, 2
    s_add_u32 s46, s46, s3
    s_mov_b32 s94, s46
    v_lshlrev_b32 v1, 7, v0
    v_mov_b32 v20, 0x7fffffff
    s_mul_i32 s47, s46, 57344
    v_add_u32 v2, s47, v1
    v_and_b32 v3, 15, v0
    v_cmp_le_u32 vcc, 9, v3
    s_nop 1
    v_cndmask_b32 v3, v20, v2, vcc
    s_mul_i32 s47, s46, 3584
    v_add_u32 v4, s47, v1
    v_cmp_gt_u32 vcc, 28, v0
    s_nop 1
    v_cndmask_b32 v4, v20, v4, vcc
    s_mul_i32 s47, s46, 896
    v_add_u32 v5, s47, v1
    v_cmp_gt_u32 vcc, 7, v0
    s_nop 1
    v_cndmask_b32 v5, v20, v5, vcc
    s_mul_i32 s47, s46, 1280
    v_add_u32 v6, s47, v1
    v_cmp_gt_u32 vcc, 10, v0
    s_nop 1
    v_cndmask_b32 v6, v20, v6, vcc
    v_min_u32 v7, 27, v0
    v_lshlrev_b32 v7, 8, v7
    v_mov_b32 v12, 0
    s_mov_b32 s99, 97768448
    s_mov_b32 s95, 1
    s_mov_b32 s62, 50462720
    s_mov_b32 s63, 15597568
    s_mov_b32 s64, 79830016
    s_mov_b32 s65, 80288768
    s_mov_b32 s61, 79822848
    s_mov_b32 s96, 0
    s_mov_b32 s98, 0
    s_cmp_lt_u32 s98, s96
    s_cbranch_scc1 Lgo_main_kernel_140
    s_mov_b32 s70, 2097152
Lgl_main_kernel_141:
    v_mov_b32 v24, v1
    v_and_b32 v25, 0x780, v24
    v_lshrrev_b32 v24, 11, v24
    v_lshl_add_u32 v24, v24, 13, v25
    s_min_u32 s96, s96, 48
    s_lshl_b32 s97, s96, 7
    s_add_u32 s97, s97, 97640448
    buffer_load_dword v25, v24, s[12:15], s97 offen sc1
    s_sub_u32 s70, s70, 1
    s_cbranch_scc1 Lexit_team
    s_waitcnt vmcnt(0)
    v_cmp_ne_u32 vcc, 28, v25
    s_nop 0
    s_or_b32 s97, vcc_lo, vcc_hi
    s_lshr_b32 vcc_lo, s97, 16
    s_or_b32 s97, s97, vcc_lo
    s_or_b32 s97, s97, 0x10000
    s_ff1_i32_b32 s97, s97
    s_add_u32 s96, s96, s97
    s_cmp_ge_u32 s96, 64
    s_cselect_b32 s96, 0x100, s96
    s_cmp_lt_u32 s98, s96
    s_cbranch_scc0 Lgl_main_kernel_141
Lgo_main_kernel_140:
    s_add_u32 s98, s98, 1
    buffer_load_dword v8, v5, s[12:15], s64 offen sc1
    buffer_load_dword v8, v6, s[12:15], s65 offen sc1
    buffer_load_dword v8, v4, s[12:15], s63 offen sc1
    s_add_u32 s66, s62, 0
    buffer_load_dword v8, v2, s[12:15], s66 offen sc1
    s_add_u32 s66, s62, 8192
    buffer_load_dword v8, v2, s[12:15], s66 offen sc1
    s_add_u32 s66, s62, 16384
    buffer_load_dword v8, v2, s[12:15], s66 offen sc1
    s_add_u32 s66, s62, 24576
    buffer_load_dword v8, v2, s[12:15], s66 offen sc1
    s_add_u32 s66, s62, 32768
    buffer_load_dword v8, v2, s[12:15], s66 offen sc1
    s_add_u32 s66, s62, 40960
    buffer_load_dword v8, v2, s[12:15], s66 offen sc1
    s_add_u32 s66, s62, 49152
    buffer_load_dword v8, v2, s[12:15], s66 offen sc1
    s_add_u32 s62, s62, 458752
    s_add_u32 s63, s63, 28672
    s_add_u32 s64, s64, 7168
    s_add_u32 s65, s65, 10240
    s_cmp_lt_u32 s98, s96
    s_cbranch_scc1 Lgo_main_kernel_142
    s_mov_b32 s70, 2097152
Lgl_main_kernel_143:
    v_mov_b32 v24, v1
    v_and_b32 v25, 0x780, v24
    v_lshrrev_b32 v24, 11, v24
    v_lshl_add_u32 v24, v24, 13, v25
    s_min_u32 s96, s96, 48
    s_lshl_b32 s97, s96, 7
    s_add_u32 s97, s97, 97640448
    buffer_load_dword v25, v24, s[12:15], s97 offen sc1
    s_sub_u32 s70, s70, 1
    s_cbranch_scc1 Lexit_team
    s_waitcnt vmcnt(0)
    v_cmp_ne_u32 vcc, 28, v25
    s_nop 0
    s_or_b32 s97, vcc_lo, vcc_hi
    s_lshr_b32 vcc_lo, s97, 16
    s_or_b32 s97, s97, vcc_lo
    s_or_b32 s97, s97, 0x10000
    s_ff1_i32_b32 s97, s97
    s_add_u32 s96, s96, s97
    s_cmp_ge_u32 s96, 64
    s_cselect_b32 s96, 0x100, s96
    s_cmp_lt_u32 s98, s96
    s_cbranch_scc0 Lgl_main_kernel_143
Lgo_main_kernel_142:
    s_add_u32 s98, s98, 1
    buffer_load_dword v8, v5, s[12:15], s64 offen sc1
    buffer_load_dword v8, v6, s[12:15], s65 offen sc1
    buffer_load_dword v8, v4, s[12:15], s63 offen sc1
    s_add_u32 s66, s62, 0
    buffer_load_dword v8, v3, s[12:15], s66 offen sc1
    s_add_u32 s66, s62, 8192
    buffer_load_dword v8, v3, s[12:15], s66 offen sc1
    s_add_u32 s66, s62, 16384
    buffer_load_dword v8, v3, s[12:15], s66 offen sc1
    s_add_u32 s66, s62, 24576
    buffer_load_dword v8, v3, s[12:15], s66 offen sc1
    s_add_u32 s66, s62, 32768
    buffer_load_dword v8, v3, s[12:15], s66 offen sc1
    s_add_u32 s66, s62, 40960
    buffer_load_dword v8, v3, s[12:15], s66 offen sc1
    s_add_u32 s66, s62, 49152
    buffer_load_dword v8, v3, s[12:15], s66 offen sc1
    s_add_u32 s62, s62, 458752
    s_add_u32 s63, s63, 28672
    s_add_u32 s64, s64, 7168
    s_add_u32 s65, s65, 10240
    s_add_u32 s61, s61, 7168
LP_main_kernel_144:
    s_cmp_ge_u32 s98, 63
    s_cbranch_scc1 LPn_main_kernel_148
    s_cmp_lt_u32 s98, s96
    s_cbranch_scc1 Lgo_main_kernel_150
    s_mov_b32 s70, 2097152
Lgl_main_kernel_151:
    v_mov_b32 v24, v1
    v_and_b32 v25, 0x780, v24
    v_lshrrev_b32 v24, 11, v24
    v_lshl_add_u32 v24, v24, 13, v25
    s_min_u32 s96, s96, 48
    s_lshl_b32 s97, s96, 7
    s_add_u32 s97, s97, 97640448
    buffer_load_dword v25, v24, s[12:15], s97 offen sc1
    s_sub_u32 s70, s70, 1
    s_cbranch_scc1 Lexit_team
    s_waitcnt vmcnt(0)
    v_cmp_ne_u32 vcc, 28, v25
    s_nop 0
    s_or_b32 s97, vcc_lo, vcc_hi
    s_lshr_b32 vcc_lo, s97, 16
    s_or_b32 s97, s97, vcc_lo
    s_or_b32 s97, s97, 0x10000
    s_ff1_i32_b32 s97, s97
    s_add_u32 s96, s96, s97
    s_cmp_ge_u32 s96, 64
    s_cselect_b32 s96, 0x100, s96
    s_cmp_lt_u32 s98, s96
    s_cbranch_scc0 Lgl_main_kernel_151
Lgo_main_kernel_150:
    s_add_u32 s98, s98, 1
    buffer_load_dword v8, v5, s[12:15], s64 offen sc1
    buffer_load_dword v8, v6, s[12:15], s65 offen sc1
    buffer_load_dword v8, v4, s[12:15], s63 offen sc1
    s_add_u32 s66, s62, 0
    buffer_load_dword v8, v3, s[12:15], s66 offen sc1
    s_add_u32 s66, s62, 8192
    buffer_load_dword v8, v3, s[12:15], s66 offen sc1
    s_add_u32 s66, s62, 16384
    buffer_load_dword v8, v3, s[12:15], s66 offen sc1
    buffer_load_dword v9, v7, s[12:15], s61 offen sc1
    s_add_u32 s66, s62, 24576
    buffer_load_dword v8, v3, s[12:15], s66 offen sc1
    s_add_u32 s66, s62, 32768
    buffer_load_dword v8, v3, s[12:15], s66 offen sc1
    s_add_u32 s66, s62, 40960
    buffer_load_dword v8, v3, s[12:15], s66 offen sc1
    s_add_u32 s66, s62, 49152
    buffer_load_dword v8, v3, s[12:15], s66 offen sc1
    s_add_u32 s62, s62, 458752
    s_add_u32 s63, s63, 28672
    s_add_u32 s64, s64, 7168
    s_add_u32 s65, s65, 10240
    s_waitcnt vmcnt(4)
    v_cmp_eq_u32 vcc, -1, v9
    s_cbranch_vccz LPg_main_kernel_146
LPn_main_kernel_148:
    s_mov_b32 s70, 2097152
LPp_main_kernel_145:
    buffer_load_dword v9, v7, s[12:15], s61 offen sc1
    s_sub_u32 s70, s70, 1
    s_cbranch_scc1 Lexit_team
    s_waitcnt vmcnt(0)
    v_cmp_eq_u32 vcc, -1, v9
    s_cbranch_vccnz LPp_main_kernel_145
LPg_main_kernel_146:
    s_cmp_lg_u32 s94, 0
    s_cbranch_scc1 LPq_main_kernel_149
    v_mov_b32 v13, s95
    s_mov_b64 exec, 1
    buffer_store_dword v13, v12, s[12:15], s99 offen sc1
    s_mov_b64 exec, -1
LPq_main_kernel_149:
    s_add_u32 s61, s61, 7168
    s_add_u32 s95, s95, 1
    s_cmp_le_u32 s95, 63
    s_cbranch_scc1 LP_main_kernel_144
LPe_main_kernel_147:
    s_add_u32 s12, s44, 82182144
    s_addc_u32 s13, s45, 0
    s_and_b32 s13, s13, 0xffff
    s_mov_b32 s14, 186253312
    s_add_u32 s0, s0, 1
    s_cmp_lt_u32 s0, 2
    s_cbranch_scc1 Ltop_main_kernel_139
    s_endpgm
Lexit_team:
    s_endpgm
Lbulk_main_kernel_1:
    s_sub_u32 s100, s46, 1
    s_lshl_b32 s100, s100, 5
    s_add_u32 s100, s100, s59
    v_and_b32 v2, 15, v0
    v_lshrrev_b32 v3, 4, v0
    v_lshrrev_b32 v4, 2, v2
    v_lshlrev_b32 v4, 3, v4
    v_and_b32 v5, 3, v2
    v_add_u32 v4, v4, v5
    v_lshlrev_b32 v6, 4, v0
    s_mul_i32 s47, s100, 9363
    s_lshr_b32 s47, s47, 16
    s_mul_i32 s48, s47, 7
    s_sub_u32 s48, s100, s48
    s_and_b32 s49, s47, 15
    s_lshr_b32 s50, s47, 4
    s_cmp_eq_u32 s50, 0
    s_cselect_b32 s8, s20, s24
    s_cselect_b32 s9, s21, s25
    s_and_b32 s9, s9, 0xffff
    s_mov_b32 s10, 3670016
    s_mov_b32 s11, 0x20000
    s_lshl_b32 s51, s49, 9
    v_lshrrev_b32 v9, 2, v0
    v_lshlrev_b32 v9, 13, v9
    v_and_b32 v10, 3, v0
    v_lshl_add_u32 v9, v10, 7, v9
    s_lshl_b32 s54, s48, 2
    s_add_u32 s54, s54, s3
    s_lshl_b32 s54, s54, 17
    s_add_u32 s54, s54, s51
    buffer_load_dword v58, v9, s[8:11], s54 offen
    v_lshrrev_b32 v9, 3, v0
    v_and_b32 v10, 7, v0
    v_xor_b32 v10, v10, v9
    v_lshrrev_b32 v11, 5, v0
    v_and_b32 v9, 3, v9
    v_lshl_add_u32 v9, v11, 3, v9
    v_lshlrev_b32 v8, 13, v9
    v_lshl_add_u32 v8, v10, 4, v8
    v_and_b32 v9, 7, v0
    v_xor_b32 v10, v3, v9
    v_lshl_add_u32 v10, v9, 3, v10
    v_lshlrev_b32 v10, 4, v10
    v_bfe_u32 v9, v0, 3, 1
    v_lshl_add_u32 v10, v9, 12, v10
    s_lshl_b32 s60, s3, 14
    s_add_u32 s60, s60, 90112
    v_add_u32 v56, s60, v10
    v_xor_b32 v57, 64, v56
    s_lshl_b32 s61, s3, 13
    s_mov_b32 s64, s22
    s_and_b32 s65, s23, 0xffff
    s_mov_b32 s66, 0x380000
    s_mov_b32 s67, 0x20000
    s_cmp_eq_u32 s50, 1
    s_cbranch_scc1 L_main_kernel_152
    s_lshr_b32 s53, s3, 1
    s_lshl_b32 s53, s53, 5
    s_and_b32 s54, s3, 1
    s_lshl_b32 s54, s54, 2
    s_add_u32 s53, s53, s54
    s_lshl_b32 s54, s48, 6
    s_add_u32 s53, s53, s54
    s_lshl_b32 s54, s53, 13
    s_add_u32 s54, s54, s51
    s_add_u32 s55, s54, 131072
    s_add_u32 m0, s61, 0
    s_nop 0
    buffer_load_dwordx4 v8, s[64:67], s54 offen offset:0 lds
    s_add_u32 m0, s61, 896
    s_nop 0
    buffer_load_dwordx4 v8, s[64:67], s54 offen offset:128 lds
    s_add_u32 m0, s61, 1792
    s_nop 0
    buffer_load_dwordx4 v8, s[64:67], s54 offen offset:256 lds
    s_add_u32 m0, s61, 2688
    s_nop 0
    buffer_load_dwordx4 v8, s[64:67], s54 offen offset:384 lds
    s_add_u32 m0, s61, 4096
    s_nop 0
    buffer_load_dwordx4 v8, s[64:67], s55 offen offset:0 lds
    s_add_u32 m0, s61, 4992
    s_nop 0
    buffer_load_dwordx4 v8, s[64:67], s55 offen offset:128 lds
    s_add_u32 m0, s61, 5888
    s_nop 0
    buffer_load_dwordx4 v8, s[64:67], s55 offen offset:256 lds
    s_add_u32 m0, s61, 6784
    s_nop 0
    buffer_load_dwordx4 v8, s[64:67], s55 offen offset:384 lds
    s_branch L_main_kernel_153
L_main_kernel_152:
    s_mov_b32 s64, s26
    s_and_b32 s65, s27, 0xffff
    s_mov_b32 s66, 0x380000
    s_mov_b32 s67, 0x20000
    v_lshrrev_b32 v9, 3, v0
    v_mul_u32_u24 v9, 896, v9
    v_and_b32 v11, 7, v0
    v_lshl_add_u32 v9, v11, 4, v9
    s_mul_i32 s54, s49, 229376
    s_lshl_b32 s55, s48, 7
    s_add_u32 s54, s54, s55
    s_mul_i32 s55, s3, 57344
    s_add_u32 s54, s54, s55
    s_add_u32 m0, s61, 0
    s_nop 0
    buffer_load_dwordx4 v9, s[64:67], s54 offen lds
    s_add_u32 s54, s54, 7168
    s_add_u32 m0, s61, 1024
    s_nop 0
    buffer_load_dwordx4 v9, s[64:67], s54 offen lds
    s_add_u32 s54, s54, 7168
    s_add_u32 m0, s61, 2048
    s_nop 0
    buffer_load_dwordx4 v9, s[64:67], s54 offen lds
    s_add_u32 s54, s54, 7168
    s_add_u32 m0, s61, 3072
    s_nop 0
    buffer_load_dwordx4 v9, s[64:67], s54 offen lds
    s_add_u32 s54, s54, 7168
    s_add_u32 m0, s61, 4096
    s_nop 0
    buffer_load_dwordx4 v9, s[64:67], s54 offen lds
    s_add_u32 s54, s54, 7168
    s_add_u32 m0, s61, 5120
    s_nop 0
    buffer_load_dwordx4 v9, s[64:67], s54 offen lds
    s_add_u32 s54, s54, 7168
    s_add_u32 m0, s61, 6144
    s_nop 0
    buffer_load_dwordx4 v9, s[64:67], s54 offen lds
    s_add_u32 s54, s54, 7168
    s_add_u32 m0, s61, 7168
    s_nop 0
    buffer_load_dwordx4 v9, s[64:67], s54 offen lds
L_main_kernel_153:
    s_add_u32 s54, s3, 0
    s_lshl_b32 s54, s54, 18
    s_add_u32 s54, s54, s51
    s_add_u32 s55, s54, 131072
    s_add_u32 m0, s60, 0
    s_nop 0
    buffer_load_dwordx4 v8, s[8:11], s54 offen offset:0 lds
    s_add_u32 m0, s60, 896
    s_nop 0
    buffer_load_dwordx4 v8, s[8:11], s54 offen offset:128 lds
    s_add_u32 m0, s60, 1792
    s_nop 0
    buffer_load_dwordx4 v8, s[8:11], s54 offen offset:256 lds
    s_add_u32 m0, s60, 2688
    s_nop 0
    buffer_load_dwordx4 v8, s[8:11], s54 offen offset:384 lds
    s_add_u32 m0, s60, 4096
    s_nop 0
    buffer_load_dwordx4 v8, s[8:11], s55 offen offset:0 lds
    s_add_u32 m0, s60, 4992
    s_nop 0
    buffer_load_dwordx4 v8, s[8:11], s55 offen offset:128 lds
    s_add_u32 m0, s60, 5888
    s_nop 0
    buffer_load_dwordx4 v8, s[8:11], s55 offen offset:256 lds
    s_add_u32 m0, s60, 6784
    s_nop 0
    buffer_load_dwordx4 v8, s[8:11], s55 offen offset:384 lds
    s_add_u32 s54, s3, 0
    s_lshl_b32 s54, s54, 18
    s_add_u32 s54, s54, s51
    s_add_u32 s54, s54, 32768
    s_add_u32 s55, s54, 131072
    s_add_u32 m0, s60, 8192
    s_nop 0
    buffer_load_dwordx4 v8, s[8:11], s54 offen offset:0 lds
    s_add_u32 m0, s60, 9088
    s_nop 0
    buffer_load_dwordx4 v8, s[8:11], s54 offen offset:128 lds
    s_add_u32 m0, s60, 9984
    s_nop 0
    buffer_load_dwordx4 v8, s[8:11], s54 offen offset:256 lds
    s_add_u32 m0, s60, 10880
    s_nop 0
    buffer_load_dwordx4 v8, s[8:11], s54 offen offset:384 lds
    s_add_u32 m0, s60, 12288
    s_nop 0
    buffer_load_dwordx4 v8, s[8:11], s55 offen offset:0 lds
    s_add_u32 m0, s60, 13184
    s_nop 0
    buffer_load_dwordx4 v8, s[8:11], s55 offen offset:128 lds
    s_add_u32 m0, s60, 14080
    s_nop 0
    buffer_load_dwordx4 v8, s[8:11], s55 offen offset:256 lds
    s_add_u32 m0, s60, 14976
    s_nop 0
    buffer_load_dwordx4 v8, s[8:11], s55 offen offset:384 lds
    s_lshl_b32 s46, s100, 2
    s_add_u32 s46, s46, s3
    s_cmp_ge_u32 s46, 812
    s_cbranch_scc1 L_main_kernel_156
    s_cmp_ge_u32 s46, 784
    s_cbranch_scc1 L_main_kernel_155
    s_cmp_ge_u32 s46, 392
    s_cbranch_scc1 L_main_kernel_154
    s_sub_u32 s52, s46, 0
    s_mul_i32 s53, s52, 4682
    s_lshr_b32 s53, s53, 16
    s_mul_i32 s54, s53, 14
    s_sub_u32 s54, s52, s54
    s_lshl_b32 s52, s52, 10
    s_mov_b32 s64, s32
    s_and_b32 s65, s33, 0xffff
    s_mov_b32 s66, 0x62000
    s_mov_b32 s67, 0x20000
    s_mov_b32 s55, 896
    s_lshl_b32 s53, s53, 4
    v_add_u32 v7, s53, v2
    s_add_u32 s52, s52, 12845056
    s_branch L_main_kernel_157
L_main_kernel_154:
    s_sub_u32 s52, s46, 392
    s_mul_i32 s53, s52, 4682
    s_lshr_b32 s53, s53, 16
    s_mul_i32 s54, s53, 14
    s_sub_u32 s54, s52, s54
    s_lshl_b32 s52, s52, 10
    s_mov_b32 s64, s38
    s_and_b32 s65, s39, 0xffff
    s_mov_b32 s66, 0x62000
    s_mov_b32 s67, 0x20000
    s_mov_b32 s55, 896
    s_and_b32 s56, s53, 1
    s_lshr_b32 s53, s53, 1
    s_lshl_b32 s53, s53, 5
    s_lshl_b32 s56, s56, 2
    s_add_u32 s53, s53, s56
    v_add_u32 v7, s53, v4
    s_add_u32 s52, s52, 13246464
    s_branch L_main_kernel_157
L_main_kernel_155:
    s_sub_u32 s52, s46, 784
    s_mul_i32 s53, s52, 4682
    s_lshr_b32 s53, s53, 16
    s_mul_i32 s54, s53, 14
    s_sub_u32 s54, s52, s54
    s_lshl_b32 s52, s52, 10
    s_mov_b32 s64, s34
    s_and_b32 s65, s35, 0xffff
    s_mov_b32 s66, 0x6200
    s_mov_b32 s67, 0x20000
    s_mov_b32 s55, 56
    s_lshl_b32 s53, s53, 2
    v_add_u32 v7, s53, v4
    s_add_u32 s52, s52, 13647872
    s_branch L_main_kernel_157
L_main_kernel_156:
    s_sub_u32 s52, s46, 812
    s_mul_i32 s53, s52, 4682
    s_lshr_b32 s53, s53, 16
    s_mul_i32 s54, s53, 14
    s_sub_u32 s54, s52, s54
    s_lshl_b32 s52, s52, 10
    s_mov_b32 s64, s36
    s_and_b32 s65, s37, 0xffff
    s_mov_b32 s66, 0x6200
    s_mov_b32 s67, 0x20000
    s_mov_b32 s55, 56
    s_lshl_b32 s53, s53, 4
    v_add_u32 v7, s53, v2
    s_add_u32 s52, s52, 13676544
    s_cmp_ge_u32 s46, 840
    s_cselect_b32 s52, 97402880, s52
L_main_kernel_157:
    s_lshl_b32 s53, s54, 5
    v_lshlrev_b32 v12, 3, v3
    v_add_u32 v12, s53, v12
    v_mul_lo_u32 v12, v12, s55
    v_lshlrev_b32 v11, 1, v7
    v_cmp_le_u32 vcc, s55, v11
    v_add_u32 v12, v12, v11
    v_mov_b32 v11, 0x7fffffff
    v_cndmask_b32 v12, v12, v11, vcc
    s_mov_b32 s53, 0
    buffer_load_ushort v48, v12, s[64:67], s53 offen
    s_add_u32 s53, s53, s55
    buffer_load_ushort v49, v12, s[64:67], s53 offen
    s_add_u32 s53, s53, s55
    buffer_load_ushort v50, v12, s[64:67], s53 offen
    s_add_u32 s53, s53, s55
    buffer_load_ushort v51, v12, s[64:67], s53 offen
    s_add_u32 s53, s53, s55
    buffer_load_ushort v52, v12, s[64:67], s53 offen
    s_add_u32 s53, s53, s55
    buffer_load_ushort v53, v12, s[64:67], s53 offen
    s_add_u32 s53, s53, s55
    buffer_load_ushort v54, v12, s[64:67], s53 offen
    s_add_u32 s53, s53, s55
    buffer_load_ushort v55, v12, s[64:67], s53 offen
    s_waitcnt vmcnt(24)
    s_barrier
    s_mov_b32 s64, s42
    s_and_b32 s65, s43, 0xffff
    s_mov_b32 s66, 0x100
    s_mov_b32 s67, 0x20000
    v_mov_b32 v13, 64
    s_cmp_eq_u32 s50, 0
    s_cbranch_scc1 L_main_kernel_158
    v_bfe_u32 v9, v0, 2, 2
    v_lshl_add_u32 v9, v3, 3, v9
    v_lshlrev_b32 v9, 7, v9
    v_and_b32 v11, 3, v0
    v_lshl_add_u32 v9, v11, 4, v9
    ds_read_b64_tr_b16 v[64:65], v9 offset:0
    ds_read_b64_tr_b16 v[66:67], v9 offset:512
    ds_read_b64_tr_b16 v[68:69], v9 offset:4096
    ds_read_b64_tr_b16 v[70:71], v9 offset:4608
    ds_read_b64_tr_b16 v[72:73], v9 offset:8192
    ds_read_b64_tr_b16 v[74:75], v9 offset:8704
    ds_read_b64_tr_b16 v[76:77], v9 offset:12288
    ds_read_b64_tr_b16 v[78:79], v9 offset:12800
    s_waitcnt lgkmcnt(4)
    ds_read_b64_tr_b16 v[80:81], v9 offset:16384
    ds_read_b64_tr_b16 v[82:83], v9 offset:16896
    ds_read_b64_tr_b16 v[84:85], v9 offset:20480
    ds_read_b64_tr_b16 v[86:87], v9 offset:20992
    ds_read_b64_tr_b16 v[88:89], v9 offset:24576
    ds_read_b64_tr_b16 v[90:91], v9 offset:25088
    ds_read_b64_tr_b16 v[92:93], v9 offset:28672
    ds_read_b64_tr_b16 v[94:95], v9 offset:29184
    s_waitcnt lgkmcnt(4)
    ds_read_b64_tr_b16 v[96:97], v9 offset:8
    ds_read_b64_tr_b16 v[98:99], v9 offset:520
    ds_read_b64_tr_b16 v[100:101], v9 offset:4104
    ds_read_b64_tr_b16 v[102:103], v9 offset:4616
    ds_read_b64_tr_b16 v[104:105], v9 offset:8200
    ds_read_b64_tr_b16 v[106:107], v9 offset:8712
    ds_read_b64_tr_b16 v[108:109], v9 offset:12296
    ds_read_b64_tr_b16 v[110:111], v9 offset:12808
    s_waitcnt lgkmcnt(4)
    ds_read_b64_tr_b16 v[112:113], v9 offset:16392
    ds_read_b64_tr_b16 v[114:115], v9 offset:16904
    ds_read_b64_tr_b16 v[116:117], v9 offset:20488
    ds_read_b64_tr_b16 v[118:119], v9 offset:21000
    ds_read_b64_tr_b16 v[120:121], v9 offset:24584
    ds_read_b64_tr_b16 v[122:123], v9 offset:25096
    ds_read_b64_tr_b16 v[124:125], v9 offset:28680
    ds_read_b64_tr_b16 v[126:127], v9 offset:29192
    s_waitcnt lgkmcnt(4)
    ds_read_b64_tr_b16 v[128:129], v9 offset:64
    ds_read_b64_tr_b16 v[130:131], v9 offset:576
    ds_read_b64_tr_b16 v[132:133], v9 offset:4160
    ds_read_b64_tr_b16 v[134:135], v9 offset:4672
    ds_read_b64_tr_b16 v[136:137], v9 offset:8256
    ds_read_b64_tr_b16 v[138:139], v9 offset:8768
    ds_read_b64_tr_b16 v[140:141], v9 offset:12352
    ds_read_b64_tr_b16 v[142:143], v9 offset:12864
    s_waitcnt lgkmcnt(4)
    ds_read_b64_tr_b16 v[144:145], v9 offset:16448
    ds_read_b64_tr_b16 v[146:147], v9 offset:16960
    ds_read_b64_tr_b16 v[148:149], v9 offset:20544
    ds_read_b64_tr_b16 v[150:151], v9 offset:21056
    ds_read_b64_tr_b16 v[152:153], v9 offset:24640
    ds_read_b64_tr_b16 v[154:155], v9 offset:25152
    ds_read_b64_tr_b16 v[156:157], v9 offset:28736
    ds_read_b64_tr_b16 v[158:159], v9 offset:29248
    s_waitcnt lgkmcnt(4)
    ds_read_b64_tr_b16 v[160:161], v9 offset:72
    ds_read_b64_tr_b16 v[162:163], v9 offset:584
    ds_read_b64_tr_b16 v[164:165], v9 offset:4168
    ds_read_b64_tr_b16 v[166:167], v9 offset:4680
    ds_read_b64_tr_b16 v[168:169], v9 offset:8264
    ds_read_b64_tr_b16 v[170:171], v9 offset:8776
    ds_read_b64_tr_b16 v[172:173], v9 offset:12360
    ds_read_b64_tr_b16 v[174:175], v9 offset:12872
    s_waitcnt lgkmcnt(4)
    ds_read_b64_tr_b16 v[176:177], v9 offset:16456
    ds_read_b64_tr_b16 v[178:179], v9 offset:16968
    ds_read_b64_tr_b16 v[180:181], v9 offset:20552
    ds_read_b64_tr_b16 v[182:183], v9 offset:21064
    ds_read_b64_tr_b16 v[184:185], v9 offset:24648
    ds_read_b64_tr_b16 v[186:187], v9 offset:25160
    ds_read_b64_tr_b16 v[188:189], v9 offset:28744
    ds_read_b64_tr_b16 v[190:191], v9 offset:29256
    s_waitcnt lgkmcnt(4)
    s_branch L_main_kernel_159
L_main_kernel_158:
    v_xor_b32 v11, 64, v10
    ds_read_b128 v[64:67], v10 offset:0
    ds_read_b128 v[68:71], v11 offset:0
    ds_read_b128 v[72:75], v10 offset:1024
    ds_read_b128 v[76:79], v11 offset:1024
    ds_read_b128 v[80:83], v10 offset:2048
    ds_read_b128 v[84:87], v11 offset:2048
    ds_read_b128 v[88:91], v10 offset:3072
    ds_read_b128 v[92:95], v11 offset:3072
    s_waitcnt lgkmcnt(4)
    ds_read_b128 v[96:99], v10 offset:8192
    ds_read_b128 v[100:103], v11 offset:8192
    ds_read_b128 v[104:107], v10 offset:9216
    ds_read_b128 v[108:111], v11 offset:9216
    ds_read_b128 v[112:115], v10 offset:10240
    ds_read_b128 v[116:119], v11 offset:10240
    ds_read_b128 v[120:123], v10 offset:11264
    ds_read_b128 v[124:127], v11 offset:11264
    s_waitcnt lgkmcnt(4)
    ds_read_b128 v[128:131], v10 offset:16384
    ds_read_b128 v[132:135], v11 offset:16384
    ds_read_b128 v[136:139], v10 offset:17408
    ds_read_b128 v[140:143], v11 offset:17408
    ds_read_b128 v[144:147], v10 offset:18432
    ds_read_b128 v[148:151], v11 offset:18432
    ds_read_b128 v[152:155], v10 offset:19456
    ds_read_b128 v[156:159], v11 offset:19456
    s_waitcnt lgkmcnt(4)
    ds_read_b128 v[160:163], v10 offset:24576
    ds_read_b128 v[164:167], v11 offset:24576
    ds_read_b128 v[168:171], v10 offset:25600
    ds_read_b128 v[172:175], v11 offset:25600
    ds_read_b128 v[176:179], v10 offset:26624
    ds_read_b128 v[180:183], v11 offset:26624
    ds_read_b128 v[184:187], v10 offset:27648
    ds_read_b128 v[188:191], v11 offset:27648
    s_waitcnt lgkmcnt(4)
L_main_kernel_159:
    s_cmp_eq_u32 s50, 0
    s_cselect_b32 s56, 0x3db8aa3b, 0x3f800000
    s_cselect_b32 s57, 0, 6422528
    s_mul_i32 s58, s49, 28
    s_lshl_b32 s59, s48, 2
    s_add_u32 s58, s58, s59
    s_mul_i32 s58, s58, 14336
    s_add_u32 s57, s57, s58
    s_lshl_b32 s58, s3, 10
    s_add_u32 s58, s58, 32768
    v_add_u32 v9, s58, v6
    s_lshl_b32 s62, s100, 7
    s_add_u32 s62, s62, 97738752
    s_lshl_b32 s63, s3, 2
    v_mov_b32 v60, s63
    s_lshl_b32 s58, s3, 10
    s_add_u32 s57, s57, s58
    s_mov_b32 s56, s56
    v_mov_b32 v62, s56
    v_mov_b32 v63, s56
    s_waitcnt vmcnt(16)
    ds_read_b128 a[0:3], v56 offset:0
    ds_read_b128 a[4:7], v57 offset:0
    ds_read_b128 a[8:11], v56 offset:1024
    ds_read_b128 a[12:15], v57 offset:1024
    ds_read_b128 a[16:19], v56 offset:2048
    ds_read_b128 a[20:23], v57 offset:2048
    ds_read_b128 a[24:27], v56 offset:3072
    ds_read_b128 a[28:31], v57 offset:3072
    s_waitcnt vmcnt(8)
    ds_read_b128 a[32:35], v56 offset:8192
    ds_read_b128 a[36:39], v57 offset:8192
    ds_read_b128 a[40:43], v56 offset:9216
    ds_read_b128 a[44:47], v57 offset:9216
    ds_read_b128 a[48:51], v56 offset:10240
    ds_read_b128 a[52:55], v57 offset:10240
    ds_read_b128 a[56:59], v56 offset:11264
    ds_read_b128 a[60:63], v57 offset:11264
    s_waitcnt lgkmcnt(0)
    v_mfma_f32_16x16x32_bf16 v[192:195], a[0:3], v[64:67], 0
    v_mfma_f32_16x16x32_bf16 v[196:199], a[0:3], v[96:99], 0
    v_mfma_f32_16x16x32_bf16 v[200:203], a[0:3], v[128:131], 0
    v_mfma_f32_16x16x32_bf16 v[204:207], a[0:3], v[160:163], 0
    s_add_u32 s54, s3, 4
    v_mfma_f32_16x16x32_bf16 v[208:211], a[32:35], v[64:67], 0
    s_lshl_b32 s54, s54, 18
    v_mfma_f32_16x16x32_bf16 v[212:215], a[32:35], v[96:99], 0
    s_add_u32 s54, s54, s51
    v_mfma_f32_16x16x32_bf16 v[216:219], a[32:35], v[128:131], 0
    s_add_u32 s55, s54, 131072
    v_mfma_f32_16x16x32_bf16 v[220:223], a[32:35], v[160:163], 0
    s_add_u32 m0, s60, 0
    v_mfma_f32_16x16x32_bf16 v[192:195], a[4:7], v[68:71], v[192:195]
    buffer_load_dwordx4 v8, s[8:11], s54 offen offset:0 lds
    v_mfma_f32_16x16x32_bf16 v[196:199], a[4:7], v[100:103], v[196:199]
    s_add_u32 m0, s60, 896
    v_mfma_f32_16x16x32_bf16 v[200:203], a[4:7], v[132:135], v[200:203]
    buffer_load_dwordx4 v8, s[8:11], s54 offen offset:128 lds
    v_mfma_f32_16x16x32_bf16 v[204:207], a[4:7], v[164:167], v[204:207]
    s_add_u32 m0, s60, 1792
    v_mfma_f32_16x16x32_bf16 v[208:211], a[36:39], v[68:71], v[208:211]
    buffer_load_dwordx4 v8, s[8:11], s54 offen offset:256 lds
    v_mfma_f32_16x16x32_bf16 v[212:215], a[36:39], v[100:103], v[212:215]
    s_add_u32 m0, s60, 2688
    v_mfma_f32_16x16x32_bf16 v[216:219], a[36:39], v[132:135], v[216:219]
    buffer_load_dwordx4 v8, s[8:11], s54 offen offset:384 lds
    v_mfma_f32_16x16x32_bf16 v[220:223], a[36:39], v[164:167], v[220:223]
    s_add_u32 m0, s60, 4096
    v_mfma_f32_16x16x32_bf16 v[192:195], a[8:11], v[72:75], v[192:195]
    buffer_load_dwordx4 v8, s[8:11], s55 offen offset:0 lds
    v_mfma_f32_16x16x32_bf16 v[196:199], a[8:11], v[104:107], v[196:199]
    s_add_u32 m0, s60, 4992
    v_mfma_f32_16x16x32_bf16 v[200:203], a[8:11], v[136:139], v[200:203]
    buffer_load_dwordx4 v8, s[8:11], s55 offen offset:128 lds
    v_mfma_f32_16x16x32_bf16 v[204:207], a[8:11], v[168:171], v[204:207]
    s_add_u32 m0, s60, 5888
    v_mfma_f32_16x16x32_bf16 v[208:211], a[40:43], v[72:75], v[208:211]
    buffer_load_dwordx4 v8, s[8:11], s55 offen offset:256 lds
    v_mfma_f32_16x16x32_bf16 v[212:215], a[40:43], v[104:107], v[212:215]
    s_add_u32 m0, s60, 6784
    v_mfma_f32_16x16x32_bf16 v[216:219], a[40:43], v[136:139], v[216:219]
    buffer_load_dwordx4 v8, s[8:11], s55 offen offset:384 lds
    v_mfma_f32_16x16x32_bf16 v[220:223], a[40:43], v[168:171], v[220:223]
    s_add_u32 s54, s3, 4
    v_mfma_f32_16x16x32_bf16 v[192:195], a[12:15], v[76:79], v[192:195]
    s_lshl_b32 s54, s54, 18
    v_mfma_f32_16x16x32_bf16 v[196:199], a[12:15], v[108:111], v[196:199]
    s_add_u32 s54, s54, s51
    v_mfma_f32_16x16x32_bf16 v[200:203], a[12:15], v[140:143], v[200:203]
    s_add_u32 s54, s54, 32768
    v_mfma_f32_16x16x32_bf16 v[204:207], a[12:15], v[172:175], v[204:207]
    s_add_u32 s55, s54, 131072
    v_mfma_f32_16x16x32_bf16 v[208:211], a[44:47], v[76:79], v[208:211]
    s_add_u32 m0, s60, 8192
    v_mfma_f32_16x16x32_bf16 v[212:215], a[44:47], v[108:111], v[212:215]
    buffer_load_dwordx4 v8, s[8:11], s54 offen offset:0 lds
    v_mfma_f32_16x16x32_bf16 v[216:219], a[44:47], v[140:143], v[216:219]
    s_add_u32 m0, s60, 9088
    v_mfma_f32_16x16x32_bf16 v[220:223], a[44:47], v[172:175], v[220:223]
    buffer_load_dwordx4 v8, s[8:11], s54 offen offset:128 lds
    v_mfma_f32_16x16x32_bf16 v[192:195], a[16:19], v[80:83], v[192:195]
    s_add_u32 m0, s60, 9984
    v_mfma_f32_16x16x32_bf16 v[196:199], a[16:19], v[112:115], v[196:199]
    buffer_load_dwordx4 v8, s[8:11], s54 offen offset:256 lds
    v_mfma_f32_16x16x32_bf16 v[200:203], a[16:19], v[144:147], v[200:203]
    s_add_u32 m0, s60, 10880
    v_mfma_f32_16x16x32_bf16 v[204:207], a[16:19], v[176:179], v[204:207]
    buffer_load_dwordx4 v8, s[8:11], s54 offen offset:384 lds
    v_mfma_f32_16x16x32_bf16 v[208:211], a[48:51], v[80:83], v[208:211]
    s_add_u32 m0, s60, 12288
    v_mfma_f32_16x16x32_bf16 v[212:215], a[48:51], v[112:115], v[212:215]
    buffer_load_dwordx4 v8, s[8:11], s55 offen offset:0 lds
    v_mfma_f32_16x16x32_bf16 v[216:219], a[48:51], v[144:147], v[216:219]
    s_add_u32 m0, s60, 13184
    v_mfma_f32_16x16x32_bf16 v[220:223], a[48:51], v[176:179], v[220:223]
    buffer_load_dwordx4 v8, s[8:11], s55 offen offset:128 lds
    v_mfma_f32_16x16x32_bf16 v[192:195], a[20:23], v[84:87], v[192:195]
    s_add_u32 m0, s60, 14080
    v_mfma_f32_16x16x32_bf16 v[196:199], a[20:23], v[116:119], v[196:199]
    buffer_load_dwordx4 v8, s[8:11], s55 offen offset:256 lds
    v_mfma_f32_16x16x32_bf16 v[200:203], a[20:23], v[148:151], v[200:203]
    s_add_u32 m0, s60, 14976
    v_mfma_f32_16x16x32_bf16 v[204:207], a[20:23], v[180:183], v[204:207]
    buffer_load_dwordx4 v8, s[8:11], s55 offen offset:384 lds
    v_mfma_f32_16x16x32_bf16 v[208:211], a[52:55], v[84:87], v[208:211]
    buffer_load_dword v14, v13, s[64:67], 0 offen sc1
    v_mfma_f32_16x16x32_bf16 v[212:215], a[52:55], v[116:119], v[212:215]
    v_mfma_f32_16x16x32_bf16 v[216:219], a[52:55], v[148:151], v[216:219]
    v_mfma_f32_16x16x32_bf16 v[220:223], a[52:55], v[180:183], v[220:223]
    v_mfma_f32_16x16x32_bf16 v[192:195], a[24:27], v[88:91], v[192:195]
    v_mfma_f32_16x16x32_bf16 v[196:199], a[24:27], v[120:123], v[196:199]
    v_mfma_f32_16x16x32_bf16 v[200:203], a[24:27], v[152:155], v[200:203]
    v_mfma_f32_16x16x32_bf16 v[204:207], a[24:27], v[184:187], v[204:207]
    v_mfma_f32_16x16x32_bf16 v[208:211], a[56:59], v[88:91], v[208:211]
    v_mfma_f32_16x16x32_bf16 v[212:215], a[56:59], v[120:123], v[212:215]
    v_mfma_f32_16x16x32_bf16 v[216:219], a[56:59], v[152:155], v[216:219]
    v_mfma_f32_16x16x32_bf16 v[220:223], a[56:59], v[184:187], v[220:223]
    v_mfma_f32_16x16x32_bf16 v[192:195], a[28:31], v[92:95], v[192:195]
    v_mfma_f32_16x16x32_bf16 v[196:199], a[28:31], v[124:127], v[196:199]
    v_mfma_f32_16x16x32_bf16 v[200:203], a[28:31], v[156:159], v[200:203]
    v_mfma_f32_16x16x32_bf16 v[204:207], a[28:31], v[188:191], v[204:207]
    v_mfma_f32_16x16x32_bf16 v[208:211], a[60:63], v[92:95], v[208:211]
    v_mfma_f32_16x16x32_bf16 v[212:215], a[60:63], v[124:127], v[212:215]
    v_mfma_f32_16x16x32_bf16 v[216:219], a[60:63], v[156:159], v[216:219]
    v_mfma_f32_16x16x32_bf16 v[220:223], a[60:63], v[188:191], v[220:223]
    s_waitcnt vmcnt(9)
    ds_read_b128 a[64:67], v56 offset:0
    ds_read_b128 a[68:71], v57 offset:0
    ds_read_b128 a[72:75], v56 offset:1024
    ds_read_b128 a[76:79], v57 offset:1024
    ds_read_b128 a[80:83], v56 offset:2048
    ds_read_b128 a[84:87], v57 offset:2048
    ds_read_b128 a[88:91], v56 offset:3072
    ds_read_b128 a[92:95], v57 offset:3072
    s_waitcnt vmcnt(1)
    ds_read_b128 a[96:99], v56 offset:8192
    ds_read_b128 a[100:103], v57 offset:8192
    ds_read_b128 a[104:107], v56 offset:9216
    ds_read_b128 a[108:111], v57 offset:9216
    ds_read_b128 a[112:115], v56 offset:10240
    ds_read_b128 a[116:119], v57 offset:10240
    ds_read_b128 a[120:123], v56 offset:11264
    ds_read_b128 a[124:127], v57 offset:11264
    s_waitcnt lgkmcnt(0)
    v_mfma_f32_16x16x32_bf16 v[16:19], a[64:67], v[64:67], 0
    v_mfma_f32_16x16x32_bf16 v[20:23], a[64:67], v[96:99], 0
    v_mfma_f32_16x16x32_bf16 v[24:27], a[64:67], v[128:131], 0
    v_mfma_f32_16x16x32_bf16 v[28:31], a[64:67], v[160:163], 0
    s_add_u32 s54, s3, 8
    s_lshl_b32 s54, s54, 18
    v_mfma_f32_16x16x32_bf16 v[32:35], a[96:99], v[64:67], 0
    s_add_u32 s54, s54, s51
    s_add_u32 s55, s54, 131072
    v_mfma_f32_16x16x32_bf16 v[36:39], a[96:99], v[96:99], 0
    s_add_u32 m0, s60, 0
    s_nop 0
    buffer_load_dwordx4 v8, s[8:11], s54 offen offset:0 lds
    v_mfma_f32_16x16x32_bf16 v[40:43], a[96:99], v[128:131], 0
    s_add_u32 m0, s60, 896
    s_nop 0
    buffer_load_dwordx4 v8, s[8:11], s54 offen offset:128 lds
    v_mfma_f32_16x16x32_bf16 v[44:47], a[96:99], v[160:163], 0
    s_add_u32 m0, s60, 1792
    s_nop 0
    buffer_load_dwordx4 v8, s[8:11], s54 offen offset:256 lds
    v_mfma_f32_16x16x32_bf16 v[16:19], a[68:71], v[68:71], v[16:19]
    s_add_u32 m0, s60, 2688
    s_nop 0
    buffer_load_dwordx4 v8, s[8:11], s54 offen offset:384 lds
    v_mfma_f32_16x16x32_bf16 v[20:23], a[68:71], v[100:103], v[20:23]
    s_add_u32 m0, s60, 4096
    s_nop 0
    buffer_load_dwordx4 v8, s[8:11], s55 offen offset:0 lds
    v_mfma_f32_16x16x32_bf16 v[24:27], a[68:71], v[132:135], v[24:27]
    s_add_u32 m0, s60, 4992
    s_nop 0
    buffer_load_dwordx4 v8, s[8:11], s55 offen offset:128 lds
    v_mfma_f32_16x16x32_bf16 v[28:31], a[68:71], v[164:167], v[28:31]
    s_add_u32 m0, s60, 5888
    s_nop 0
    buffer_load_dwordx4 v8, s[8:11], s55 offen offset:256 lds
    v_mfma_f32_16x16x32_bf16 v[32:35], a[100:103], v[68:71], v[32:35]
    s_add_u32 m0, s60, 6784
    s_nop 0
    buffer_load_dwordx4 v8, s[8:11], s55 offen offset:384 lds
    v_mfma_f32_16x16x32_bf16 v[36:39], a[100:103], v[100:103], v[36:39]
    s_add_u32 s54, s3, 8
    s_lshl_b32 s54, s54, 18
    v_mfma_f32_16x16x32_bf16 v[40:43], a[100:103], v[132:135], v[40:43]
    s_add_u32 s54, s54, s51
    s_add_u32 s54, s54, 32768
    v_mfma_f32_16x16x32_bf16 v[44:47], a[100:103], v[164:167], v[44:47]
    s_add_u32 s55, s54, 131072
    s_add_u32 m0, s60, 8192
    v_mfma_f32_16x16x32_bf16 v[16:19], a[72:75], v[72:75], v[16:19]
    buffer_load_dwordx4 v8, s[8:11], s54 offen offset:0 lds
    s_add_u32 m0, s60, 9088
    v_mfma_f32_16x16x32_bf16 v[20:23], a[72:75], v[104:107], v[20:23]
    buffer_load_dwordx4 v8, s[8:11], s54 offen offset:128 lds
    s_add_u32 m0, s60, 9984
    v_mfma_f32_16x16x32_bf16 v[24:27], a[72:75], v[136:139], v[24:27]
    buffer_load_dwordx4 v8, s[8:11], s54 offen offset:256 lds
    s_add_u32 m0, s60, 10880
    v_mfma_f32_16x16x32_bf16 v[28:31], a[72:75], v[168:171], v[28:31]
    buffer_load_dwordx4 v8, s[8:11], s54 offen offset:384 lds
    s_add_u32 m0, s60, 12288
    v_mfma_f32_16x16x32_bf16 v[32:35], a[104:107], v[72:75], v[32:35]
    buffer_load_dwordx4 v8, s[8:11], s55 offen offset:0 lds
    s_add_u32 m0, s60, 13184
    v_mfma_f32_16x16x32_bf16 v[36:39], a[104:107], v[104:107], v[36:39]
    buffer_load_dwordx4 v8, s[8:11], s55 offen offset:128 lds
    s_add_u32 m0, s60, 14080
    v_mfma_f32_16x16x32_bf16 v[40:43], a[104:107], v[136:139], v[40:43]
    buffer_load_dwordx4 v8, s[8:11], s55 offen offset:256 lds
    s_add_u32 m0, s60, 14976
    v_mfma_f32_16x16x32_bf16 v[44:47], a[104:107], v[168:171], v[44:47]
    buffer_load_dwordx4 v8, s[8:11], s55 offen offset:384 lds
    v_mul_f32 v192, s56, v192
    v_mfma_f32_16x16x32_bf16 v[16:19], a[76:79], v[76:79], v[16:19]
    v_mul_f32 v193, s56, v193
    v_mul_f32 v194, s56, v194
    v_mfma_f32_16x16x32_bf16 v[20:23], a[76:79], v[108:111], v[20:23]
    v_mul_f32 v195, s56, v195
    v_cvt_pk_bf16_f32 v224, v192, v193
    v_mfma_f32_16x16x32_bf16 v[24:27], a[76:79], v[140:143], v[24:27]
    v_cvt_pk_bf16_f32 v225, v194, v195
    v_mul_f32 v208, s56, v208
    v_mfma_f32_16x16x32_bf16 v[28:31], a[76:79], v[172:175], v[28:31]
    v_mul_f32 v209, s56, v209
    v_mul_f32 v210, s56, v210
    v_mfma_f32_16x16x32_bf16 v[32:35], a[108:111], v[76:79], v[32:35]
    v_mul_f32 v211, s56, v211
    v_cvt_pk_bf16_f32 v226, v208, v209
    v_mfma_f32_16x16x32_bf16 v[36:39], a[108:111], v[108:111], v[36:39]
    v_cvt_pk_bf16_f32 v227, v210, v211
    s_add_u32 s58, s57, 0
    v_mfma_f32_16x16x32_bf16 v[40:43], a[108:111], v[140:143], v[40:43]
    buffer_store_dwordx4 v[224:227], v6, s[4:7], s58 offen sc1
    ds_write_b128 v9, v[224:227] offset:0
    v_mfma_f32_16x16x32_bf16 v[44:47], a[108:111], v[172:175], v[44:47]
    v_mul_f32 v196, s56, v196
    v_mul_f32 v197, s56, v197
    v_mfma_f32_16x16x32_bf16 v[16:19], a[80:83], v[80:83], v[16:19]
    v_mul_f32 v198, s56, v198
    v_mul_f32 v199, s56, v199
    v_mfma_f32_16x16x32_bf16 v[20:23], a[80:83], v[112:115], v[20:23]
    v_cvt_pk_bf16_f32 v228, v196, v197
    v_cvt_pk_bf16_f32 v229, v198, v199
    v_mfma_f32_16x16x32_bf16 v[24:27], a[80:83], v[144:147], v[24:27]
    v_mul_f32 v212, s56, v212
    v_mul_f32 v213, s56, v213
    v_mfma_f32_16x16x32_bf16 v[28:31], a[80:83], v[176:179], v[28:31]
    v_mul_f32 v214, s56, v214
    v_mul_f32 v215, s56, v215
    v_mfma_f32_16x16x32_bf16 v[32:35], a[112:115], v[80:83], v[32:35]
    v_cvt_pk_bf16_f32 v230, v212, v213
    v_cvt_pk_bf16_f32 v231, v214, v215
    v_mfma_f32_16x16x32_bf16 v[36:39], a[112:115], v[112:115], v[36:39]
    s_add_u32 s58, s57, 14336
    buffer_store_dwordx4 v[228:231], v6, s[4:7], s58 offen sc1
    v_mfma_f32_16x16x32_bf16 v[40:43], a[112:115], v[144:147], v[40:43]
    ds_write_b128 v9, v[228:231] offset:14336
    v_mul_f32 v200, s56, v200
    v_mfma_f32_16x16x32_bf16 v[44:47], a[112:115], v[176:179], v[44:47]
    v_mul_f32 v201, s56, v201
    v_mul_f32 v202, s56, v202
    v_mfma_f32_16x16x32_bf16 v[16:19], a[84:87], v[84:87], v[16:19]
    v_mul_f32 v203, s56, v203
    v_cvt_pk_bf16_f32 v232, v200, v201
    v_mfma_f32_16x16x32_bf16 v[20:23], a[84:87], v[116:119], v[20:23]
    v_cvt_pk_bf16_f32 v233, v202, v203
    v_mul_f32 v216, s56, v216
    v_mfma_f32_16x16x32_bf16 v[24:27], a[84:87], v[148:151], v[24:27]
    v_mul_f32 v217, s56, v217
    v_mul_f32 v218, s56, v218
    v_mfma_f32_16x16x32_bf16 v[28:31], a[84:87], v[180:183], v[28:31]
    v_mul_f32 v219, s56, v219
    v_cvt_pk_bf16_f32 v234, v216, v217
    v_mfma_f32_16x16x32_bf16 v[32:35], a[116:119], v[84:87], v[32:35]
    v_cvt_pk_bf16_f32 v235, v218, v219
    s_add_u32 s58, s57, 28672
    v_mfma_f32_16x16x32_bf16 v[36:39], a[116:119], v[116:119], v[36:39]
    buffer_store_dwordx4 v[232:235], v6, s[4:7], s58 offen sc1
    ds_write_b128 v9, v[232:235] offset:28672
    v_mfma_f32_16x16x32_bf16 v[40:43], a[116:119], v[148:151], v[40:43]
    v_mul_f32 v204, s56, v204
    v_mul_f32 v205, s56, v205
    v_mfma_f32_16x16x32_bf16 v[44:47], a[116:119], v[180:183], v[44:47]
    v_mul_f32 v206, s56, v206
    v_mul_f32 v207, s56, v207
    v_mfma_f32_16x16x32_bf16 v[16:19], a[88:91], v[88:91], v[16:19]
    v_cvt_pk_bf16_f32 v236, v204, v205
    v_cvt_pk_bf16_f32 v237, v206, v207
    v_mfma_f32_16x16x32_bf16 v[20:23], a[88:91], v[120:123], v[20:23]
    v_mul_f32 v220, s56, v220
    v_mul_f32 v221, s56, v221
    v_mfma_f32_16x16x32_bf16 v[24:27], a[88:91], v[152:155], v[24:27]
    v_mul_f32 v222, s56, v222
    v_mul_f32 v223, s56, v223
    v_mfma_f32_16x16x32_bf16 v[28:31], a[88:91], v[184:187], v[28:31]
    v_cvt_pk_bf16_f32 v238, v220, v221
    v_cvt_pk_bf16_f32 v239, v222, v223
    v_mfma_f32_16x16x32_bf16 v[32:35], a[120:123], v[88:91], v[32:35]
    s_add_u32 s58, s57, 43008
    buffer_store_dwordx4 v[236:239], v6, s[4:7], s58 offen sc1
    v_mfma_f32_16x16x32_bf16 v[36:39], a[120:123], v[120:123], v[36:39]
    ds_write_b128 v9, v[236:239] offset:43008
    v_mfma_f32_16x16x32_bf16 v[40:43], a[120:123], v[152:155], v[40:43]
    v_mfma_f32_16x16x32_bf16 v[44:47], a[120:123], v[184:187], v[44:47]
    v_mfma_f32_16x16x32_bf16 v[16:19], a[92:95], v[92:95], v[16:19]
    v_mfma_f32_16x16x32_bf16 v[20:23], a[92:95], v[124:127], v[20:23]
    v_mfma_f32_16x16x32_bf16 v[24:27], a[92:95], v[156:159], v[24:27]
    v_mfma_f32_16x16x32_bf16 v[28:31], a[92:95], v[188:191], v[28:31]
    v_mfma_f32_16x16x32_bf16 v[32:35], a[124:127], v[92:95], v[32:35]
    v_mfma_f32_16x16x32_bf16 v[36:39], a[124:127], v[124:127], v[36:39]
    v_mfma_f32_16x16x32_bf16 v[40:43], a[124:127], v[156:159], v[40:43]
    v_mfma_f32_16x16x32_bf16 v[44:47], a[124:127], v[188:191], v[44:47]
    s_waitcnt vmcnt(12)
    ds_read_b128 a[128:131], v56 offset:0
    ds_read_b128 a[132:135], v57 offset:0
    ds_read_b128 a[136:139], v56 offset:1024
    ds_read_b128 a[140:143], v57 offset:1024
    ds_read_b128 a[144:147], v56 offset:2048
    ds_read_b128 a[148:151], v57 offset:2048
    ds_read_b128 a[152:155], v56 offset:3072
    ds_read_b128 a[156:159], v57 offset:3072
    s_waitcnt vmcnt(4)
    ds_read_b128 a[160:163], v56 offset:8192
    ds_read_b128 a[164:167], v57 offset:8192
    ds_read_b128 a[168:171], v56 offset:9216
    ds_read_b128 a[172:175], v57 offset:9216
    ds_read_b128 a[176:179], v56 offset:10240
    ds_read_b128 a[180:183], v57 offset:10240
    ds_read_b128 a[184:187], v56 offset:11264
    ds_read_b128 a[188:191], v57 offset:11264
    v_cmp_ne_u32 vcc, 32, v14
    s_cbranch_vccz L_main_kernel_161
    s_mov_b32 s47, 2097152
Lwc_main_kernel_162:
    buffer_load_dword v14, v13, s[64:67], 0 offen sc1
    s_sub_u32 s47, s47, 1
    s_cbranch_scc1 Lexit_main_kernel
    s_waitcnt vmcnt(0)
    v_cmp_ne_u32 vcc, 32, v14
    s_cbranch_vccz Lwo_main_kernel_163
    s_sleep 2
    s_branch Lwc_main_kernel_162
Lwo_main_kernel_163:
L_main_kernel_161:
    s_waitcnt lgkmcnt(0)
    v_mfma_f32_16x16x32_bf16 v[192:195], a[128:131], v[64:67], 0
    v_mfma_f32_16x16x32_bf16 v[196:199], a[128:131], v[96:99], 0
    v_mfma_f32_16x16x32_bf16 v[200:203], a[128:131], v[128:131], 0
    v_mfma_f32_16x16x32_bf16 v[204:207], a[128:131], v[160:163], 0
    s_add_u32 s54, s3, 12
    s_lshl_b32 s54, s54, 18
    v_mfma_f32_16x16x32_bf16 v[208:211], a[160:163], v[64:67], 0
    s_add_u32 s54, s54, s51
    s_add_u32 s55, s54, 131072
    v_mfma_f32_16x16x32_bf16 v[212:215], a[160:163], v[96:99], 0
    s_add_u32 m0, s60, 0
    s_nop 0
    buffer_load_dwordx4 v8, s[8:11], s54 offen offset:0 lds
    v_mfma_f32_16x16x32_bf16 v[216:219], a[160:163], v[128:131], 0
    s_add_u32 m0, s60, 896
    s_nop 0
    buffer_load_dwordx4 v8, s[8:11], s54 offen offset:128 lds
    v_mfma_f32_16x16x32_bf16 v[220:223], a[160:163], v[160:163], 0
    s_add_u32 m0, s60, 1792
    s_nop 0
    buffer_load_dwordx4 v8, s[8:11], s54 offen offset:256 lds
    v_mfma_f32_16x16x32_bf16 v[192:195], a[132:135], v[68:71], v[192:195]
    s_add_u32 m0, s60, 2688
    s_nop 0
    buffer_load_dwordx4 v8, s[8:11], s54 offen offset:384 lds
    v_mfma_f32_16x16x32_bf16 v[196:199], a[132:135], v[100:103], v[196:199]
    s_add_u32 m0, s60, 4096
    s_nop 0
    buffer_load_dwordx4 v8, s[8:11], s55 offen offset:0 lds
    v_mfma_f32_16x16x32_bf16 v[200:203], a[132:135], v[132:135], v[200:203]
    s_add_u32 m0, s60, 4992
    s_nop 0
    buffer_load_dwordx4 v8, s[8:11], s55 offen offset:128 lds
    v_mfma_f32_16x16x32_bf16 v[204:207], a[132:135], v[164:167], v[204:207]
    s_add_u32 m0, s60, 5888
    s_nop 0
    buffer_load_dwordx4 v8, s[8:11], s55 offen offset:256 lds
    v_mfma_f32_16x16x32_bf16 v[208:211], a[164:167], v[68:71], v[208:211]
    s_add_u32 m0, s60, 6784
    s_nop 0
    buffer_load_dwordx4 v8, s[8:11], s55 offen offset:384 lds
    v_mfma_f32_16x16x32_bf16 v[212:215], a[164:167], v[100:103], v[212:215]
    s_add_u32 s54, s3, 12
    s_lshl_b32 s54, s54, 18
    v_mfma_f32_16x16x32_bf16 v[216:219], a[164:167], v[132:135], v[216:219]
    s_add_u32 s54, s54, s51
    s_add_u32 s54, s54, 32768
    v_mfma_f32_16x16x32_bf16 v[220:223], a[164:167], v[164:167], v[220:223]
    s_add_u32 s55, s54, 131072
    s_add_u32 m0, s60, 8192
    v_mfma_f32_16x16x32_bf16 v[192:195], a[136:139], v[72:75], v[192:195]
    buffer_load_dwordx4 v8, s[8:11], s54 offen offset:0 lds
    s_add_u32 m0, s60, 9088
    v_mfma_f32_16x16x32_bf16 v[196:199], a[136:139], v[104:107], v[196:199]
    buffer_load_dwordx4 v8, s[8:11], s54 offen offset:128 lds
    s_add_u32 m0, s60, 9984
    v_mfma_f32_16x16x32_bf16 v[200:203], a[136:139], v[136:139], v[200:203]
    buffer_load_dwordx4 v8, s[8:11], s54 offen offset:256 lds
    s_add_u32 m0, s60, 10880
    v_mfma_f32_16x16x32_bf16 v[204:207], a[136:139], v[168:171], v[204:207]
    buffer_load_dwordx4 v8, s[8:11], s54 offen offset:384 lds
    s_add_u32 m0, s60, 12288
    v_mfma_f32_16x16x32_bf16 v[208:211], a[168:171], v[72:75], v[208:211]
    buffer_load_dwordx4 v8, s[8:11], s55 offen offset:0 lds
    s_add_u32 m0, s60, 13184
    v_mfma_f32_16x16x32_bf16 v[212:215], a[168:171], v[104:107], v[212:215]
    buffer_load_dwordx4 v8, s[8:11], s55 offen offset:128 lds
    s_add_u32 m0, s60, 14080
    v_mfma_f32_16x16x32_bf16 v[216:219], a[168:171], v[136:139], v[216:219]
    buffer_load_dwordx4 v8, s[8:11], s55 offen offset:256 lds
    s_add_u32 m0, s60, 14976
    v_mfma_f32_16x16x32_bf16 v[220:223], a[168:171], v[168:171], v[220:223]
    buffer_load_dwordx4 v8, s[8:11], s55 offen offset:384 lds
    v_mul_f32 v16, s56, v16
    v_mfma_f32_16x16x32_bf16 v[192:195], a[140:143], v[76:79], v[192:195]
    v_mul_f32 v17, s56, v17
    v_mul_f32 v18, s56, v18
    v_mfma_f32_16x16x32_bf16 v[196:199], a[140:143], v[108:111], v[196:199]
    v_mul_f32 v19, s56, v19
    v_cvt_pk_bf16_f32 v224, v16, v17
    v_mfma_f32_16x16x32_bf16 v[200:203], a[140:143], v[140:143], v[200:203]
    v_cvt_pk_bf16_f32 v225, v18, v19
    v_mul_f32 v32, s56, v32
    v_mfma_f32_16x16x32_bf16 v[204:207], a[140:143], v[172:175], v[204:207]
    v_mul_f32 v33, s56, v33
    v_mul_f32 v34, s56, v34
    v_mfma_f32_16x16x32_bf16 v[208:211], a[172:175], v[76:79], v[208:211]
    v_mul_f32 v35, s56, v35
    v_cvt_pk_bf16_f32 v226, v32, v33
    v_mfma_f32_16x16x32_bf16 v[212:215], a[172:175], v[108:111], v[212:215]
    v_cvt_pk_bf16_f32 v227, v34, v35
    s_add_u32 s58, s57, 4096
    v_mfma_f32_16x16x32_bf16 v[216:219], a[172:175], v[140:143], v[216:219]
    buffer_store_dwordx4 v[224:227], v6, s[4:7], s58 offen sc1
    ds_write_b128 v9, v[224:227] offset:4096
    v_mfma_f32_16x16x32_bf16 v[220:223], a[172:175], v[172:175], v[220:223]
    v_mul_f32 v20, s56, v20
    v_mul_f32 v21, s56, v21
    v_mfma_f32_16x16x32_bf16 v[192:195], a[144:147], v[80:83], v[192:195]
    v_mul_f32 v22, s56, v22
    v_mul_f32 v23, s56, v23
    v_mfma_f32_16x16x32_bf16 v[196:199], a[144:147], v[112:115], v[196:199]
    v_cvt_pk_bf16_f32 v228, v20, v21
    v_cvt_pk_bf16_f32 v229, v22, v23
    v_mfma_f32_16x16x32_bf16 v[200:203], a[144:147], v[144:147], v[200:203]
    v_mul_f32 v36, s56, v36
    v_mul_f32 v37, s56, v37
    v_mfma_f32_16x16x32_bf16 v[204:207], a[144:147], v[176:179], v[204:207]
    v_mul_f32 v38, s56, v38
    v_mul_f32 v39, s56, v39
    v_mfma_f32_16x16x32_bf16 v[208:211], a[176:179], v[80:83], v[208:211]
    v_cvt_pk_bf16_f32 v230, v36, v37
    v_cvt_pk_bf16_f32 v231, v38, v39
    v_mfma_f32_16x16x32_bf16 v[212:215], a[176:179], v[112:115], v[212:215]
    s_add_u32 s58, s57, 18432
    buffer_store_dwordx4 v[228:231], v6, s[4:7], s58 offen sc1
    v_mfma_f32_16x16x32_bf16 v[216:219], a[176:179], v[144:147], v[216:219]
    ds_write_b128 v9, v[228:231] offset:18432
    v_mul_f32 v24, s56, v24
    v_mfma_f32_16x16x32_bf16 v[220:223], a[176:179], v[176:179], v[220:223]
    v_mul_f32 v25, s56, v25
    v_mul_f32 v26, s56, v26
    v_mfma_f32_16x16x32_bf16 v[192:195], a[148:151], v[84:87], v[192:195]
    v_mul_f32 v27, s56, v27
    v_cvt_pk_bf16_f32 v232, v24, v25
    v_mfma_f32_16x16x32_bf16 v[196:199], a[148:151], v[116:119], v[196:199]
    v_cvt_pk_bf16_f32 v233, v26, v27
    v_mul_f32 v40, s56, v40
    v_mfma_f32_16x16x32_bf16 v[200:203], a[148:151], v[148:151], v[200:203]
    v_mul_f32 v41, s56, v41
    v_mul_f32 v42, s56, v42
    v_mfma_f32_16x16x32_bf16 v[204:207], a[148:151], v[180:183], v[204:207]
    v_mul_f32 v43, s56, v43
    v_cvt_pk_bf16_f32 v234, v40, v41
    v_mfma_f32_16x16x32_bf16 v[208:211], a[180:183], v[84:87], v[208:211]
    v_cvt_pk_bf16_f32 v235, v42, v43
    s_add_u32 s58, s57, 32768
    v_mfma_f32_16x16x32_bf16 v[212:215], a[180:183], v[116:119], v[212:215]
    buffer_store_dwordx4 v[232:235], v6, s[4:7], s58 offen sc1
    ds_write_b128 v9, v[232:235] offset:32768
    v_mfma_f32_16x16x32_bf16 v[216:219], a[180:183], v[148:151], v[216:219]
    v_mul_f32 v28, s56, v28
    v_mul_f32 v29, s56, v29
    v_mfma_f32_16x16x32_bf16 v[220:223], a[180:183], v[180:183], v[220:223]
    v_mul_f32 v30, s56, v30
    v_mul_f32 v31, s56, v31
    v_mfma_f32_16x16x32_bf16 v[192:195], a[152:155], v[88:91], v[192:195]
    v_cvt_pk_bf16_f32 v236, v28, v29
    v_cvt_pk_bf16_f32 v237, v30, v31
    v_mfma_f32_16x16x32_bf16 v[196:199], a[152:155], v[120:123], v[196:199]
    v_mul_f32 v44, s56, v44
    v_mul_f32 v45, s56, v45
    v_mfma_f32_16x16x32_bf16 v[200:203], a[152:155], v[152:155], v[200:203]
    v_mul_f32 v46, s56, v46
    v_mul_f32 v47, s56, v47
    v_mfma_f32_16x16x32_bf16 v[204:207], a[152:155], v[184:187], v[204:207]
    v_cvt_pk_bf16_f32 v238, v44, v45
    v_cvt_pk_bf16_f32 v239, v46, v47
    v_mfma_f32_16x16x32_bf16 v[208:211], a[184:187], v[88:91], v[208:211]
    s_add_u32 s58, s57, 47104
    buffer_store_dwordx4 v[236:239], v6, s[4:7], s58 offen sc1
    v_mfma_f32_16x16x32_bf16 v[212:215], a[184:187], v[120:123], v[212:215]
    ds_write_b128 v9, v[236:239] offset:47104
    v_mfma_f32_16x16x32_bf16 v[216:219], a[184:187], v[152:155], v[216:219]
    v_mfma_f32_16x16x32_bf16 v[220:223], a[184:187], v[184:187], v[220:223]
    v_mfma_f32_16x16x32_bf16 v[192:195], a[156:159], v[92:95], v[192:195]
    v_mfma_f32_16x16x32_bf16 v[196:199], a[156:159], v[124:127], v[196:199]
    v_mfma_f32_16x16x32_bf16 v[200:203], a[156:159], v[156:159], v[200:203]
    v_mfma_f32_16x16x32_bf16 v[204:207], a[156:159], v[188:191], v[204:207]
    v_mfma_f32_16x16x32_bf16 v[208:211], a[188:191], v[92:95], v[208:211]
    v_mfma_f32_16x16x32_bf16 v[212:215], a[188:191], v[124:127], v[212:215]
    v_mfma_f32_16x16x32_bf16 v[216:219], a[188:191], v[156:159], v[216:219]
    v_mfma_f32_16x16x32_bf16 v[220:223], a[188:191], v[188:191], v[220:223]
    s_cmp_ge_u32 s3, 2
    s_cbranch_scc1 L_main_kernel_160
    s_waitcnt vmcnt(12)
    ds_read_b128 a[192:195], v56 offset:0
    ds_read_b128 a[196:199], v57 offset:0
    ds_read_b128 a[200:203], v56 offset:1024
    ds_read_b128 a[204:207], v57 offset:1024
    ds_read_b128 a[208:211], v56 offset:2048
    ds_read_b128 a[212:215], v57 offset:2048
    ds_read_b128 a[216:219], v56 offset:3072
    ds_read_b128 a[220:223], v57 offset:3072
    s_waitcnt vmcnt(4)
    ds_read_b128 a[224:227], v56 offset:8192
    ds_read_b128 a[228:231], v57 offset:8192
    ds_read_b128 a[232:235], v56 offset:9216
    ds_read_b128 a[236:239], v57 offset:9216
    ds_read_b128 a[240:243], v56 offset:10240
    ds_read_b128 a[244:247], v57 offset:10240
    ds_read_b128 a[248:251], v56 offset:11264
    ds_read_b128 a[252:255], v57 offset:11264
    v_mov_b32 v61, 1
    s_mov_b64 exec, 1
    buffer_store_dword v61, v60, s[4:7], s62 offen sc1
    s_mov_b64 exec, -1
    s_waitcnt lgkmcnt(0)
    v_mfma_f32_16x16x32_bf16 v[16:19], a[192:195], v[64:67], 0
    v_mfma_f32_16x16x32_bf16 v[20:23], a[192:195], v[96:99], 0
    v_mfma_f32_16x16x32_bf16 v[24:27], a[192:195], v[128:131], 0
    v_mfma_f32_16x16x32_bf16 v[28:31], a[192:195], v[160:163], 0
    v_mul_f32 v192, s56, v192
    v_mfma_f32_16x16x32_bf16 v[32:35], a[224:227], v[64:67], 0
    v_mul_f32 v193, s56, v193
    v_mfma_f32_16x16x32_bf16 v[36:39], a[224:227], v[96:99], 0
    v_mul_f32 v194, s56, v194
    v_mfma_f32_16x16x32_bf16 v[40:43], a[224:227], v[128:131], 0
    v_mul_f32 v195, s56, v195
    v_mfma_f32_16x16x32_bf16 v[44:47], a[224:227], v[160:163], 0
    v_cvt_pk_bf16_f32 v224, v192, v193
    v_mfma_f32_16x16x32_bf16 v[16:19], a[196:199], v[68:71], v[16:19]
    v_cvt_pk_bf16_f32 v225, v194, v195
    v_mfma_f32_16x16x32_bf16 v[20:23], a[196:199], v[100:103], v[20:23]
    v_mul_f32 v208, s56, v208
    v_mfma_f32_16x16x32_bf16 v[24:27], a[196:199], v[132:135], v[24:27]
    v_mul_f32 v209, s56, v209
    v_mfma_f32_16x16x32_bf16 v[28:31], a[196:199], v[164:167], v[28:31]
    v_mul_f32 v210, s56, v210
    v_mfma_f32_16x16x32_bf16 v[32:35], a[228:231], v[68:71], v[32:35]
    v_mul_f32 v211, s56, v211
    v_mfma_f32_16x16x32_bf16 v[36:39], a[228:231], v[100:103], v[36:39]
    v_cvt_pk_bf16_f32 v226, v208, v209
    v_mfma_f32_16x16x32_bf16 v[40:43], a[228:231], v[132:135], v[40:43]
    v_cvt_pk_bf16_f32 v227, v210, v211
    v_mfma_f32_16x16x32_bf16 v[44:47], a[228:231], v[164:167], v[44:47]
    s_add_u32 s58, s57, 8192
    v_mfma_f32_16x16x32_bf16 v[16:19], a[200:203], v[72:75], v[16:19]
    buffer_store_dwordx4 v[224:227], v6, s[4:7], s58 offen sc1
    v_mfma_f32_16x16x32_bf16 v[20:23], a[200:203], v[104:107], v[20:23]
    ds_write_b128 v9, v[224:227] offset:8192
    v_mfma_f32_16x16x32_bf16 v[24:27], a[200:203], v[136:139], v[24:27]
    v_mul_f32 v196, s56, v196
    v_mfma_f32_16x16x32_bf16 v[28:31], a[200:203], v[168:171], v[28:31]
    v_mul_f32 v197, s56, v197
    v_mfma_f32_16x16x32_bf16 v[32:35], a[232:235], v[72:75], v[32:35]
    v_mul_f32 v198, s56, v198
    v_mfma_f32_16x16x32_bf16 v[36:39], a[232:235], v[104:107], v[36:39]
    v_mul_f32 v199, s56, v199
    v_mfma_f32_16x16x32_bf16 v[40:43], a[232:235], v[136:139], v[40:43]
    v_cvt_pk_bf16_f32 v228, v196, v197
    v_mfma_f32_16x16x32_bf16 v[44:47], a[232:235], v[168:171], v[44:47]
    v_cvt_pk_bf16_f32 v229, v198, v199
    v_mfma_f32_16x16x32_bf16 v[16:19], a[204:207], v[76:79], v[16:19]
    v_mul_f32 v212, s56, v212
    v_mfma_f32_16x16x32_bf16 v[20:23], a[204:207], v[108:111], v[20:23]
    v_mul_f32 v213, s56, v213
    v_mfma_f32_16x16x32_bf16 v[24:27], a[204:207], v[140:143], v[24:27]
    v_mul_f32 v214, s56, v214
    v_mfma_f32_16x16x32_bf16 v[28:31], a[204:207], v[172:175], v[28:31]
    v_mul_f32 v215, s56, v215
    v_mfma_f32_16x16x32_bf16 v[32:35], a[236:239], v[76:79], v[32:35]
    v_cvt_pk_bf16_f32 v230, v212, v213
    v_mfma_f32_16x16x32_bf16 v[36:39], a[236:239], v[108:111], v[36:39]
    v_cvt_pk_bf16_f32 v231, v214, v215
    v_mfma_f32_16x16x32_bf16 v[40:43], a[236:239], v[140:143], v[40:43]
    s_add_u32 s58, s57, 22528
    v_mfma_f32_16x16x32_bf16 v[44:47], a[236:239], v[172:175], v[44:47]
    buffer_store_dwordx4 v[228:231], v6, s[4:7], s58 offen sc1
    v_mfma_f32_16x16x32_bf16 v[16:19], a[208:211], v[80:83], v[16:19]
    ds_write_b128 v9, v[228:231] offset:22528
    v_mfma_f32_16x16x32_bf16 v[20:23], a[208:211], v[112:115], v[20:23]
    v_mul_f32 v200, s56, v200
    v_mfma_f32_16x16x32_bf16 v[24:27], a[208:211], v[144:147], v[24:27]
    v_mul_f32 v201, s56, v201
    v_mfma_f32_16x16x32_bf16 v[28:31], a[208:211], v[176:179], v[28:31]
    v_mul_f32 v202, s56, v202
    v_mfma_f32_16x16x32_bf16 v[32:35], a[240:243], v[80:83], v[32:35]
    v_mul_f32 v203, s56, v203
    v_mfma_f32_16x16x32_bf16 v[36:39], a[240:243], v[112:115], v[36:39]
    v_cvt_pk_bf16_f32 v232, v200, v201
    v_mfma_f32_16x16x32_bf16 v[40:43], a[240:243], v[144:147], v[40:43]
    v_cvt_pk_bf16_f32 v233, v202, v203
    v_mfma_f32_16x16x32_bf16 v[44:47], a[240:243], v[176:179], v[44:47]
    v_mul_f32 v216, s56, v216
    v_mfma_f32_16x16x32_bf16 v[16:19], a[212:215], v[84:87], v[16:19]
    v_mul_f32 v217, s56, v217
    v_mfma_f32_16x16x32_bf16 v[20:23], a[212:215], v[116:119], v[20:23]
    v_mul_f32 v218, s56, v218
    v_mfma_f32_16x16x32_bf16 v[24:27], a[212:215], v[148:151], v[24:27]
    v_mul_f32 v219, s56, v219
    v_mfma_f32_16x16x32_bf16 v[28:31], a[212:215], v[180:183], v[28:31]
    v_cvt_pk_bf16_f32 v234, v216, v217
    v_mfma_f32_16x16x32_bf16 v[32:35], a[244:247], v[84:87], v[32:35]
    v_cvt_pk_bf16_f32 v235, v218, v219
    v_mfma_f32_16x16x32_bf16 v[36:39], a[244:247], v[116:119], v[36:39]
    s_add_u32 s58, s57, 36864
    v_mfma_f32_16x16x32_bf16 v[40:43], a[244:247], v[148:151], v[40:43]
    buffer_store_dwordx4 v[232:235], v6, s[4:7], s58 offen sc1
    v_mfma_f32_16x16x32_bf16 v[44:47], a[244:247], v[180:183], v[44:47]
    ds_write_b128 v9, v[232:235] offset:36864
    v_mfma_f32_16x16x32_bf16 v[16:19], a[216:219], v[88:91], v[16:19]
    v_mul_f32 v204, s56, v204
    v_mfma_f32_16x16x32_bf16 v[20:23], a[216:219], v[120:123], v[20:23]
    v_mul_f32 v205, s56, v205
    v_mfma_f32_16x16x32_bf16 v[24:27], a[216:219], v[152:155], v[24:27]
    v_mul_f32 v206, s56, v206
    v_mfma_f32_16x16x32_bf16 v[28:31], a[216:219], v[184:187], v[28:31]
    v_mul_f32 v207, s56, v207
    v_mfma_f32_16x16x32_bf16 v[32:35], a[248:251], v[88:91], v[32:35]
    v_cvt_pk_bf16_f32 v236, v204, v205
    v_mfma_f32_16x16x32_bf16 v[36:39], a[248:251], v[120:123], v[36:39]
    v_cvt_pk_bf16_f32 v237, v206, v207
    v_mfma_f32_16x16x32_bf16 v[40:43], a[248:251], v[152:155], v[40:43]
    v_mul_f32 v220, s56, v220
    v_mfma_f32_16x16x32_bf16 v[44:47], a[248:251], v[184:187], v[44:47]
    v_mul_f32 v221, s56, v221
    v_mfma_f32_16x16x32_bf16 v[16:19], a[220:223], v[92:95], v[16:19]
    v_mul_f32 v222, s56, v222
    v_mfma_f32_16x16x32_bf16 v[20:23], a[220:223], v[124:127], v[20:23]
    v_mul_f32 v223, s56, v223
    v_mfma_f32_16x16x32_bf16 v[24:27], a[220:223], v[156:159], v[24:27]
    v_cvt_pk_bf16_f32 v238, v220, v221
    v_mfma_f32_16x16x32_bf16 v[28:31], a[220:223], v[188:191], v[28:31]
    v_cvt_pk_bf16_f32 v239, v222, v223
    v_mfma_f32_16x16x32_bf16 v[32:35], a[252:255], v[92:95], v[32:35]
    s_add_u32 s58, s57, 51200
    v_mfma_f32_16x16x32_bf16 v[36:39], a[252:255], v[124:127], v[36:39]
    buffer_store_dwordx4 v[236:239], v6, s[4:7], s58 offen sc1
    v_mfma_f32_16x16x32_bf16 v[40:43], a[252:255], v[156:159], v[40:43]
    ds_write_b128 v9, v[236:239] offset:51200
    v_mfma_f32_16x16x32_bf16 v[44:47], a[252:255], v[188:191], v[44:47]
    s_waitcnt vmcnt(4)
    v_mov_b32 v61, 2
    s_mov_b64 exec, 1
    buffer_store_dword v61, v60, s[4:7], s62 offen sc1
    s_mov_b64 exec, -1
    v_mul_f32 v16, s56, v16
    v_mul_f32 v17, s56, v17
    v_mul_f32 v18, s56, v18
    v_mul_f32 v19, s56, v19
    v_cvt_pk_bf16_f32 v224, v16, v17
    v_cvt_pk_bf16_f32 v225, v18, v19
    v_mul_f32 v32, s56, v32
    v_mul_f32 v33, s56, v33
    v_mul_f32 v34, s56, v34
    v_mul_f32 v35, s56, v35
    v_cvt_pk_bf16_f32 v226, v32, v33
    v_cvt_pk_bf16_f32 v227, v34, v35
    s_add_u32 s58, s57, 12288
    buffer_store_dwordx4 v[224:227], v6, s[4:7], s58 offen sc1
    ds_write_b128 v9, v[224:227] offset:12288
    v_mul_f32 v20, s56, v20
    v_mul_f32 v21, s56, v21
    v_mul_f32 v22, s56, v22
    v_mul_f32 v23, s56, v23
    v_cvt_pk_bf16_f32 v228, v20, v21
    v_cvt_pk_bf16_f32 v229, v22, v23
    v_mul_f32 v36, s56, v36
    v_mul_f32 v37, s56, v37
    v_mul_f32 v38, s56, v38
    v_mul_f32 v39, s56, v39
    v_cvt_pk_bf16_f32 v230, v36, v37
    v_cvt_pk_bf16_f32 v231, v38, v39
    s_add_u32 s58, s57, 26624
    buffer_store_dwordx4 v[228:231], v6, s[4:7], s58 offen sc1
    ds_write_b128 v9, v[228:231] offset:26624
    v_mul_f32 v24, s56, v24
    v_mul_f32 v25, s56, v25
    v_mul_f32 v26, s56, v26
    v_mul_f32 v27, s56, v27
    v_cvt_pk_bf16_f32 v232, v24, v25
    v_cvt_pk_bf16_f32 v233, v26, v27
    v_mul_f32 v40, s56, v40
    v_mul_f32 v41, s56, v41
    v_mul_f32 v42, s56, v42
    v_mul_f32 v43, s56, v43
    v_cvt_pk_bf16_f32 v234, v40, v41
    v_cvt_pk_bf16_f32 v235, v42, v43
    s_add_u32 s58, s57, 40960
    buffer_store_dwordx4 v[232:235], v6, s[4:7], s58 offen sc1
    ds_write_b128 v9, v[232:235] offset:40960
    v_mul_f32 v28, s56, v28
    v_mul_f32 v29, s56, v29
    v_mul_f32 v30, s56, v30
    v_mul_f32 v31, s56, v31
    v_cvt_pk_bf16_f32 v236, v28, v29
    v_cvt_pk_bf16_f32 v237, v30, v31
    v_mul_f32 v44, s56, v44
    v_mul_f32 v45, s56, v45
    v_mul_f32 v46, s56, v46
    v_mul_f32 v47, s56, v47
    v_cvt_pk_bf16_f32 v238, v44, v45
    v_cvt_pk_bf16_f32 v239, v46, v47
    s_add_u32 s58, s57, 55296
    buffer_store_dwordx4 v[236:239], v6, s[4:7], s58 offen sc1
    ds_write_b128 v9, v[236:239] offset:55296
    s_branch L_main_kernel_164
L_main_kernel_160:
    s_waitcnt vmcnt(4)
    v_mov_b32 v61, 1
    s_mov_b64 exec, 1
    buffer_store_dword v61, v60, s[4:7], s62 offen sc1
    s_mov_b64 exec, -1
    v_mul_f32 v192, s56, v192
    v_mul_f32 v193, s56, v193
    v_mul_f32 v194, s56, v194
    v_mul_f32 v195, s56, v195
    v_cvt_pk_bf16_f32 v224, v192, v193
    v_cvt_pk_bf16_f32 v225, v194, v195
    v_mul_f32 v208, s56, v208
    v_mul_f32 v209, s56, v209
    v_mul_f32 v210, s56, v210
    v_mul_f32 v211, s56, v211
    v_cvt_pk_bf16_f32 v226, v208, v209
    v_cvt_pk_bf16_f32 v227, v210, v211
    s_add_u32 s58, s57, 8192
    buffer_store_dwordx4 v[224:227], v6, s[4:7], s58 offen sc1
    ds_write_b128 v9, v[224:227] offset:8192
    v_mul_f32 v196, s56, v196
    v_mul_f32 v197, s56, v197
    v_mul_f32 v198, s56, v198
    v_mul_f32 v199, s56, v199
    v_cvt_pk_bf16_f32 v228, v196, v197
    v_cvt_pk_bf16_f32 v229, v198, v199
    v_mul_f32 v212, s56, v212
    v_mul_f32 v213, s56, v213
    v_mul_f32 v214, s56, v214
    v_mul_f32 v215, s56, v215
    v_cvt_pk_bf16_f32 v230, v212, v213
    v_cvt_pk_bf16_f32 v231, v214, v215
    s_add_u32 s58, s57, 22528
    buffer_store_dwordx4 v[228:231], v6, s[4:7], s58 offen sc1
    ds_write_b128 v9, v[228:231] offset:22528
    v_mul_f32 v200, s56, v200
    v_mul_f32 v201, s56, v201
    v_mul_f32 v202, s56, v202
    v_mul_f32 v203, s56, v203
    v_cvt_pk_bf16_f32 v232, v200, v201
    v_cvt_pk_bf16_f32 v233, v202, v203
    v_mul_f32 v216, s56, v216
    v_mul_f32 v217, s56, v217
    v_mul_f32 v218, s56, v218
    v_mul_f32 v219, s56, v219
    v_cvt_pk_bf16_f32 v234, v216, v217
    v_cvt_pk_bf16_f32 v235, v218, v219
    s_add_u32 s58, s57, 36864
    buffer_store_dwordx4 v[232:235], v6, s[4:7], s58 offen sc1
    ds_write_b128 v9, v[232:235] offset:36864
    v_mul_f32 v204, s56, v204
    v_mul_f32 v205, s56, v205
    v_mul_f32 v206, s56, v206
    v_mul_f32 v207, s56, v207
    v_cvt_pk_bf16_f32 v236, v204, v205
    v_cvt_pk_bf16_f32 v237, v206, v207
    v_mul_f32 v220, s56, v220
    v_mul_f32 v221, s56, v221
    v_mul_f32 v222, s56, v222
    v_mul_f32 v223, s56, v223
    v_cvt_pk_bf16_f32 v238, v220, v221
    v_cvt_pk_bf16_f32 v239, v222, v223
    s_add_u32 s58, s57, 51200
    buffer_store_dwordx4 v[236:239], v6, s[4:7], s58 offen sc1
    ds_write_b128 v9, v[236:239] offset:51200
L_main_kernel_164:
    v_lshl_or_b32 v12, v49, 16, v48
    v_lshl_or_b32 v13, v51, 16, v50
    v_lshl_or_b32 v14, v53, 16, v52
    v_lshl_or_b32 v15, v55, 16, v54
    buffer_store_dwordx4 v[12:15], v6, s[4:7], s52 offen sc1
    s_waitcnt vmcnt(0) lgkmcnt(0)
    v_mov_b32 v61, 4
    s_mov_b64 exec, 1
    buffer_store_dword v61, v60, s[4:7], s62 offen sc1
    s_mov_b64 exec, -1
    s_cmp_eq_u32 s50, 0
    s_cbranch_scc1 L_main_kernel_165
    v_mov_b32 v16, -1
    v_mov_b32 v17, -1
    v_mov_b32 v18, -1
    v_mov_b32 v19, -1
    s_sub_u32 s46, s100, 112
    s_lshl_b32 s46, s46, 2
    s_add_u32 s46, s46, s3
    v_lshl_add_u32 v9, s46, 10, v6
    v_cmp_gt_u32 vcc, 196608, v9
    v_mov_b32 v10, 0x7fffffff
    s_nop 0
    v_cndmask_b32 v10, v10, v9, vcc
    s_mov_b32 s53, 79830016
    buffer_store_dwordx4 v[16:19], v9, s[4:7], s53 offen sc1
    s_mov_b32 s53, 80288768
    buffer_store_dwordx4 v[16:19], v9, s[4:7], s53 offen sc1
    s_mov_b32 s53, 80747520
    buffer_store_dwordx4 v[16:19], v10, s[4:7], s53 offen sc1
    s_mov_b32 s53, 162012160
    buffer_store_dwordx4 v[16:19], v9, s[4:7], s53 offen sc1
    s_mov_b32 s53, 162470912
    buffer_store_dwordx4 v[16:19], v9, s[4:7], s53 offen sc1
    s_mov_b32 s53, 162929664
    buffer_store_dwordx4 v[16:19], v10, s[4:7], s53 offen sc1
    v_cmp_gt_u32 vcc, 71680, v9
    v_mov_b32 v10, 0x7fffffff
    s_nop 0
    v_cndmask_b32 v10, v10, v9, vcc
    s_mov_b32 s53, 81332224
    buffer_store_dwordx4 v[16:19], v10, s[4:7], s53 offen sc1
    s_mov_b32 s53, 163514368
    buffer_store_dwordx4 v[16:19], v10, s[4:7], s53 offen sc1
    s_mov_b32 s53, 87597056
    buffer_store_dwordx4 v[16:19], v9, s[4:7], s53 offen sc1
    s_mov_b32 s53, 169779200
    buffer_store_dwordx4 v[16:19], v9, s[4:7], s53 offen sc1
    s_mov_b32 s53, 88055808
    buffer_store_dwordx4 v[16:19], v9, s[4:7], s53 offen sc1
    s_mov_b32 s53, 170237952
    buffer_store_dwordx4 v[16:19], v9, s[4:7], s53 offen sc1
    v_cmp_gt_u32 vcc, 229376, v9
    v_mov_b32 v10, 0x7fffffff
    s_nop 0
    v_cndmask_b32 v10, v10, v9, vcc
    s_mov_b32 s53, 88514560
    buffer_store_dwordx4 v[16:19], v10, s[4:7], s53 offen sc1
    s_mov_b32 s53, 170696704
    buffer_store_dwordx4 v[16:19], v10, s[4:7], s53 offen sc1
    v_cmp_gt_u32 vcc, 262144, v9
    v_mov_b32 v10, 0x7fffffff
    s_nop 0
    v_cndmask_b32 v10, v10, v9, vcc
    s_mov_b32 s53, 97140736
    buffer_store_dwordx4 v[16:19], v10, s[4:7], s53 offen sc1
    s_mov_b32 s53, 179322880
    buffer_store_dwordx4 v[16:19], v10, s[4:7], s53 offen sc1
    v_cmp_gt_u32 vcc, 114688, v9
    v_mov_b32 v10, 0x7fffffff
    s_nop 0
    v_cndmask_b32 v10, v10, v9, vcc
    s_mov_b32 s53, 19152896
    buffer_store_dwordx4 v[16:19], v10, s[4:7], s53 offen sc1
    s_mov_b32 s53, 101335040
    buffer_store_dwordx4 v[16:19], v10, s[4:7], s53 offen sc1
    v_cmp_gt_u32 vcc, 8192, v9
    v_mov_b32 v10, 0x7fffffff
    s_nop 0
    v_cndmask_b32 v10, v10, v9, vcc
    s_mov_b32 s53, 88866816
    buffer_store_dwordx4 v[16:19], v10, s[4:7], s53 offen sc1
    s_mov_b32 s53, 171048960
    buffer_store_dwordx4 v[16:19], v10, s[4:7], s53 offen sc1
    v_cmp_gt_u32 vcc, 8192, v9
    v_mov_b32 v10, 0x7fffffff
    s_nop 0
    v_cndmask_b32 v10, v10, v9, vcc
    s_mov_b32 s53, 89001984
    buffer_store_dwordx4 v[16:19], v10, s[4:7], s53 offen sc1
    s_mov_b32 s53, 171184128
    buffer_store_dwordx4 v[16:19], v10, s[4:7], s53 offen sc1
    v_cmp_gt_u32 vcc, 229376, v9
    v_mov_b32 v10, 0x7fffffff
    s_nop 0
    v_cndmask_b32 v10, v10, v9, vcc
    s_mov_b32 s53, 97411072
    buffer_store_dwordx4 v[16:19], v10, s[4:7], s53 offen sc1
    s_mov_b32 s53, 179593216
    buffer_store_dwordx4 v[16:19], v10, s[4:7], s53 offen sc1
L_main_kernel_165:
    v_lshlrev_b32 v1, 4, v0
    v_add_u32 v2, 32768, v1
    s_waitcnt lgkmcnt(0)
    s_barrier
    ds_read_b128 a[0:3], v2 offset:0
    ds_read_b128 a[4:7], v2 offset:1024
    ds_read_b128 a[8:11], v2 offset:2048
    ds_read_b128 a[12:15], v2 offset:3072
    ds_read_b128 a[16:19], v2 offset:4096
    ds_read_b128 a[20:23], v2 offset:5120
    ds_read_b128 a[24:27], v2 offset:6144
    ds_read_b128 a[28:31], v2 offset:7168
    ds_read_b128 a[32:35], v2 offset:8192
    ds_read_b128 a[36:39], v2 offset:9216
    ds_read_b128 a[40:43], v2 offset:10240
    ds_read_b128 a[44:47], v2 offset:11264
    s_waitcnt lgkmcnt(4)
    ds_read_b128 a[48:51], v2 offset:12288
    ds_read_b128 a[52:55], v2 offset:13312
    ds_read_b128 a[56:59], v2 offset:14336
    ds_read_b128 a[60:63], v2 offset:15360
    ds_read_b128 a[64:67], v2 offset:16384
    ds_read_b128 a[68:71], v2 offset:17408
    ds_read_b128 a[72:75], v2 offset:18432
    ds_read_b128 a[76:79], v2 offset:19456
    ds_read_b128 a[80:83], v2 offset:20480
    ds_read_b128 a[84:87], v2 offset:21504
    ds_read_b128 a[88:91], v2 offset:22528
    ds_read_b128 a[92:95], v2 offset:23552
    s_waitcnt lgkmcnt(4)
    ds_read_b128 a[96:99], v2 offset:24576
    ds_read_b128 a[100:103], v2 offset:25600
    ds_read_b128 a[104:107], v2 offset:26624
    ds_read_b128 a[108:111], v2 offset:27648
    ds_read_b128 a[112:115], v2 offset:28672
    ds_read_b128 a[116:119], v2 offset:29696
    ds_read_b128 a[120:123], v2 offset:30720
    ds_read_b128 a[124:127], v2 offset:31744
    ds_read_b128 a[128:131], v2 offset:32768
    ds_read_b128 a[132:135], v2 offset:33792
    ds_read_b128 a[136:139], v2 offset:34816
    ds_read_b128 a[140:143], v2 offset:35840
    s_waitcnt lgkmcnt(4)
    ds_read_b128 a[144:147], v2 offset:36864
    ds_read_b128 a[148:151], v2 offset:37888
    ds_read_b128 a[152:155], v2 offset:38912
    ds_read_b128 a[156:159], v2 offset:39936
    ds_read_b128 a[160:163], v2 offset:40960
    ds_read_b128 a[164:167], v2 offset:41984
    ds_read_b128 a[168:171], v2 offset:43008
    ds_read_b128 a[172:175], v2 offset:44032
    ds_read_b128 a[176:179], v2 offset:45056
    ds_read_b128 a[180:183], v2 offset:46080
    ds_read_b128 a[184:187], v2 offset:47104
    ds_read_b128 a[188:191], v2 offset:48128
    s_waitcnt lgkmcnt(4)
    ds_read_b128 a[192:195], v2 offset:49152
    ds_read_b128 a[196:199], v2 offset:50176
    ds_read_b128 a[200:203], v2 offset:51200
    ds_read_b128 a[204:207], v2 offset:52224
    ds_read_b128 a[208:211], v2 offset:53248
    ds_read_b128 a[212:215], v2 offset:54272
    ds_read_b128 a[216:219], v2 offset:55296
    ds_read_b128 a[220:223], v2 offset:56320
L_main_kernel_166:
Ltop_main_kernel_167:
    s_mul_i32 s47, s100, 9363
    s_lshr_b32 s47, s47, 16
    s_mul_i32 s48, s47, 7
    s_sub_u32 s48, s100, s48
    s_and_b32 s49, s47, 15
    s_lshr_b32 s50, s47, 4
    v_lshlrev_b32 v1, 4, v0
    s_cmp_eq_u32 s50, 0
    s_mov_b32 s56, 97640448
    s_cselect_b32 s56, 97673216, s56
    v_mov_b32 v4, 0
    v_mov_b32 v5, 1
    s_lshl_b32 s58, s3, 7
    s_add_u32 s56, s56, s58
    s_and_b32 s58, s100, 3
    s_lshl_b32 s58, s58, 13
    s_add_u32 s56, s56, s58
    s_mov_b32 s96, 0
    s_mov_b32 s98, s3
    s_mul_i32 s52, s3, 28672
    s_add_u32 s52, s52, 15597568
    s_waitcnt vmcnt(0) lgkmcnt(0)
    s_barrier
    s_min_u32 s99, s98, 63
    s_cmp_lt_u32 s99, s96
    s_cbranch_scc1 Lgo_main_kernel_168
    s_mov_b32 s70, 2097152
    v_lshlrev_b32 v6, 3, v1
    v_and_b32 v6, 0x780, v6
Lgl_main_kernel_169:
    s_min_u32 s96, s96, 48
    s_lshl_b32 s97, s96, 7
    s_add_u32 s97, s97, 97722368
    s_mov_b64 exec, 0xffff
    buffer_load_dword v7, v6, s[12:15], s97 offen sc1
    s_mov_b64 exec, -1
    s_sub_u32 s70, s70, 1
    s_cbranch_scc1 Lexit_main_kernel
    s_waitcnt vmcnt(0)
    v_cmp_ne_u32 vcc, 32, v7
    s_nop 0
    s_or_b32 s97, vcc_lo, 0x10000
    s_ff1_i32_b32 s97, s97
    s_add_u32 s96, s96, s97
    s_cmp_eq_u32 s97, 16
    s_cselect_b32 s97, 1, 0
    s_cmp_ge_u32 s96, 64
    s_cselect_b32 s96, 0x100, s96
    s_cbranch_scc1 Lgo_main_kernel_168
    s_cmp_lt_u32 s99, s96
    s_cbranch_scc1 Lgo_main_kernel_168
    s_cmp_eq_u32 s97, 1
    s_cbranch_scc1 Lgl_main_kernel_169
    s_cmp_lt_u32 s99, s96
    s_cbranch_scc1 Lgo_main_kernel_168
    s_add_u32 s97, s96, 1
    s_cmp_gt_u32 s99, s97
    s_cbranch_scc1 Lgf_main_kernel_170
    s_sleep 2
    s_branch Lgl_main_kernel_169
Lgf_main_kernel_170:
    s_sleep 2
    s_branch Lgl_main_kernel_169
Lgo_main_kernel_168:
    s_add_u32 s98, s98, 4
    s_add_u32 s53, s52, 0
    s_add_u32 s57, s52, 14336
    buffer_load_dwordx4 v[16:19], v1, s[12:15], s53 offen offset:0 sc1
    buffer_load_dwordx4 v[72:75], v1, s[12:15], s57 offen offset:0 sc1
    buffer_load_dwordx4 v[20:23], v1, s[12:15], s53 offen offset:1024 sc1
    buffer_load_dwordx4 v[76:79], v1, s[12:15], s57 offen offset:1024 sc1
    buffer_load_dwordx4 v[24:27], v1, s[12:15], s53 offen offset:2048 sc1
    buffer_load_dwordx4 v[80:83], v1, s[12:15], s57 offen offset:2048 sc1
    buffer_load_dwordx4 v[28:31], v1, s[12:15], s53 offen offset:3072 sc1
    buffer_load_dwordx4 v[84:87], v1, s[12:15], s57 offen offset:3072 sc1
    s_add_u32 s53, s52, 4096
    s_add_u32 s57, s52, 18432
    buffer_load_dwordx4 v[32:35], v1, s[12:15], s53 offen offset:0 sc1
    buffer_load_dwordx4 v[88:91], v1, s[12:15], s57 offen offset:0 sc1
    buffer_load_dwordx4 v[36:39], v1, s[12:15], s53 offen offset:1024 sc1
    buffer_load_dwordx4 v[92:95], v1, s[12:15], s57 offen offset:1024 sc1
    buffer_load_dwordx4 v[40:43], v1, s[12:15], s53 offen offset:2048 sc1
    buffer_load_dwordx4 v[96:99], v1, s[12:15], s57 offen offset:2048 sc1
    buffer_load_dwordx4 v[44:47], v1, s[12:15], s53 offen offset:3072 sc1
    buffer_load_dwordx4 v[100:103], v1, s[12:15], s57 offen offset:3072 sc1
    s_add_u32 s53, s52, 8192
    s_add_u32 s57, s52, 22528
    buffer_load_dwordx4 v[48:51], v1, s[12:15], s53 offen offset:0 sc1
    buffer_load_dwordx4 v[104:107], v1, s[12:15], s57 offen offset:0 sc1
    buffer_load_dwordx4 v[52:55], v1, s[12:15], s53 offen offset:1024 sc1
    buffer_load_dwordx4 v[108:111], v1, s[12:15], s57 offen offset:1024 sc1
    buffer_load_dwordx4 v[56:59], v1, s[12:15], s53 offen offset:2048 sc1
    buffer_load_dwordx4 v[112:115], v1, s[12:15], s57 offen offset:2048 sc1
    buffer_load_dwordx4 v[60:63], v1, s[12:15], s53 offen offset:3072 sc1
    buffer_load_dwordx4 v[116:119], v1, s[12:15], s57 offen offset:3072 sc1
    s_add_u32 s53, s52, 12288
    s_add_u32 s57, s52, 26624
    buffer_load_dwordx4 v[64:67], v1, s[12:15], s53 offen offset:0 sc1
    buffer_load_dwordx4 v[120:123], v1, s[12:15], s57 offen offset:0 sc1
    buffer_load_dwordx4 v[68:71], v1, s[12:15], s53 offen offset:1024 sc1
    buffer_load_dwordx4 v[124:127], v1, s[12:15], s57 offen offset:1024 sc1
    s_add_u32 s52, s52, 114688
    s_min_u32 s52, s52, 17403904
    s_cmp_eq_u32 s50, 0
    s_cbranch_scc1 L_main_kernel_171
    s_lshl_b32 s54, s3, 4
    s_add_u32 s54, s54, s49
    s_mul_i32 s54, s54, 28672
    s_lshl_b32 s55, s48, 12
    s_add_u32 s54, s54, s55
    s_add_u32 s54, s54, 50462720
    s_mov_b32 s51, 8
L_main_kernel_173:
    s_waitcnt vmcnt(27)
    v_mfma_f32_16x16x32_bf16 v[208:211], v[16:19], a[0:3], 0
    v_mfma_f32_16x16x32_bf16 v[212:215], v[16:19], a[56:59], 0
    v_mfma_f32_16x16x32_bf16 v[216:219], v[16:19], a[112:115], 0
    v_mfma_f32_16x16x32_bf16 v[220:223], v[16:19], a[168:171], 0
    s_waitcnt vmcnt(26)
    v_mfma_f32_16x16x32_bf16 v[224:227], v[72:75], a[0:3], 0
    v_mfma_f32_16x16x32_bf16 v[228:231], v[72:75], a[56:59], 0
    v_mfma_f32_16x16x32_bf16 v[232:235], v[72:75], a[112:115], 0
    v_mfma_f32_16x16x32_bf16 v[236:239], v[72:75], a[168:171], 0
    s_waitcnt vmcnt(25)
    v_mfma_f32_16x16x32_bf16 v[208:211], v[20:23], a[4:7], v[208:211]
    v_mfma_f32_16x16x32_bf16 v[212:215], v[20:23], a[60:63], v[212:215]
    v_mfma_f32_16x16x32_bf16 v[216:219], v[20:23], a[116:119], v[216:219]
    v_mfma_f32_16x16x32_bf16 v[220:223], v[20:23], a[172:175], v[220:223]
    s_waitcnt vmcnt(24)
    v_mfma_f32_16x16x32_bf16 v[224:227], v[76:79], a[4:7], v[224:227]
    v_mfma_f32_16x16x32_bf16 v[228:231], v[76:79], a[60:63], v[228:231]
    v_mfma_f32_16x16x32_bf16 v[232:235], v[76:79], a[116:119], v[232:235]
    v_mfma_f32_16x16x32_bf16 v[236:239], v[76:79], a[172:175], v[236:239]
    s_waitcnt vmcnt(23)
    v_mfma_f32_16x16x32_bf16 v[208:211], v[24:27], a[8:11], v[208:211]
    v_mfma_f32_16x16x32_bf16 v[212:215], v[24:27], a[64:67], v[212:215]
    v_mfma_f32_16x16x32_bf16 v[216:219], v[24:27], a[120:123], v[216:219]
    v_mfma_f32_16x16x32_bf16 v[220:223], v[24:27], a[176:179], v[220:223]
    s_waitcnt vmcnt(22)
    v_mfma_f32_16x16x32_bf16 v[224:227], v[80:83], a[8:11], v[224:227]
    v_mfma_f32_16x16x32_bf16 v[228:231], v[80:83], a[64:67], v[228:231]
    v_mfma_f32_16x16x32_bf16 v[232:235], v[80:83], a[120:123], v[232:235]
    v_mfma_f32_16x16x32_bf16 v[236:239], v[80:83], a[176:179], v[236:239]
    s_waitcnt vmcnt(21)
    v_mfma_f32_16x16x32_bf16 v[208:211], v[28:31], a[12:15], v[208:211]
    v_mfma_f32_16x16x32_bf16 v[212:215], v[28:31], a[68:71], v[212:215]
    v_mfma_f32_16x16x32_bf16 v[216:219], v[28:31], a[124:127], v[216:219]
    v_mfma_f32_16x16x32_bf16 v[220:223], v[28:31], a[180:183], v[220:223]
    s_waitcnt vmcnt(20)
    v_mfma_f32_16x16x32_bf16 v[224:227], v[84:87], a[12:15], v[224:227]
    v_mfma_f32_16x16x32_bf16 v[228:231], v[84:87], a[68:71], v[228:231]
    v_mfma_f32_16x16x32_bf16 v[232:235], v[84:87], a[124:127], v[232:235]
    v_mfma_f32_16x16x32_bf16 v[236:239], v[84:87], a[180:183], v[236:239]
    s_waitcnt vmcnt(19)
    v_mfma_f32_16x16x32_bf16 v[208:211], v[32:35], a[16:19], v[208:211]
    v_mfma_f32_16x16x32_bf16 v[212:215], v[32:35], a[72:75], v[212:215]
    v_mfma_f32_16x16x32_bf16 v[216:219], v[32:35], a[128:131], v[216:219]
    v_mfma_f32_16x16x32_bf16 v[220:223], v[32:35], a[184:187], v[220:223]
    s_waitcnt vmcnt(18)
    v_mfma_f32_16x16x32_bf16 v[224:227], v[88:91], a[16:19], v[224:227]
    v_mfma_f32_16x16x32_bf16 v[228:231], v[88:91], a[72:75], v[228:231]
    v_mfma_f32_16x16x32_bf16 v[232:235], v[88:91], a[128:131], v[232:235]
    v_mfma_f32_16x16x32_bf16 v[236:239], v[88:91], a[184:187], v[236:239]
    s_waitcnt vmcnt(17)
    v_mfma_f32_16x16x32_bf16 v[208:211], v[36:39], a[20:23], v[208:211]
    v_mfma_f32_16x16x32_bf16 v[212:215], v[36:39], a[76:79], v[212:215]
    v_mfma_f32_16x16x32_bf16 v[216:219], v[36:39], a[132:135], v[216:219]
    v_mfma_f32_16x16x32_bf16 v[220:223], v[36:39], a[188:191], v[220:223]
    s_waitcnt vmcnt(16)
    v_mfma_f32_16x16x32_bf16 v[224:227], v[92:95], a[20:23], v[224:227]
    v_mfma_f32_16x16x32_bf16 v[228:231], v[92:95], a[76:79], v[228:231]
    v_mfma_f32_16x16x32_bf16 v[232:235], v[92:95], a[132:135], v[232:235]
    v_mfma_f32_16x16x32_bf16 v[236:239], v[92:95], a[188:191], v[236:239]
    s_waitcnt vmcnt(15)
    v_mfma_f32_16x16x32_bf16 v[208:211], v[40:43], a[24:27], v[208:211]
    v_mfma_f32_16x16x32_bf16 v[212:215], v[40:43], a[80:83], v[212:215]
    v_mfma_f32_16x16x32_bf16 v[216:219], v[40:43], a[136:139], v[216:219]
    v_mfma_f32_16x16x32_bf16 v[220:223], v[40:43], a[192:195], v[220:223]
    s_waitcnt vmcnt(14)
    v_mfma_f32_16x16x32_bf16 v[224:227], v[96:99], a[24:27], v[224:227]
    v_mfma_f32_16x16x32_bf16 v[228:231], v[96:99], a[80:83], v[228:231]
    v_mfma_f32_16x16x32_bf16 v[232:235], v[96:99], a[136:139], v[232:235]
    v_mfma_f32_16x16x32_bf16 v[236:239], v[96:99], a[192:195], v[236:239]
    s_waitcnt vmcnt(13)
    v_mfma_f32_16x16x32_bf16 v[208:211], v[44:47], a[28:31], v[208:211]
    v_mfma_f32_16x16x32_bf16 v[212:215], v[44:47], a[84:87], v[212:215]
    v_mfma_f32_16x16x32_bf16 v[216:219], v[44:47], a[140:143], v[216:219]
    v_mfma_f32_16x16x32_bf16 v[220:223], v[44:47], a[196:199], v[220:223]
    s_waitcnt vmcnt(12)
    v_mfma_f32_16x16x32_bf16 v[224:227], v[100:103], a[28:31], v[224:227]
    v_mfma_f32_16x16x32_bf16 v[228:231], v[100:103], a[84:87], v[228:231]
    v_mfma_f32_16x16x32_bf16 v[232:235], v[100:103], a[140:143], v[232:235]
    v_mfma_f32_16x16x32_bf16 v[236:239], v[100:103], a[196:199], v[236:239]
    s_waitcnt vmcnt(11)
    v_mfma_f32_16x16x32_bf16 v[208:211], v[48:51], a[32:35], v[208:211]
    v_mfma_f32_16x16x32_bf16 v[212:215], v[48:51], a[88:91], v[212:215]
    v_mfma_f32_16x16x32_bf16 v[216:219], v[48:51], a[144:147], v[216:219]
    v_mfma_f32_16x16x32_bf16 v[220:223], v[48:51], a[200:203], v[220:223]
    s_waitcnt vmcnt(10)
    v_mfma_f32_16x16x32_bf16 v[224:227], v[104:107], a[32:35], v[224:227]
    v_mfma_f32_16x16x32_bf16 v[228:231], v[104:107], a[88:91], v[228:231]
    v_mfma_f32_16x16x32_bf16 v[232:235], v[104:107], a[144:147], v[232:235]
    v_mfma_f32_16x16x32_bf16 v[236:239], v[104:107], a[200:203], v[236:239]
    s_waitcnt vmcnt(9)
    v_mfma_f32_16x16x32_bf16 v[208:211], v[52:55], a[36:39], v[208:211]
    v_mfma_f32_16x16x32_bf16 v[212:215], v[52:55], a[92:95], v[212:215]
    v_mfma_f32_16x16x32_bf16 v[216:219], v[52:55], a[148:151], v[216:219]
    v_mfma_f32_16x16x32_bf16 v[220:223], v[52:55], a[204:207], v[220:223]
    s_waitcnt vmcnt(8)
    v_mfma_f32_16x16x32_bf16 v[224:227], v[108:111], a[36:39], v[224:227]
    v_mfma_f32_16x16x32_bf16 v[228:231], v[108:111], a[92:95], v[228:231]
    v_mfma_f32_16x16x32_bf16 v[232:235], v[108:111], a[148:151], v[232:235]
    v_mfma_f32_16x16x32_bf16 v[236:239], v[108:111], a[204:207], v[236:239]
    s_waitcnt vmcnt(7)
    v_mfma_f32_16x16x32_bf16 v[208:211], v[56:59], a[40:43], v[208:211]
    v_mfma_f32_16x16x32_bf16 v[212:215], v[56:59], a[96:99], v[212:215]
    v_mfma_f32_16x16x32_bf16 v[216:219], v[56:59], a[152:155], v[216:219]
    v_mfma_f32_16x16x32_bf16 v[220:223], v[56:59], a[208:211], v[220:223]
    s_waitcnt vmcnt(6)
    v_mfma_f32_16x16x32_bf16 v[224:227], v[112:115], a[40:43], v[224:227]
    v_mfma_f32_16x16x32_bf16 v[228:231], v[112:115], a[96:99], v[228:231]
    v_mfma_f32_16x16x32_bf16 v[232:235], v[112:115], a[152:155], v[232:235]
    v_mfma_f32_16x16x32_bf16 v[236:239], v[112:115], a[208:211], v[236:239]
    s_waitcnt vmcnt(5)
    v_mfma_f32_16x16x32_bf16 v[208:211], v[60:63], a[44:47], v[208:211]
    v_mfma_f32_16x16x32_bf16 v[212:215], v[60:63], a[100:103], v[212:215]
    v_mfma_f32_16x16x32_bf16 v[216:219], v[60:63], a[156:159], v[216:219]
    v_mfma_f32_16x16x32_bf16 v[220:223], v[60:63], a[212:215], v[220:223]
    s_waitcnt vmcnt(4)
    v_mfma_f32_16x16x32_bf16 v[224:227], v[116:119], a[44:47], v[224:227]
    v_mfma_f32_16x16x32_bf16 v[228:231], v[116:119], a[100:103], v[228:231]
    v_mfma_f32_16x16x32_bf16 v[232:235], v[116:119], a[156:159], v[232:235]
    v_mfma_f32_16x16x32_bf16 v[236:239], v[116:119], a[212:215], v[236:239]
    s_waitcnt vmcnt(3)
    v_mfma_f32_16x16x32_bf16 v[208:211], v[64:67], a[48:51], v[208:211]
    v_mfma_f32_16x16x32_bf16 v[212:215], v[64:67], a[104:107], v[212:215]
    v_mfma_f32_16x16x32_bf16 v[216:219], v[64:67], a[160:163], v[216:219]
    v_mfma_f32_16x16x32_bf16 v[220:223], v[64:67], a[216:219], v[220:223]
    s_waitcnt vmcnt(2)
    v_mfma_f32_16x16x32_bf16 v[224:227], v[120:123], a[48:51], v[224:227]
    v_mfma_f32_16x16x32_bf16 v[228:231], v[120:123], a[104:107], v[228:231]
    v_mfma_f32_16x16x32_bf16 v[232:235], v[120:123], a[160:163], v[232:235]
    v_mfma_f32_16x16x32_bf16 v[236:239], v[120:123], a[216:219], v[236:239]
    s_waitcnt vmcnt(1)
    v_mfma_f32_16x16x32_bf16 v[208:211], v[68:71], a[52:55], v[208:211]
    v_mfma_f32_16x16x32_bf16 v[212:215], v[68:71], a[108:111], v[212:215]
    v_mfma_f32_16x16x32_bf16 v[216:219], v[68:71], a[164:167], v[216:219]
    v_mfma_f32_16x16x32_bf16 v[220:223], v[68:71], a[220:223], v[220:223]
    s_waitcnt vmcnt(0)
    v_mfma_f32_16x16x32_bf16 v[224:227], v[124:127], a[52:55], v[224:227]
    v_mfma_f32_16x16x32_bf16 v[228:231], v[124:127], a[108:111], v[228:231]
    v_mfma_f32_16x16x32_bf16 v[232:235], v[124:127], a[164:167], v[232:235]
    v_mfma_f32_16x16x32_bf16 v[236:239], v[124:127], a[220:223], v[236:239]
    v_cvt_pk_bf16_f32 v240, v208, v209
    v_cvt_pk_bf16_f32 v241, v210, v211
    v_cvt_pk_bf16_f32 v242, v224, v225
    v_cvt_pk_bf16_f32 v243, v226, v227
    buffer_store_dwordx4 v[240:243], v1, s[12:15], s54 offen offset:0 sc1
    v_cvt_pk_bf16_f32 v244, v212, v213
    v_cvt_pk_bf16_f32 v245, v214, v215
    v_cvt_pk_bf16_f32 v246, v228, v229
    v_cvt_pk_bf16_f32 v247, v230, v231
    buffer_store_dwordx4 v[244:247], v1, s[12:15], s54 offen offset:1024 sc1
    v_cvt_pk_bf16_f32 v248, v216, v217
    v_cvt_pk_bf16_f32 v249, v218, v219
    v_cvt_pk_bf16_f32 v250, v232, v233
    v_cvt_pk_bf16_f32 v251, v234, v235
    buffer_store_dwordx4 v[248:251], v1, s[12:15], s54 offen offset:2048 sc1
    v_cvt_pk_bf16_f32 v252, v220, v221
    v_cvt_pk_bf16_f32 v253, v222, v223
    v_cvt_pk_bf16_f32 v254, v236, v237
    v_cvt_pk_bf16_f32 v255, v238, v239
    buffer_store_dwordx4 v[252:255], v1, s[12:15], s54 offen offset:3072 sc1
    s_add_u32 s54, s54, 1835008
    s_waitcnt vmcnt(0)
    s_mov_b64 exec, 1
    buffer_atomic_add v5, v4, s[12:15], s56 offen sc1
    s_mov_b64 exec, -1
    s_min_u32 s99, s98, 63
    s_cmp_lt_u32 s99, s96
    s_cbranch_scc1 Lgo_main_kernel_174
    s_mov_b32 s70, 2097152
    v_lshlrev_b32 v6, 3, v1
    v_and_b32 v6, 0x780, v6
Lgl_main_kernel_175:
    s_min_u32 s96, s96, 48
    s_lshl_b32 s97, s96, 7
    s_add_u32 s97, s97, 97722368
    s_mov_b64 exec, 0xffff
    buffer_load_dword v7, v6, s[12:15], s97 offen sc1
    s_mov_b64 exec, -1
    s_sub_u32 s70, s70, 1
    s_cbranch_scc1 Lexit_main_kernel
    s_waitcnt vmcnt(0)
    v_cmp_ne_u32 vcc, 32, v7
    s_nop 0
    s_or_b32 s97, vcc_lo, 0x10000
    s_ff1_i32_b32 s97, s97
    s_add_u32 s96, s96, s97
    s_cmp_eq_u32 s97, 16
    s_cselect_b32 s97, 1, 0
    s_cmp_ge_u32 s96, 64
    s_cselect_b32 s96, 0x100, s96
    s_cbranch_scc1 Lgo_main_kernel_174
    s_cmp_lt_u32 s99, s96
    s_cbranch_scc1 Lgo_main_kernel_174
    s_cmp_eq_u32 s97, 1
    s_cbranch_scc1 Lgl_main_kernel_175
    s_cmp_lt_u32 s99, s96
    s_cbranch_scc1 Lgo_main_kernel_174
    s_add_u32 s97, s96, 1
    s_cmp_gt_u32 s99, s97
    s_cbranch_scc1 Lgf_main_kernel_176
    s_sleep 2
    s_branch Lgl_main_kernel_175
Lgf_main_kernel_176:
    s_sleep 2
    s_branch Lgl_main_kernel_175
Lgo_main_kernel_174:
    s_add_u32 s98, s98, 4
    s_add_u32 s53, s52, 0
    s_add_u32 s57, s52, 14336
    buffer_load_dwordx4 v[128:131], v1, s[12:15], s53 offen offset:0 sc1
    buffer_load_dwordx4 v[184:187], v1, s[12:15], s57 offen offset:0 sc1
    buffer_load_dwordx4 v[132:135], v1, s[12:15], s53 offen offset:1024 sc1
    buffer_load_dwordx4 v[188:191], v1, s[12:15], s57 offen offset:1024 sc1
    buffer_load_dwordx4 v[136:139], v1, s[12:15], s53 offen offset:2048 sc1
    buffer_load_dwordx4 v[192:195], v1, s[12:15], s57 offen offset:2048 sc1
    buffer_load_dwordx4 v[140:143], v1, s[12:15], s53 offen offset:3072 sc1
    buffer_load_dwordx4 v[196:199], v1, s[12:15], s57 offen offset:3072 sc1
    s_add_u32 s53, s52, 4096
    s_add_u32 s57, s52, 18432
    buffer_load_dwordx4 v[144:147], v1, s[12:15], s53 offen offset:0 sc1
    buffer_load_dwordx4 v[200:203], v1, s[12:15], s57 offen offset:0 sc1
    buffer_load_dwordx4 v[148:151], v1, s[12:15], s53 offen offset:1024 sc1
    buffer_load_dwordx4 v[204:207], v1, s[12:15], s57 offen offset:1024 sc1
    buffer_load_dwordx4 v[152:155], v1, s[12:15], s53 offen offset:2048 sc1
    buffer_load_dwordx4 a[224:227], v1, s[12:15], s57 offen offset:2048 sc1
    buffer_load_dwordx4 v[156:159], v1, s[12:15], s53 offen offset:3072 sc1
    buffer_load_dwordx4 a[228:231], v1, s[12:15], s57 offen offset:3072 sc1
    s_add_u32 s53, s52, 8192
    s_add_u32 s57, s52, 22528
    buffer_load_dwordx4 v[160:163], v1, s[12:15], s53 offen offset:0 sc1
    buffer_load_dwordx4 a[232:235], v1, s[12:15], s57 offen offset:0 sc1
    buffer_load_dwordx4 v[164:167], v1, s[12:15], s53 offen offset:1024 sc1
    buffer_load_dwordx4 a[236:239], v1, s[12:15], s57 offen offset:1024 sc1
    buffer_load_dwordx4 v[168:171], v1, s[12:15], s53 offen offset:2048 sc1
    buffer_load_dwordx4 a[240:243], v1, s[12:15], s57 offen offset:2048 sc1
    buffer_load_dwordx4 v[172:175], v1, s[12:15], s53 offen offset:3072 sc1
    buffer_load_dwordx4 a[244:247], v1, s[12:15], s57 offen offset:3072 sc1
    s_add_u32 s53, s52, 12288
    s_add_u32 s57, s52, 26624
    buffer_load_dwordx4 v[176:179], v1, s[12:15], s53 offen offset:0 sc1
    buffer_load_dwordx4 a[248:251], v1, s[12:15], s57 offen offset:0 sc1
    buffer_load_dwordx4 v[180:183], v1, s[12:15], s53 offen offset:1024 sc1
    buffer_load_dwordx4 a[252:255], v1, s[12:15], s57 offen offset:1024 sc1
    s_add_u32 s52, s52, 114688
    s_min_u32 s52, s52, 17403904
    s_add_u32 s56, s56, 512
    s_waitcnt vmcnt(27)
    v_mfma_f32_16x16x32_bf16 v[208:211], v[128:131], a[0:3], 0
    v_mfma_f32_16x16x32_bf16 v[212:215], v[128:131], a[56:59], 0
    v_mfma_f32_16x16x32_bf16 v[216:219], v[128:131], a[112:115], 0
    v_mfma_f32_16x16x32_bf16 v[220:223], v[128:131], a[168:171], 0
    s_waitcnt vmcnt(26)
    v_mfma_f32_16x16x32_bf16 v[224:227], v[184:187], a[0:3], 0
    v_mfma_f32_16x16x32_bf16 v[228:231], v[184:187], a[56:59], 0
    v_mfma_f32_16x16x32_bf16 v[232:235], v[184:187], a[112:115], 0
    v_mfma_f32_16x16x32_bf16 v[236:239], v[184:187], a[168:171], 0
    s_waitcnt vmcnt(25)
    v_mfma_f32_16x16x32_bf16 v[208:211], v[132:135], a[4:7], v[208:211]
    v_mfma_f32_16x16x32_bf16 v[212:215], v[132:135], a[60:63], v[212:215]
    v_mfma_f32_16x16x32_bf16 v[216:219], v[132:135], a[116:119], v[216:219]
    v_mfma_f32_16x16x32_bf16 v[220:223], v[132:135], a[172:175], v[220:223]
    s_waitcnt vmcnt(24)
    v_mfma_f32_16x16x32_bf16 v[224:227], v[188:191], a[4:7], v[224:227]
    v_mfma_f32_16x16x32_bf16 v[228:231], v[188:191], a[60:63], v[228:231]
    v_mfma_f32_16x16x32_bf16 v[232:235], v[188:191], a[116:119], v[232:235]
    v_mfma_f32_16x16x32_bf16 v[236:239], v[188:191], a[172:175], v[236:239]
    s_waitcnt vmcnt(23)
    v_mfma_f32_16x16x32_bf16 v[208:211], v[136:139], a[8:11], v[208:211]
    v_mfma_f32_16x16x32_bf16 v[212:215], v[136:139], a[64:67], v[212:215]
    v_mfma_f32_16x16x32_bf16 v[216:219], v[136:139], a[120:123], v[216:219]
    v_mfma_f32_16x16x32_bf16 v[220:223], v[136:139], a[176:179], v[220:223]
    s_waitcnt vmcnt(22)
    v_mfma_f32_16x16x32_bf16 v[224:227], v[192:195], a[8:11], v[224:227]
    v_mfma_f32_16x16x32_bf16 v[228:231], v[192:195], a[64:67], v[228:231]
    v_mfma_f32_16x16x32_bf16 v[232:235], v[192:195], a[120:123], v[232:235]
    v_mfma_f32_16x16x32_bf16 v[236:239], v[192:195], a[176:179], v[236:239]
    s_waitcnt vmcnt(21)
    v_mfma_f32_16x16x32_bf16 v[208:211], v[140:143], a[12:15], v[208:211]
    v_mfma_f32_16x16x32_bf16 v[212:215], v[140:143], a[68:71], v[212:215]
    v_mfma_f32_16x16x32_bf16 v[216:219], v[140:143], a[124:127], v[216:219]
    v_mfma_f32_16x16x32_bf16 v[220:223], v[140:143], a[180:183], v[220:223]
    s_waitcnt vmcnt(20)
    v_mfma_f32_16x16x32_bf16 v[224:227], v[196:199], a[12:15], v[224:227]
    v_mfma_f32_16x16x32_bf16 v[228:231], v[196:199], a[68:71], v[228:231]
    v_mfma_f32_16x16x32_bf16 v[232:235], v[196:199], a[124:127], v[232:235]
    v_mfma_f32_16x16x32_bf16 v[236:239], v[196:199], a[180:183], v[236:239]
    s_waitcnt vmcnt(19)
    v_mfma_f32_16x16x32_bf16 v[208:211], v[144:147], a[16:19], v[208:211]
    v_mfma_f32_16x16x32_bf16 v[212:215], v[144:147], a[72:75], v[212:215]
    v_mfma_f32_16x16x32_bf16 v[216:219], v[144:147], a[128:131], v[216:219]
    v_mfma_f32_16x16x32_bf16 v[220:223], v[144:147], a[184:187], v[220:223]
    s_waitcnt vmcnt(18)
    v_mfma_f32_16x16x32_bf16 v[224:227], v[200:203], a[16:19], v[224:227]
    v_mfma_f32_16x16x32_bf16 v[228:231], v[200:203], a[72:75], v[228:231]
    v_mfma_f32_16x16x32_bf16 v[232:235], v[200:203], a[128:131], v[232:235]
    v_mfma_f32_16x16x32_bf16 v[236:239], v[200:203], a[184:187], v[236:239]
    s_waitcnt vmcnt(17)
    v_mfma_f32_16x16x32_bf16 v[208:211], v[148:151], a[20:23], v[208:211]
    v_mfma_f32_16x16x32_bf16 v[212:215], v[148:151], a[76:79], v[212:215]
    v_mfma_f32_16x16x32_bf16 v[216:219], v[148:151], a[132:135], v[216:219]
    v_mfma_f32_16x16x32_bf16 v[220:223], v[148:151], a[188:191], v[220:223]
    s_waitcnt vmcnt(16)
    v_mfma_f32_16x16x32_bf16 v[224:227], v[204:207], a[20:23], v[224:227]
    v_mfma_f32_16x16x32_bf16 v[228:231], v[204:207], a[76:79], v[228:231]
    v_mfma_f32_16x16x32_bf16 v[232:235], v[204:207], a[132:135], v[232:235]
    v_mfma_f32_16x16x32_bf16 v[236:239], v[204:207], a[188:191], v[236:239]
    s_waitcnt vmcnt(15)
    v_mfma_f32_16x16x32_bf16 v[208:211], v[152:155], a[24:27], v[208:211]
    v_mfma_f32_16x16x32_bf16 v[212:215], v[152:155], a[80:83], v[212:215]
    v_mfma_f32_16x16x32_bf16 v[216:219], v[152:155], a[136:139], v[216:219]
    v_mfma_f32_16x16x32_bf16 v[220:223], v[152:155], a[192:195], v[220:223]
    s_waitcnt vmcnt(14)
    v_mfma_f32_16x16x32_bf16 v[224:227], a[224:227], a[24:27], v[224:227]
    v_mfma_f32_16x16x32_bf16 v[228:231], a[224:227], a[80:83], v[228:231]
    v_mfma_f32_16x16x32_bf16 v[232:235], a[224:227], a[136:139], v[232:235]
    v_mfma_f32_16x16x32_bf16 v[236:239], a[224:227], a[192:195], v[236:239]
    s_waitcnt vmcnt(13)
    v_mfma_f32_16x16x32_bf16 v[208:211], v[156:159], a[28:31], v[208:211]
    v_mfma_f32_16x16x32_bf16 v[212:215], v[156:159], a[84:87], v[212:215]
    v_mfma_f32_16x16x32_bf16 v[216:219], v[156:159], a[140:143], v[216:219]
    v_mfma_f32_16x16x32_bf16 v[220:223], v[156:159], a[196:199], v[220:223]
    s_waitcnt vmcnt(12)
    v_mfma_f32_16x16x32_bf16 v[224:227], a[228:231], a[28:31], v[224:227]
    v_mfma_f32_16x16x32_bf16 v[228:231], a[228:231], a[84:87], v[228:231]
    v_mfma_f32_16x16x32_bf16 v[232:235], a[228:231], a[140:143], v[232:235]
    v_mfma_f32_16x16x32_bf16 v[236:239], a[228:231], a[196:199], v[236:239]
    s_waitcnt vmcnt(11)
    v_mfma_f32_16x16x32_bf16 v[208:211], v[160:163], a[32:35], v[208:211]
    v_mfma_f32_16x16x32_bf16 v[212:215], v[160:163], a[88:91], v[212:215]
    v_mfma_f32_16x16x32_bf16 v[216:219], v[160:163], a[144:147], v[216:219]
    v_mfma_f32_16x16x32_bf16 v[220:223], v[160:163], a[200:203], v[220:223]
    s_waitcnt vmcnt(10)
    v_mfma_f32_16x16x32_bf16 v[224:227], a[232:235], a[32:35], v[224:227]
    v_mfma_f32_16x16x32_bf16 v[228:231], a[232:235], a[88:91], v[228:231]
    v_mfma_f32_16x16x32_bf16 v[232:235], a[232:235], a[144:147], v[232:235]
    v_mfma_f32_16x16x32_bf16 v[236:239], a[232:235], a[200:203], v[236:239]
    s_waitcnt vmcnt(9)
    v_mfma_f32_16x16x32_bf16 v[208:211], v[164:167], a[36:39], v[208:211]
    v_mfma_f32_16x16x32_bf16 v[212:215], v[164:167], a[92:95], v[212:215]
    v_mfma_f32_16x16x32_bf16 v[216:219], v[164:167], a[148:151], v[216:219]
    v_mfma_f32_16x16x32_bf16 v[220:223], v[164:167], a[204:207], v[220:223]
    s_waitcnt vmcnt(8)
    v_mfma_f32_16x16x32_bf16 v[224:227], a[236:239], a[36:39], v[224:227]
    v_mfma_f32_16x16x32_bf16 v[228:231], a[236:239], a[92:95], v[228:231]
    v_mfma_f32_16x16x32_bf16 v[232:235], a[236:239], a[148:151], v[232:235]
    v_mfma_f32_16x16x32_bf16 v[236:239], a[236:239], a[204:207], v[236:239]
    s_waitcnt vmcnt(7)
    v_mfma_f32_16x16x32_bf16 v[208:211], v[168:171], a[40:43], v[208:211]
    v_mfma_f32_16x16x32_bf16 v[212:215], v[168:171], a[96:99], v[212:215]
    v_mfma_f32_16x16x32_bf16 v[216:219], v[168:171], a[152:155], v[216:219]
    v_mfma_f32_16x16x32_bf16 v[220:223], v[168:171], a[208:211], v[220:223]
    s_waitcnt vmcnt(6)
    v_mfma_f32_16x16x32_bf16 v[224:227], a[240:243], a[40:43], v[224:227]
    v_mfma_f32_16x16x32_bf16 v[228:231], a[240:243], a[96:99], v[228:231]
    v_mfma_f32_16x16x32_bf16 v[232:235], a[240:243], a[152:155], v[232:235]
    v_mfma_f32_16x16x32_bf16 v[236:239], a[240:243], a[208:211], v[236:239]
    s_waitcnt vmcnt(5)
    v_mfma_f32_16x16x32_bf16 v[208:211], v[172:175], a[44:47], v[208:211]
    v_mfma_f32_16x16x32_bf16 v[212:215], v[172:175], a[100:103], v[212:215]
    v_mfma_f32_16x16x32_bf16 v[216:219], v[172:175], a[156:159], v[216:219]
    v_mfma_f32_16x16x32_bf16 v[220:223], v[172:175], a[212:215], v[220:223]
    s_waitcnt vmcnt(4)
    v_mfma_f32_16x16x32_bf16 v[224:227], a[244:247], a[44:47], v[224:227]
    v_mfma_f32_16x16x32_bf16 v[228:231], a[244:247], a[100:103], v[228:231]
    v_mfma_f32_16x16x32_bf16 v[232:235], a[244:247], a[156:159], v[232:235]
    v_mfma_f32_16x16x32_bf16 v[236:239], a[244:247], a[212:215], v[236:239]
    s_waitcnt vmcnt(3)
    v_mfma_f32_16x16x32_bf16 v[208:211], v[176:179], a[48:51], v[208:211]
    v_mfma_f32_16x16x32_bf16 v[212:215], v[176:179], a[104:107], v[212:215]
    v_mfma_f32_16x16x32_bf16 v[216:219], v[176:179], a[160:163], v[216:219]
    v_mfma_f32_16x16x32_bf16 v[220:223], v[176:179], a[216:219], v[220:223]
    s_waitcnt vmcnt(2)
    v_mfma_f32_16x16x32_bf16 v[224:227], a[248:251], a[48:51], v[224:227]
    v_mfma_f32_16x16x32_bf16 v[228:231], a[248:251], a[104:107], v[228:231]
    v_mfma_f32_16x16x32_bf16 v[232:235], a[248:251], a[160:163], v[232:235]
    v_mfma_f32_16x16x32_bf16 v[236:239], a[248:251], a[216:219], v[236:239]
    s_waitcnt vmcnt(1)
    v_mfma_f32_16x16x32_bf16 v[208:211], v[180:183], a[52:55], v[208:211]
    v_mfma_f32_16x16x32_bf16 v[212:215], v[180:183], a[108:111], v[212:215]
    v_mfma_f32_16x16x32_bf16 v[216:219], v[180:183], a[164:167], v[216:219]
    v_mfma_f32_16x16x32_bf16 v[220:223], v[180:183], a[220:223], v[220:223]
    s_waitcnt vmcnt(0)
    v_mfma_f32_16x16x32_bf16 v[224:227], a[252:255], a[52:55], v[224:227]
    v_mfma_f32_16x16x32_bf16 v[228:231], a[252:255], a[108:111], v[228:231]
    v_mfma_f32_16x16x32_bf16 v[232:235], a[252:255], a[164:167], v[232:235]
    v_mfma_f32_16x16x32_bf16 v[236:239], a[252:255], a[220:223], v[236:239]
    v_cvt_pk_bf16_f32 v240, v208, v209
    v_cvt_pk_bf16_f32 v241, v210, v211
    v_cvt_pk_bf16_f32 v242, v224, v225
    v_cvt_pk_bf16_f32 v243, v226, v227
    buffer_store_dwordx4 v[240:243], v1, s[12:15], s54 offen offset:0 sc1
    v_cvt_pk_bf16_f32 v244, v212, v213
    v_cvt_pk_bf16_f32 v245, v214, v215
    v_cvt_pk_bf16_f32 v246, v228, v229
    v_cvt_pk_bf16_f32 v247, v230, v231
    buffer_store_dwordx4 v[244:247], v1, s[12:15], s54 offen offset:1024 sc1
    v_cvt_pk_bf16_f32 v248, v216, v217
    v_cvt_pk_bf16_f32 v249, v218, v219
    v_cvt_pk_bf16_f32 v250, v232, v233
    v_cvt_pk_bf16_f32 v251, v234, v235
    buffer_store_dwordx4 v[248:251], v1, s[12:15], s54 offen offset:2048 sc1
    v_cvt_pk_bf16_f32 v252, v220, v221
    v_cvt_pk_bf16_f32 v253, v222, v223
    v_cvt_pk_bf16_f32 v254, v236, v237
    v_cvt_pk_bf16_f32 v255, v238, v239
    buffer_store_dwordx4 v[252:255], v1, s[12:15], s54 offen offset:3072 sc1
    s_add_u32 s54, s54, 1835008
    s_waitcnt vmcnt(0)
    s_mov_b64 exec, 1
    buffer_atomic_add v5, v4, s[12:15], s56 offen sc1
    s_mov_b64 exec, -1
    s_min_u32 s99, s98, 63
    s_cmp_lt_u32 s99, s96
    s_cbranch_scc1 Lgo_main_kernel_177
    s_mov_b32 s70, 2097152
    v_lshlrev_b32 v6, 3, v1
    v_and_b32 v6, 0x780, v6
Lgl_main_kernel_178:
    s_min_u32 s96, s96, 48
    s_lshl_b32 s97, s96, 7
    s_add_u32 s97, s97, 97722368
    s_mov_b64 exec, 0xffff
    buffer_load_dword v7, v6, s[12:15], s97 offen sc1
    s_mov_b64 exec, -1
    s_sub_u32 s70, s70, 1
    s_cbranch_scc1 Lexit_main_kernel
    s_waitcnt vmcnt(0)
    v_cmp_ne_u32 vcc, 32, v7
    s_nop 0
    s_or_b32 s97, vcc_lo, 0x10000
    s_ff1_i32_b32 s97, s97
    s_add_u32 s96, s96, s97
    s_cmp_eq_u32 s97, 16
    s_cselect_b32 s97, 1, 0
    s_cmp_ge_u32 s96, 64
    s_cselect_b32 s96, 0x100, s96
    s_cbranch_scc1 Lgo_main_kernel_177
    s_cmp_lt_u32 s99, s96
    s_cbranch_scc1 Lgo_main_kernel_177
    s_cmp_eq_u32 s97, 1
    s_cbranch_scc1 Lgl_main_kernel_178
    s_cmp_lt_u32 s99, s96
    s_cbranch_scc1 Lgo_main_kernel_177
    s_add_u32 s97, s96, 1
    s_cmp_gt_u32 s99, s97
    s_cbranch_scc1 Lgf_main_kernel_179
    s_sleep 2
    s_branch Lgl_main_kernel_178
Lgf_main_kernel_179:
    s_sleep 2
    s_branch Lgl_main_kernel_178
Lgo_main_kernel_177:
    s_add_u32 s98, s98, 4
    s_add_u32 s53, s52, 0
    s_add_u32 s57, s52, 14336
    buffer_load_dwordx4 v[16:19], v1, s[12:15], s53 offen offset:0 sc1
    buffer_load_dwordx4 v[72:75], v1, s[12:15], s57 offen offset:0 sc1
    buffer_load_dwordx4 v[20:23], v1, s[12:15], s53 offen offset:1024 sc1
    buffer_load_dwordx4 v[76:79], v1, s[12:15], s57 offen offset:1024 sc1
    buffer_load_dwordx4 v[24:27], v1, s[12:15], s53 offen offset:2048 sc1
    buffer_load_dwordx4 v[80:83], v1, s[12:15], s57 offen offset:2048 sc1
    buffer_load_dwordx4 v[28:31], v1, s[12:15], s53 offen offset:3072 sc1
    buffer_load_dwordx4 v[84:87], v1, s[12:15], s57 offen offset:3072 sc1
    s_add_u32 s53, s52, 4096
    s_add_u32 s57, s52, 18432
    buffer_load_dwordx4 v[32:35], v1, s[12:15], s53 offen offset:0 sc1
    buffer_load_dwordx4 v[88:91], v1, s[12:15], s57 offen offset:0 sc1
    buffer_load_dwordx4 v[36:39], v1, s[12:15], s53 offen offset:1024 sc1
    buffer_load_dwordx4 v[92:95], v1, s[12:15], s57 offen offset:1024 sc1
    buffer_load_dwordx4 v[40:43], v1, s[12:15], s53 offen offset:2048 sc1
    buffer_load_dwordx4 v[96:99], v1, s[12:15], s57 offen offset:2048 sc1
    buffer_load_dwordx4 v[44:47], v1, s[12:15], s53 offen offset:3072 sc1
    buffer_load_dwordx4 v[100:103], v1, s[12:15], s57 offen offset:3072 sc1
    s_add_u32 s53, s52, 8192
    s_add_u32 s57, s52, 22528
    buffer_load_dwordx4 v[48:51], v1, s[12:15], s53 offen offset:0 sc1
    buffer_load_dwordx4 v[104:107], v1, s[12:15], s57 offen offset:0 sc1
    buffer_load_dwordx4 v[52:55], v1, s[12:15], s53 offen offset:1024 sc1
    buffer_load_dwordx4 v[108:111], v1, s[12:15], s57 offen offset:1024 sc1
    buffer_load_dwordx4 v[56:59], v1, s[12:15], s53 offen offset:2048 sc1
    buffer_load_dwordx4 v[112:115], v1, s[12:15], s57 offen offset:2048 sc1
    buffer_load_dwordx4 v[60:63], v1, s[12:15], s53 offen offset:3072 sc1
    buffer_load_dwordx4 v[116:119], v1, s[12:15], s57 offen offset:3072 sc1
    s_add_u32 s53, s52, 12288
    s_add_u32 s57, s52, 26624
    buffer_load_dwordx4 v[64:67], v1, s[12:15], s53 offen offset:0 sc1
    buffer_load_dwordx4 v[120:123], v1, s[12:15], s57 offen offset:0 sc1
    buffer_load_dwordx4 v[68:71], v1, s[12:15], s53 offen offset:1024 sc1
    buffer_load_dwordx4 v[124:127], v1, s[12:15], s57 offen offset:1024 sc1
    s_add_u32 s52, s52, 114688
    s_min_u32 s52, s52, 17403904
    s_add_u32 s56, s56, 512
    s_sub_u32 s51, s51, 1
    s_cmp_lg_u32 s51, 0
    s_cbranch_scc1 L_main_kernel_173
    s_branch L_main_kernel_172
L_main_kernel_171:
    s_lshl_b32 s54, s3, 4
    s_add_u32 s54, s54, s49
    s_mul_i32 s54, s54, 28672
    s_lshl_b32 s55, s48, 11
    s_add_u32 s54, s54, s55
    s_add_u32 s54, s54, 21102592
    s_mov_b32 s51, 8
L_main_kernel_180:
    s_waitcnt vmcnt(27)
    v_mfma_f32_16x16x32_bf16 v[208:211], a[0:3], v[16:19], 0
    v_mfma_f32_16x16x32_bf16 v[212:215], a[56:59], v[16:19], 0
    v_mfma_f32_16x16x32_bf16 v[216:219], a[112:115], v[16:19], 0
    v_mfma_f32_16x16x32_bf16 v[220:223], a[168:171], v[16:19], 0
    s_waitcnt vmcnt(26)
    v_mfma_f32_16x16x32_bf16 v[224:227], a[0:3], v[72:75], 0
    v_mfma_f32_16x16x32_bf16 v[228:231], a[56:59], v[72:75], 0
    v_mfma_f32_16x16x32_bf16 v[232:235], a[112:115], v[72:75], 0
    v_mfma_f32_16x16x32_bf16 v[236:239], a[168:171], v[72:75], 0
    s_waitcnt vmcnt(25)
    v_mfma_f32_16x16x32_bf16 v[208:211], a[4:7], v[20:23], v[208:211]
    v_mfma_f32_16x16x32_bf16 v[212:215], a[60:63], v[20:23], v[212:215]
    v_mfma_f32_16x16x32_bf16 v[216:219], a[116:119], v[20:23], v[216:219]
    v_mfma_f32_16x16x32_bf16 v[220:223], a[172:175], v[20:23], v[220:223]
    s_waitcnt vmcnt(24)
    v_mfma_f32_16x16x32_bf16 v[224:227], a[4:7], v[76:79], v[224:227]
    v_mfma_f32_16x16x32_bf16 v[228:231], a[60:63], v[76:79], v[228:231]
    v_mfma_f32_16x16x32_bf16 v[232:235], a[116:119], v[76:79], v[232:235]
    v_mfma_f32_16x16x32_bf16 v[236:239], a[172:175], v[76:79], v[236:239]
    s_waitcnt vmcnt(23)
    v_mfma_f32_16x16x32_bf16 v[208:211], a[8:11], v[24:27], v[208:211]
    v_mfma_f32_16x16x32_bf16 v[212:215], a[64:67], v[24:27], v[212:215]
    v_mfma_f32_16x16x32_bf16 v[216:219], a[120:123], v[24:27], v[216:219]
    v_mfma_f32_16x16x32_bf16 v[220:223], a[176:179], v[24:27], v[220:223]
    s_waitcnt vmcnt(22)
    v_mfma_f32_16x16x32_bf16 v[224:227], a[8:11], v[80:83], v[224:227]
    v_mfma_f32_16x16x32_bf16 v[228:231], a[64:67], v[80:83], v[228:231]
    v_mfma_f32_16x16x32_bf16 v[232:235], a[120:123], v[80:83], v[232:235]
    v_mfma_f32_16x16x32_bf16 v[236:239], a[176:179], v[80:83], v[236:239]
    s_waitcnt vmcnt(21)
    v_mfma_f32_16x16x32_bf16 v[208:211], a[12:15], v[28:31], v[208:211]
    v_mfma_f32_16x16x32_bf16 v[212:215], a[68:71], v[28:31], v[212:215]
    v_mfma_f32_16x16x32_bf16 v[216:219], a[124:127], v[28:31], v[216:219]
    v_mfma_f32_16x16x32_bf16 v[220:223], a[180:183], v[28:31], v[220:223]
    s_waitcnt vmcnt(20)
    v_mfma_f32_16x16x32_bf16 v[224:227], a[12:15], v[84:87], v[224:227]
    v_mfma_f32_16x16x32_bf16 v[228:231], a[68:71], v[84:87], v[228:231]
    v_mfma_f32_16x16x32_bf16 v[232:235], a[124:127], v[84:87], v[232:235]
    v_mfma_f32_16x16x32_bf16 v[236:239], a[180:183], v[84:87], v[236:239]
    s_waitcnt vmcnt(19)
    v_mfma_f32_16x16x32_bf16 v[208:211], a[16:19], v[32:35], v[208:211]
    v_mfma_f32_16x16x32_bf16 v[212:215], a[72:75], v[32:35], v[212:215]
    v_mfma_f32_16x16x32_bf16 v[216:219], a[128:131], v[32:35], v[216:219]
    v_mfma_f32_16x16x32_bf16 v[220:223], a[184:187], v[32:35], v[220:223]
    s_waitcnt vmcnt(18)
    v_mfma_f32_16x16x32_bf16 v[224:227], a[16:19], v[88:91], v[224:227]
    v_mfma_f32_16x16x32_bf16 v[228:231], a[72:75], v[88:91], v[228:231]
    v_mfma_f32_16x16x32_bf16 v[232:235], a[128:131], v[88:91], v[232:235]
    v_mfma_f32_16x16x32_bf16 v[236:239], a[184:187], v[88:91], v[236:239]
    s_waitcnt vmcnt(17)
    v_mfma_f32_16x16x32_bf16 v[208:211], a[20:23], v[36:39], v[208:211]
    v_mfma_f32_16x16x32_bf16 v[212:215], a[76:79], v[36:39], v[212:215]
    v_mfma_f32_16x16x32_bf16 v[216:219], a[132:135], v[36:39], v[216:219]
    v_mfma_f32_16x16x32_bf16 v[220:223], a[188:191], v[36:39], v[220:223]
    s_waitcnt vmcnt(16)
    v_mfma_f32_16x16x32_bf16 v[224:227], a[20:23], v[92:95], v[224:227]
    v_mfma_f32_16x16x32_bf16 v[228:231], a[76:79], v[92:95], v[228:231]
    v_mfma_f32_16x16x32_bf16 v[232:235], a[132:135], v[92:95], v[232:235]
    v_mfma_f32_16x16x32_bf16 v[236:239], a[188:191], v[92:95], v[236:239]
    s_waitcnt vmcnt(15)
    v_mfma_f32_16x16x32_bf16 v[208:211], a[24:27], v[40:43], v[208:211]
    v_mfma_f32_16x16x32_bf16 v[212:215], a[80:83], v[40:43], v[212:215]
    v_mfma_f32_16x16x32_bf16 v[216:219], a[136:139], v[40:43], v[216:219]
    v_mfma_f32_16x16x32_bf16 v[220:223], a[192:195], v[40:43], v[220:223]
    s_waitcnt vmcnt(14)
    v_mfma_f32_16x16x32_bf16 v[224:227], a[24:27], v[96:99], v[224:227]
    v_mfma_f32_16x16x32_bf16 v[228:231], a[80:83], v[96:99], v[228:231]
    v_mfma_f32_16x16x32_bf16 v[232:235], a[136:139], v[96:99], v[232:235]
    v_mfma_f32_16x16x32_bf16 v[236:239], a[192:195], v[96:99], v[236:239]
    s_waitcnt vmcnt(13)
    v_mfma_f32_16x16x32_bf16 v[208:211], a[28:31], v[44:47], v[208:211]
    v_mfma_f32_16x16x32_bf16 v[212:215], a[84:87], v[44:47], v[212:215]
    v_mfma_f32_16x16x32_bf16 v[216:219], a[140:143], v[44:47], v[216:219]
    v_mfma_f32_16x16x32_bf16 v[220:223], a[196:199], v[44:47], v[220:223]
    s_waitcnt vmcnt(12)
    v_mfma_f32_16x16x32_bf16 v[224:227], a[28:31], v[100:103], v[224:227]
    v_mfma_f32_16x16x32_bf16 v[228:231], a[84:87], v[100:103], v[228:231]
    v_mfma_f32_16x16x32_bf16 v[232:235], a[140:143], v[100:103], v[232:235]
    v_mfma_f32_16x16x32_bf16 v[236:239], a[196:199], v[100:103], v[236:239]
    s_waitcnt vmcnt(11)
    v_mfma_f32_16x16x32_bf16 v[208:211], a[32:35], v[48:51], v[208:211]
    v_mfma_f32_16x16x32_bf16 v[212:215], a[88:91], v[48:51], v[212:215]
    v_mfma_f32_16x16x32_bf16 v[216:219], a[144:147], v[48:51], v[216:219]
    v_mfma_f32_16x16x32_bf16 v[220:223], a[200:203], v[48:51], v[220:223]
    s_waitcnt vmcnt(10)
    v_mfma_f32_16x16x32_bf16 v[224:227], a[32:35], v[104:107], v[224:227]
    v_mfma_f32_16x16x32_bf16 v[228:231], a[88:91], v[104:107], v[228:231]
    v_mfma_f32_16x16x32_bf16 v[232:235], a[144:147], v[104:107], v[232:235]
    v_mfma_f32_16x16x32_bf16 v[236:239], a[200:203], v[104:107], v[236:239]
    s_waitcnt vmcnt(9)
    v_mfma_f32_16x16x32_bf16 v[208:211], a[36:39], v[52:55], v[208:211]
    v_mfma_f32_16x16x32_bf16 v[212:215], a[92:95], v[52:55], v[212:215]
    v_mfma_f32_16x16x32_bf16 v[216:219], a[148:151], v[52:55], v[216:219]
    v_mfma_f32_16x16x32_bf16 v[220:223], a[204:207], v[52:55], v[220:223]
    s_waitcnt vmcnt(8)
    v_mfma_f32_16x16x32_bf16 v[224:227], a[36:39], v[108:111], v[224:227]
    v_mfma_f32_16x16x32_bf16 v[228:231], a[92:95], v[108:111], v[228:231]
    v_mfma_f32_16x16x32_bf16 v[232:235], a[148:151], v[108:111], v[232:235]
    v_mfma_f32_16x16x32_bf16 v[236:239], a[204:207], v[108:111], v[236:239]
    s_waitcnt vmcnt(7)
    v_mfma_f32_16x16x32_bf16 v[208:211], a[40:43], v[56:59], v[208:211]
    v_mfma_f32_16x16x32_bf16 v[212:215], a[96:99], v[56:59], v[212:215]
    v_mfma_f32_16x16x32_bf16 v[216:219], a[152:155], v[56:59], v[216:219]
    v_mfma_f32_16x16x32_bf16 v[220:223], a[208:211], v[56:59], v[220:223]
    s_waitcnt vmcnt(6)
    v_mfma_f32_16x16x32_bf16 v[224:227], a[40:43], v[112:115], v[224:227]
    v_mfma_f32_16x16x32_bf16 v[228:231], a[96:99], v[112:115], v[228:231]
    v_mfma_f32_16x16x32_bf16 v[232:235], a[152:155], v[112:115], v[232:235]
    v_mfma_f32_16x16x32_bf16 v[236:239], a[208:211], v[112:115], v[236:239]
    s_waitcnt vmcnt(5)
    v_mfma_f32_16x16x32_bf16 v[208:211], a[44:47], v[60:63], v[208:211]
    v_mfma_f32_16x16x32_bf16 v[212:215], a[100:103], v[60:63], v[212:215]
    v_mfma_f32_16x16x32_bf16 v[216:219], a[156:159], v[60:63], v[216:219]
    v_mfma_f32_16x16x32_bf16 v[220:223], a[212:215], v[60:63], v[220:223]
    s_waitcnt vmcnt(4)
    v_mfma_f32_16x16x32_bf16 v[224:227], a[44:47], v[116:119], v[224:227]
    v_mfma_f32_16x16x32_bf16 v[228:231], a[100:103], v[116:119], v[228:231]
    v_mfma_f32_16x16x32_bf16 v[232:235], a[156:159], v[116:119], v[232:235]
    v_mfma_f32_16x16x32_bf16 v[236:239], a[212:215], v[116:119], v[236:239]
    s_waitcnt vmcnt(3)
    v_mfma_f32_16x16x32_bf16 v[208:211], a[48:51], v[64:67], v[208:211]
    v_mfma_f32_16x16x32_bf16 v[212:215], a[104:107], v[64:67], v[212:215]
    v_mfma_f32_16x16x32_bf16 v[216:219], a[160:163], v[64:67], v[216:219]
    v_mfma_f32_16x16x32_bf16 v[220:223], a[216:219], v[64:67], v[220:223]
    s_waitcnt vmcnt(2)
    v_mfma_f32_16x16x32_bf16 v[224:227], a[48:51], v[120:123], v[224:227]
    v_mfma_f32_16x16x32_bf16 v[228:231], a[104:107], v[120:123], v[228:231]
    v_mfma_f32_16x16x32_bf16 v[232:235], a[160:163], v[120:123], v[232:235]
    v_mfma_f32_16x16x32_bf16 v[236:239], a[216:219], v[120:123], v[236:239]
    s_waitcnt vmcnt(1)
    v_mfma_f32_16x16x32_bf16 v[208:211], a[52:55], v[68:71], v[208:211]
    v_mfma_f32_16x16x32_bf16 v[212:215], a[108:111], v[68:71], v[212:215]
    v_mfma_f32_16x16x32_bf16 v[216:219], a[164:167], v[68:71], v[216:219]
    v_mfma_f32_16x16x32_bf16 v[220:223], a[220:223], v[68:71], v[220:223]
    s_waitcnt vmcnt(0)
    v_mfma_f32_16x16x32_bf16 v[224:227], a[52:55], v[124:127], v[224:227]
    v_mfma_f32_16x16x32_bf16 v[228:231], a[108:111], v[124:127], v[228:231]
    v_mfma_f32_16x16x32_bf16 v[232:235], a[164:167], v[124:127], v[232:235]
    v_mfma_f32_16x16x32_bf16 v[236:239], a[220:223], v[124:127], v[236:239]
    v_cvt_pk_bf16_f32 v240, v208, v209
    v_cvt_pk_bf16_f32 v241, v210, v211
    v_cvt_pk_bf16_f32 v242, v212, v213
    v_cvt_pk_bf16_f32 v243, v214, v215
    buffer_store_dwordx4 v[240:243], v1, s[12:15], s54 offen offset:0 sc1
    v_cvt_pk_bf16_f32 v244, v216, v217
    v_cvt_pk_bf16_f32 v245, v218, v219
    v_cvt_pk_bf16_f32 v246, v220, v221
    v_cvt_pk_bf16_f32 v247, v222, v223
    buffer_store_dwordx4 v[244:247], v1, s[12:15], s54 offen offset:1024 sc1
    s_add_u32 s55, s54, 14336
    v_cvt_pk_bf16_f32 v248, v224, v225
    v_cvt_pk_bf16_f32 v249, v226, v227
    v_cvt_pk_bf16_f32 v250, v228, v229
    v_cvt_pk_bf16_f32 v251, v230, v231
    buffer_store_dwordx4 v[248:251], v1, s[12:15], s55 offen offset:0 sc1
    v_cvt_pk_bf16_f32 v252, v232, v233
    v_cvt_pk_bf16_f32 v253, v234, v235
    v_cvt_pk_bf16_f32 v254, v236, v237
    v_cvt_pk_bf16_f32 v255, v238, v239
    buffer_store_dwordx4 v[252:255], v1, s[12:15], s55 offen offset:1024 sc1
    s_add_u32 s54, s54, 1835008
    s_waitcnt vmcnt(0)
    s_mov_b64 exec, 1
    buffer_atomic_add v5, v4, s[12:15], s56 offen sc1
    s_mov_b64 exec, -1
    s_min_u32 s99, s98, 63
    s_cmp_lt_u32 s99, s96
    s_cbranch_scc1 Lgo_main_kernel_181
    s_mov_b32 s70, 2097152
    v_lshlrev_b32 v6, 3, v1
    v_and_b32 v6, 0x780, v6
Lgl_main_kernel_182:
    s_min_u32 s96, s96, 48
    s_lshl_b32 s97, s96, 7
    s_add_u32 s97, s97, 97722368
    s_mov_b64 exec, 0xffff
    buffer_load_dword v7, v6, s[12:15], s97 offen sc1
    s_mov_b64 exec, -1
    s_sub_u32 s70, s70, 1
    s_cbranch_scc1 Lexit_main_kernel
    s_waitcnt vmcnt(0)
    v_cmp_ne_u32 vcc, 32, v7
    s_nop 0
    s_or_b32 s97, vcc_lo, 0x10000
    s_ff1_i32_b32 s97, s97
    s_add_u32 s96, s96, s97
    s_cmp_eq_u32 s97, 16
    s_cselect_b32 s97, 1, 0
    s_cmp_ge_u32 s96, 64
    s_cselect_b32 s96, 0x100, s96
    s_cbranch_scc1 Lgo_main_kernel_181
    s_cmp_lt_u32 s99, s96
    s_cbranch_scc1 Lgo_main_kernel_181
    s_cmp_eq_u32 s97, 1
    s_cbranch_scc1 Lgl_main_kernel_182
    s_cmp_lt_u32 s99, s96
    s_cbranch_scc1 Lgo_main_kernel_181
    s_add_u32 s97, s96, 1
    s_cmp_gt_u32 s99, s97
    s_cbranch_scc1 Lgf_main_kernel_183
    s_sleep 2
    s_branch Lgl_main_kernel_182
Lgf_main_kernel_183:
    s_sleep 2
    s_branch Lgl_main_kernel_182
Lgo_main_kernel_181:
    s_add_u32 s98, s98, 4
    s_add_u32 s53, s52, 0
    s_add_u32 s57, s52, 14336
    buffer_load_dwordx4 v[128:131], v1, s[12:15], s53 offen offset:0 sc1
    buffer_load_dwordx4 v[184:187], v1, s[12:15], s57 offen offset:0 sc1
    buffer_load_dwordx4 v[132:135], v1, s[12:15], s53 offen offset:1024 sc1
    buffer_load_dwordx4 v[188:191], v1, s[12:15], s57 offen offset:1024 sc1
    buffer_load_dwordx4 v[136:139], v1, s[12:15], s53 offen offset:2048 sc1
    buffer_load_dwordx4 v[192:195], v1, s[12:15], s57 offen offset:2048 sc1
    buffer_load_dwordx4 v[140:143], v1, s[12:15], s53 offen offset:3072 sc1
    buffer_load_dwordx4 v[196:199], v1, s[12:15], s57 offen offset:3072 sc1
    s_add_u32 s53, s52, 4096
    s_add_u32 s57, s52, 18432
    buffer_load_dwordx4 v[144:147], v1, s[12:15], s53 offen offset:0 sc1
    buffer_load_dwordx4 v[200:203], v1, s[12:15], s57 offen offset:0 sc1
    buffer_load_dwordx4 v[148:151], v1, s[12:15], s53 offen offset:1024 sc1
    buffer_load_dwordx4 v[204:207], v1, s[12:15], s57 offen offset:1024 sc1
    buffer_load_dwordx4 v[152:155], v1, s[12:15], s53 offen offset:2048 sc1
    buffer_load_dwordx4 a[224:227], v1, s[12:15], s57 offen offset:2048 sc1
    buffer_load_dwordx4 v[156:159], v1, s[12:15], s53 offen offset:3072 sc1
    buffer_load_dwordx4 a[228:231], v1, s[12:15], s57 offen offset:3072 sc1
    s_add_u32 s53, s52, 8192
    s_add_u32 s57, s52, 22528
    buffer_load_dwordx4 v[160:163], v1, s[12:15], s53 offen offset:0 sc1
    buffer_load_dwordx4 a[232:235], v1, s[12:15], s57 offen offset:0 sc1
    buffer_load_dwordx4 v[164:167], v1, s[12:15], s53 offen offset:1024 sc1
    buffer_load_dwordx4 a[236:239], v1, s[12:15], s57 offen offset:1024 sc1
    buffer_load_dwordx4 v[168:171], v1, s[12:15], s53 offen offset:2048 sc1
    buffer_load_dwordx4 a[240:243], v1, s[12:15], s57 offen offset:2048 sc1
    buffer_load_dwordx4 v[172:175], v1, s[12:15], s53 offen offset:3072 sc1
    buffer_load_dwordx4 a[244:247], v1, s[12:15], s57 offen offset:3072 sc1
    s_add_u32 s53, s52, 12288
    s_add_u32 s57, s52, 26624
    buffer_load_dwordx4 v[176:179], v1, s[12:15], s53 offen offset:0 sc1
    buffer_load_dwordx4 a[248:251], v1, s[12:15], s57 offen offset:0 sc1
    buffer_load_dwordx4 v[180:183], v1, s[12:15], s53 offen offset:1024 sc1
    buffer_load_dwordx4 a[252:255], v1, s[12:15], s57 offen offset:1024 sc1
    s_add_u32 s52, s52, 114688
    s_min_u32 s52, s52, 17403904
    s_add_u32 s56, s56, 512
    s_waitcnt vmcnt(27)
    v_mfma_f32_16x16x32_bf16 v[208:211], a[0:3], v[128:131], 0
    v_mfma_f32_16x16x32_bf16 v[212:215], a[56:59], v[128:131], 0
    v_mfma_f32_16x16x32_bf16 v[216:219], a[112:115], v[128:131], 0
    v_mfma_f32_16x16x32_bf16 v[220:223], a[168:171], v[128:131], 0
    s_waitcnt vmcnt(26)
    v_mfma_f32_16x16x32_bf16 v[224:227], a[0:3], v[184:187], 0
    v_mfma_f32_16x16x32_bf16 v[228:231], a[56:59], v[184:187], 0
    v_mfma_f32_16x16x32_bf16 v[232:235], a[112:115], v[184:187], 0
    v_mfma_f32_16x16x32_bf16 v[236:239], a[168:171], v[184:187], 0
    s_waitcnt vmcnt(25)
    v_mfma_f32_16x16x32_bf16 v[208:211], a[4:7], v[132:135], v[208:211]
    v_mfma_f32_16x16x32_bf16 v[212:215], a[60:63], v[132:135], v[212:215]
    v_mfma_f32_16x16x32_bf16 v[216:219], a[116:119], v[132:135], v[216:219]
    v_mfma_f32_16x16x32_bf16 v[220:223], a[172:175], v[132:135], v[220:223]
    s_waitcnt vmcnt(24)
    v_mfma_f32_16x16x32_bf16 v[224:227], a[4:7], v[188:191], v[224:227]
    v_mfma_f32_16x16x32_bf16 v[228:231], a[60:63], v[188:191], v[228:231]
    v_mfma_f32_16x16x32_bf16 v[232:235], a[116:119], v[188:191], v[232:235]
    v_mfma_f32_16x16x32_bf16 v[236:239], a[172:175], v[188:191], v[236:239]
    s_waitcnt vmcnt(23)
    v_mfma_f32_16x16x32_bf16 v[208:211], a[8:11], v[136:139], v[208:211]
    v_mfma_f32_16x16x32_bf16 v[212:215], a[64:67], v[136:139], v[212:215]
    v_mfma_f32_16x16x32_bf16 v[216:219], a[120:123], v[136:139], v[216:219]
    v_mfma_f32_16x16x32_bf16 v[220:223], a[176:179], v[136:139], v[220:223]
    s_waitcnt vmcnt(22)
    v_mfma_f32_16x16x32_bf16 v[224:227], a[8:11], v[192:195], v[224:227]
    v_mfma_f32_16x16x32_bf16 v[228:231], a[64:67], v[192:195], v[228:231]
    v_mfma_f32_16x16x32_bf16 v[232:235], a[120:123], v[192:195], v[232:235]
    v_mfma_f32_16x16x32_bf16 v[236:239], a[176:179], v[192:195], v[236:239]
    s_waitcnt vmcnt(21)
    v_mfma_f32_16x16x32_bf16 v[208:211], a[12:15], v[140:143], v[208:211]
    v_mfma_f32_16x16x32_bf16 v[212:215], a[68:71], v[140:143], v[212:215]
    v_mfma_f32_16x16x32_bf16 v[216:219], a[124:127], v[140:143], v[216:219]
    v_mfma_f32_16x16x32_bf16 v[220:223], a[180:183], v[140:143], v[220:223]
    s_waitcnt vmcnt(20)
    v_mfma_f32_16x16x32_bf16 v[224:227], a[12:15], v[196:199], v[224:227]
    v_mfma_f32_16x16x32_bf16 v[228:231], a[68:71], v[196:199], v[228:231]
    v_mfma_f32_16x16x32_bf16 v[232:235], a[124:127], v[196:199], v[232:235]
    v_mfma_f32_16x16x32_bf16 v[236:239], a[180:183], v[196:199], v[236:239]
    s_waitcnt vmcnt(19)
    v_mfma_f32_16x16x32_bf16 v[208:211], a[16:19], v[144:147], v[208:211]
    v_mfma_f32_16x16x32_bf16 v[212:215], a[72:75], v[144:147], v[212:215]
    v_mfma_f32_16x16x32_bf16 v[216:219], a[128:131], v[144:147], v[216:219]
    v_mfma_f32_16x16x32_bf16 v[220:223], a[184:187], v[144:147], v[220:223]
    s_waitcnt vmcnt(18)
    v_mfma_f32_16x16x32_bf16 v[224:227], a[16:19], v[200:203], v[224:227]
    v_mfma_f32_16x16x32_bf16 v[228:231], a[72:75], v[200:203], v[228:231]
    v_mfma_f32_16x16x32_bf16 v[232:235], a[128:131], v[200:203], v[232:235]
    v_mfma_f32_16x16x32_bf16 v[236:239], a[184:187], v[200:203], v[236:239]
    s_waitcnt vmcnt(17)
    v_mfma_f32_16x16x32_bf16 v[208:211], a[20:23], v[148:151], v[208:211]
    v_mfma_f32_16x16x32_bf16 v[212:215], a[76:79], v[148:151], v[212:215]
    v_mfma_f32_16x16x32_bf16 v[216:219], a[132:135], v[148:151], v[216:219]
    v_mfma_f32_16x16x32_bf16 v[220:223], a[188:191], v[148:151], v[220:223]
    s_waitcnt vmcnt(16)
    v_mfma_f32_16x16x32_bf16 v[224:227], a[20:23], v[204:207], v[224:227]
    v_mfma_f32_16x16x32_bf16 v[228:231], a[76:79], v[204:207], v[228:231]
    v_mfma_f32_16x16x32_bf16 v[232:235], a[132:135], v[204:207], v[232:235]
    v_mfma_f32_16x16x32_bf16 v[236:239], a[188:191], v[204:207], v[236:239]
    s_waitcnt vmcnt(15)
    v_mfma_f32_16x16x32_bf16 v[208:211], a[24:27], v[152:155], v[208:211]
    v_mfma_f32_16x16x32_bf16 v[212:215], a[80:83], v[152:155], v[212:215]
    v_mfma_f32_16x16x32_bf16 v[216:219], a[136:139], v[152:155], v[216:219]
    v_mfma_f32_16x16x32_bf16 v[220:223], a[192:195], v[152:155], v[220:223]
    s_waitcnt vmcnt(14)
    v_mfma_f32_16x16x32_bf16 v[224:227], a[24:27], a[224:227], v[224:227]
    v_mfma_f32_16x16x32_bf16 v[228:231], a[80:83], a[224:227], v[228:231]
    v_mfma_f32_16x16x32_bf16 v[232:235], a[136:139], a[224:227], v[232:235]
    v_mfma_f32_16x16x32_bf16 v[236:239], a[192:195], a[224:227], v[236:239]
    s_waitcnt vmcnt(13)
    v_mfma_f32_16x16x32_bf16 v[208:211], a[28:31], v[156:159], v[208:211]
    v_mfma_f32_16x16x32_bf16 v[212:215], a[84:87], v[156:159], v[212:215]
    v_mfma_f32_16x16x32_bf16 v[216:219], a[140:143], v[156:159], v[216:219]
    v_mfma_f32_16x16x32_bf16 v[220:223], a[196:199], v[156:159], v[220:223]
    s_waitcnt vmcnt(12)
    v_mfma_f32_16x16x32_bf16 v[224:227], a[28:31], a[228:231], v[224:227]
    v_mfma_f32_16x16x32_bf16 v[228:231], a[84:87], a[228:231], v[228:231]
    v_mfma_f32_16x16x32_bf16 v[232:235], a[140:143], a[228:231], v[232:235]
    v_mfma_f32_16x16x32_bf16 v[236:239], a[196:199], a[228:231], v[236:239]
    s_waitcnt vmcnt(11)
    v_mfma_f32_16x16x32_bf16 v[208:211], a[32:35], v[160:163], v[208:211]
    v_mfma_f32_16x16x32_bf16 v[212:215], a[88:91], v[160:163], v[212:215]
    v_mfma_f32_16x16x32_bf16 v[216:219], a[144:147], v[160:163], v[216:219]
    v_mfma_f32_16x16x32_bf16 v[220:223], a[200:203], v[160:163], v[220:223]
    s_waitcnt vmcnt(10)
    v_mfma_f32_16x16x32_bf16 v[224:227], a[32:35], a[232:235], v[224:227]
    v_mfma_f32_16x16x32_bf16 v[228:231], a[88:91], a[232:235], v[228:231]
    v_mfma_f32_16x16x32_bf16 v[232:235], a[144:147], a[232:235], v[232:235]
    v_mfma_f32_16x16x32_bf16 v[236:239], a[200:203], a[232:235], v[236:239]
    s_waitcnt vmcnt(9)
    v_mfma_f32_16x16x32_bf16 v[208:211], a[36:39], v[164:167], v[208:211]
    v_mfma_f32_16x16x32_bf16 v[212:215], a[92:95], v[164:167], v[212:215]
    v_mfma_f32_16x16x32_bf16 v[216:219], a[148:151], v[164:167], v[216:219]
    v_mfma_f32_16x16x32_bf16 v[220:223], a[204:207], v[164:167], v[220:223]
    s_waitcnt vmcnt(8)
    v_mfma_f32_16x16x32_bf16 v[224:227], a[36:39], a[236:239], v[224:227]
    v_mfma_f32_16x16x32_bf16 v[228:231], a[92:95], a[236:239], v[228:231]
    v_mfma_f32_16x16x32_bf16 v[232:235], a[148:151], a[236:239], v[232:235]
    v_mfma_f32_16x16x32_bf16 v[236:239], a[204:207], a[236:239], v[236:239]
    s_waitcnt vmcnt(7)
    v_mfma_f32_16x16x32_bf16 v[208:211], a[40:43], v[168:171], v[208:211]
    v_mfma_f32_16x16x32_bf16 v[212:215], a[96:99], v[168:171], v[212:215]
    v_mfma_f32_16x16x32_bf16 v[216:219], a[152:155], v[168:171], v[216:219]
    v_mfma_f32_16x16x32_bf16 v[220:223], a[208:211], v[168:171], v[220:223]
    s_waitcnt vmcnt(6)
    v_mfma_f32_16x16x32_bf16 v[224:227], a[40:43], a[240:243], v[224:227]
    v_mfma_f32_16x16x32_bf16 v[228:231], a[96:99], a[240:243], v[228:231]
    v_mfma_f32_16x16x32_bf16 v[232:235], a[152:155], a[240:243], v[232:235]
    v_mfma_f32_16x16x32_bf16 v[236:239], a[208:211], a[240:243], v[236:239]
    s_waitcnt vmcnt(5)
    v_mfma_f32_16x16x32_bf16 v[208:211], a[44:47], v[172:175], v[208:211]
    v_mfma_f32_16x16x32_bf16 v[212:215], a[100:103], v[172:175], v[212:215]
    v_mfma_f32_16x16x32_bf16 v[216:219], a[156:159], v[172:175], v[216:219]
    v_mfma_f32_16x16x32_bf16 v[220:223], a[212:215], v[172:175], v[220:223]
    s_waitcnt vmcnt(4)
    v_mfma_f32_16x16x32_bf16 v[224:227], a[44:47], a[244:247], v[224:227]
    v_mfma_f32_16x16x32_bf16 v[228:231], a[100:103], a[244:247], v[228:231]
    v_mfma_f32_16x16x32_bf16 v[232:235], a[156:159], a[244:247], v[232:235]
    v_mfma_f32_16x16x32_bf16 v[236:239], a[212:215], a[244:247], v[236:239]
    s_waitcnt vmcnt(3)
    v_mfma_f32_16x16x32_bf16 v[208:211], a[48:51], v[176:179], v[208:211]
    v_mfma_f32_16x16x32_bf16 v[212:215], a[104:107], v[176:179], v[212:215]
    v_mfma_f32_16x16x32_bf16 v[216:219], a[160:163], v[176:179], v[216:219]
    v_mfma_f32_16x16x32_bf16 v[220:223], a[216:219], v[176:179], v[220:223]
    s_waitcnt vmcnt(2)
    v_mfma_f32_16x16x32_bf16 v[224:227], a[48:51], a[248:251], v[224:227]
    v_mfma_f32_16x16x32_bf16 v[228:231], a[104:107], a[248:251], v[228:231]
    v_mfma_f32_16x16x32_bf16 v[232:235], a[160:163], a[248:251], v[232:235]
    v_mfma_f32_16x16x32_bf16 v[236:239], a[216:219], a[248:251], v[236:239]
    s_waitcnt vmcnt(1)
    v_mfma_f32_16x16x32_bf16 v[208:211], a[52:55], v[180:183], v[208:211]
    v_mfma_f32_16x16x32_bf16 v[212:215], a[108:111], v[180:183], v[212:215]
    v_mfma_f32_16x16x32_bf16 v[216:219], a[164:167], v[180:183], v[216:219]
    v_mfma_f32_16x16x32_bf16 v[220:223], a[220:223], v[180:183], v[220:223]
    s_waitcnt vmcnt(0)
    v_mfma_f32_16x16x32_bf16 v[224:227], a[52:55], a[252:255], v[224:227]
    v_mfma_f32_16x16x32_bf16 v[228:231], a[108:111], a[252:255], v[228:231]
    v_mfma_f32_16x16x32_bf16 v[232:235], a[164:167], a[252:255], v[232:235]
    v_mfma_f32_16x16x32_bf16 v[236:239], a[220:223], a[252:255], v[236:239]
    v_cvt_pk_bf16_f32 v240, v208, v209
    v_cvt_pk_bf16_f32 v241, v210, v211
    v_cvt_pk_bf16_f32 v242, v212, v213
    v_cvt_pk_bf16_f32 v243, v214, v215
    buffer_store_dwordx4 v[240:243], v1, s[12:15], s54 offen offset:0 sc1
    v_cvt_pk_bf16_f32 v244, v216, v217
    v_cvt_pk_bf16_f32 v245, v218, v219
    v_cvt_pk_bf16_f32 v246, v220, v221
    v_cvt_pk_bf16_f32 v247, v222, v223
    buffer_store_dwordx4 v[244:247], v1, s[12:15], s54 offen offset:1024 sc1
    s_add_u32 s55, s54, 14336
    v_cvt_pk_bf16_f32 v248, v224, v225
    v_cvt_pk_bf16_f32 v249, v226, v227
    v_cvt_pk_bf16_f32 v250, v228, v229
    v_cvt_pk_bf16_f32 v251, v230, v231
    buffer_store_dwordx4 v[248:251], v1, s[12:15], s55 offen offset:0 sc1
    v_cvt_pk_bf16_f32 v252, v232, v233
    v_cvt_pk_bf16_f32 v253, v234, v235
    v_cvt_pk_bf16_f32 v254, v236, v237
    v_cvt_pk_bf16_f32 v255, v238, v239
    buffer_store_dwordx4 v[252:255], v1, s[12:15], s55 offen offset:1024 sc1
    s_add_u32 s54, s54, 1835008
    s_waitcnt vmcnt(0)
    s_mov_b64 exec, 1
    buffer_atomic_add v5, v4, s[12:15], s56 offen sc1
    s_mov_b64 exec, -1
    s_min_u32 s99, s98, 63
    s_cmp_lt_u32 s99, s96
    s_cbranch_scc1 Lgo_main_kernel_184
    s_mov_b32 s70, 2097152
    v_lshlrev_b32 v6, 3, v1
    v_and_b32 v6, 0x780, v6
Lgl_main_kernel_185:
    s_min_u32 s96, s96, 48
    s_lshl_b32 s97, s96, 7
    s_add_u32 s97, s97, 97722368
    s_mov_b64 exec, 0xffff
    buffer_load_dword v7, v6, s[12:15], s97 offen sc1
    s_mov_b64 exec, -1
    s_sub_u32 s70, s70, 1
    s_cbranch_scc1 Lexit_main_kernel
    s_waitcnt vmcnt(0)
    v_cmp_ne_u32 vcc, 32, v7
    s_nop 0
    s_or_b32 s97, vcc_lo, 0x10000
    s_ff1_i32_b32 s97, s97
    s_add_u32 s96, s96, s97
    s_cmp_eq_u32 s97, 16
    s_cselect_b32 s97, 1, 0
    s_cmp_ge_u32 s96, 64
    s_cselect_b32 s96, 0x100, s96
    s_cbranch_scc1 Lgo_main_kernel_184
    s_cmp_lt_u32 s99, s96
    s_cbranch_scc1 Lgo_main_kernel_184
    s_cmp_eq_u32 s97, 1
    s_cbranch_scc1 Lgl_main_kernel_185
    s_cmp_lt_u32 s99, s96
    s_cbranch_scc1 Lgo_main_kernel_184
    s_add_u32 s97, s96, 1
    s_cmp_gt_u32 s99, s97
    s_cbranch_scc1 Lgf_main_kernel_186
    s_sleep 2
    s_branch Lgl_main_kernel_185
Lgf_main_kernel_186:
    s_sleep 2
    s_branch Lgl_main_kernel_185
Lgo_main_kernel_184:
    s_add_u32 s98, s98, 4
    s_add_u32 s53, s52, 0
    s_add_u32 s57, s52, 14336
    buffer_load_dwordx4 v[16:19], v1, s[12:15], s53 offen offset:0 sc1
    buffer_load_dwordx4 v[72:75], v1, s[12:15], s57 offen offset:0 sc1
    buffer_load_dwordx4 v[20:23], v1, s[12:15], s53 offen offset:1024 sc1
    buffer_load_dwordx4 v[76:79], v1, s[12:15], s57 offen offset:1024 sc1
    buffer_load_dwordx4 v[24:27], v1, s[12:15], s53 offen offset:2048 sc1
    buffer_load_dwordx4 v[80:83], v1, s[12:15], s57 offen offset:2048 sc1
    buffer_load_dwordx4 v[28:31], v1, s[12:15], s53 offen offset:3072 sc1
    buffer_load_dwordx4 v[84:87], v1, s[12:15], s57 offen offset:3072 sc1
    s_add_u32 s53, s52, 4096
    s_add_u32 s57, s52, 18432
    buffer_load_dwordx4 v[32:35], v1, s[12:15], s53 offen offset:0 sc1
    buffer_load_dwordx4 v[88:91], v1, s[12:15], s57 offen offset:0 sc1
    buffer_load_dwordx4 v[36:39], v1, s[12:15], s53 offen offset:1024 sc1
    buffer_load_dwordx4 v[92:95], v1, s[12:15], s57 offen offset:1024 sc1
    buffer_load_dwordx4 v[40:43], v1, s[12:15], s53 offen offset:2048 sc1
    buffer_load_dwordx4 v[96:99], v1, s[12:15], s57 offen offset:2048 sc1
    buffer_load_dwordx4 v[44:47], v1, s[12:15], s53 offen offset:3072 sc1
    buffer_load_dwordx4 v[100:103], v1, s[12:15], s57 offen offset:3072 sc1
    s_add_u32 s53, s52, 8192
    s_add_u32 s57, s52, 22528
    buffer_load_dwordx4 v[48:51], v1, s[12:15], s53 offen offset:0 sc1
    buffer_load_dwordx4 v[104:107], v1, s[12:15], s57 offen offset:0 sc1
    buffer_load_dwordx4 v[52:55], v1, s[12:15], s53 offen offset:1024 sc1
    buffer_load_dwordx4 v[108:111], v1, s[12:15], s57 offen offset:1024 sc1
    buffer_load_dwordx4 v[56:59], v1, s[12:15], s53 offen offset:2048 sc1
    buffer_load_dwordx4 v[112:115], v1, s[12:15], s57 offen offset:2048 sc1
    buffer_load_dwordx4 v[60:63], v1, s[12:15], s53 offen offset:3072 sc1
    buffer_load_dwordx4 v[116:119], v1, s[12:15], s57 offen offset:3072 sc1
    s_add_u32 s53, s52, 12288
    s_add_u32 s57, s52, 26624
    buffer_load_dwordx4 v[64:67], v1, s[12:15], s53 offen offset:0 sc1
    buffer_load_dwordx4 v[120:123], v1, s[12:15], s57 offen offset:0 sc1
    buffer_load_dwordx4 v[68:71], v1, s[12:15], s53 offen offset:1024 sc1
    buffer_load_dwordx4 v[124:127], v1, s[12:15], s57 offen offset:1024 sc1
    s_add_u32 s52, s52, 114688
    s_min_u32 s52, s52, 17403904
    s_add_u32 s56, s56, 512
    s_sub_u32 s51, s51, 1
    s_cmp_lg_u32 s51, 0
    s_cbranch_scc1 L_main_kernel_180
L_main_kernel_172:
    s_waitcnt vmcnt(0)
    s_cmp_lt_u32 s100, 112
    s_cbranch_scc1 Lq_main_kernel_190
    s_sub_u32 s46, s100, 112
    s_mul_i32 s47, s46, 5462
    s_lshr_b32 s47, s47, 16
    s_mul_i32 s48, s47, 12
    s_sub_u32 s48, s46, s48
    s_add_u32 s49, s47, 1
    s_min_u32 s49, s49, 9
    s_lshl_b32 s49, s49, 2
    s_sub_u32 s60, s46, s49
    s_cmp_ge_u32 s48, 4
    s_cbranch_scc1 L7_main_kernel_189
    s_cmp_ge_u32 s47, 9
    s_cbranch_scc1 L7_main_kernel_189
    s_lshl_b32 s93, s47, 2
    s_add_u32 s93, s93, s48
    s_getreg_b32 s94, hwreg(HW_REG_XCC_ID)
    s_and_b32 s94, s94, 15
    s_add_u32 s94, s94, 1
    s_lshr_b32 s49, s93, 2
    s_lshl_b32 s49, s49, 7
    s_add_u32 s49, s49, 97768960
    s_and_b32 s46, s93, 3
    s_lshl_b32 s46, s46, 2
    v_mov_b32 v2, s46
    v_mov_b32 v3, s94
    s_mov_b64 exec, 1
    buffer_store_dword v3, v2, s[12:15], s49 offen sc1
    s_mov_b64 exec, -1
    v_and_b32 v2, 3, v0
    v_lshlrev_b32 v2, 2, v2
    s_mov_b32 s47, 2097152
Lwc_main_kernel_193:
    buffer_load_dword v3, v2, s[12:15], s49 offen sc1
    s_sub_u32 s47, s47, 1
    s_cbranch_scc1 Lexit_main_kernel
    s_waitcnt vmcnt(0)
    v_cmp_gt_u32 vcc, 1, v3
    s_cbranch_vccz Lwo_main_kernel_194
    s_sleep 4
    s_branch Lwc_main_kernel_193
Lwo_main_kernel_194:
    v_cmp_ne_u32 vcc, s94, v3
    s_nop 0
    s_cmp_eq_u64 vcc, 0
    s_cselect_b32 s94, 1, 0
Lag_main_kernel_188:
    s_lshr_b32 s60, s93, 2
    s_and_b32 s71, s93, 3
    v_lshlrev_b32 v1, 4, v0
    v_and_b32 v2, 15, v0
    v_lshrrev_b32 v3, 4, v0
    v_lshlrev_b32 v4, 2, v3
    v_add_u32 v5, 0, v4
    v_cmp_le_u32 s[72:73], v5, v2
    v_add_u32 v5, 1, v4
    v_cmp_le_u32 s[74:75], v5, v2
    v_add_u32 v5, 2, v4
    v_cmp_le_u32 s[76:77], v5, v2
    v_add_u32 v5, 3, v4
    v_cmp_le_u32 s[78:79], v5, v2
    v_cmp_gt_u32 s[80:81], 2, v3
    v_bfe_u32 v5, v0, 1, 1
    v_lshlrev_b32 v5, 2, v5
    v_bfe_u32 v6, v0, 2, 1
    v_lshl_add_u32 v5, v6, 1, v5
    v_and_b32 v6, 1, v0
    v_add_u32 v5, v5, v6
    v_lshlrev_b32 v5, 4, v5
    v_lshl_add_u32 v5, v3, 7, v5
    s_lshl_b32 s46, s3, 11
    v_add_u32 v6, s46, v1
    s_lshl_b32 s46, s3, 8
    s_add_u32 s46, s46, 8192
    v_lshlrev_b32 v7, 4, v2
    v_lshl_add_u32 v7, v3, 3, v7
    v_add_u32 v7, s46, v7
    v_mov_b32 v8, 10240
    v_cndmask_b32 v7, v8, v7, s[80:81]
    s_lshl_b32 s61, s3, 2
    s_cmp_eq_u32 s3, 3
    s_cselect_b32 s61, 11, s61
    s_lshl_b32 s48, s60, 7
    s_add_u32 s49, s48, 97640448
    v_and_b32 v12, 7, v0
    v_lshlrev_b32 v12, 13, v12
    s_cmp_lg_u32 s3, 0
    s_cbranch_scc1 Lwo_main_kernel_196
    s_mov_b32 s47, 2097152
Lwc_main_kernel_195:
    buffer_load_dword v13, v12, s[12:15], s49 offen sc1
    s_sub_u32 s47, s47, 1
    s_cbranch_scc1 Lexit_main_kernel
    s_waitcnt vmcnt(0)
    v_cmp_ne_u32 vcc, 28, v13
    s_cbranch_vccz Lwo_main_kernel_196
    s_sleep 8
    s_branch Lwc_main_kernel_195
Lwo_main_kernel_196:
    s_barrier
    s_lshl_b32 s63, s60, 2
    s_add_u32 s63, s63, s71
    s_lshl_b32 s63, s63, 2
    s_add_u32 s46, s63, s3
    s_mul_i32 s52, s46, 28672
    v_lshlrev_b32 v12, 7, v0
    v_min_u32 v13, 4096-128, v12
    s_mul_i32 s46, s60, 28672
    s_add_u32 s46, s46, 15597568
    buffer_load_dwordx4 a[128:131], v1, s[12:15], s46 offen offset:0 sc1
    buffer_load_dwordx4 a[132:135], v1, s[12:15], s46 offen offset:1024 sc1
    buffer_load_dwordx4 a[136:139], v1, s[12:15], s46 offen offset:2048 sc1
    buffer_load_dwordx4 a[140:143], v1, s[12:15], s46 offen offset:3072 sc1
    s_add_u32 s47, s46, 4096
    buffer_load_dwordx4 a[144:147], v1, s[12:15], s47 offen offset:0 sc1
    buffer_load_dwordx4 a[148:151], v1, s[12:15], s47 offen offset:1024 sc1
    buffer_load_dwordx4 a[152:155], v1, s[12:15], s47 offen offset:2048 sc1
    buffer_load_dwordx4 a[156:159], v1, s[12:15], s47 offen offset:3072 sc1
    s_add_u32 s47, s47, 4096
    buffer_load_dwordx4 a[160:163], v1, s[12:15], s47 offen offset:0 sc1
    buffer_load_dwordx4 a[164:167], v1, s[12:15], s47 offen offset:1024 sc1
    buffer_load_dwordx4 a[168:171], v1, s[12:15], s47 offen offset:2048 sc1
    buffer_load_dwordx4 a[172:175], v1, s[12:15], s47 offen offset:3072 sc1
    s_add_u32 s47, s47, 4096
    buffer_load_dwordx4 a[176:179], v1, s[12:15], s47 offen offset:0 sc1
    buffer_load_dwordx4 a[180:183], v1, s[12:15], s47 offen offset:1024 sc1
    buffer_load_dwordx4 a[184:187], v1, s[12:15], s47 offen offset:2048 sc1
    buffer_load_dwordx4 a[188:191], v1, s[12:15], s47 offen offset:3072 sc1
    s_add_u32 s47, s47, 4096
    buffer_load_dwordx4 a[192:195], v1, s[12:15], s47 offen offset:0 sc1
    buffer_load_dwordx4 a[196:199], v1, s[12:15], s47 offen offset:1024 sc1
    buffer_load_dwordx4 a[200:203], v1, s[12:15], s47 offen offset:2048 sc1
    buffer_load_dwordx4 a[204:207], v1, s[12:15], s47 offen offset:3072 sc1
    s_add_u32 s47, s47, 4096
    buffer_load_dwordx4 a[208:211], v1, s[12:15], s47 offen offset:0 sc1
    buffer_load_dwordx4 a[212:215], v1, s[12:15], s47 offen offset:1024 sc1
    buffer_load_dwordx4 a[216:219], v1, s[12:15], s47 offen offset:2048 sc1
    buffer_load_dwordx4 a[220:223], v1, s[12:15], s47 offen offset:3072 sc1
    s_add_u32 s47, s47, 4096
    buffer_load_dwordx4 a[224:227], v1, s[12:15], s47 offen offset:0 sc1
    buffer_load_dwordx4 a[228:231], v1, s[12:15], s47 offen offset:1024 sc1
    buffer_load_dwordx4 a[232:235], v1, s[12:15], s47 offen offset:2048 sc1
    buffer_load_dwordx4 a[236:239], v1, s[12:15], s47 offen offset:3072 sc1
    s_add_u32 s46, s52, 21102592
    s_waitcnt vmcnt(28)
    buffer_load_dwordx4 v[64:67], v1, s[12:15], s46 offen offset:0 sc1
    buffer_load_dwordx4 v[68:71], v1, s[12:15], s46 offen offset:1024 sc1
    buffer_load_dwordx4 v[72:75], v1, s[12:15], s46 offen offset:2048 sc1
    buffer_load_dwordx4 v[76:79], v1, s[12:15], s46 offen offset:3072 sc1
    s_add_u32 s47, s46, 4096
    buffer_load_dwordx4 v[80:83], v1, s[12:15], s47 offen offset:0 sc1
    buffer_load_dwordx4 v[84:87], v1, s[12:15], s47 offen offset:1024 sc1
    buffer_load_dwordx4 v[88:91], v1, s[12:15], s47 offen offset:2048 sc1
    buffer_load_dwordx4 v[92:95], v1, s[12:15], s47 offen offset:3072 sc1
    s_add_u32 s47, s47, 4096
    buffer_load_dwordx4 v[96:99], v1, s[12:15], s47 offen offset:0 sc1
    buffer_load_dwordx4 v[100:103], v1, s[12:15], s47 offen offset:1024 sc1
    buffer_load_dwordx4 v[104:107], v1, s[12:15], s47 offen offset:2048 sc1
    buffer_load_dwordx4 v[108:111], v1, s[12:15], s47 offen offset:3072 sc1
    s_add_u32 s47, s47, 4096
    buffer_load_dwordx4 v[112:115], v1, s[12:15], s47 offen offset:0 sc1
    buffer_load_dwordx4 v[116:119], v1, s[12:15], s47 offen offset:1024 sc1
    buffer_load_dwordx4 v[120:123], v1, s[12:15], s47 offen offset:2048 sc1
    buffer_load_dwordx4 v[124:127], v1, s[12:15], s47 offen offset:3072 sc1
    s_add_u32 s47, s47, 4096
    buffer_load_dwordx4 v[128:131], v1, s[12:15], s47 offen offset:0 sc1
    buffer_load_dwordx4 v[132:135], v1, s[12:15], s47 offen offset:1024 sc1
    buffer_load_dwordx4 v[136:139], v1, s[12:15], s47 offen offset:2048 sc1
    buffer_load_dwordx4 v[140:143], v1, s[12:15], s47 offen offset:3072 sc1
    s_add_u32 s47, s47, 4096
    buffer_load_dwordx4 v[144:147], v1, s[12:15], s47 offen offset:0 sc1
    buffer_load_dwordx4 v[148:151], v1, s[12:15], s47 offen offset:1024 sc1
    buffer_load_dwordx4 v[152:155], v1, s[12:15], s47 offen offset:2048 sc1
    buffer_load_dwordx4 v[156:159], v1, s[12:15], s47 offen offset:3072 sc1
    s_add_u32 s47, s47, 4096
    buffer_load_dwordx4 v[160:163], v1, s[12:15], s47 offen offset:0 sc1
    buffer_load_dwordx4 v[164:167], v1, s[12:15], s47 offen offset:1024 sc1
    buffer_load_dwordx4 v[168:171], v1, s[12:15], s47 offen offset:2048 sc1
    buffer_load_dwordx4 v[172:175], v1, s[12:15], s47 offen offset:3072 sc1
    s_mul_i32 s64, s63, 28672
    s_lshl_b32 s46, s61, 11
    s_add_u32 s64, s64, s46
    s_add_u32 s64, s64, 50462720
    s_mul_i32 s65, s63, 7168
    s_add_u32 s65, s65, s46
    s_add_u32 s65, s65, 81403904
    v_and_b32 v11, 7, v0
    v_bfe_u32 v12, v0, 3, 1
    v_mul_u32_u24 v8, 896, v11
    v_lshl_add_u32 v8, v3, 4, v8
    v_lshl_add_u32 v8, v12, 6, v8
    v_lshlrev_b32 v13, 4, v11
    v_lshl_add_u32 v13, v3, 7, v13
    v_lshl_add_u32 v15, v12, 15, v13
    v_lshl_add_u32 v13, v12, 9, v13
    v_lshlrev_b32 v14, 4, v11
    v_lshl_add_u32 v14, v3, 8, v14
    v_lshl_add_u32 v14, v12, 10, v14
    s_lshl_b32 s46, s3, 2
    v_lshlrev_b32 v10, 4, v11
    v_add_u32 v9, s46, v10
    s_cmp_ge_u32 s3, 2
    s_cselect_b32 s46, 1, 2
    v_cmp_ne_u32 s[82:83], s46, v12
    s_lshl_b32 s62, s60, 2
    s_add_u32 s62, s62, s71
    s_mul_i32 s62, s62, 7168
    s_lshl_b32 s46, s61, 6
    s_add_u32 s62, s62, s46
    s_add_u32 s8, s44, 13705216
    s_addc_u32 s9, s45, 0
    s_cmp_eq_u32 s0, 0
    s_cselect_b32 s8, s16, s8
    s_cselect_b32 s9, s17, s9
    s_and_b32 s9, s9, 0xffff
    s_mov_b32 s10, 1835008
    s_mov_b32 s11, 0x20000
    s_waitcnt vmcnt(28)
    s_add_u32 s46, s64, 0
    buffer_load_dwordx4 a[0:3], v1, s[12:15], s46 offen offset:0 sc1
    buffer_load_dwordx4 a[4:7], v1, s[12:15], s46 offen offset:1024 sc1
    buffer_load_dwordx4 a[8:11], v1, s[12:15], s46 offen offset:2048 sc1
    buffer_load_dwordx4 a[12:15], v1, s[12:15], s46 offen offset:3072 sc1
    s_add_u32 s47, s46, 4096
    buffer_load_dwordx4 a[16:19], v1, s[12:15], s47 offen offset:0 sc1
    buffer_load_dwordx4 a[20:23], v1, s[12:15], s47 offen offset:1024 sc1
    buffer_load_dwordx4 a[24:27], v1, s[12:15], s47 offen offset:2048 sc1
    buffer_load_dwordx4 a[28:31], v1, s[12:15], s47 offen offset:3072 sc1
    s_add_u32 s46, s64, 28672
    buffer_load_dwordx4 a[32:35], v1, s[12:15], s46 offen offset:0 sc1
    buffer_load_dwordx4 a[36:39], v1, s[12:15], s46 offen offset:1024 sc1
    buffer_load_dwordx4 a[40:43], v1, s[12:15], s46 offen offset:2048 sc1
    buffer_load_dwordx4 a[44:47], v1, s[12:15], s46 offen offset:3072 sc1
    s_add_u32 s47, s46, 4096
    buffer_load_dwordx4 a[48:51], v1, s[12:15], s47 offen offset:0 sc1
    buffer_load_dwordx4 a[52:55], v1, s[12:15], s47 offen offset:1024 sc1
    buffer_load_dwordx4 a[56:59], v1, s[12:15], s47 offen offset:2048 sc1
    buffer_load_dwordx4 a[60:63], v1, s[12:15], s47 offen offset:3072 sc1
    s_add_u32 s46, s64, 57344
    buffer_load_dwordx4 a[64:67], v1, s[12:15], s46 offen offset:0 sc1
    buffer_load_dwordx4 a[68:71], v1, s[12:15], s46 offen offset:1024 sc1
    buffer_load_dwordx4 a[72:75], v1, s[12:15], s46 offen offset:2048 sc1
    buffer_load_dwordx4 a[76:79], v1, s[12:15], s46 offen offset:3072 sc1
    s_add_u32 s47, s46, 4096
    buffer_load_dwordx4 a[80:83], v1, s[12:15], s47 offen offset:0 sc1
    buffer_load_dwordx4 a[84:87], v1, s[12:15], s47 offen offset:1024 sc1
    buffer_load_dwordx4 a[88:91], v1, s[12:15], s47 offen offset:2048 sc1
    buffer_load_dwordx4 a[92:95], v1, s[12:15], s47 offen offset:3072 sc1
    s_add_u32 s46, s64, 86016
    buffer_load_dwordx4 a[96:99], v1, s[12:15], s46 offen offset:0 sc1
    buffer_load_dwordx4 a[100:103], v1, s[12:15], s46 offen offset:1024 sc1
    buffer_load_dwordx4 a[104:107], v1, s[12:15], s46 offen offset:2048 sc1
    buffer_load_dwordx4 a[108:111], v1, s[12:15], s46 offen offset:3072 sc1
    s_add_u32 s47, s46, 4096
    buffer_load_dwordx4 a[112:115], v1, s[12:15], s47 offen offset:0 sc1
    buffer_load_dwordx4 a[116:119], v1, s[12:15], s47 offen offset:1024 sc1
    buffer_load_dwordx4 a[120:123], v1, s[12:15], s47 offen offset:2048 sc1
    buffer_load_dwordx4 a[124:127], v1, s[12:15], s47 offen offset:3072 sc1
    s_lshr_b32 s46, s71, 1
    s_lshl_b32 s47, s60, 1
    s_add_u32 s46, s46, s47
    s_mul_i32 s46, s46, 14
    s_add_u32 s46, s46, s61
    s_lshl_b32 s46, s46, 10
    s_and_b32 s47, s71, 1
    s_lshl_b32 s47, s47, 7
    s_add_u32 s68, s46, s47
    s_cmp_eq_u32 s0, 0
    s_cselect_b32 s62, s62, s68
    s_movk_i32 s46, 2048
    s_cselect_b32 s46, 128, s46
    s_cselect_b64 vcc, -1, 0
    s_add_u32 s46, s46, s62
    v_cndmask_b32 v8, v14, v8, vcc
    buffer_load_dwordx4 v[176:179], v8, s[8:11], s62 offen sc1
    buffer_load_dwordx4 v[180:183], v8, s[8:11], s46 offen sc1
    s_waitcnt vmcnt(34)
    v_mfma_f32_16x16x32_bf16 v[16:19], a[128:131], v[64:67], 0
    v_mfma_f32_16x16x32_bf16 v[24:27], a[128:131], v[120:123], 0
    v_mfma_f32_16x16x32_bf16 v[28:31], a[184:187], v[120:123], 0
    v_mfma_f32_16x16x32_bf16 v[16:19], a[132:135], v[68:71], v[16:19]
    v_mfma_f32_16x16x32_bf16 v[24:27], a[132:135], v[124:127], v[24:27]
    v_mfma_f32_16x16x32_bf16 v[28:31], a[188:191], v[124:127], v[28:31]
    v_mfma_f32_16x16x32_bf16 v[16:19], a[136:139], v[72:75], v[16:19]
    v_mfma_f32_16x16x32_bf16 v[24:27], a[136:139], v[128:131], v[24:27]
    v_mfma_f32_16x16x32_bf16 v[28:31], a[192:195], v[128:131], v[28:31]
    v_mfma_f32_16x16x32_bf16 v[16:19], a[140:143], v[76:79], v[16:19]
    v_mfma_f32_16x16x32_bf16 v[24:27], a[140:143], v[132:135], v[24:27]
    v_mfma_f32_16x16x32_bf16 v[28:31], a[196:199], v[132:135], v[28:31]
    v_mfma_f32_16x16x32_bf16 v[16:19], a[144:147], v[80:83], v[16:19]
    v_mfma_f32_16x16x32_bf16 v[24:27], a[144:147], v[136:139], v[24:27]
    v_mfma_f32_16x16x32_bf16 v[28:31], a[200:203], v[136:139], v[28:31]
    v_mfma_f32_16x16x32_bf16 v[16:19], a[148:151], v[84:87], v[16:19]
    v_mfma_f32_16x16x32_bf16 v[24:27], a[148:151], v[140:143], v[24:27]
    v_mfma_f32_16x16x32_bf16 v[28:31], a[204:207], v[140:143], v[28:31]
    v_mfma_f32_16x16x32_bf16 v[16:19], a[152:155], v[88:91], v[16:19]
    v_mfma_f32_16x16x32_bf16 v[24:27], a[152:155], v[144:147], v[24:27]
    v_mfma_f32_16x16x32_bf16 v[28:31], a[208:211], v[144:147], v[28:31]
    v_mfma_f32_16x16x32_bf16 v[16:19], a[156:159], v[92:95], v[16:19]
    v_mfma_f32_16x16x32_bf16 v[24:27], a[156:159], v[148:151], v[24:27]
    v_mfma_f32_16x16x32_bf16 v[28:31], a[212:215], v[148:151], v[28:31]
    v_mfma_f32_16x16x32_bf16 v[16:19], a[160:163], v[96:99], v[16:19]
    v_mfma_f32_16x16x32_bf16 v[24:27], a[160:163], v[152:155], v[24:27]
    v_mfma_f32_16x16x32_bf16 v[28:31], a[216:219], v[152:155], v[28:31]
    v_mfma_f32_16x16x32_bf16 v[16:19], a[164:167], v[100:103], v[16:19]
    v_mfma_f32_16x16x32_bf16 v[24:27], a[164:167], v[156:159], v[24:27]
    v_mfma_f32_16x16x32_bf16 v[28:31], a[220:223], v[156:159], v[28:31]
    v_mfma_f32_16x16x32_bf16 v[16:19], a[168:171], v[104:107], v[16:19]
    v_mfma_f32_16x16x32_bf16 v[24:27], a[168:171], v[160:163], v[24:27]
    v_mfma_f32_16x16x32_bf16 v[28:31], a[224:227], v[160:163], v[28:31]
    v_mfma_f32_16x16x32_bf16 v[16:19], a[172:175], v[108:111], v[16:19]
    v_mfma_f32_16x16x32_bf16 v[24:27], a[172:175], v[164:167], v[24:27]
    v_mfma_f32_16x16x32_bf16 v[28:31], a[228:231], v[164:167], v[28:31]
    v_mfma_f32_16x16x32_bf16 v[16:19], a[176:179], v[112:115], v[16:19]
    v_mfma_f32_16x16x32_bf16 v[24:27], a[176:179], v[168:171], v[24:27]
    v_mfma_f32_16x16x32_bf16 v[28:31], a[232:235], v[168:171], v[28:31]
    v_mfma_f32_16x16x32_bf16 v[16:19], a[180:183], v[116:119], v[16:19]
    v_mfma_f32_16x16x32_bf16 v[24:27], a[180:183], v[172:175], v[24:27]
    v_mfma_f32_16x16x32_bf16 v[28:31], a[236:239], v[172:175], v[28:31]
    v_mov_b32 v11, 0xceabfb8f
    s_nop 0
    v_cndmask_b32 v16, v11, v16, s[72:73]
    s_nop 4
    v_cndmask_b32 v28, v11, v28, s[72:73]
    v_cndmask_b32 v17, v11, v17, s[74:75]
    v_cndmask_b32 v29, v11, v29, s[74:75]
    v_cndmask_b32 v18, v11, v18, s[76:77]
    v_cndmask_b32 v30, v11, v30, s[76:77]
    v_cndmask_b32 v19, v11, v19, s[78:79]
    v_cndmask_b32 v31, v11, v31, s[78:79]
    v_max3_f32 v52, v16, v17, v18
    v_max_f32 v52, v52, v19
    v_max3_f32 v53, v24, v25, v26
    v_max3_f32 v53, v53, v27, v28
    v_max3_f32 v53, v53, v29, v30
    v_max_f32 v53, v53, v31
    s_cmp_lt_u32 s60, 62
    s_cbranch_scc1 L_main_kernel_197
    s_lshl_b32 s46, s60, 17
    s_lshl_b32 s47, s71, 15
    s_add_u32 s46, s46, s47
    s_lshl_b32 s47, s3, 13
    s_add_u32 s46, s46, s47
    s_add_u32 s46, s46, 89014272
    v_lshlrev_b32 v54, 7, v0
    buffer_load_dword v55, v54, s[12:15], s46 offen sc1
L_main_kernel_197:
    s_mov_b32 s49, 97768448
    s_add_u32 s50, s60, 2
    s_sub_u32 s51, s60, 1
    s_cmp_ge_u32 s60, 54
    s_cselect_b32 s50, s51, s50
    v_mov_b32 v54, 0
    s_waitcnt vmcnt(0)
    s_sub_u32 s51, s50, 2
    s_cmp_lg_u32 s3, 0
    s_cbranch_scc1 Lwo_main_kernel_199
    s_mov_b32 s47, 2097152
    s_mov_b32 s46, 97768448
Lwf_main_kernel_200:
    v_mov_b32 v55, 0
    buffer_load_dword v55, v55, s[12:15], s46 offen sc1
    s_sub_u32 s47, s47, 1
    s_cbranch_scc1 Lexit_main_kernel
    s_waitcnt vmcnt(0)
    v_cmp_gt_i32 vcc, s51, v55
    s_cbranch_vccz Lwn_main_kernel_201
    s_sleep 48
    s_branch Lwf_main_kernel_200
Lwn_main_kernel_201:
Lwc_main_kernel_198:
    buffer_load_dword v55, v54, s[12:15], s49 offen sc1
    s_sub_u32 s47, s47, 1
    s_cbranch_scc1 Lexit_main_kernel
    s_waitcnt vmcnt(0)
    v_cmp_gt_u32 vcc, s50, v55
    s_cbranch_vccz Lwo_main_kernel_199
    s_sleep 1
    s_branch Lwc_main_kernel_198
Lwo_main_kernel_199:
    s_barrier
    s_mul_i32 s52, s60, 7168
    s_add_u32 s52, s52, 80945152
    s_add_u32 s53, s52, 4096
    s_mov_b32 s70, 2097152
Lmk_main_kernel_202:
    buffer_load_dwordx4 v[192:195], v5, s[12:15], s52 offen offset:0 sc1
    buffer_load_dwordx4 v[196:199], v5, s[12:15], s52 offen offset:512 sc1
    buffer_load_dwordx4 v[200:203], v5, s[12:15], s52 offen offset:1024 sc1
    buffer_load_dwordx4 v[204:207], v5, s[12:15], s52 offen offset:1536 sc1
    buffer_load_dwordx4 v[208:211], v5, s[12:15], s52 offen offset:2048 sc1
    buffer_load_dwordx4 v[212:215], v5, s[12:15], s52 offen offset:2560 sc1
    buffer_load_dwordx4 v[216:219], v5, s[12:15], s52 offen offset:3072 sc1
    buffer_load_dwordx4 v[220:223], v5, s[12:15], s52 offen offset:3584 sc1
    buffer_load_dwordx4 v[224:227], v5, s[12:15], s53 offen offset:0 sc1
    buffer_load_dwordx4 v[228:231], v5, s[12:15], s53 offen offset:512 sc1
    buffer_load_dwordx4 v[232:235], v5, s[12:15], s53 offen offset:1024 sc1
    buffer_load_dwordx4 v[236:239], v5, s[12:15], s53 offen offset:1536 sc1
    buffer_load_dwordx4 v[240:243], v5, s[12:15], s53 offen offset:2048 sc1
    buffer_load_dwordx4 v[244:247], v5, s[12:15], s53 offen offset:2560 sc1
    s_sub_u32 s70, s70, 1
    s_cbranch_scc1 Lexit_main_kernel
    s_waitcnt vmcnt(13)
    v_mfma_f32_16x16x32_bf16 v[20:23], v[192:195], v[64:67], 0
    v_max3_u32 v54, v192, v193, v192
    v_mfma_f32_16x16x32_bf16 v[32:35], v[192:195], v[120:123], 0
    v_max3_u32 v54, v194, v195, v54
    s_waitcnt vmcnt(12)
    v_mfma_f32_16x16x32_bf16 v[20:23], v[196:199], v[68:71], v[20:23]
    v_max3_u32 v54, v196, v197, v54
    v_mfma_f32_16x16x32_bf16 v[32:35], v[196:199], v[124:127], v[32:35]
    v_max3_u32 v54, v198, v199, v54
    s_waitcnt vmcnt(11)
    v_mfma_f32_16x16x32_bf16 v[20:23], v[200:203], v[72:75], v[20:23]
    v_max3_u32 v54, v200, v201, v54
    v_mfma_f32_16x16x32_bf16 v[32:35], v[200:203], v[128:131], v[32:35]
    v_max3_u32 v54, v202, v203, v54
    s_waitcnt vmcnt(10)
    v_mfma_f32_16x16x32_bf16 v[20:23], v[204:207], v[76:79], v[20:23]
    v_max3_u32 v54, v204, v205, v54
    v_mfma_f32_16x16x32_bf16 v[32:35], v[204:207], v[132:135], v[32:35]
    v_max3_u32 v54, v206, v207, v54
    s_waitcnt vmcnt(9)
    v_mfma_f32_16x16x32_bf16 v[20:23], v[208:211], v[80:83], v[20:23]
    v_max3_u32 v54, v208, v209, v54
    v_mfma_f32_16x16x32_bf16 v[32:35], v[208:211], v[136:139], v[32:35]
    v_max3_u32 v54, v210, v211, v54
    s_waitcnt vmcnt(8)
    v_mfma_f32_16x16x32_bf16 v[20:23], v[212:215], v[84:87], v[20:23]
    v_max3_u32 v54, v212, v213, v54
    v_mfma_f32_16x16x32_bf16 v[32:35], v[212:215], v[140:143], v[32:35]
    v_max3_u32 v54, v214, v215, v54
    s_waitcnt vmcnt(7)
    v_mfma_f32_16x16x32_bf16 v[20:23], v[216:219], v[88:91], v[20:23]
    v_max3_u32 v54, v216, v217, v54
    v_mfma_f32_16x16x32_bf16 v[32:35], v[216:219], v[144:147], v[32:35]
    v_max3_u32 v54, v218, v219, v54
    s_waitcnt vmcnt(6)
    v_mfma_f32_16x16x32_bf16 v[20:23], v[220:223], v[92:95], v[20:23]
    v_max3_u32 v54, v220, v221, v54
    v_mfma_f32_16x16x32_bf16 v[32:35], v[220:223], v[148:151], v[32:35]
    v_max3_u32 v54, v222, v223, v54
    s_waitcnt vmcnt(5)
    v_mfma_f32_16x16x32_bf16 v[20:23], v[224:227], v[96:99], v[20:23]
    v_max3_u32 v54, v224, v225, v54
    v_mfma_f32_16x16x32_bf16 v[32:35], v[224:227], v[152:155], v[32:35]
    v_max3_u32 v54, v226, v227, v54
    s_waitcnt vmcnt(4)
    v_mfma_f32_16x16x32_bf16 v[20:23], v[228:231], v[100:103], v[20:23]
    v_max3_u32 v54, v228, v229, v54
    v_mfma_f32_16x16x32_bf16 v[32:35], v[228:231], v[156:159], v[32:35]
    v_max3_u32 v54, v230, v231, v54
    s_waitcnt vmcnt(3)
    v_mfma_f32_16x16x32_bf16 v[20:23], v[232:235], v[104:107], v[20:23]
    v_max3_u32 v54, v232, v233, v54
    v_mfma_f32_16x16x32_bf16 v[32:35], v[232:235], v[160:163], v[32:35]
    v_max3_u32 v54, v234, v235, v54
    s_waitcnt vmcnt(2)
    v_mfma_f32_16x16x32_bf16 v[20:23], v[236:239], v[108:111], v[20:23]
    v_max3_u32 v54, v236, v237, v54
    v_mfma_f32_16x16x32_bf16 v[32:35], v[236:239], v[164:167], v[32:35]
    v_max3_u32 v54, v238, v239, v54
    s_waitcnt vmcnt(1)
    v_mfma_f32_16x16x32_bf16 v[20:23], v[240:243], v[112:115], v[20:23]
    v_max3_u32 v54, v240, v241, v54
    v_mfma_f32_16x16x32_bf16 v[32:35], v[240:243], v[168:171], v[32:35]
    v_max3_u32 v54, v242, v243, v54
    s_waitcnt vmcnt(0)
    v_mfma_f32_16x16x32_bf16 v[20:23], v[244:247], v[116:119], v[20:23]
    v_max3_u32 v54, v244, v245, v54
    v_mfma_f32_16x16x32_bf16 v[32:35], v[244:247], v[172:175], v[32:35]
    v_max3_u32 v54, v246, v247, v54
    v_cmp_eq_u32 vcc, -1, v54
    s_cbranch_vccnz Lmk_main_kernel_202
    buffer_load_dwordx4 v[120:123], v1, s[12:15], s65 offen offset:0 sc1
    buffer_load_dwordx4 v[124:127], v1, s[12:15], s65 offen offset:1024 sc1
    buffer_load_dwordx4 v[128:131], v1, s[12:15], s65 offen offset:2048 sc1
    buffer_load_dwordx4 v[132:135], v1, s[12:15], s65 offen offset:3072 sc1
    s_add_u32 s47, s65, 4096
    buffer_load_dwordx4 v[136:139], v1, s[12:15], s47 offen offset:0 sc1
    buffer_load_dwordx4 v[140:143], v1, s[12:15], s47 offen offset:1024 sc1
    buffer_load_dwordx4 v[144:147], v1, s[12:15], s47 offen offset:2048 sc1
    buffer_load_dwordx4 v[148:151], v1, s[12:15], s47 offen offset:3072 sc1
    v_mov_b64 v[192:193], 0
    v_mov_b64 v[194:195], 0
    v_mov_b64 v[196:197], 0
    v_mov_b64 v[198:199], 0
    v_mov_b64 v[200:201], 0
    v_mov_b64 v[202:203], 0
    v_mov_b64 v[204:205], 0
    v_mov_b64 v[206:207], 0
    v_mov_b64 v[208:209], 0
    v_mov_b64 v[210:211], 0
    v_mov_b64 v[212:213], 0
    v_mov_b64 v[214:215], 0
    v_mov_b64 v[216:217], 0
    v_mov_b64 v[218:219], 0
    v_mov_b64 v[220:221], 0
    v_mov_b64 v[222:223], 0
    v_mov_b64 v[224:225], 0
    v_mov_b64 v[226:227], 0
    v_mov_b64 v[228:229], 0
    v_mov_b64 v[230:231], 0
    v_mov_b64 v[232:233], 0
    v_mov_b64 v[234:235], 0
    v_mov_b64 v[236:237], 0
    v_mov_b64 v[238:239], 0
    v_mov_b64 v[240:241], 0
    v_mov_b64 v[242:243], 0
    v_mov_b64 v[244:245], 0
    v_mov_b64 v[246:247], 0
    v_mov_b64 v[248:249], 0
    v_mov_b64 v[250:251], 0
    v_mov_b64 v[252:253], 0
    v_mov_b64 v[254:255], 0
    s_mul_i32 s46, s3, 14336
    s_add_u32 s46, s46, 13647872
    buffer_load_dwordx4 v[64:67], v1, s[4:7], s46 offen offset:0 sc1
    buffer_load_dwordx4 v[68:71], v1, s[4:7], s46 offen offset:1024 sc1
    buffer_load_dwordx4 v[72:75], v1, s[4:7], s46 offen offset:2048 sc1
    buffer_load_dwordx4 v[76:79], v1, s[4:7], s46 offen offset:3072 sc1
    s_add_u32 s47, s46, 4096
    buffer_load_dwordx4 v[80:83], v1, s[4:7], s47 offen offset:0 sc1
    buffer_load_dwordx4 v[84:87], v1, s[4:7], s47 offen offset:1024 sc1
    buffer_load_dwordx4 v[88:91], v1, s[4:7], s47 offen offset:2048 sc1
    buffer_load_dwordx4 v[92:95], v1, s[4:7], s47 offen offset:3072 sc1
    s_add_u32 s47, s47, 4096
    buffer_load_dwordx4 v[96:99], v1, s[4:7], s47 offen offset:0 sc1
    buffer_load_dwordx4 v[100:103], v1, s[4:7], s47 offen offset:1024 sc1
    buffer_load_dwordx4 v[104:107], v1, s[4:7], s47 offen offset:2048 sc1
    buffer_load_dwordx4 v[108:111], v1, s[4:7], s47 offen offset:3072 sc1
    s_add_u32 s47, s47, 4096
    buffer_load_dwordx4 v[112:115], v1, s[4:7], s47 offen offset:0 sc1
    buffer_load_dwordx4 v[116:119], v1, s[4:7], s47 offen offset:1024 sc1
    v_mov_b32 v11, 0xceabfb8f
    v_mov_b32 v12, 0xff61b1e6
    v_cndmask_b32 v20, v12, v20, s[80:81]
    v_cndmask_b32 v32, v12, v32, s[80:81]
    v_cndmask_b32 v21, v12, v21, s[80:81]
    v_cndmask_b32 v33, v12, v33, s[80:81]
    v_cndmask_b32 v22, v12, v22, s[80:81]
    v_cndmask_b32 v34, v12, v34, s[80:81]
    v_cndmask_b32 v23, v12, v23, s[80:81]
    v_cndmask_b32 v35, v12, v35, s[80:81]
    v_max3_f32 v36, v52, v20, v21
    v_max3_f32 v36, v36, v22, v23
    v_max3_f32 v37, v53, v32, v33
    v_max3_f32 v37, v37, v34, v35
    v_mov_b32 v38, v36
    v_mov_b32 v39, v37
    s_nop 0
    v_permlane16_swap_b32 v36, v38
    v_permlane16_swap_b32 v37, v39
    v_max_f32 v36, v36, v38
    v_max_f32 v37, v37, v39
    v_mov_b32 v38, v36
    v_mov_b32 v39, v37
    s_nop 0
    v_permlane32_swap_b32 v36, v38
    v_permlane32_swap_b32 v37, v39
    v_max_f32 v36, v36, v38
    v_max_f32 v37, v37, v39
    v_sub_f32 v16, v16, v36
    v_sub_f32 v17, v17, v36
    v_sub_f32 v18, v18, v36
    v_sub_f32 v19, v19, v36
    v_sub_f32 v20, v20, v36
    v_sub_f32 v21, v21, v36
    v_sub_f32 v22, v22, v36
    v_sub_f32 v23, v23, v36
    v_exp_f32 v16, v16
    v_exp_f32 v17, v17
    v_exp_f32 v18, v18
    v_exp_f32 v19, v19
    v_exp_f32 v20, v20
    v_exp_f32 v21, v21
    v_exp_f32 v22, v22
    v_exp_f32 v23, v23
    v_sub_f32 v24, v24, v37
    v_sub_f32 v25, v25, v37
    v_sub_f32 v26, v26, v37
    v_sub_f32 v27, v27, v37
    v_sub_f32 v28, v28, v37
    v_sub_f32 v29, v29, v37
    v_sub_f32 v30, v30, v37
    v_sub_f32 v31, v31, v37
    v_sub_f32 v32, v32, v37
    v_sub_f32 v33, v33, v37
    v_sub_f32 v34, v34, v37
    v_sub_f32 v35, v35, v37
    v_exp_f32 v24, v24
    v_exp_f32 v25, v25
    v_exp_f32 v26, v26
    v_exp_f32 v27, v27
    v_exp_f32 v28, v28
    v_exp_f32 v29, v29
    v_exp_f32 v30, v30
    v_exp_f32 v31, v31
    v_exp_f32 v32, v32
    v_exp_f32 v33, v33
    v_exp_f32 v34, v34
    v_exp_f32 v35, v35
    v_add_f32 v36, v16, v17
    v_add_f32 v38, v18, v19
    v_add_f32 v36, v36, v20
    v_add_f32 v38, v38, v21
    v_add_f32 v36, v36, v22
    v_add_f32 v38, v38, v23
    v_add_f32 v36, v36, v38
    v_add_f32 v37, v24, v25
    v_add_f32 v39, v26, v27
    v_add_f32 v37, v37, v28
    v_add_f32 v39, v39, v29
    v_add_f32 v37, v37, v30
    v_add_f32 v39, v39, v31
    v_add_f32 v37, v37, v32
    v_add_f32 v39, v39, v33
    v_add_f32 v37, v37, v34
    v_add_f32 v39, v39, v35
    v_add_f32 v37, v37, v39
    v_mov_b32 v38, v36
    v_mov_b32 v39, v37
    s_nop 0
    v_permlane16_swap_b32 v36, v38
    v_permlane16_swap_b32 v37, v39
    v_add_f32 v36, v36, v38
    v_add_f32 v37, v37, v39
    v_mov_b32 v38, v36
    v_mov_b32 v39, v37
    s_nop 0
    v_permlane32_swap_b32 v36, v38
    v_permlane32_swap_b32 v37, v39
    v_add_f32 v36, v36, v38
    v_add_f32 v37, v37, v39
    v_rcp_f32 v36, v36
    v_rcp_f32 v37, v37
    v_mul_f32 v16, v16, v36
    v_mul_f32 v17, v17, v36
    v_mul_f32 v18, v18, v36
    v_mul_f32 v19, v19, v36
    v_mul_f32 v20, v20, v36
    v_mul_f32 v21, v21, v36
    v_mul_f32 v22, v22, v36
    v_mul_f32 v23, v23, v36
    v_mul_f32 v24, v24, v37
    v_mul_f32 v25, v25, v37
    v_mul_f32 v26, v26, v37
    v_mul_f32 v27, v27, v37
    v_mul_f32 v28, v28, v37
    v_mul_f32 v29, v29, v37
    v_mul_f32 v30, v30, v37
    v_mul_f32 v31, v31, v37
    v_mul_f32 v32, v32, v37
    v_mul_f32 v33, v33, v37
    v_mul_f32 v34, v34, v37
    v_mul_f32 v35, v35, v37
    v_cvt_pk_bf16_f32 v40, v16, v17
    v_cvt_pk_bf16_f32 v41, v18, v19
    v_mov_b64 v[42:43], 0
    v_cvt_pk_bf16_f32 v44, v24, v25
    v_cvt_pk_bf16_f32 v45, v26, v27
    v_cvt_pk_bf16_f32 v46, v28, v29
    v_cvt_pk_bf16_f32 v47, v30, v31
    v_cvt_pk_bf16_f32 v48, v20, v21
    v_cvt_pk_bf16_f32 v49, v22, v23
    v_cvt_pk_bf16_f32 v50, v32, v33
    v_cvt_pk_bf16_f32 v51, v34, v35
    ds_write_b128 v6, v[40:43]
    ds_write_b128 v6, v[44:47] offset:1024
    ds_write_b64 v7, v[48:49]
    ds_write_b64 v7, v[50:51] offset:1024
    s_waitcnt lgkmcnt(0)
    s_barrier
    ds_read_b128 v[16:19], v1 offset:0
    ds_read_b128 v[20:23], v1 offset:1024
    ds_read_b128 v[24:27], v1 offset:2048
    ds_read_b128 v[28:31], v1 offset:3072
    ds_read_b128 v[32:35], v1 offset:4096
    ds_read_b128 v[36:39], v1 offset:5120
    ds_read_b128 v[40:43], v1 offset:6144
    ds_read_b128 v[44:47], v1 offset:7168
    ds_read_b128 v[48:51], v1 offset:8192
    ds_read_b128 v[52:55], v1 offset:9216
    s_lshl_b32 s66, s60, 17
    s_lshl_b32 s46, s71, 13
    s_add_u32 s66, s66, s46
    s_lshl_b32 s46, s61, 9
    s_add_u32 s66, s66, s46
    s_add_u32 s66, s66, 89014272
    s_add_u32 s67, s66, 65536
    s_waitcnt lgkmcnt(0)
    v_mfma_f32_16x16x32_bf16 v[192:195], a[0:3], v[16:19], v[192:195]
    v_mfma_f32_16x16x32_bf16 v[196:199], a[0:3], v[20:23], v[196:199]
    v_mfma_f32_16x16x32_bf16 v[200:203], a[4:7], v[16:19], v[200:203]
    v_mfma_f32_16x16x32_bf16 v[204:207], a[4:7], v[20:23], v[204:207]
    v_mfma_f32_16x16x32_bf16 v[192:195], a[32:35], v[24:27], v[192:195]
    v_mfma_f32_16x16x32_bf16 v[196:199], a[32:35], v[28:31], v[196:199]
    v_mfma_f32_16x16x32_bf16 v[200:203], a[36:39], v[24:27], v[200:203]
    v_mfma_f32_16x16x32_bf16 v[204:207], a[36:39], v[28:31], v[204:207]
    v_mfma_f32_16x16x32_bf16 v[192:195], a[64:67], v[32:35], v[192:195]
    v_mfma_f32_16x16x32_bf16 v[196:199], a[64:67], v[36:39], v[196:199]
    v_mfma_f32_16x16x32_bf16 v[200:203], a[68:71], v[32:35], v[200:203]
    v_mfma_f32_16x16x32_bf16 v[204:207], a[68:71], v[36:39], v[204:207]
    v_mfma_f32_16x16x32_bf16 v[192:195], a[96:99], v[40:43], v[192:195]
    v_mfma_f32_16x16x32_bf16 v[196:199], a[96:99], v[44:47], v[196:199]
    v_mfma_f32_16x16x32_bf16 v[200:203], a[100:103], v[40:43], v[200:203]
    v_mfma_f32_16x16x32_bf16 v[204:207], a[100:103], v[44:47], v[204:207]
    v_mfma_f32_16x16x32_bf16 v[208:211], a[8:11], v[16:19], v[208:211]
    v_mfma_f32_16x16x32_bf16 v[212:215], a[8:11], v[20:23], v[212:215]
    v_mfma_f32_16x16x32_bf16 v[216:219], a[12:15], v[16:19], v[216:219]
    v_mfma_f32_16x16x32_bf16 v[220:223], a[12:15], v[20:23], v[220:223]
    v_mfma_f32_16x16x32_bf16 v[208:211], a[40:43], v[24:27], v[208:211]
    v_mfma_f32_16x16x32_bf16 v[212:215], a[40:43], v[28:31], v[212:215]
    v_mfma_f32_16x16x32_bf16 v[216:219], a[44:47], v[24:27], v[216:219]
    v_mfma_f32_16x16x32_bf16 v[220:223], a[44:47], v[28:31], v[220:223]
    v_mfma_f32_16x16x32_bf16 v[208:211], a[72:75], v[32:35], v[208:211]
    v_mfma_f32_16x16x32_bf16 v[212:215], a[72:75], v[36:39], v[212:215]
    v_mfma_f32_16x16x32_bf16 v[216:219], a[76:79], v[32:35], v[216:219]
    v_mfma_f32_16x16x32_bf16 v[220:223], a[76:79], v[36:39], v[220:223]
    v_mfma_f32_16x16x32_bf16 v[208:211], a[104:107], v[40:43], v[208:211]
    v_mfma_f32_16x16x32_bf16 v[212:215], a[104:107], v[44:47], v[212:215]
    v_mfma_f32_16x16x32_bf16 v[216:219], a[108:111], v[40:43], v[216:219]
    v_mfma_f32_16x16x32_bf16 v[220:223], a[108:111], v[44:47], v[220:223]
    v_mfma_f32_16x16x32_bf16 v[224:227], a[16:19], v[16:19], v[224:227]
    v_mfma_f32_16x16x32_bf16 v[228:231], a[16:19], v[20:23], v[228:231]
    v_mfma_f32_16x16x32_bf16 v[232:235], a[20:23], v[16:19], v[232:235]
    v_mfma_f32_16x16x32_bf16 v[236:239], a[20:23], v[20:23], v[236:239]
    v_mfma_f32_16x16x32_bf16 v[224:227], a[48:51], v[24:27], v[224:227]
    v_mfma_f32_16x16x32_bf16 v[228:231], a[48:51], v[28:31], v[228:231]
    v_mfma_f32_16x16x32_bf16 v[232:235], a[52:55], v[24:27], v[232:235]
    v_mfma_f32_16x16x32_bf16 v[236:239], a[52:55], v[28:31], v[236:239]
    v_mfma_f32_16x16x32_bf16 v[224:227], a[80:83], v[32:35], v[224:227]
    v_mfma_f32_16x16x32_bf16 v[228:231], a[80:83], v[36:39], v[228:231]
    v_mfma_f32_16x16x32_bf16 v[232:235], a[84:87], v[32:35], v[232:235]
    v_mfma_f32_16x16x32_bf16 v[236:239], a[84:87], v[36:39], v[236:239]
    v_mfma_f32_16x16x32_bf16 v[224:227], a[112:115], v[40:43], v[224:227]
    v_mfma_f32_16x16x32_bf16 v[228:231], a[112:115], v[44:47], v[228:231]
    v_mfma_f32_16x16x32_bf16 v[232:235], a[116:119], v[40:43], v[232:235]
    v_mfma_f32_16x16x32_bf16 v[236:239], a[116:119], v[44:47], v[236:239]
    s_cmp_ge_u32 s3, 2
    s_cbranch_scc1 L_main_kernel_203
    v_mfma_f32_16x16x32_bf16 v[240:243], a[24:27], v[16:19], v[240:243]
    v_mfma_f32_16x16x32_bf16 v[244:247], a[24:27], v[20:23], v[244:247]
    v_mfma_f32_16x16x32_bf16 v[248:251], a[28:31], v[16:19], v[248:251]
    v_mfma_f32_16x16x32_bf16 v[252:255], a[28:31], v[20:23], v[252:255]
    v_mfma_f32_16x16x32_bf16 v[240:243], a[56:59], v[24:27], v[240:243]
    v_mfma_f32_16x16x32_bf16 v[244:247], a[56:59], v[28:31], v[244:247]
    v_mfma_f32_16x16x32_bf16 v[248:251], a[60:63], v[24:27], v[248:251]
    v_mfma_f32_16x16x32_bf16 v[252:255], a[60:63], v[28:31], v[252:255]
    v_mfma_f32_16x16x32_bf16 v[240:243], a[88:91], v[32:35], v[240:243]
    v_mfma_f32_16x16x32_bf16 v[244:247], a[88:91], v[36:39], v[244:247]
    v_mfma_f32_16x16x32_bf16 v[248:251], a[92:95], v[32:35], v[248:251]
    v_mfma_f32_16x16x32_bf16 v[252:255], a[92:95], v[36:39], v[252:255]
    v_mfma_f32_16x16x32_bf16 v[240:243], a[120:123], v[40:43], v[240:243]
    v_mfma_f32_16x16x32_bf16 v[244:247], a[120:123], v[44:47], v[244:247]
    v_mfma_f32_16x16x32_bf16 v[248:251], a[124:127], v[40:43], v[248:251]
    v_mfma_f32_16x16x32_bf16 v[252:255], a[124:127], v[44:47], v[252:255]
L_main_kernel_203:
Lvm_main_kernel_204:
    s_waitcnt vmcnt(0)
    v_max3_u32 v56, v120, v121, v122
    v_max3_u32 v56, v56, v123, v124
    v_max3_u32 v56, v56, v125, v126
    v_max3_u32 v56, v56, v127, v128
    v_max3_u32 v56, v56, v129, v130
    v_max3_u32 v56, v56, v131, v132
    v_max3_u32 v56, v56, v133, v134
    v_max3_u32 v56, v56, v135, v136
    v_max3_u32 v56, v56, v137, v138
    v_max3_u32 v56, v56, v139, v140
    v_max3_u32 v56, v56, v141, v142
    v_max_u32 v56, v56, v143
    v_max3_u32 v57, v144, v145, v146
    v_max3_u32 v57, v57, v147, v148
    v_max3_u32 v57, v57, v149, v150
    v_max_u32 v57, v57, v151
    s_cmp_ge_u32 s3, 2
    s_cselect_b32 s46, 0, -1
    v_and_b32 v57, s46, v57
    v_max_u32 v56, v56, v57
    v_cmp_eq_u32 vcc, -1, v56
    s_cbranch_vccz Lvk_main_kernel_205
    s_sub_u32 s70, s70, 1
    s_cbranch_scc1 Lexit_main_kernel
    buffer_load_dwordx4 v[120:123], v1, s[12:15], s65 offen offset:0 sc1
    buffer_load_dwordx4 v[124:127], v1, s[12:15], s65 offen offset:1024 sc1
    buffer_load_dwordx4 v[128:131], v1, s[12:15], s65 offen offset:2048 sc1
    buffer_load_dwordx4 v[132:135], v1, s[12:15], s65 offen offset:3072 sc1
    s_add_u32 s47, s65, 4096
    buffer_load_dwordx4 v[136:139], v1, s[12:15], s47 offen offset:0 sc1
    buffer_load_dwordx4 v[140:143], v1, s[12:15], s47 offen offset:1024 sc1
    buffer_load_dwordx4 v[144:147], v1, s[12:15], s47 offen offset:2048 sc1
    buffer_load_dwordx4 v[148:151], v1, s[12:15], s47 offen offset:3072 sc1
    s_branch Lvm_main_kernel_204
Lvk_main_kernel_205:
    v_mfma_f32_16x16x32_bf16 v[192:195], v[120:123], v[48:51], v[192:195]
    v_mfma_f32_16x16x32_bf16 v[196:199], v[120:123], v[52:55], v[196:199]
    v_mfma_f32_16x16x32_bf16 v[200:203], v[124:127], v[48:51], v[200:203]
    v_mfma_f32_16x16x32_bf16 v[204:207], v[124:127], v[52:55], v[204:207]
    v_mfma_f32_16x16x32_bf16 v[208:211], v[128:131], v[48:51], v[208:211]
    v_mfma_f32_16x16x32_bf16 v[212:215], v[128:131], v[52:55], v[212:215]
    v_mfma_f32_16x16x32_bf16 v[216:219], v[132:135], v[48:51], v[216:219]
    v_mfma_f32_16x16x32_bf16 v[220:223], v[132:135], v[52:55], v[220:223]
    v_mfma_f32_16x16x32_bf16 v[224:227], v[136:139], v[48:51], v[224:227]
    v_mfma_f32_16x16x32_bf16 v[228:231], v[136:139], v[52:55], v[228:231]
    v_mfma_f32_16x16x32_bf16 v[232:235], v[140:143], v[48:51], v[232:235]
    v_mfma_f32_16x16x32_bf16 v[236:239], v[140:143], v[52:55], v[236:239]
    v_mfma_f32_16x16x32_bf16 v[240:243], v[144:147], v[48:51], v[240:243]
    v_mfma_f32_16x16x32_bf16 v[244:247], v[144:147], v[52:55], v[244:247]
    v_mfma_f32_16x16x32_bf16 v[248:251], v[148:151], v[48:51], v[248:251]
    v_mfma_f32_16x16x32_bf16 v[252:255], v[148:151], v[52:55], v[252:255]
    s_cmp_ge_u32 s60, 62
    s_cselect_b32 s46, s94, 0
    s_cmp_eq_u32 s46, 0
    s_cbranch_scc1 L_main_kernel_207
    v_cvt_pk_bf16_f32 v128, v192, v193
    v_cvt_pk_bf16_f32 v129, v194, v195
    v_cvt_pk_bf16_f32 v130, v200, v201
    v_cvt_pk_bf16_f32 v131, v202, v203
    v_min_u32 v128, -2, v128
    v_min_u32 v129, -2, v129
    v_min_u32 v130, -2, v130
    v_min_u32 v131, -2, v131
    buffer_store_dwordx4 v[128:131], v15, s[12:15], s66 offen offset:0
    v_cvt_pk_bf16_f32 v132, v196, v197
    v_cvt_pk_bf16_f32 v133, v198, v199
    v_cvt_pk_bf16_f32 v134, v204, v205
    v_cvt_pk_bf16_f32 v135, v206, v207
    v_min_u32 v132, -2, v132
    v_min_u32 v133, -2, v133
    v_min_u32 v134, -2, v134
    v_min_u32 v135, -2, v135
    buffer_store_dwordx4 v[132:135], v15, s[12:15], s67 offen offset:0
    v_cvt_pk_bf16_f32 v56, v208, v209
    v_cvt_pk_bf16_f32 v57, v210, v211
    v_cvt_pk_bf16_f32 v58, v216, v217
    v_cvt_pk_bf16_f32 v59, v218, v219
    v_min_u32 v56, -2, v56
    v_min_u32 v57, -2, v57
    v_min_u32 v58, -2, v58
    v_min_u32 v59, -2, v59
    buffer_store_dwordx4 v[56:59], v15, s[12:15], s66 offen offset:512
    v_cvt_pk_bf16_f32 v60, v212, v213
    v_cvt_pk_bf16_f32 v61, v214, v215
    v_cvt_pk_bf16_f32 v62, v220, v221
    v_cvt_pk_bf16_f32 v63, v222, v223
    v_min_u32 v60, -2, v60
    v_min_u32 v61, -2, v61
    v_min_u32 v62, -2, v62
    v_min_u32 v63, -2, v63
    buffer_store_dwordx4 v[60:63], v15, s[12:15], s67 offen offset:512
    v_cvt_pk_bf16_f32 v128, v224, v225
    v_cvt_pk_bf16_f32 v129, v226, v227
    v_cvt_pk_bf16_f32 v130, v232, v233
    v_cvt_pk_bf16_f32 v131, v234, v235
    v_min_u32 v128, -2, v128
    v_min_u32 v129, -2, v129
    v_min_u32 v130, -2, v130
    v_min_u32 v131, -2, v131
    buffer_store_dwordx4 v[128:131], v15, s[12:15], s66 offen offset:1024
    v_cvt_pk_bf16_f32 v132, v228, v229
    v_cvt_pk_bf16_f32 v133, v230, v231
    v_cvt_pk_bf16_f32 v134, v236, v237
    v_cvt_pk_bf16_f32 v135, v238, v239
    v_min_u32 v132, -2, v132
    v_min_u32 v133, -2, v133
    v_min_u32 v134, -2, v134
    v_min_u32 v135, -2, v135
    buffer_store_dwordx4 v[132:135], v15, s[12:15], s67 offen offset:1024
    s_cmp_ge_u32 s3, 2
    s_cbranch_scc1 L_main_kernel_206
    v_cvt_pk_bf16_f32 v56, v240, v241
    v_cvt_pk_bf16_f32 v57, v242, v243
    v_cvt_pk_bf16_f32 v58, v248, v249
    v_cvt_pk_bf16_f32 v59, v250, v251
    v_min_u32 v56, -2, v56
    v_min_u32 v57, -2, v57
    v_min_u32 v58, -2, v58
    v_min_u32 v59, -2, v59
    buffer_store_dwordx4 v[56:59], v15, s[12:15], s66 offen offset:1536
    v_cvt_pk_bf16_f32 v60, v244, v245
    v_cvt_pk_bf16_f32 v61, v246, v247
    v_cvt_pk_bf16_f32 v62, v252, v253
    v_cvt_pk_bf16_f32 v63, v254, v255
    v_min_u32 v60, -2, v60
    v_min_u32 v61, -2, v61
    v_min_u32 v62, -2, v62
    v_min_u32 v63, -2, v63
    buffer_store_dwordx4 v[60:63], v15, s[12:15], s67 offen offset:1536
    s_branch L_main_kernel_206
L_main_kernel_207:
    v_cvt_pk_bf16_f32 v128, v192, v193
    v_cvt_pk_bf16_f32 v129, v194, v195
    v_cvt_pk_bf16_f32 v130, v200, v201
    v_cvt_pk_bf16_f32 v131, v202, v203
    v_min_u32 v128, -2, v128
    v_min_u32 v129, -2, v129
    v_min_u32 v130, -2, v130
    v_min_u32 v131, -2, v131
    buffer_store_dwordx4 v[128:131], v15, s[12:15], s66 offen offset:0 sc1
    v_cvt_pk_bf16_f32 v132, v196, v197
    v_cvt_pk_bf16_f32 v133, v198, v199
    v_cvt_pk_bf16_f32 v134, v204, v205
    v_cvt_pk_bf16_f32 v135, v206, v207
    v_min_u32 v132, -2, v132
    v_min_u32 v133, -2, v133
    v_min_u32 v134, -2, v134
    v_min_u32 v135, -2, v135
    buffer_store_dwordx4 v[132:135], v15, s[12:15], s67 offen offset:0 sc1
    v_cvt_pk_bf16_f32 v56, v208, v209
    v_cvt_pk_bf16_f32 v57, v210, v211
    v_cvt_pk_bf16_f32 v58, v216, v217
    v_cvt_pk_bf16_f32 v59, v218, v219
    v_min_u32 v56, -2, v56
    v_min_u32 v57, -2, v57
    v_min_u32 v58, -2, v58
    v_min_u32 v59, -2, v59
    buffer_store_dwordx4 v[56:59], v15, s[12:15], s66 offen offset:512 sc1
    v_cvt_pk_bf16_f32 v60, v212, v213
    v_cvt_pk_bf16_f32 v61, v214, v215
    v_cvt_pk_bf16_f32 v62, v220, v221
    v_cvt_pk_bf16_f32 v63, v222, v223
    v_min_u32 v60, -2, v60
    v_min_u32 v61, -2, v61
    v_min_u32 v62, -2, v62
    v_min_u32 v63, -2, v63
    buffer_store_dwordx4 v[60:63], v15, s[12:15], s67 offen offset:512 sc1
    v_cvt_pk_bf16_f32 v128, v224, v225
    v_cvt_pk_bf16_f32 v129, v226, v227
    v_cvt_pk_bf16_f32 v130, v232, v233
    v_cvt_pk_bf16_f32 v131, v234, v235
    v_min_u32 v128, -2, v128
    v_min_u32 v129, -2, v129
    v_min_u32 v130, -2, v130
    v_min_u32 v131, -2, v131
    buffer_store_dwordx4 v[128:131], v15, s[12:15], s66 offen offset:1024 sc1
    v_cvt_pk_bf16_f32 v132, v228, v229
    v_cvt_pk_bf16_f32 v133, v230, v231
    v_cvt_pk_bf16_f32 v134, v236, v237
    v_cvt_pk_bf16_f32 v135, v238, v239
    v_min_u32 v132, -2, v132
    v_min_u32 v133, -2, v133
    v_min_u32 v134, -2, v134
    v_min_u32 v135, -2, v135
    buffer_store_dwordx4 v[132:135], v15, s[12:15], s67 offen offset:1024 sc1
    s_cmp_ge_u32 s3, 2
    s_cbranch_scc1 L_main_kernel_206
    v_cvt_pk_bf16_f32 v56, v240, v241
    v_cvt_pk_bf16_f32 v57, v242, v243
    v_cvt_pk_bf16_f32 v58, v248, v249
    v_cvt_pk_bf16_f32 v59, v250, v251
    v_min_u32 v56, -2, v56
    v_min_u32 v57, -2, v57
    v_min_u32 v58, -2, v58
    v_min_u32 v59, -2, v59
    buffer_store_dwordx4 v[56:59], v15, s[12:15], s66 offen offset:1536 sc1
    v_cvt_pk_bf16_f32 v60, v244, v245
    v_cvt_pk_bf16_f32 v61, v246, v247
    v_cvt_pk_bf16_f32 v62, v252, v253
    v_cvt_pk_bf16_f32 v63, v254, v255
    v_min_u32 v60, -2, v60
    v_min_u32 v61, -2, v61
    v_min_u32 v62, -2, v62
    v_min_u32 v63, -2, v63
    buffer_store_dwordx4 v[60:63], v15, s[12:15], s67 offen offset:1536 sc1
L_main_kernel_206:
    s_cmp_ge_u32 s60, 62
    s_cbranch_scc1 Ldir_main_kernel_208
    s_waitcnt vmcnt(0)
    s_barrier
    s_cmp_lg_u32 s3, 0
    s_cbranch_scc1 L_main_kernel_209
    v_mov_b32 v56, 0
    v_mov_b32 v57, 1
    s_add_u32 s46, s48, 97705984
    s_mov_b64 exec, 1
    buffer_atomic_add v57, v56, s[12:15], s46 offen sc1
    s_mov_b64 exec, -1
L_main_kernel_209:
    s_add_u32 s49, s48, 97705984
    v_mov_b32 v54, 0
    s_cmp_lg_u32 s3, 0
    s_cbranch_scc1 Lwo_main_kernel_211
    s_mov_b32 s47, 2097152
Lwc_main_kernel_210:
    buffer_load_dword v55, v54, s[12:15], s49 offen sc1
    s_sub_u32 s47, s47, 1
    s_cbranch_scc1 Lexit_main_kernel
    s_waitcnt vmcnt(0)
    v_cmp_ne_u32 vcc, 4, v55
    s_cbranch_vccz Lwo_main_kernel_211
    s_sleep 1
    s_branch Lwc_main_kernel_210
Lwo_main_kernel_211:
    s_barrier
Ldir_main_kernel_208:
    s_lshl_b32 s66, s60, 17
    s_lshl_b32 s46, s71, 15
    s_add_u32 s66, s66, s46
    s_lshl_b32 s46, s61, 9
    s_add_u32 s66, s66, s46
    s_add_u32 s66, s66, 89014272
Lpt_main_kernel_212:
    s_add_u32 s67, s66, 0
    buffer_load_dwordx4 v[16:19], v13, s[12:15], s67 offen offset:0 sc1
    buffer_load_dwordx4 v[20:23], v13, s[12:15], s67 offen offset:1024 sc1
    s_add_u32 s67, s66, 8192
    buffer_load_dwordx4 v[24:27], v13, s[12:15], s67 offen offset:0 sc1
    buffer_load_dwordx4 v[28:31], v13, s[12:15], s67 offen offset:1024 sc1
    s_add_u32 s67, s66, 16384
    buffer_load_dwordx4 v[32:35], v13, s[12:15], s67 offen offset:0 sc1
    buffer_load_dwordx4 v[36:39], v13, s[12:15], s67 offen offset:1024 sc1
    s_add_u32 s67, s66, 24576
    buffer_load_dwordx4 v[40:43], v13, s[12:15], s67 offen offset:0 sc1
    buffer_load_dwordx4 v[44:47], v13, s[12:15], s67 offen offset:1024 sc1
    s_sub_u32 s70, s70, 1
    s_cbranch_scc1 Lexit_main_kernel
    v_lshlrev_b32 v192, 16, v176
    v_and_b32 v193, 0xffff0000, v176
    v_lshlrev_b32 v194, 16, v177
    v_and_b32 v195, 0xffff0000, v177
    v_lshlrev_b32 v196, 16, v178
    v_and_b32 v197, 0xffff0000, v178
    v_lshlrev_b32 v198, 16, v179
    v_and_b32 v199, 0xffff0000, v179
    v_lshlrev_b32 v200, 16, v180
    v_and_b32 v201, 0xffff0000, v180
    v_lshlrev_b32 v202, 16, v181
    v_and_b32 v203, 0xffff0000, v181
    v_lshlrev_b32 v204, 16, v182
    v_and_b32 v205, 0xffff0000, v182
    v_lshlrev_b32 v206, 16, v183
    v_and_b32 v207, 0xffff0000, v183
    v_mov_b32 v56, 0
    v_mov_b32 v57, 0
    s_waitcnt vmcnt(6)
    v_max3_u32 v56, v56, v16, v17
    v_max3_u32 v56, v56, v18, v19
    v_max3_u32 v57, v57, v20, v21
    v_max3_u32 v57, v57, v22, v23
    v_lshlrev_b32 v54, 16, v16
    v_and_b32 v55, 0xffff0000, v16
    v_pk_add_f32 v[192:193], v[192:193], v[54:55]
    v_lshlrev_b32 v54, 16, v17
    v_and_b32 v55, 0xffff0000, v17
    v_pk_add_f32 v[194:195], v[194:195], v[54:55]
    v_lshlrev_b32 v54, 16, v18
    v_and_b32 v55, 0xffff0000, v18
    v_pk_add_f32 v[196:197], v[196:197], v[54:55]
    v_lshlrev_b32 v54, 16, v19
    v_and_b32 v55, 0xffff0000, v19
    v_pk_add_f32 v[198:199], v[198:199], v[54:55]
    v_lshlrev_b32 v54, 16, v20
    v_and_b32 v55, 0xffff0000, v20
    v_pk_add_f32 v[200:201], v[200:201], v[54:55]
    v_lshlrev_b32 v54, 16, v21
    v_and_b32 v55, 0xffff0000, v21
    v_pk_add_f32 v[202:203], v[202:203], v[54:55]
    v_lshlrev_b32 v54, 16, v22
    v_and_b32 v55, 0xffff0000, v22
    v_pk_add_f32 v[204:205], v[204:205], v[54:55]
    v_lshlrev_b32 v54, 16, v23
    v_and_b32 v55, 0xffff0000, v23
    v_pk_add_f32 v[206:207], v[206:207], v[54:55]
    s_waitcnt vmcnt(4)
    v_max3_u32 v56, v56, v24, v25
    v_max3_u32 v56, v56, v26, v27
    v_max3_u32 v57, v57, v28, v29
    v_max3_u32 v57, v57, v30, v31
    v_lshlrev_b32 v54, 16, v24
    v_and_b32 v55, 0xffff0000, v24
    v_pk_add_f32 v[192:193], v[192:193], v[54:55]
    v_lshlrev_b32 v54, 16, v25
    v_and_b32 v55, 0xffff0000, v25
    v_pk_add_f32 v[194:195], v[194:195], v[54:55]
    v_lshlrev_b32 v54, 16, v26
    v_and_b32 v55, 0xffff0000, v26
    v_pk_add_f32 v[196:197], v[196:197], v[54:55]
    v_lshlrev_b32 v54, 16, v27
    v_and_b32 v55, 0xffff0000, v27
    v_pk_add_f32 v[198:199], v[198:199], v[54:55]
    v_lshlrev_b32 v54, 16, v28
    v_and_b32 v55, 0xffff0000, v28
    v_pk_add_f32 v[200:201], v[200:201], v[54:55]
    v_lshlrev_b32 v54, 16, v29
    v_and_b32 v55, 0xffff0000, v29
    v_pk_add_f32 v[202:203], v[202:203], v[54:55]
    v_lshlrev_b32 v54, 16, v30
    v_and_b32 v55, 0xffff0000, v30
    v_pk_add_f32 v[204:205], v[204:205], v[54:55]
    v_lshlrev_b32 v54, 16, v31
    v_and_b32 v55, 0xffff0000, v31
    v_pk_add_f32 v[206:207], v[206:207], v[54:55]
    s_waitcnt vmcnt(2)
    v_max3_u32 v56, v56, v32, v33
    v_max3_u32 v56, v56, v34, v35
    v_max3_u32 v57, v57, v36, v37
    v_max3_u32 v57, v57, v38, v39
    v_lshlrev_b32 v54, 16, v32
    v_and_b32 v55, 0xffff0000, v32
    v_pk_add_f32 v[192:193], v[192:193], v[54:55]
    v_lshlrev_b32 v54, 16, v33
    v_and_b32 v55, 0xffff0000, v33
    v_pk_add_f32 v[194:195], v[194:195], v[54:55]
    v_lshlrev_b32 v54, 16, v34
    v_and_b32 v55, 0xffff0000, v34
    v_pk_add_f32 v[196:197], v[196:197], v[54:55]
    v_lshlrev_b32 v54, 16, v35
    v_and_b32 v55, 0xffff0000, v35
    v_pk_add_f32 v[198:199], v[198:199], v[54:55]
    v_lshlrev_b32 v54, 16, v36
    v_and_b32 v55, 0xffff0000, v36
    v_pk_add_f32 v[200:201], v[200:201], v[54:55]
    v_lshlrev_b32 v54, 16, v37
    v_and_b32 v55, 0xffff0000, v37
    v_pk_add_f32 v[202:203], v[202:203], v[54:55]
    v_lshlrev_b32 v54, 16, v38
    v_and_b32 v55, 0xffff0000, v38
    v_pk_add_f32 v[204:205], v[204:205], v[54:55]
    v_lshlrev_b32 v54, 16, v39
    v_and_b32 v55, 0xffff0000, v39
    v_pk_add_f32 v[206:207], v[206:207], v[54:55]
    s_waitcnt vmcnt(0)
    v_max3_u32 v56, v56, v40, v41
    v_max3_u32 v56, v56, v42, v43
    v_max3_u32 v57, v57, v44, v45
    v_max3_u32 v57, v57, v46, v47
    v_lshlrev_b32 v54, 16, v40
    v_and_b32 v55, 0xffff0000, v40
    v_pk_add_f32 v[192:193], v[192:193], v[54:55]
    v_lshlrev_b32 v54, 16, v41
    v_and_b32 v55, 0xffff0000, v41
    v_pk_add_f32 v[194:195], v[194:195], v[54:55]
    v_lshlrev_b32 v54, 16, v42
    v_and_b32 v55, 0xffff0000, v42
    v_pk_add_f32 v[196:197], v[196:197], v[54:55]
    v_lshlrev_b32 v54, 16, v43
    v_and_b32 v55, 0xffff0000, v43
    v_pk_add_f32 v[198:199], v[198:199], v[54:55]
    v_lshlrev_b32 v54, 16, v44
    v_and_b32 v55, 0xffff0000, v44
    v_pk_add_f32 v[200:201], v[200:201], v[54:55]
    v_lshlrev_b32 v54, 16, v45
    v_and_b32 v55, 0xffff0000, v45
    v_pk_add_f32 v[202:203], v[202:203], v[54:55]
    v_lshlrev_b32 v54, 16, v46
    v_and_b32 v55, 0xffff0000, v46
    v_pk_add_f32 v[204:205], v[204:205], v[54:55]
    v_lshlrev_b32 v54, 16, v47
    v_and_b32 v55, 0xffff0000, v47
    v_pk_add_f32 v[206:207], v[206:207], v[54:55]
    v_cndmask_b32 v57, 0, v57, s[82:83]
    v_max_u32 v56, v56, v57
    v_cmp_eq_u32 vcc, -1, v56
    s_cbranch_vccnz Lpt_main_kernel_212
    v_cvt_pk_bf16_f32 v176, v192, v193
    v_cvt_pk_bf16_f32 v177, v194, v195
    v_cvt_pk_bf16_f32 v178, v196, v197
    v_cvt_pk_bf16_f32 v179, v198, v199
    v_cvt_pk_bf16_f32 v180, v200, v201
    v_cvt_pk_bf16_f32 v181, v202, v203
    v_cvt_pk_bf16_f32 v182, v204, v205
    v_cvt_pk_bf16_f32 v183, v206, v207
    v_mov_b32 v11, 0x7fffffff
    v_cndmask_b32 v8, v11, v14, s[82:83]
    s_add_u32 s46, s68, 19267584
    buffer_store_dwordx4 v[176:179], v14, s[12:15], s46 offen sc1
    buffer_store_dwordx4 v[180:183], v8, s[12:15], s46 offen offset:2048 sc1
    v_add_f32 v54, v192, v193
    v_add_f32 v54, v54, v194
    v_add_f32 v54, v54, v195
    v_add_f32 v54, v54, v196
    v_add_f32 v54, v54, v197
    v_add_f32 v54, v54, v198
    v_add_f32 v54, v54, v199
    v_add_f32 v55, v200, v201
    v_add_f32 v55, v55, v202
    v_add_f32 v55, v55, v203
    v_add_f32 v55, v55, v204
    v_add_f32 v55, v55, v205
    v_add_f32 v55, v55, v206
    v_add_f32 v55, v55, v207
    v_cndmask_b32 v55, 0, v55, s[82:83]
    v_add_f32 v54, v54, v55
    s_nop 1
    v_add_f32_dpp v54, v54, v54 row_ror:8 row_mask:0xf bank_mask:0xf
    v_mov_b32 v55, v54
    s_nop 1
    v_permlane16_swap_b32 v54, v55
    s_nop 0
    v_add_f32 v54, v54, v55
    v_mov_b32 v55, v54
    s_nop 1
    v_permlane32_swap_b32 v54, v55
    s_nop 0
    v_add_f32 v54, v54, v55
    ds_write_b32 v9, v54 offset:12288
    s_waitcnt lgkmcnt(0)
    s_barrier
    ds_read_b128 v[56:59], v10 offset:12288
    s_waitcnt lgkmcnt(0)
    v_add_f32 v56, v56, v57
    v_add_f32 v58, v58, v59
    v_add_f32 v54, v56, v58
    v_mul_f32 v54, 0x3b124925, v54
    v_sub_f32 v192, v192, v54
    v_sub_f32 v193, v193, v54
    v_sub_f32 v194, v194, v54
    v_sub_f32 v195, v195, v54
    v_sub_f32 v196, v196, v54
    v_sub_f32 v197, v197, v54
    v_sub_f32 v198, v198, v54
    v_sub_f32 v199, v199, v54
    v_sub_f32 v200, v200, v54
    v_sub_f32 v201, v201, v54
    v_sub_f32 v202, v202, v54
    v_sub_f32 v203, v203, v54
    v_sub_f32 v204, v204, v54
    v_sub_f32 v205, v205, v54
    v_sub_f32 v206, v206, v54
    v_sub_f32 v207, v207, v54
    v_mul_f32 v54, v192, v192
    v_fmac_f32 v54, v193, v193
    v_fmac_f32 v54, v194, v194
    v_fmac_f32 v54, v195, v195
    v_fmac_f32 v54, v196, v196
    v_fmac_f32 v54, v197, v197
    v_fmac_f32 v54, v198, v198
    v_fmac_f32 v54, v199, v199
    v_mul_f32 v55, v200, v200
    v_fmac_f32 v55, v201, v201
    v_fmac_f32 v55, v202, v202
    v_fmac_f32 v55, v203, v203
    v_fmac_f32 v55, v204, v204
    v_fmac_f32 v55, v205, v205
    v_fmac_f32 v55, v206, v206
    v_fmac_f32 v55, v207, v207
    v_cndmask_b32 v55, 0, v55, s[82:83]
    v_add_f32 v54, v54, v55
    s_nop 1
    v_add_f32_dpp v54, v54, v54 row_ror:8 row_mask:0xf bank_mask:0xf
    v_mov_b32 v55, v54
    s_nop 1
    v_permlane16_swap_b32 v54, v55
    s_nop 0
    v_add_f32 v54, v54, v55
    v_mov_b32 v55, v54
    s_nop 1
    v_permlane32_swap_b32 v54, v55
    s_nop 0
    v_add_f32 v54, v54, v55
    ds_write_b32 v9, v54 offset:12544
    s_waitcnt lgkmcnt(0)
    s_barrier
    ds_read_b128 v[56:59], v10 offset:12544
    s_waitcnt lgkmcnt(0)
    v_add_f32 v56, v56, v57
    v_add_f32 v58, v58, v59
    v_add_f32 v54, v56, v58
    v_mov_b32 v55, 0x3727c5ac
    v_fmac_f32 v55, 0x3b124925, v54
    v_rsq_f32 v55, v55
    s_nop 0
    v_mul_f32 v192, v192, v55
    v_mul_f32 v193, v193, v55
    v_mul_f32 v194, v194, v55
    v_mul_f32 v195, v195, v55
    v_mul_f32 v196, v196, v55
    v_mul_f32 v197, v197, v55
    v_mul_f32 v198, v198, v55
    v_mul_f32 v199, v199, v55
    v_mul_f32 v200, v200, v55
    v_mul_f32 v201, v201, v55
    v_mul_f32 v202, v202, v55
    v_mul_f32 v203, v203, v55
    v_mul_f32 v204, v204, v55
    v_mul_f32 v205, v205, v55
    v_mul_f32 v206, v206, v55
    v_mul_f32 v207, v207, v55
    v_cvt_pk_bf16_f32 v16, v192, v193
    v_cvt_pk_bf16_f32 v17, v194, v195
    v_cvt_pk_bf16_f32 v18, v196, v197
    v_cvt_pk_bf16_f32 v19, v198, v199
    v_cvt_pk_bf16_f32 v20, v200, v201
    v_cvt_pk_bf16_f32 v21, v202, v203
    v_cvt_pk_bf16_f32 v22, v204, v205
    v_cvt_pk_bf16_f32 v23, v206, v207
    v_min_u32 v16, -2, v16
    v_min_u32 v17, -2, v17
    v_min_u32 v18, -2, v18
    v_min_u32 v19, -2, v19
    v_min_u32 v20, -2, v20
    v_min_u32 v21, -2, v21
    v_min_u32 v22, -2, v22
    v_min_u32 v23, -2, v23
    s_lshl_b32 s46, s61, 9
    s_add_u32 s46, s46, 13312
    v_add_u32 v12, s46, v13
    v_mov_b32 v54, 9216
    v_cndmask_b32 v54, v54, v12, s[82:83]
    ds_write_b128 v12, v[16:19]
    ds_write_b128 v54, v[20:23] offset:1024
    s_add_u32 s46, s68, 17432576
    buffer_store_dwordx4 v[16:19], v14, s[12:15], s46 offen sc1
    buffer_store_dwordx4 v[20:23], v8, s[12:15], s46 offen offset:2048 sc1
    s_waitcnt lgkmcnt(0)
    s_barrier
    v_and_b32 v12, 7, v0
    v_lshlrev_b32 v12, 4, v12
    v_lshl_add_u32 v12, v3, 7, v12
    ds_read_b128 v[192:195], v12 offset:13312
    ds_read_b128 v[196:199], v12 offset:13824
    ds_read_b128 v[200:203], v12 offset:14336
    ds_read_b128 v[204:207], v12 offset:14848
    ds_read_b128 v[208:211], v12 offset:15360
    ds_read_b128 v[212:215], v12 offset:15872
    ds_read_b128 v[216:219], v12 offset:16384
    ds_read_b128 v[220:223], v12 offset:16896
    ds_read_b128 v[224:227], v12 offset:17408
    ds_read_b128 v[228:231], v12 offset:17920
    ds_read_b128 v[232:235], v12 offset:18432
    ds_read_b128 v[236:239], v12 offset:18944
    ds_read_b128 v[240:243], v12 offset:19456
    ds_read_b128 v[244:247], v12 offset:19968
    s_lshl_b32 s49, s60, 11
    s_cmp_ge_u32 s3, 2
    s_cbranch_scc1 LV_main_kernel_213
    v_lshrrev_b32 v12, 1, v3
    v_lshlrev_b32 v12, 10, v12
    v_and_b32 v54, 1, v3
    v_lshl_add_u32 v12, v54, 9, v12
    v_lshl_add_u32 v12, v2, 4, v12
    v_cmp_gt_u32 vcc, 8, v2
    s_nop 1
    v_cndmask_b32 v12, v11, v12, vcc
    s_lshl_b32 s46, s71, 7
    s_lshl_b32 s47, s3, 3
    s_add_u32 s46, s46, s47
    s_add_u32 s46, s46, s49
    s_add_u32 s46, s46, 88743936
    s_waitcnt lgkmcnt(0)
    v_mfma_f32_16x16x32_bf16 v[16:19], v[64:67], v[192:195], 0
    v_mfma_f32_16x16x32_bf16 v[16:19], v[68:71], v[196:199], v[16:19]
    v_mfma_f32_16x16x32_bf16 v[16:19], v[72:75], v[200:203], v[16:19]
    v_mfma_f32_16x16x32_bf16 v[16:19], v[76:79], v[204:207], v[16:19]
    v_mfma_f32_16x16x32_bf16 v[16:19], v[80:83], v[208:211], v[16:19]
    v_mfma_f32_16x16x32_bf16 v[16:19], v[84:87], v[212:215], v[16:19]
    v_mfma_f32_16x16x32_bf16 v[16:19], v[88:91], v[216:219], v[16:19]
    v_mfma_f32_16x16x32_bf16 v[16:19], v[92:95], v[220:223], v[16:19]
    v_mfma_f32_16x16x32_bf16 v[16:19], v[96:99], v[224:227], v[16:19]
    v_mfma_f32_16x16x32_bf16 v[16:19], v[100:103], v[228:231], v[16:19]
    v_mfma_f32_16x16x32_bf16 v[16:19], v[104:107], v[232:235], v[16:19]
    v_mfma_f32_16x16x32_bf16 v[16:19], v[108:111], v[236:239], v[16:19]
    v_mfma_f32_16x16x32_bf16 v[16:19], v[112:115], v[240:243], v[16:19]
    v_mfma_f32_16x16x32_bf16 v[16:19], v[116:119], v[244:247], v[16:19]
    s_nop 7
    v_cvt_pk_bf16_f32 v24, v16, v17
    v_cvt_pk_bf16_f32 v25, v18, v19
    s_branch LE_main_kernel_214
LV_main_kernel_213:
    v_lshlrev_b32 v12, 9, v3
    v_lshl_add_u32 v12, v2, 4, v12
    v_cndmask_b32 v12, v11, v12, s[80:81]
    s_lshr_b32 s46, s71, 1
    s_lshl_b32 s46, s46, 10
    s_and_b32 s47, s71, 1
    s_lshl_b32 s47, s47, 3
    s_add_u32 s46, s46, s47
    s_and_b32 s47, s3, 1
    s_lshl_b32 s47, s47, 8
    s_add_u32 s46, s46, s47
    s_add_u32 s46, s46, s49
    s_add_u32 s46, s46, 88879104
    s_cmp_eq_u32 s3, 3
    s_cselect_b32 s47, 12, 99
    v_cmp_eq_u32 vcc, s47, v2
    v_mov_b32 v54, 0x3f803f80
    s_waitcnt lgkmcnt(0)
    v_mfma_f32_16x16x32_bf16 v[16:19], v[192:195], v[64:67], 0
    v_mfma_f32_16x16x32_bf16 v[16:19], v[196:199], v[68:71], v[16:19]
    v_mfma_f32_16x16x32_bf16 v[16:19], v[200:203], v[72:75], v[16:19]
    v_mfma_f32_16x16x32_bf16 v[16:19], v[204:207], v[76:79], v[16:19]
    v_mfma_f32_16x16x32_bf16 v[16:19], v[208:211], v[80:83], v[16:19]
    v_mfma_f32_16x16x32_bf16 v[16:19], v[212:215], v[84:87], v[16:19]
    v_mfma_f32_16x16x32_bf16 v[16:19], v[216:219], v[88:91], v[16:19]
    v_mfma_f32_16x16x32_bf16 v[16:19], v[220:223], v[92:95], v[16:19]
    v_mfma_f32_16x16x32_bf16 v[16:19], v[224:227], v[96:99], v[16:19]
    v_mfma_f32_16x16x32_bf16 v[16:19], v[228:231], v[100:103], v[16:19]
    v_mfma_f32_16x16x32_bf16 v[16:19], v[232:235], v[104:107], v[16:19]
    v_mfma_f32_16x16x32_bf16 v[16:19], v[236:239], v[108:111], v[16:19]
    v_mfma_f32_16x16x32_bf16 v[16:19], v[240:243], v[112:115], v[16:19]
    v_mfma_f32_16x16x32_bf16 v[16:19], v[244:247], v[116:119], v[16:19]
    s_nop 7
    v_cvt_pk_bf16_f32 v24, v16, v17
    v_cvt_pk_bf16_f32 v25, v18, v19
    v_cndmask_b32 v24, v24, v54, vcc
    v_cndmask_b32 v25, v25, v54, vcc
LE_main_kernel_214:
    v_min_u32 v24, -2, v24
    v_min_u32 v25, -2, v25
    buffer_store_dwordx2 v[24:25], v12, s[12:15], s46 offen sc1
    s_waitcnt vmcnt(0)
    s_barrier
    s_cmp_lg_u32 s3, 0
    s_cbranch_scc1 L_main_kernel_215
    s_add_u32 s47, s48, 97714176
    v_mov_b32 v4, 0
    v_mov_b32 v5, 1
    s_mov_b64 exec, 1
    buffer_atomic_add v5, v4, s[12:15], s47 offen sc1
    s_mov_b64 exec, -1
L_main_kernel_215:
    s_add_u32 s93, s93, 36
    s_cmp_lt_u32 s93, 256
    s_cbranch_scc1 Lag_main_kernel_188
    s_cmp_eq_u32 s0, 1
    s_cbranch_scc1 L_main_kernel_216
    s_mul_i32 s53, s100, 9363
    s_lshr_b32 s53, s53, 16
    s_mul_i32 s54, s53, 7
    s_sub_u32 s54, s100, s54
    s_and_b32 s55, s53, 15
    s_lshr_b32 s53, s53, 4
    s_cmp_eq_u32 s53, 0
    s_cselect_b32 s57, 0, 6422528
    s_mul_i32 s58, s55, 28
    s_lshl_b32 s59, s54, 2
    s_add_u32 s58, s58, s59
    s_add_u32 s58, s58, s3
    s_mul_i32 s58, s58, 14336
    s_add_u32 s57, s57, s58
    buffer_load_dwordx4 v[128:131], v1, s[4:7], s57 offen offset:0 sc1
    buffer_load_dwordx4 v[132:135], v1, s[4:7], s57 offen offset:1024 sc1
    buffer_load_dwordx4 v[136:139], v1, s[4:7], s57 offen offset:2048 sc1
    buffer_load_dwordx4 v[140:143], v1, s[4:7], s57 offen offset:3072 sc1
    s_add_u32 s57, s57, 4096
    buffer_load_dwordx4 v[144:147], v1, s[4:7], s57 offen offset:0 sc1
    buffer_load_dwordx4 v[148:151], v1, s[4:7], s57 offen offset:1024 sc1
    buffer_load_dwordx4 v[152:155], v1, s[4:7], s57 offen offset:2048 sc1
    buffer_load_dwordx4 v[156:159], v1, s[4:7], s57 offen offset:3072 sc1
    s_add_u32 s57, s57, 4096
    buffer_load_dwordx4 v[160:163], v1, s[4:7], s57 offen offset:0 sc1
    buffer_load_dwordx4 v[164:167], v1, s[4:7], s57 offen offset:1024 sc1
    buffer_load_dwordx4 v[168:171], v1, s[4:7], s57 offen offset:2048 sc1
    buffer_load_dwordx4 v[172:175], v1, s[4:7], s57 offen offset:3072 sc1
    s_add_u32 s57, s57, 4096
    buffer_load_dwordx4 v[176:179], v1, s[4:7], s57 offen offset:0 sc1
    buffer_load_dwordx4 v[180:183], v1, s[4:7], s57 offen offset:1024 sc1
L_main_kernel_216:
    s_cmp_eq_u32 s0, 1
    s_cbranch_scc1 L_main_kernel_217
    s_mul_i32 s58, s3, 14336
    s_add_u32 s58, s58, 32768
    v_add_u32 v2, s58, v1
    s_waitcnt vmcnt(0)
    s_barrier
    ds_write_b128 v2, v[128:131] offset:0
    ds_write_b128 v2, v[132:135] offset:1024
    ds_write_b128 v2, v[136:139] offset:2048
    ds_write_b128 v2, v[140:143] offset:3072
    ds_write_b128 v2, v[144:147] offset:4096
    ds_write_b128 v2, v[148:151] offset:5120
    ds_write_b128 v2, v[152:155] offset:6144
    ds_write_b128 v2, v[156:159] offset:7168
    ds_write_b128 v2, v[160:163] offset:8192
    ds_write_b128 v2, v[164:167] offset:9216
    ds_write_b128 v2, v[168:171] offset:10240
    ds_write_b128 v2, v[172:175] offset:11264
    ds_write_b128 v2, v[176:179] offset:12288
    ds_write_b128 v2, v[180:183] offset:13312
    s_nop 0
    v_add_u32 v2, 32768, v1
    s_waitcnt lgkmcnt(0)
    s_barrier
    ds_read_b128 a[0:3], v2 offset:0
    ds_read_b128 a[4:7], v2 offset:1024
    ds_read_b128 a[8:11], v2 offset:2048
    ds_read_b128 a[12:15], v2 offset:3072
    ds_read_b128 a[16:19], v2 offset:4096
    ds_read_b128 a[20:23], v2 offset:5120
    ds_read_b128 a[24:27], v2 offset:6144
    ds_read_b128 a[28:31], v2 offset:7168
    ds_read_b128 a[32:35], v2 offset:8192
    ds_read_b128 a[36:39], v2 offset:9216
    ds_read_b128 a[40:43], v2 offset:10240
    ds_read_b128 a[44:47], v2 offset:11264
    s_waitcnt lgkmcnt(4)
    ds_read_b128 a[48:51], v2 offset:12288
    ds_read_b128 a[52:55], v2 offset:13312
    ds_read_b128 a[56:59], v2 offset:14336
    ds_read_b128 a[60:63], v2 offset:15360
    ds_read_b128 a[64:67], v2 offset:16384
    ds_read_b128 a[68:71], v2 offset:17408
    ds_read_b128 a[72:75], v2 offset:18432
    ds_read_b128 a[76:79], v2 offset:19456
    ds_read_b128 a[80:83], v2 offset:20480
    ds_read_b128 a[84:87], v2 offset:21504
    ds_read_b128 a[88:91], v2 offset:22528
    ds_read_b128 a[92:95], v2 offset:23552
    s_waitcnt lgkmcnt(4)
    ds_read_b128 a[96:99], v2 offset:24576
    ds_read_b128 a[100:103], v2 offset:25600
    ds_read_b128 a[104:107], v2 offset:26624
    ds_read_b128 a[108:111], v2 offset:27648
    ds_read_b128 a[112:115], v2 offset:28672
    ds_read_b128 a[116:119], v2 offset:29696
    ds_read_b128 a[120:123], v2 offset:30720
    ds_read_b128 a[124:127], v2 offset:31744
    ds_read_b128 a[128:131], v2 offset:32768
    ds_read_b128 a[132:135], v2 offset:33792
    ds_read_b128 a[136:139], v2 offset:34816
    ds_read_b128 a[140:143], v2 offset:35840
    s_waitcnt lgkmcnt(4)
    ds_read_b128 a[144:147], v2 offset:36864
    ds_read_b128 a[148:151], v2 offset:37888
    ds_read_b128 a[152:155], v2 offset:38912
    ds_read_b128 a[156:159], v2 offset:39936
    ds_read_b128 a[160:163], v2 offset:40960
    ds_read_b128 a[164:167], v2 offset:41984
    ds_read_b128 a[168:171], v2 offset:43008
    ds_read_b128 a[172:175], v2 offset:44032
    ds_read_b128 a[176:179], v2 offset:45056
    ds_read_b128 a[180:183], v2 offset:46080
    ds_read_b128 a[184:187], v2 offset:47104
    ds_read_b128 a[188:191], v2 offset:48128
    s_waitcnt lgkmcnt(4)
    ds_read_b128 a[192:195], v2 offset:49152
    ds_read_b128 a[196:199], v2 offset:50176
    ds_read_b128 a[200:203], v2 offset:51200
    ds_read_b128 a[204:207], v2 offset:52224
    ds_read_b128 a[208:211], v2 offset:53248
    ds_read_b128 a[212:215], v2 offset:54272
    ds_read_b128 a[216:219], v2 offset:55296
    ds_read_b128 a[220:223], v2 offset:56320
L_main_kernel_217:
    s_branch Lnx_main_kernel_187
L7_main_kernel_189:
    v_lshlrev_b32 v1, 4, v0
    v_and_b32 v2, 15, v0
    v_lshrrev_b32 v3, 4, v0
    s_mul_i32 s46, s3, 100352
    s_add_u32 s46, s46, 12845056
    buffer_load_dwordx4 a[0:3], v1, s[4:7], s46 offen offset:0 sc1
    buffer_load_dwordx4 a[4:7], v1, s[4:7], s46 offen offset:1024 sc1
    buffer_load_dwordx4 a[8:11], v1, s[4:7], s46 offen offset:2048 sc1
    buffer_load_dwordx4 a[12:15], v1, s[4:7], s46 offen offset:3072 sc1
    s_add_u32 s46, s46, 4096
    buffer_load_dwordx4 a[16:19], v1, s[4:7], s46 offen offset:0 sc1
    buffer_load_dwordx4 a[20:23], v1, s[4:7], s46 offen offset:1024 sc1
    buffer_load_dwordx4 a[24:27], v1, s[4:7], s46 offen offset:2048 sc1
    buffer_load_dwordx4 a[28:31], v1, s[4:7], s46 offen offset:3072 sc1
    s_add_u32 s46, s46, 4096
    buffer_load_dwordx4 a[32:35], v1, s[4:7], s46 offen offset:0 sc1
    buffer_load_dwordx4 a[36:39], v1, s[4:7], s46 offen offset:1024 sc1
    buffer_load_dwordx4 a[40:43], v1, s[4:7], s46 offen offset:2048 sc1
    buffer_load_dwordx4 a[44:47], v1, s[4:7], s46 offen offset:3072 sc1
    s_add_u32 s46, s46, 4096
    buffer_load_dwordx4 a[48:51], v1, s[4:7], s46 offen offset:0 sc1
    buffer_load_dwordx4 a[52:55], v1, s[4:7], s46 offen offset:1024 sc1
    buffer_load_dwordx4 a[56:59], v1, s[4:7], s46 offen offset:2048 sc1
    buffer_load_dwordx4 a[60:63], v1, s[4:7], s46 offen offset:3072 sc1
    s_add_u32 s46, s46, 4096
    buffer_load_dwordx4 a[64:67], v1, s[4:7], s46 offen offset:0 sc1
    buffer_load_dwordx4 a[68:71], v1, s[4:7], s46 offen offset:1024 sc1
    buffer_load_dwordx4 a[72:75], v1, s[4:7], s46 offen offset:2048 sc1
    buffer_load_dwordx4 a[76:79], v1, s[4:7], s46 offen offset:3072 sc1
    s_add_u32 s46, s46, 4096
    buffer_load_dwordx4 a[80:83], v1, s[4:7], s46 offen offset:0 sc1
    buffer_load_dwordx4 a[84:87], v1, s[4:7], s46 offen offset:1024 sc1
    buffer_load_dwordx4 a[88:91], v1, s[4:7], s46 offen offset:2048 sc1
    buffer_load_dwordx4 a[92:95], v1, s[4:7], s46 offen offset:3072 sc1
    s_add_u32 s46, s46, 4096
    buffer_load_dwordx4 a[96:99], v1, s[4:7], s46 offen offset:0 sc1
    buffer_load_dwordx4 a[100:103], v1, s[4:7], s46 offen offset:1024 sc1
    buffer_load_dwordx4 a[104:107], v1, s[4:7], s46 offen offset:2048 sc1
    buffer_load_dwordx4 a[108:111], v1, s[4:7], s46 offen offset:3072 sc1
    s_add_u32 s46, s46, 4096
    buffer_load_dwordx4 a[112:115], v1, s[4:7], s46 offen offset:0 sc1
    buffer_load_dwordx4 a[116:119], v1, s[4:7], s46 offen offset:1024 sc1
    buffer_load_dwordx4 a[120:123], v1, s[4:7], s46 offen offset:2048 sc1
    buffer_load_dwordx4 a[124:127], v1, s[4:7], s46 offen offset:3072 sc1
    s_add_u32 s46, s46, 4096
    buffer_load_dwordx4 a[128:131], v1, s[4:7], s46 offen offset:0 sc1
    buffer_load_dwordx4 a[132:135], v1, s[4:7], s46 offen offset:1024 sc1
    buffer_load_dwordx4 a[136:139], v1, s[4:7], s46 offen offset:2048 sc1
    buffer_load_dwordx4 a[140:143], v1, s[4:7], s46 offen offset:3072 sc1
    s_add_u32 s46, s46, 4096
    buffer_load_dwordx4 a[144:147], v1, s[4:7], s46 offen offset:0 sc1
    buffer_load_dwordx4 a[148:151], v1, s[4:7], s46 offen offset:1024 sc1
    buffer_load_dwordx4 a[152:155], v1, s[4:7], s46 offen offset:2048 sc1
    buffer_load_dwordx4 a[156:159], v1, s[4:7], s46 offen offset:3072 sc1
    s_add_u32 s46, s46, 4096
    buffer_load_dwordx4 a[160:163], v1, s[4:7], s46 offen offset:0 sc1
    buffer_load_dwordx4 a[164:167], v1, s[4:7], s46 offen offset:1024 sc1
    buffer_load_dwordx4 a[168:171], v1, s[4:7], s46 offen offset:2048 sc1
    buffer_load_dwordx4 a[172:175], v1, s[4:7], s46 offen offset:3072 sc1
    s_add_u32 s46, s46, 4096
    buffer_load_dwordx4 a[176:179], v1, s[4:7], s46 offen offset:0 sc1
    buffer_load_dwordx4 a[180:183], v1, s[4:7], s46 offen offset:1024 sc1
    buffer_load_dwordx4 a[184:187], v1, s[4:7], s46 offen offset:2048 sc1
    buffer_load_dwordx4 a[188:191], v1, s[4:7], s46 offen offset:3072 sc1
    s_add_u32 s46, s46, 4096
    buffer_load_dwordx4 a[192:195], v1, s[4:7], s46 offen offset:0 sc1
    buffer_load_dwordx4 a[196:199], v1, s[4:7], s46 offen offset:1024 sc1
    buffer_load_dwordx4 a[200:203], v1, s[4:7], s46 offen offset:2048 sc1
    buffer_load_dwordx4 a[204:207], v1, s[4:7], s46 offen offset:3072 sc1
    s_add_u32 s46, s46, 4096
    buffer_load_dwordx4 a[208:211], v1, s[4:7], s46 offen offset:0 sc1
    buffer_load_dwordx4 a[212:215], v1, s[4:7], s46 offen offset:1024 sc1
    buffer_load_dwordx4 a[216:219], v1, s[4:7], s46 offen offset:2048 sc1
    buffer_load_dwordx4 a[220:223], v1, s[4:7], s46 offen offset:3072 sc1
    s_add_u32 s46, s46, 4096
    buffer_load_dwordx4 a[224:227], v1, s[4:7], s46 offen offset:0 sc1
    buffer_load_dwordx4 a[228:231], v1, s[4:7], s46 offen offset:1024 sc1
    buffer_load_dwordx4 a[232:235], v1, s[4:7], s46 offen offset:2048 sc1
    buffer_load_dwordx4 a[236:239], v1, s[4:7], s46 offen offset:3072 sc1
    s_add_u32 s46, s46, 4096
    buffer_load_dwordx4 a[240:243], v1, s[4:7], s46 offen offset:0 sc1
    buffer_load_dwordx4 a[244:247], v1, s[4:7], s46 offen offset:1024 sc1
    buffer_load_dwordx4 a[248:251], v1, s[4:7], s46 offen offset:2048 sc1
    buffer_load_dwordx4 a[252:255], v1, s[4:7], s46 offen offset:3072 sc1
    s_add_u32 s46, s46, 4096
    buffer_load_dwordx4 v[120:123], v1, s[4:7], s46 offen offset:0 sc1
    buffer_load_dwordx4 v[124:127], v1, s[4:7], s46 offen offset:1024 sc1
    buffer_load_dwordx4 v[128:131], v1, s[4:7], s46 offen offset:2048 sc1
    buffer_load_dwordx4 v[132:135], v1, s[4:7], s46 offen offset:3072 sc1
    s_add_u32 s46, s46, 4096
    buffer_load_dwordx4 v[136:139], v1, s[4:7], s46 offen offset:0 sc1
    buffer_load_dwordx4 v[140:143], v1, s[4:7], s46 offen offset:1024 sc1
    buffer_load_dwordx4 v[144:147], v1, s[4:7], s46 offen offset:2048 sc1
    buffer_load_dwordx4 v[148:151], v1, s[4:7], s46 offen offset:3072 sc1
    s_add_u32 s46, s46, 4096
    buffer_load_dwordx4 v[152:155], v1, s[4:7], s46 offen offset:0 sc1
    buffer_load_dwordx4 v[156:159], v1, s[4:7], s46 offen offset:1024 sc1
    buffer_load_dwordx4 v[160:163], v1, s[4:7], s46 offen offset:2048 sc1
    buffer_load_dwordx4 v[164:167], v1, s[4:7], s46 offen offset:3072 sc1
    s_add_u32 s46, s46, 4096
    buffer_load_dwordx4 v[168:171], v1, s[4:7], s46 offen offset:0 sc1
    buffer_load_dwordx4 v[172:175], v1, s[4:7], s46 offen offset:1024 sc1
    buffer_load_dwordx4 v[176:179], v1, s[4:7], s46 offen offset:2048 sc1
    buffer_load_dwordx4 v[180:183], v1, s[4:7], s46 offen offset:3072 sc1
    s_add_u32 s46, s46, 4096
    buffer_load_dwordx4 v[184:187], v1, s[4:7], s46 offen offset:0 sc1
    buffer_load_dwordx4 v[188:191], v1, s[4:7], s46 offen offset:1024 sc1
    buffer_load_dwordx4 v[192:195], v1, s[4:7], s46 offen offset:2048 sc1
    buffer_load_dwordx4 v[196:199], v1, s[4:7], s46 offen offset:3072 sc1
    s_add_u32 s46, s46, 4096
    buffer_load_dwordx4 v[200:203], v1, s[4:7], s46 offen offset:0 sc1
    buffer_load_dwordx4 v[204:207], v1, s[4:7], s46 offen offset:1024 sc1
    buffer_load_dwordx4 v[208:211], v1, s[4:7], s46 offen offset:2048 sc1
    buffer_load_dwordx4 v[212:215], v1, s[4:7], s46 offen offset:3072 sc1
    s_add_u32 s46, s46, 4096
    buffer_load_dwordx4 v[216:219], v1, s[4:7], s46 offen offset:0 sc1
    buffer_load_dwordx4 v[220:223], v1, s[4:7], s46 offen offset:1024 sc1
    buffer_load_dwordx4 v[224:227], v1, s[4:7], s46 offen offset:2048 sc1
    buffer_load_dwordx4 v[228:231], v1, s[4:7], s46 offen offset:3072 sc1
    s_add_u32 s46, s46, 4096
    buffer_load_dwordx4 v[232:235], v1, s[4:7], s46 offen offset:0 sc1
    buffer_load_dwordx4 v[236:239], v1, s[4:7], s46 offen offset:1024 sc1
    buffer_load_dwordx4 v[240:243], v1, s[4:7], s46 offen offset:2048 sc1
    buffer_load_dwordx4 v[244:247], v1, s[4:7], s46 offen offset:3072 sc1
    s_add_u32 s46, s46, 4096
    buffer_load_dwordx4 v[248:251], v1, s[4:7], s46 offen offset:0 sc1
    buffer_load_dwordx4 v[252:255], v1, s[4:7], s46 offen offset:1024 sc1
    s_mul_i32 s61, s60, 14
    v_min_u32 v4, 13, v2
    v_add_u32 v4, s61, v4
    v_lshrrev_b32 v5, 4, v4
    v_mul_u32_u24 v5, 14336, v5
    v_and_b32 v6, 15, v4
    v_lshl_add_u32 v5, v6, 4, v5
    v_lshl_add_u32 v5, v3, 8, v5
    v_mov_b64 v[8:9], 0
    v_mov_b64 v[10:11], 0
    s_lshl_b32 s46, s3, 12
    v_add_u32 v7, s46, v1
    ds_write_b128 v7, v[8:11] offset:0
    ds_write_b128 v7, v[8:11] offset:1024
    ds_write_b128 v7, v[8:11] offset:2048
    ds_write_b128 v7, v[8:11] offset:3072
    s_nop 0
    v_mov_b32 v7, 36608
    ds_write_b32 v7, v8
    v_lshrrev_b32 v12, 5, v4
    v_lshlrev_b32 v12, 7, v12
    s_mov_b32 s49, 97714176
    s_lshr_b32 s50, s61, 5
    s_min_u32 s50, s50, 61
    s_waitcnt vmcnt(0)
    s_cmp_lg_u32 s3, 0
    s_cbranch_scc1 Lwo_main_kernel_219
    s_mov_b32 s47, 2097152
    s_mov_b32 s46, 97768448
Lwf_main_kernel_220:
    v_mov_b32 v13, 0
    buffer_load_dword v13, v13, s[12:15], s46 offen sc1
    s_sub_u32 s47, s47, 1
    s_cbranch_scc1 Lexit_main_kernel
    s_waitcnt vmcnt(0)
    v_cmp_gt_i32 vcc, s50, v13
    s_cbranch_vccz Lwn_main_kernel_221
    s_sleep 48
    s_branch Lwf_main_kernel_220
Lwn_main_kernel_221:
Lwc_main_kernel_218:
    buffer_load_dword v13, v12, s[12:15], s49 offen sc1
    s_sub_u32 s47, s47, 1
    s_cbranch_scc1 Lexit_main_kernel
    s_waitcnt vmcnt(0)
    v_cmp_ne_u32 vcc, 4, v13
    s_cbranch_vccz Lwo_main_kernel_219
    s_sleep 1
    s_branch Lwc_main_kernel_218
Lwo_main_kernel_219:
    s_barrier
    s_mov_b32 s48, 17432576
    s_mov_b32 s70, 2097152
    s_waitcnt lgkmcnt(0)
    s_barrier
    s_mul_i32 s63, s3, 112
    v_lshlrev_b32 v6, 2, v3
    v_add_u32 v6, s63, v6
    v_lshlrev_b32 v7, 10, v2
    v_add_u32 v8, 0, v6
    v_mul_u32_u24 v9, 2341, v8
    v_lshrrev_b32 v9, 16, v9
    v_lshl_add_u32 v8, v8, 1, v7
    v_lshl_add_u32 v100, v9, 3, v8
    v_add_u32 v8, 16, v6
    v_mul_u32_u24 v9, 2341, v8
    v_lshrrev_b32 v9, 16, v9
    v_lshl_add_u32 v8, v8, 1, v7
    v_lshl_add_u32 v101, v9, 3, v8
    v_add_u32 v8, 32, v6
    v_mul_u32_u24 v9, 2341, v8
    v_lshrrev_b32 v9, 16, v9
    v_lshl_add_u32 v8, v8, 1, v7
    v_lshl_add_u32 v102, v9, 3, v8
    v_add_u32 v8, 48, v6
    v_mul_u32_u24 v9, 2341, v8
    v_lshrrev_b32 v9, 16, v9
    v_lshl_add_u32 v8, v8, 1, v7
    v_lshl_add_u32 v103, v9, 3, v8
    v_add_u32 v8, 64, v6
    v_mul_u32_u24 v9, 2341, v8
    v_lshrrev_b32 v9, 16, v9
    v_lshl_add_u32 v8, v8, 1, v7
    v_lshl_add_u32 v104, v9, 3, v8
    v_add_u32 v8, 80, v6
    v_mul_u32_u24 v9, 2341, v8
    v_lshrrev_b32 v9, 16, v9
    v_lshl_add_u32 v8, v8, 1, v7
    v_lshl_add_u32 v105, v9, 3, v8
    v_add_u32 v8, 96, v6
    v_mul_u32_u24 v9, 2341, v8
    v_lshrrev_b32 v9, 16, v9
    v_lshl_add_u32 v8, v8, 1, v7
    v_lshl_add_u32 v106, v9, 3, v8
    s_mov_b32 s64, 0x3e8b97f6
Lx_main_kernel_222:
    buffer_load_dwordx4 v[16:19], v5, s[12:15], s48 offen offset:0 sc1
    buffer_load_dwordx4 v[20:23], v5, s[12:15], s48 offen offset:1024 sc1
    buffer_load_dwordx4 v[24:27], v5, s[12:15], s48 offen offset:2048 sc1
    buffer_load_dwordx4 v[28:31], v5, s[12:15], s48 offen offset:3072 sc1
    s_add_u32 s47, s48, 4096
    buffer_load_dwordx4 v[32:35], v5, s[12:15], s47 offen offset:0 sc1
    buffer_load_dwordx4 v[36:39], v5, s[12:15], s47 offen offset:1024 sc1
    buffer_load_dwordx4 v[40:43], v5, s[12:15], s47 offen offset:2048 sc1
    buffer_load_dwordx4 v[44:47], v5, s[12:15], s47 offen offset:3072 sc1
    s_add_u32 s47, s47, 4096
    buffer_load_dwordx4 v[48:51], v5, s[12:15], s47 offen offset:0 sc1
    buffer_load_dwordx4 v[52:55], v5, s[12:15], s47 offen offset:1024 sc1
    buffer_load_dwordx4 v[56:59], v5, s[12:15], s47 offen offset:2048 sc1
    buffer_load_dwordx4 v[60:63], v5, s[12:15], s47 offen offset:3072 sc1
    s_add_u32 s47, s47, 4096
    buffer_load_dwordx4 v[64:67], v5, s[12:15], s47 offen offset:0 sc1
    buffer_load_dwordx4 v[68:71], v5, s[12:15], s47 offen offset:1024 sc1
    s_waitcnt vmcnt(13)
    v_mfma_f32_16x16x32_bf16 v[72:75], a[0:3], v[16:19], 0
    v_mfma_f32_16x16x32_bf16 v[76:79], a[56:59], v[16:19], 0
    v_mfma_f32_16x16x32_bf16 v[80:83], a[112:115], v[16:19], 0
    v_mfma_f32_16x16x32_bf16 v[84:87], a[168:171], v[16:19], 0
    v_mfma_f32_16x16x32_bf16 v[88:91], a[224:227], v[16:19], 0
    v_mfma_f32_16x16x32_bf16 v[92:95], v[144:147], v[16:19], 0
    v_mfma_f32_16x16x32_bf16 v[96:99], v[200:203], v[16:19], 0
    s_waitcnt vmcnt(12)
    v_mfma_f32_16x16x32_bf16 v[72:75], a[4:7], v[20:23], v[72:75]
    v_mfma_f32_16x16x32_bf16 v[76:79], a[60:63], v[20:23], v[76:79]
    v_mfma_f32_16x16x32_bf16 v[80:83], a[116:119], v[20:23], v[80:83]
    v_mfma_f32_16x16x32_bf16 v[84:87], a[172:175], v[20:23], v[84:87]
    v_mfma_f32_16x16x32_bf16 v[88:91], a[228:231], v[20:23], v[88:91]
    v_mfma_f32_16x16x32_bf16 v[92:95], v[148:151], v[20:23], v[92:95]
    v_mfma_f32_16x16x32_bf16 v[96:99], v[204:207], v[20:23], v[96:99]
    s_waitcnt vmcnt(11)
    v_mfma_f32_16x16x32_bf16 v[72:75], a[8:11], v[24:27], v[72:75]
    v_mfma_f32_16x16x32_bf16 v[76:79], a[64:67], v[24:27], v[76:79]
    v_mfma_f32_16x16x32_bf16 v[80:83], a[120:123], v[24:27], v[80:83]
    v_mfma_f32_16x16x32_bf16 v[84:87], a[176:179], v[24:27], v[84:87]
    v_mfma_f32_16x16x32_bf16 v[88:91], a[232:235], v[24:27], v[88:91]
    v_mfma_f32_16x16x32_bf16 v[92:95], v[152:155], v[24:27], v[92:95]
    v_mfma_f32_16x16x32_bf16 v[96:99], v[208:211], v[24:27], v[96:99]
    s_waitcnt vmcnt(10)
    v_mfma_f32_16x16x32_bf16 v[72:75], a[12:15], v[28:31], v[72:75]
    v_mfma_f32_16x16x32_bf16 v[76:79], a[68:71], v[28:31], v[76:79]
    v_mfma_f32_16x16x32_bf16 v[80:83], a[124:127], v[28:31], v[80:83]
    v_mfma_f32_16x16x32_bf16 v[84:87], a[180:183], v[28:31], v[84:87]
    v_mfma_f32_16x16x32_bf16 v[88:91], a[236:239], v[28:31], v[88:91]
    v_mfma_f32_16x16x32_bf16 v[92:95], v[156:159], v[28:31], v[92:95]
    v_mfma_f32_16x16x32_bf16 v[96:99], v[212:215], v[28:31], v[96:99]
    s_waitcnt vmcnt(9)
    v_mfma_f32_16x16x32_bf16 v[72:75], a[16:19], v[32:35], v[72:75]
    v_mfma_f32_16x16x32_bf16 v[76:79], a[72:75], v[32:35], v[76:79]
    v_mfma_f32_16x16x32_bf16 v[80:83], a[128:131], v[32:35], v[80:83]
    v_mfma_f32_16x16x32_bf16 v[84:87], a[184:187], v[32:35], v[84:87]
    v_mfma_f32_16x16x32_bf16 v[88:91], a[240:243], v[32:35], v[88:91]
    v_mfma_f32_16x16x32_bf16 v[92:95], v[160:163], v[32:35], v[92:95]
    v_mfma_f32_16x16x32_bf16 v[96:99], v[216:219], v[32:35], v[96:99]
    s_waitcnt vmcnt(8)
    v_mfma_f32_16x16x32_bf16 v[72:75], a[20:23], v[36:39], v[72:75]
    v_mfma_f32_16x16x32_bf16 v[76:79], a[76:79], v[36:39], v[76:79]
    v_mfma_f32_16x16x32_bf16 v[80:83], a[132:135], v[36:39], v[80:83]
    v_mfma_f32_16x16x32_bf16 v[84:87], a[188:191], v[36:39], v[84:87]
    v_mfma_f32_16x16x32_bf16 v[88:91], a[244:247], v[36:39], v[88:91]
    v_mfma_f32_16x16x32_bf16 v[92:95], v[164:167], v[36:39], v[92:95]
    v_mfma_f32_16x16x32_bf16 v[96:99], v[220:223], v[36:39], v[96:99]
    s_waitcnt vmcnt(7)
    v_mfma_f32_16x16x32_bf16 v[72:75], a[24:27], v[40:43], v[72:75]
    v_mfma_f32_16x16x32_bf16 v[76:79], a[80:83], v[40:43], v[76:79]
    v_mfma_f32_16x16x32_bf16 v[80:83], a[136:139], v[40:43], v[80:83]
    v_mfma_f32_16x16x32_bf16 v[84:87], a[192:195], v[40:43], v[84:87]
    v_mfma_f32_16x16x32_bf16 v[88:91], a[248:251], v[40:43], v[88:91]
    v_mfma_f32_16x16x32_bf16 v[92:95], v[168:171], v[40:43], v[92:95]
    v_mfma_f32_16x16x32_bf16 v[96:99], v[224:227], v[40:43], v[96:99]
    s_waitcnt vmcnt(6)
    v_mfma_f32_16x16x32_bf16 v[72:75], a[28:31], v[44:47], v[72:75]
    v_mfma_f32_16x16x32_bf16 v[76:79], a[84:87], v[44:47], v[76:79]
    v_mfma_f32_16x16x32_bf16 v[80:83], a[140:143], v[44:47], v[80:83]
    v_mfma_f32_16x16x32_bf16 v[84:87], a[196:199], v[44:47], v[84:87]
    v_mfma_f32_16x16x32_bf16 v[88:91], a[252:255], v[44:47], v[88:91]
    v_mfma_f32_16x16x32_bf16 v[92:95], v[172:175], v[44:47], v[92:95]
    v_mfma_f32_16x16x32_bf16 v[96:99], v[228:231], v[44:47], v[96:99]
    s_waitcnt vmcnt(5)
    v_mfma_f32_16x16x32_bf16 v[72:75], a[32:35], v[48:51], v[72:75]
    v_mfma_f32_16x16x32_bf16 v[76:79], a[88:91], v[48:51], v[76:79]
    v_mfma_f32_16x16x32_bf16 v[80:83], a[144:147], v[48:51], v[80:83]
    v_mfma_f32_16x16x32_bf16 v[84:87], a[200:203], v[48:51], v[84:87]
    v_mfma_f32_16x16x32_bf16 v[88:91], v[120:123], v[48:51], v[88:91]
    v_mfma_f32_16x16x32_bf16 v[92:95], v[176:179], v[48:51], v[92:95]
    v_mfma_f32_16x16x32_bf16 v[96:99], v[232:235], v[48:51], v[96:99]
    s_waitcnt vmcnt(4)
    v_mfma_f32_16x16x32_bf16 v[72:75], a[36:39], v[52:55], v[72:75]
    v_mfma_f32_16x16x32_bf16 v[76:79], a[92:95], v[52:55], v[76:79]
    v_mfma_f32_16x16x32_bf16 v[80:83], a[148:151], v[52:55], v[80:83]
    v_mfma_f32_16x16x32_bf16 v[84:87], a[204:207], v[52:55], v[84:87]
    v_mfma_f32_16x16x32_bf16 v[88:91], v[124:127], v[52:55], v[88:91]
    v_mfma_f32_16x16x32_bf16 v[92:95], v[180:183], v[52:55], v[92:95]
    v_mfma_f32_16x16x32_bf16 v[96:99], v[236:239], v[52:55], v[96:99]
    s_waitcnt vmcnt(3)
    v_mfma_f32_16x16x32_bf16 v[72:75], a[40:43], v[56:59], v[72:75]
    v_mfma_f32_16x16x32_bf16 v[76:79], a[96:99], v[56:59], v[76:79]
    v_mfma_f32_16x16x32_bf16 v[80:83], a[152:155], v[56:59], v[80:83]
    v_mfma_f32_16x16x32_bf16 v[84:87], a[208:211], v[56:59], v[84:87]
    v_mfma_f32_16x16x32_bf16 v[88:91], v[128:131], v[56:59], v[88:91]
    v_mfma_f32_16x16x32_bf16 v[92:95], v[184:187], v[56:59], v[92:95]
    v_mfma_f32_16x16x32_bf16 v[96:99], v[240:243], v[56:59], v[96:99]
    s_waitcnt vmcnt(2)
    v_mfma_f32_16x16x32_bf16 v[72:75], a[44:47], v[60:63], v[72:75]
    v_mfma_f32_16x16x32_bf16 v[76:79], a[100:103], v[60:63], v[76:79]
    v_mfma_f32_16x16x32_bf16 v[80:83], a[156:159], v[60:63], v[80:83]
    v_mfma_f32_16x16x32_bf16 v[84:87], a[212:215], v[60:63], v[84:87]
    v_mfma_f32_16x16x32_bf16 v[88:91], v[132:135], v[60:63], v[88:91]
    v_mfma_f32_16x16x32_bf16 v[92:95], v[188:191], v[60:63], v[92:95]
    v_mfma_f32_16x16x32_bf16 v[96:99], v[244:247], v[60:63], v[96:99]
    s_waitcnt vmcnt(1)
    v_mfma_f32_16x16x32_bf16 v[72:75], a[48:51], v[64:67], v[72:75]
    v_mfma_f32_16x16x32_bf16 v[76:79], a[104:107], v[64:67], v[76:79]
    v_mfma_f32_16x16x32_bf16 v[80:83], a[160:163], v[64:67], v[80:83]
    v_mfma_f32_16x16x32_bf16 v[84:87], a[216:219], v[64:67], v[84:87]
    v_mfma_f32_16x16x32_bf16 v[88:91], v[136:139], v[64:67], v[88:91]
    v_mfma_f32_16x16x32_bf16 v[92:95], v[192:195], v[64:67], v[92:95]
    v_mfma_f32_16x16x32_bf16 v[96:99], v[248:251], v[64:67], v[96:99]
    s_waitcnt vmcnt(0)
    v_mfma_f32_16x16x32_bf16 v[72:75], a[52:55], v[68:71], v[72:75]
    v_mfma_f32_16x16x32_bf16 v[76:79], a[108:111], v[68:71], v[76:79]
    v_mfma_f32_16x16x32_bf16 v[80:83], a[164:167], v[68:71], v[80:83]
    v_mfma_f32_16x16x32_bf16 v[84:87], a[220:223], v[68:71], v[84:87]
    v_mfma_f32_16x16x32_bf16 v[88:91], v[140:143], v[68:71], v[88:91]
    v_mfma_f32_16x16x32_bf16 v[92:95], v[196:199], v[68:71], v[92:95]
    v_mfma_f32_16x16x32_bf16 v[96:99], v[252:255], v[68:71], v[96:99]
    s_lshl_b32 s65, s3, 11
    s_add_u32 s66, s65, 88879104
    s_add_u32 s65, s65, 88743936
    s_mov_b32 s67, s65
    s_mov_b32 s68, s66
    s_mov_b32 s78, 0
    s_mov_b32 s96, 0
    s_mov_b32 s98, s3
    v_mul_f32 v72, s64, v72
    v_mul_f32 v73, s64, v73
    v_mul_f32 v74, s64, v74
    v_mul_f32 v75, s64, v75
    v_cvt_pk_bf16_f32 v72, v72, v73
    v_cvt_pk_bf16_f32 v73, v74, v75
    ds_write_b64 v100, v[72:73] offset:0
    v_mul_f32 v76, s64, v76
    v_mul_f32 v77, s64, v77
    v_mul_f32 v78, s64, v78
    v_mul_f32 v79, s64, v79
    v_cvt_pk_bf16_f32 v76, v76, v77
    v_cvt_pk_bf16_f32 v77, v78, v79
    ds_write_b64 v101, v[76:77] offset:0
    v_mul_f32 v80, s64, v80
    v_mul_f32 v81, s64, v81
    v_mul_f32 v82, s64, v82
    v_mul_f32 v83, s64, v83
    v_cvt_pk_bf16_f32 v80, v80, v81
    v_cvt_pk_bf16_f32 v81, v82, v83
    ds_write_b64 v102, v[80:81] offset:0
    v_mul_f32 v84, s64, v84
    v_mul_f32 v85, s64, v85
    v_mul_f32 v86, s64, v86
    v_mul_f32 v87, s64, v87
    v_cvt_pk_bf16_f32 v84, v84, v85
    v_cvt_pk_bf16_f32 v85, v86, v87
    ds_write_b64 v103, v[84:85] offset:0
    v_mul_f32 v88, s64, v88
    v_mul_f32 v89, s64, v89
    v_mul_f32 v90, s64, v90
    v_mul_f32 v91, s64, v91
    v_cvt_pk_bf16_f32 v88, v88, v89
    v_cvt_pk_bf16_f32 v89, v90, v91
    ds_write_b64 v104, v[88:89] offset:0
    v_mul_f32 v92, s64, v92
    v_mul_f32 v93, s64, v93
    v_mul_f32 v94, s64, v94
    v_mul_f32 v95, s64, v95
    v_cvt_pk_bf16_f32 v92, v92, v93
    v_cvt_pk_bf16_f32 v93, v94, v95
    ds_write_b64 v105, v[92:93] offset:0
    v_mul_f32 v96, s64, v96
    v_mul_f32 v97, s64, v97
    v_mul_f32 v98, s64, v98
    v_mul_f32 v99, s64, v99
    v_cvt_pk_bf16_f32 v96, v96, v97
    v_cvt_pk_bf16_f32 v97, v98, v99
    ds_write_b64 v106, v[96:97] offset:0
    s_lshl_b32 s69, s3, 2
    s_cmp_eq_u32 s3, 3
    s_cselect_b32 s69, 11, s69
    s_mul_i32 s62, s69, 28672
    s_add_u32 s62, s62, 13246464
    s_add_u32 s46, s62, 0
    buffer_load_dwordx4 a[0:3], v1, s[4:7], s46 offen offset:0 sc1
    buffer_load_dwordx4 a[4:7], v1, s[4:7], s46 offen offset:1024 sc1
    buffer_load_dwordx4 a[8:11], v1, s[4:7], s46 offen offset:2048 sc1
    buffer_load_dwordx4 a[12:15], v1, s[4:7], s46 offen offset:3072 sc1
    s_add_u32 s46, s62, 4096
    buffer_load_dwordx4 a[16:19], v1, s[4:7], s46 offen offset:0 sc1
    buffer_load_dwordx4 a[20:23], v1, s[4:7], s46 offen offset:1024 sc1
    buffer_load_dwordx4 a[24:27], v1, s[4:7], s46 offen offset:2048 sc1
    buffer_load_dwordx4 a[28:31], v1, s[4:7], s46 offen offset:3072 sc1
    s_add_u32 s46, s62, 8192
    buffer_load_dwordx4 a[32:35], v1, s[4:7], s46 offen offset:0 sc1
    buffer_load_dwordx4 a[36:39], v1, s[4:7], s46 offen offset:1024 sc1
    buffer_load_dwordx4 a[40:43], v1, s[4:7], s46 offen offset:2048 sc1
    buffer_load_dwordx4 a[44:47], v1, s[4:7], s46 offen offset:3072 sc1
    s_add_u32 s46, s62, 12288
    buffer_load_dwordx4 a[48:51], v1, s[4:7], s46 offen offset:0 sc1
    buffer_load_dwordx4 a[52:55], v1, s[4:7], s46 offen offset:1024 sc1
    buffer_load_dwordx4 a[56:59], v1, s[4:7], s46 offen offset:2048 sc1
    buffer_load_dwordx4 a[60:63], v1, s[4:7], s46 offen offset:3072 sc1
    s_add_u32 s46, s62, 16384
    buffer_load_dwordx4 a[64:67], v1, s[4:7], s46 offen offset:0 sc1
    buffer_load_dwordx4 a[68:71], v1, s[4:7], s46 offen offset:1024 sc1
    buffer_load_dwordx4 a[72:75], v1, s[4:7], s46 offen offset:2048 sc1
    buffer_load_dwordx4 a[76:79], v1, s[4:7], s46 offen offset:3072 sc1
    s_add_u32 s46, s62, 20480
    buffer_load_dwordx4 a[80:83], v1, s[4:7], s46 offen offset:0 sc1
    buffer_load_dwordx4 a[84:87], v1, s[4:7], s46 offen offset:1024 sc1
    buffer_load_dwordx4 a[88:91], v1, s[4:7], s46 offen offset:2048 sc1
    buffer_load_dwordx4 a[92:95], v1, s[4:7], s46 offen offset:3072 sc1
    s_add_u32 s46, s62, 24576
    buffer_load_dwordx4 a[96:99], v1, s[4:7], s46 offen offset:0 sc1
    buffer_load_dwordx4 a[100:103], v1, s[4:7], s46 offen offset:1024 sc1
    buffer_load_dwordx4 a[104:107], v1, s[4:7], s46 offen offset:2048 sc1
    buffer_load_dwordx4 a[108:111], v1, s[4:7], s46 offen offset:3072 sc1
    s_add_u32 s46, s62, 28672
    buffer_load_dwordx4 a[112:115], v1, s[4:7], s46 offen offset:0 sc1
    buffer_load_dwordx4 a[116:119], v1, s[4:7], s46 offen offset:1024 sc1
    buffer_load_dwordx4 a[120:123], v1, s[4:7], s46 offen offset:2048 sc1
    buffer_load_dwordx4 a[124:127], v1, s[4:7], s46 offen offset:3072 sc1
    s_add_u32 s46, s62, 32768
    buffer_load_dwordx4 a[128:131], v1, s[4:7], s46 offen offset:0 sc1
    buffer_load_dwordx4 a[132:135], v1, s[4:7], s46 offen offset:1024 sc1
    buffer_load_dwordx4 a[136:139], v1, s[4:7], s46 offen offset:2048 sc1
    buffer_load_dwordx4 a[140:143], v1, s[4:7], s46 offen offset:3072 sc1
    s_add_u32 s46, s62, 36864
    buffer_load_dwordx4 a[144:147], v1, s[4:7], s46 offen offset:0 sc1
    buffer_load_dwordx4 a[148:151], v1, s[4:7], s46 offen offset:1024 sc1
    buffer_load_dwordx4 a[152:155], v1, s[4:7], s46 offen offset:2048 sc1
    buffer_load_dwordx4 a[156:159], v1, s[4:7], s46 offen offset:3072 sc1
    s_add_u32 s46, s62, 40960
    buffer_load_dwordx4 a[160:163], v1, s[4:7], s46 offen offset:0 sc1
    buffer_load_dwordx4 a[164:167], v1, s[4:7], s46 offen offset:1024 sc1
    buffer_load_dwordx4 a[168:171], v1, s[4:7], s46 offen offset:2048 sc1
    buffer_load_dwordx4 a[172:175], v1, s[4:7], s46 offen offset:3072 sc1
    s_add_u32 s46, s62, 45056
    buffer_load_dwordx4 a[176:179], v1, s[4:7], s46 offen offset:0 sc1
    buffer_load_dwordx4 a[180:183], v1, s[4:7], s46 offen offset:1024 sc1
    buffer_load_dwordx4 a[184:187], v1, s[4:7], s46 offen offset:2048 sc1
    buffer_load_dwordx4 a[188:191], v1, s[4:7], s46 offen offset:3072 sc1
    s_add_u32 s46, s62, 49152
    buffer_load_dwordx4 a[192:195], v1, s[4:7], s46 offen offset:0 sc1
    buffer_load_dwordx4 a[196:199], v1, s[4:7], s46 offen offset:1024 sc1
    buffer_load_dwordx4 a[200:203], v1, s[4:7], s46 offen offset:2048 sc1
    buffer_load_dwordx4 a[204:207], v1, s[4:7], s46 offen offset:3072 sc1
    s_add_u32 s46, s62, 53248
    buffer_load_dwordx4 a[208:211], v1, s[4:7], s46 offen offset:0 sc1
    buffer_load_dwordx4 a[212:215], v1, s[4:7], s46 offen offset:1024 sc1
    buffer_load_dwordx4 a[216:219], v1, s[4:7], s46 offen offset:2048 sc1
    buffer_load_dwordx4 a[220:223], v1, s[4:7], s46 offen offset:3072 sc1
    s_add_u32 s46, s62, 57344
    buffer_load_dwordx4 a[224:227], v1, s[4:7], s46 offen offset:0 sc1
    buffer_load_dwordx4 a[228:231], v1, s[4:7], s46 offen offset:1024 sc1
    buffer_load_dwordx4 a[232:235], v1, s[4:7], s46 offen offset:2048 sc1
    buffer_load_dwordx4 a[236:239], v1, s[4:7], s46 offen offset:3072 sc1
    s_add_u32 s46, s62, 61440
    buffer_load_dwordx4 a[240:243], v1, s[4:7], s46 offen offset:0 sc1
    buffer_load_dwordx4 a[244:247], v1, s[4:7], s46 offen offset:1024 sc1
    buffer_load_dwordx4 a[248:251], v1, s[4:7], s46 offen offset:2048 sc1
    buffer_load_dwordx4 a[252:255], v1, s[4:7], s46 offen offset:3072 sc1
    s_waitcnt lgkmcnt(0)
    s_barrier
    v_bfe_u32 v6, v0, 4, 1
    v_lshlrev_b32 v6, 10, v6
    v_lshl_add_u32 v6, v2, 6, v6
    v_lshrrev_b32 v7, 5, v0
    v_lshl_add_u32 v6, v7, 4, v6
    ds_read_b128 v[16:19], v6 offset:0
    ds_read_b128 v[20:23], v6 offset:32
    ds_read_b128 v[24:27], v6 offset:2048
    ds_read_b128 v[28:31], v6 offset:2080
    ds_read_b128 v[32:35], v6 offset:4096
    ds_read_b128 v[36:39], v6 offset:4128
    ds_read_b128 v[40:43], v6 offset:6144
    ds_read_b128 v[44:47], v6 offset:6176
    ds_read_b128 v[48:51], v6 offset:8192
    ds_read_b128 v[52:55], v6 offset:8224
    ds_read_b128 v[56:59], v6 offset:10240
    ds_read_b128 v[60:63], v6 offset:10272
    ds_read_b128 v[64:67], v6 offset:12288
    ds_read_b128 v[68:71], v6 offset:12320
    v_mov_b64 v[144:145], 0
    v_mov_b64 v[146:147], 0
    v_mov_b64 v[148:149], 0
    v_mov_b64 v[150:151], 0
    v_mov_b64 v[152:153], 0
    v_mov_b64 v[154:155], 0
    v_mov_b64 v[156:157], 0
    v_mov_b64 v[158:159], 0
    v_mov_b64 v[160:161], 0
    v_mov_b64 v[162:163], 0
    v_mov_b64 v[164:165], 0
    v_mov_b64 v[166:167], 0
    v_mov_b64 v[168:169], 0
    v_mov_b64 v[170:171], 0
    v_mov_b64 v[172:173], 0
    v_mov_b64 v[174:175], 0
    v_mov_b64 v[176:177], 0
    v_mov_b64 v[178:179], 0
    v_mov_b64 v[180:181], 0
    v_mov_b64 v[182:183], 0
    v_mov_b64 v[184:185], 0
    v_mov_b64 v[186:187], 0
    v_mov_b64 v[188:189], 0
    v_mov_b64 v[190:191], 0
    v_mov_b64 v[192:193], 0
    v_mov_b64 v[194:195], 0
    v_mov_b64 v[196:197], 0
    v_mov_b64 v[198:199], 0
    v_mov_b64 v[200:201], 0
    v_mov_b64 v[202:203], 0
    v_mov_b64 v[204:205], 0
    v_mov_b64 v[206:207], 0
    v_mov_b64 v[208:209], 0
    v_mov_b64 v[210:211], 0
    v_mov_b64 v[212:213], 0
    v_mov_b64 v[214:215], 0
    v_mov_b64 v[216:217], 0
    v_mov_b64 v[218:219], 0
    v_mov_b64 v[220:221], 0
    v_mov_b64 v[222:223], 0
    v_mov_b64 v[224:225], 0
    v_mov_b64 v[226:227], 0
    v_mov_b64 v[228:229], 0
    v_mov_b64 v[230:231], 0
    v_mov_b64 v[232:233], 0
    v_mov_b64 v[234:235], 0
    v_mov_b64 v[236:237], 0
    v_mov_b64 v[238:239], 0
    v_mov_b64 v[240:241], 0
    v_mov_b64 v[242:243], 0
    v_mov_b64 v[244:245], 0
    v_mov_b64 v[246:247], 0
    v_mov_b64 v[248:249], 0
    v_mov_b64 v[250:251], 0
    v_mov_b64 v[252:253], 0
    v_mov_b64 v[254:255], 0
    s_cmp_lt_u32 s98, s96
    s_cbranch_scc1 Lgo_main_kernel_223
    s_mov_b32 s70, 2097152
    v_lshlrev_b32 v8, 3, v1
    v_and_b32 v8, 0x780, v8
Lgl_main_kernel_224:
    s_min_u32 s96, s96, 48
    s_lshl_b32 s97, s96, 7
    s_add_u32 s97, s97, 97714176
    s_mov_b64 exec, 0xffff
    buffer_load_dword v9, v8, s[12:15], s97 offen sc1
    s_mov_b64 exec, -1
    s_sub_u32 s70, s70, 1
    s_cbranch_scc1 Lexit_main_kernel
    s_waitcnt vmcnt(0)
    v_cmp_ne_u32 vcc, 4, v9
    s_nop 0
    s_or_b32 s97, vcc_lo, 0x10000
    s_ff1_i32_b32 s97, s97
    s_add_u32 s96, s96, s97
    s_cmp_eq_u32 s97, 16
    s_cselect_b32 s97, 1, 0
    s_cmp_ge_u32 s96, 64
    s_cselect_b32 s96, 0x100, s96
    s_cbranch_scc1 Lgo_main_kernel_223
    s_cmp_eq_u32 s97, 1
    s_cbranch_scc1 Lgl_main_kernel_224
    s_cmp_lt_u32 s98, s96
    s_cbranch_scc1 Lgo_main_kernel_223
    s_add_u32 s97, s96, 1
    s_cmp_gt_u32 s98, s97
    s_cbranch_scc1 Lgf_main_kernel_225
    s_sleep 2
    s_branch Lgl_main_kernel_224
Lgf_main_kernel_225:
    s_sleep 40
    s_branch Lgl_main_kernel_224
Lgo_main_kernel_223:
    buffer_load_dwordx4 v[72:75], v1, s[12:15], s67 offen offset:0 sc1
    buffer_load_dwordx4 v[76:79], v1, s[12:15], s67 offen offset:1024 sc1
    buffer_load_dwordx4 v[80:83], v1, s[12:15], s68 offen offset:0 sc1
    buffer_load_dwordx4 v[84:87], v1, s[12:15], s68 offen offset:1024 sc1
    s_add_u32 s67, s67, 8192
    s_add_u32 s68, s68, 8192
    s_add_u32 s98, s98, 4
    s_waitcnt lgkmcnt(0)
LK_main_kernel_226:
    s_cmp_lt_u32 s98, s96
    s_cselect_b32 s79, 1, 0
    s_cmp_lt_u32 s98, 56
    s_cselect_b32 s79, s79, 0
    s_cmp_eq_u32 s79, 0
    s_cbranch_scc1 L_main_kernel_232
    buffer_load_dwordx4 v[88:91], v1, s[12:15], s67 offen offset:0 sc1
    buffer_load_dwordx4 v[92:95], v1, s[12:15], s67 offen offset:1024 sc1
    buffer_load_dwordx4 v[96:99], v1, s[12:15], s68 offen offset:0 sc1
    buffer_load_dwordx4 v[100:103], v1, s[12:15], s68 offen offset:1024 sc1
    s_add_u32 s67, s67, 8192
    s_add_u32 s68, s68, 8192
    s_waitcnt vmcnt(4)
    s_branch L_main_kernel_233
LKd_main_kernel_230:
    s_cmp_lt_u32 s98, s96
    s_cselect_b32 s79, 1, 0
    s_cmp_lt_u32 s98, 56
    s_cselect_b32 s79, s79, 0
    s_cmp_eq_u32 s79, 0
    s_cbranch_scc1 LKw_main_kernel_228
    buffer_load_dwordx4 v[88:91], v1, s[12:15], s67 offen offset:0 sc1
    buffer_load_dwordx4 v[92:95], v1, s[12:15], s67 offen offset:1024 sc1
    buffer_load_dwordx4 v[96:99], v1, s[12:15], s68 offen offset:0 sc1
    buffer_load_dwordx4 v[100:103], v1, s[12:15], s68 offen offset:1024 sc1
    s_add_u32 s67, s67, 8192
    s_add_u32 s68, s68, 8192
    s_branch LKw_main_kernel_228
L_main_kernel_232:
    s_waitcnt vmcnt(0)
L_main_kernel_233:
    v_mfma_f32_32x32x16_bf16 v[104:119], v[72:75], v[16:19], 0
    v_mfma_f32_32x32x16_bf16 v[104:119], v[76:79], v[20:23], v[104:119]
LKw_main_kernel_228:
    v_mfma_f32_32x32x16_bf16 v[120:135], v[72:75], v[24:27], 0
    s_nop 4
    v_exp_f32 v104, v104
    v_exp_f32 v105, v105
    v_exp_f32 v106, v106
    v_exp_f32 v107, v107
    v_exp_f32 v108, v108
    v_exp_f32 v109, v109
    v_exp_f32 v110, v110
    v_exp_f32 v111, v111
    v_mfma_f32_32x32x16_bf16 v[120:135], v[76:79], v[28:31], v[120:135]
    v_cvt_pk_bf16_f32 v136, v104, v105
    v_cvt_pk_bf16_f32 v137, v106, v107
    v_cvt_pk_bf16_f32 v138, v108, v109
    v_cvt_pk_bf16_f32 v139, v110, v111
    v_exp_f32 v112, v112
    v_exp_f32 v113, v113
    v_exp_f32 v114, v114
    v_exp_f32 v115, v115
    v_mfma_f32_32x32x16_bf16 v[144:159], v[80:83], v[136:139], v[144:159]
    v_exp_f32 v116, v116
    v_exp_f32 v117, v117
    v_exp_f32 v118, v118
    v_exp_f32 v119, v119
    v_cvt_pk_bf16_f32 v140, v112, v113
    v_cvt_pk_bf16_f32 v141, v114, v115
    v_cvt_pk_bf16_f32 v142, v116, v117
    v_cvt_pk_bf16_f32 v143, v118, v119
    v_mfma_f32_32x32x16_bf16 v[104:119], v[72:75], v[32:35], 0
    v_exp_f32 v120, v120
    v_exp_f32 v121, v121
    v_exp_f32 v122, v122
    v_exp_f32 v123, v123
    v_mfma_f32_32x32x16_bf16 v[144:159], v[84:87], v[140:143], v[144:159]
    v_exp_f32 v124, v124
    v_exp_f32 v125, v125
    v_exp_f32 v126, v126
    v_exp_f32 v127, v127
    v_mfma_f32_32x32x16_bf16 v[104:119], v[76:79], v[36:39], v[104:119]
    v_cvt_pk_bf16_f32 v136, v120, v121
    v_cvt_pk_bf16_f32 v137, v122, v123
    v_cvt_pk_bf16_f32 v138, v124, v125
    v_cvt_pk_bf16_f32 v139, v126, v127
    v_exp_f32 v128, v128
    v_exp_f32 v129, v129
    v_exp_f32 v130, v130
    v_exp_f32 v131, v131
    v_mfma_f32_32x32x16_bf16 v[160:175], v[80:83], v[136:139], v[160:175]
    v_exp_f32 v132, v132
    v_exp_f32 v133, v133
    v_exp_f32 v134, v134
    v_exp_f32 v135, v135
    v_cvt_pk_bf16_f32 v140, v128, v129
    v_cvt_pk_bf16_f32 v141, v130, v131
    v_cvt_pk_bf16_f32 v142, v132, v133
    v_cvt_pk_bf16_f32 v143, v134, v135
    v_mfma_f32_32x32x16_bf16 v[120:135], v[72:75], v[40:43], 0
    v_exp_f32 v104, v104
    v_exp_f32 v105, v105
    v_exp_f32 v106, v106
    v_exp_f32 v107, v107
    v_mfma_f32_32x32x16_bf16 v[160:175], v[84:87], v[140:143], v[160:175]
    v_exp_f32 v108, v108
    v_exp_f32 v109, v109
    v_exp_f32 v110, v110
    v_exp_f32 v111, v111
    v_mfma_f32_32x32x16_bf16 v[120:135], v[76:79], v[44:47], v[120:135]
    v_cvt_pk_bf16_f32 v136, v104, v105
    v_cvt_pk_bf16_f32 v137, v106, v107
    v_cvt_pk_bf16_f32 v138, v108, v109
    v_cvt_pk_bf16_f32 v139, v110, v111
    v_exp_f32 v112, v112
    v_exp_f32 v113, v113
    v_exp_f32 v114, v114
    v_exp_f32 v115, v115
    v_mfma_f32_32x32x16_bf16 v[176:191], v[80:83], v[136:139], v[176:191]
    v_exp_f32 v116, v116
    v_exp_f32 v117, v117
    v_exp_f32 v118, v118
    v_exp_f32 v119, v119
    v_cvt_pk_bf16_f32 v140, v112, v113
    v_cvt_pk_bf16_f32 v141, v114, v115
    v_cvt_pk_bf16_f32 v142, v116, v117
    v_cvt_pk_bf16_f32 v143, v118, v119
    v_mfma_f32_32x32x16_bf16 v[104:119], v[72:75], v[48:51], 0
    v_exp_f32 v120, v120
    v_exp_f32 v121, v121
    v_exp_f32 v122, v122
    v_exp_f32 v123, v123
    v_mfma_f32_32x32x16_bf16 v[176:191], v[84:87], v[140:143], v[176:191]
    v_exp_f32 v124, v124
    v_exp_f32 v125, v125
    v_exp_f32 v126, v126
    v_exp_f32 v127, v127
    v_mfma_f32_32x32x16_bf16 v[104:119], v[76:79], v[52:55], v[104:119]
    v_cvt_pk_bf16_f32 v136, v120, v121
    v_cvt_pk_bf16_f32 v137, v122, v123
    v_cvt_pk_bf16_f32 v138, v124, v125
    v_cvt_pk_bf16_f32 v139, v126, v127
    v_exp_f32 v128, v128
    v_exp_f32 v129, v129
    v_exp_f32 v130, v130
    v_exp_f32 v131, v131
    v_mfma_f32_32x32x16_bf16 v[192:207], v[80:83], v[136:139], v[192:207]
    v_exp_f32 v132, v132
    v_exp_f32 v133, v133
    v_exp_f32 v134, v134
    v_exp_f32 v135, v135
    v_cvt_pk_bf16_f32 v140, v128, v129
    v_cvt_pk_bf16_f32 v141, v130, v131
    v_cvt_pk_bf16_f32 v142, v132, v133
    v_cvt_pk_bf16_f32 v143, v134, v135
    v_mfma_f32_32x32x16_bf16 v[120:135], v[72:75], v[56:59], 0
    v_exp_f32 v104, v104
    v_exp_f32 v105, v105
    v_exp_f32 v106, v106
    v_exp_f32 v107, v107
    v_mfma_f32_32x32x16_bf16 v[192:207], v[84:87], v[140:143], v[192:207]
    v_exp_f32 v108, v108
    v_exp_f32 v109, v109
    v_exp_f32 v110, v110
    v_exp_f32 v111, v111
    v_mfma_f32_32x32x16_bf16 v[120:135], v[76:79], v[60:63], v[120:135]
    v_cvt_pk_bf16_f32 v136, v104, v105
    v_cvt_pk_bf16_f32 v137, v106, v107
    v_cvt_pk_bf16_f32 v138, v108, v109
    v_cvt_pk_bf16_f32 v139, v110, v111
    v_exp_f32 v112, v112
    v_exp_f32 v113, v113
    v_exp_f32 v114, v114
    v_exp_f32 v115, v115
    v_mfma_f32_32x32x16_bf16 v[208:223], v[80:83], v[136:139], v[208:223]
    v_exp_f32 v116, v116
    v_exp_f32 v117, v117
    v_exp_f32 v118, v118
    v_exp_f32 v119, v119
    v_cvt_pk_bf16_f32 v140, v112, v113
    v_cvt_pk_bf16_f32 v141, v114, v115
    v_cvt_pk_bf16_f32 v142, v116, v117
    v_cvt_pk_bf16_f32 v143, v118, v119
    v_mfma_f32_32x32x16_bf16 v[104:119], v[72:75], v[64:67], 0
    v_exp_f32 v120, v120
    v_exp_f32 v121, v121
    v_exp_f32 v122, v122
    v_exp_f32 v123, v123
    v_mfma_f32_32x32x16_bf16 v[208:223], v[84:87], v[140:143], v[208:223]
    v_exp_f32 v124, v124
    v_exp_f32 v125, v125
    v_exp_f32 v126, v126
    v_exp_f32 v127, v127
    v_mfma_f32_32x32x16_bf16 v[104:119], v[76:79], v[68:71], v[104:119]
    v_cvt_pk_bf16_f32 v136, v120, v121
    v_cvt_pk_bf16_f32 v137, v122, v123
    v_cvt_pk_bf16_f32 v138, v124, v125
    v_cvt_pk_bf16_f32 v139, v126, v127
    v_exp_f32 v128, v128
    v_exp_f32 v129, v129
    v_exp_f32 v130, v130
    v_exp_f32 v131, v131
    v_mfma_f32_32x32x16_bf16 v[224:239], v[80:83], v[136:139], v[224:239]
    v_exp_f32 v132, v132
    v_exp_f32 v133, v133
    v_exp_f32 v134, v134
    v_exp_f32 v135, v135
    v_cvt_pk_bf16_f32 v140, v128, v129
    v_cvt_pk_bf16_f32 v141, v130, v131
    v_cvt_pk_bf16_f32 v142, v132, v133
    v_cvt_pk_bf16_f32 v143, v134, v135
    s_cmp_eq_u32 s79, 0
    s_cbranch_scc1 L_main_kernel_235
    s_waitcnt vmcnt(0)
    v_mfma_f32_32x32x16_bf16 v[120:135], v[88:91], v[16:19], 0
    v_exp_f32 v104, v104
    v_exp_f32 v105, v105
    v_exp_f32 v106, v106
    v_exp_f32 v107, v107
    v_mfma_f32_32x32x16_bf16 v[224:239], v[84:87], v[140:143], v[224:239]
    v_exp_f32 v108, v108
    v_exp_f32 v109, v109
    v_exp_f32 v110, v110
    v_exp_f32 v111, v111
    v_mfma_f32_32x32x16_bf16 v[120:135], v[92:95], v[20:23], v[120:135]
    v_cvt_pk_bf16_f32 v136, v104, v105
    v_cvt_pk_bf16_f32 v137, v106, v107
    v_cvt_pk_bf16_f32 v138, v108, v109
    v_cvt_pk_bf16_f32 v139, v110, v111
    v_exp_f32 v112, v112
    v_exp_f32 v113, v113
    v_exp_f32 v114, v114
    v_exp_f32 v115, v115
    v_mfma_f32_32x32x16_bf16 v[240:255], v[80:83], v[136:139], v[240:255]
    v_exp_f32 v116, v116
    v_exp_f32 v117, v117
    v_exp_f32 v118, v118
    v_exp_f32 v119, v119
    v_cvt_pk_bf16_f32 v140, v112, v113
    v_cvt_pk_bf16_f32 v141, v114, v115
    v_cvt_pk_bf16_f32 v142, v116, v117
    v_cvt_pk_bf16_f32 v143, v118, v119
    s_nop 1
    v_mfma_f32_32x32x16_bf16 v[240:255], v[84:87], v[140:143], v[240:255]
    s_add_u32 s98, s98, 4
    s_branch LKd_main_kernel_231
L_main_kernel_235:
    v_exp_f32 v104, v104
    v_exp_f32 v105, v105
    v_exp_f32 v106, v106
    v_exp_f32 v107, v107
    v_mfma_f32_32x32x16_bf16 v[224:239], v[84:87], v[140:143], v[224:239]
    v_exp_f32 v108, v108
    v_exp_f32 v109, v109
    v_exp_f32 v110, v110
    v_exp_f32 v111, v111
    v_cvt_pk_bf16_f32 v136, v104, v105
    v_cvt_pk_bf16_f32 v137, v106, v107
    v_cvt_pk_bf16_f32 v138, v108, v109
    v_cvt_pk_bf16_f32 v139, v110, v111
    v_exp_f32 v112, v112
    v_exp_f32 v113, v113
    v_exp_f32 v114, v114
    v_exp_f32 v115, v115
    v_mfma_f32_32x32x16_bf16 v[240:255], v[80:83], v[136:139], v[240:255]
    v_exp_f32 v116, v116
    v_exp_f32 v117, v117
    v_exp_f32 v118, v118
    v_exp_f32 v119, v119
    v_cvt_pk_bf16_f32 v140, v112, v113
    v_cvt_pk_bf16_f32 v141, v114, v115
    v_cvt_pk_bf16_f32 v142, v116, v117
    v_cvt_pk_bf16_f32 v143, v118, v119
    s_nop 1
    v_mfma_f32_32x32x16_bf16 v[240:255], v[84:87], v[140:143], v[240:255]
    s_cmp_lt_u32 s98, s96
    s_cbranch_scc1 Lgo_main_kernel_236
    s_mov_b32 s70, 2097152
    v_lshlrev_b32 v8, 3, v1
    v_and_b32 v8, 0x780, v8
Lgl_main_kernel_237:
    s_min_u32 s96, s96, 48
    s_lshl_b32 s97, s96, 7
    s_add_u32 s97, s97, 97714176
    s_mov_b64 exec, 0xffff
    buffer_load_dword v9, v8, s[12:15], s97 offen sc1
    s_mov_b64 exec, -1
    s_sub_u32 s70, s70, 1
    s_cbranch_scc1 Lexit_main_kernel
    s_waitcnt vmcnt(0)
    v_cmp_ne_u32 vcc, 4, v9
    s_nop 0
    s_or_b32 s97, vcc_lo, 0x10000
    s_ff1_i32_b32 s97, s97
    s_add_u32 s96, s96, s97
    s_cmp_eq_u32 s97, 16
    s_cselect_b32 s97, 1, 0
    s_cmp_ge_u32 s96, 64
    s_cselect_b32 s96, 0x100, s96
    s_cbranch_scc1 Lgo_main_kernel_236
    s_cmp_eq_u32 s97, 1
    s_cbranch_scc1 Lgl_main_kernel_237
    s_cmp_lt_u32 s98, s96
    s_cbranch_scc1 Lgo_main_kernel_236
    s_add_u32 s97, s96, 1
    s_cmp_gt_u32 s98, s97
    s_cbranch_scc1 Lgf_main_kernel_238
    s_sleep 2
    s_branch Lgl_main_kernel_237
Lgf_main_kernel_238:
    s_sleep 40
    s_branch Lgl_main_kernel_237
Lgo_main_kernel_236:
    buffer_load_dwordx4 v[88:91], v1, s[12:15], s67 offen offset:0 sc1
    buffer_load_dwordx4 v[92:95], v1, s[12:15], s67 offen offset:1024 sc1
    buffer_load_dwordx4 v[96:99], v1, s[12:15], s68 offen offset:0 sc1
    buffer_load_dwordx4 v[100:103], v1, s[12:15], s68 offen offset:1024 sc1
    s_add_u32 s67, s67, 8192
    s_add_u32 s68, s68, 8192
L_main_kernel_234:
    s_add_u32 s98, s98, 4
    s_cmp_lt_u32 s98, s96
    s_cselect_b32 s79, 1, 0
    s_cmp_lt_u32 s98, 56
    s_cselect_b32 s79, s79, 0
    s_cmp_eq_u32 s79, 0
    s_cbranch_scc1 L_main_kernel_239
    buffer_load_dwordx4 v[72:75], v1, s[12:15], s67 offen offset:0 sc1
    buffer_load_dwordx4 v[76:79], v1, s[12:15], s67 offen offset:1024 sc1
    buffer_load_dwordx4 v[80:83], v1, s[12:15], s68 offen offset:0 sc1
    buffer_load_dwordx4 v[84:87], v1, s[12:15], s68 offen offset:1024 sc1
    s_add_u32 s67, s67, 8192
    s_add_u32 s68, s68, 8192
    s_waitcnt vmcnt(4)
    s_branch L_main_kernel_240
LKd_main_kernel_231:
    s_cmp_lt_u32 s98, s96
    s_cselect_b32 s79, 1, 0
    s_cmp_lt_u32 s98, 56
    s_cselect_b32 s79, s79, 0
    s_cmp_eq_u32 s79, 0
    s_cbranch_scc1 LKw_main_kernel_229
    buffer_load_dwordx4 v[72:75], v1, s[12:15], s67 offen offset:0 sc1
    buffer_load_dwordx4 v[76:79], v1, s[12:15], s67 offen offset:1024 sc1
    buffer_load_dwordx4 v[80:83], v1, s[12:15], s68 offen offset:0 sc1
    buffer_load_dwordx4 v[84:87], v1, s[12:15], s68 offen offset:1024 sc1
    s_add_u32 s67, s67, 8192
    s_add_u32 s68, s68, 8192
    s_branch LKw_main_kernel_229
L_main_kernel_239:
    s_waitcnt vmcnt(0)
L_main_kernel_240:
    v_mfma_f32_32x32x16_bf16 v[120:135], v[88:91], v[16:19], 0
    v_mfma_f32_32x32x16_bf16 v[120:135], v[92:95], v[20:23], v[120:135]
LKw_main_kernel_229:
    v_mfma_f32_32x32x16_bf16 v[104:119], v[88:91], v[24:27], 0
    s_nop 4
    v_exp_f32 v120, v120
    v_exp_f32 v121, v121
    v_exp_f32 v122, v122
    v_exp_f32 v123, v123
    v_exp_f32 v124, v124
    v_exp_f32 v125, v125
    v_exp_f32 v126, v126
    v_exp_f32 v127, v127
    v_mfma_f32_32x32x16_bf16 v[104:119], v[92:95], v[28:31], v[104:119]
    v_cvt_pk_bf16_f32 v136, v120, v121
    v_cvt_pk_bf16_f32 v137, v122, v123
    v_cvt_pk_bf16_f32 v138, v124, v125
    v_cvt_pk_bf16_f32 v139, v126, v127
    v_exp_f32 v128, v128
    v_exp_f32 v129, v129
    v_exp_f32 v130, v130
    v_exp_f32 v131, v131
    v_mfma_f32_32x32x16_bf16 v[144:159], v[96:99], v[136:139], v[144:159]
    v_exp_f32 v132, v132
    v_exp_f32 v133, v133
    v_exp_f32 v134, v134
    v_exp_f32 v135, v135
    v_cvt_pk_bf16_f32 v140, v128, v129
    v_cvt_pk_bf16_f32 v141, v130, v131
    v_cvt_pk_bf16_f32 v142, v132, v133
    v_cvt_pk_bf16_f32 v143, v134, v135
    v_mfma_f32_32x32x16_bf16 v[120:135], v[88:91], v[32:35], 0
    v_exp_f32 v104, v104
    v_exp_f32 v105, v105
    v_exp_f32 v106, v106
    v_exp_f32 v107, v107
    v_mfma_f32_32x32x16_bf16 v[144:159], v[100:103], v[140:143], v[144:159]
    v_exp_f32 v108, v108
    v_exp_f32 v109, v109
    v_exp_f32 v110, v110
    v_exp_f32 v111, v111
    v_mfma_f32_32x32x16_bf16 v[120:135], v[92:95], v[36:39], v[120:135]
    v_cvt_pk_bf16_f32 v136, v104, v105
    v_cvt_pk_bf16_f32 v137, v106, v107
    v_cvt_pk_bf16_f32 v138, v108, v109
    v_cvt_pk_bf16_f32 v139, v110, v111
    v_exp_f32 v112, v112
    v_exp_f32 v113, v113
    v_exp_f32 v114, v114
    v_exp_f32 v115, v115
    v_mfma_f32_32x32x16_bf16 v[160:175], v[96:99], v[136:139], v[160:175]
    v_exp_f32 v116, v116
    v_exp_f32 v117, v117
    v_exp_f32 v118, v118
    v_exp_f32 v119, v119
    v_cvt_pk_bf16_f32 v140, v112, v113
    v_cvt_pk_bf16_f32 v141, v114, v115
    v_cvt_pk_bf16_f32 v142, v116, v117
    v_cvt_pk_bf16_f32 v143, v118, v119
    v_mfma_f32_32x32x16_bf16 v[104:119], v[88:91], v[40:43], 0
    v_exp_f32 v120, v120
    v_exp_f32 v121, v121
    v_exp_f32 v122, v122
    v_exp_f32 v123, v123
    v_mfma_f32_32x32x16_bf16 v[160:175], v[100:103], v[140:143], v[160:175]
    v_exp_f32 v124, v124
    v_exp_f32 v125, v125
    v_exp_f32 v126, v126
    v_exp_f32 v127, v127
    v_mfma_f32_32x32x16_bf16 v[104:119], v[92:95], v[44:47], v[104:119]
    v_cvt_pk_bf16_f32 v136, v120, v121
    v_cvt_pk_bf16_f32 v137, v122, v123
    v_cvt_pk_bf16_f32 v138, v124, v125
    v_cvt_pk_bf16_f32 v139, v126, v127
    v_exp_f32 v128, v128
    v_exp_f32 v129, v129
    v_exp_f32 v130, v130
    v_exp_f32 v131, v131
    v_mfma_f32_32x32x16_bf16 v[176:191], v[96:99], v[136:139], v[176:191]
    v_exp_f32 v132, v132
    v_exp_f32 v133, v133
    v_exp_f32 v134, v134
    v_exp_f32 v135, v135
    v_cvt_pk_bf16_f32 v140, v128, v129
    v_cvt_pk_bf16_f32 v141, v130, v131
    v_cvt_pk_bf16_f32 v142, v132, v133
    v_cvt_pk_bf16_f32 v143, v134, v135
    v_mfma_f32_32x32x16_bf16 v[120:135], v[88:91], v[48:51], 0
    v_exp_f32 v104, v104
    v_exp_f32 v105, v105
    v_exp_f32 v106, v106
    v_exp_f32 v107, v107
    v_mfma_f32_32x32x16_bf16 v[176:191], v[100:103], v[140:143], v[176:191]
    v_exp_f32 v108, v108
    v_exp_f32 v109, v109
    v_exp_f32 v110, v110
    v_exp_f32 v111, v111
    v_mfma_f32_32x32x16_bf16 v[120:135], v[92:95], v[52:55], v[120:135]
    v_cvt_pk_bf16_f32 v136, v104, v105
    v_cvt_pk_bf16_f32 v137, v106, v107
    v_cvt_pk_bf16_f32 v138, v108, v109
    v_cvt_pk_bf16_f32 v139, v110, v111
    v_exp_f32 v112, v112
    v_exp_f32 v113, v113
    v_exp_f32 v114, v114
    v_exp_f32 v115, v115
    v_mfma_f32_32x32x16_bf16 v[192:207], v[96:99], v[136:139], v[192:207]
    v_exp_f32 v116, v116
    v_exp_f32 v117, v117
    v_exp_f32 v118, v118
    v_exp_f32 v119, v119
    v_cvt_pk_bf16_f32 v140, v112, v113
    v_cvt_pk_bf16_f32 v141, v114, v115
    v_cvt_pk_bf16_f32 v142, v116, v117
    v_cvt_pk_bf16_f32 v143, v118, v119
    v_mfma_f32_32x32x16_bf16 v[104:119], v[88:91], v[56:59], 0
    v_exp_f32 v120, v120
    v_exp_f32 v121, v121
    v_exp_f32 v122, v122
    v_exp_f32 v123, v123
    v_mfma_f32_32x32x16_bf16 v[192:207], v[100:103], v[140:143], v[192:207]
    v_exp_f32 v124, v124
    v_exp_f32 v125, v125
    v_exp_f32 v126, v126
    v_exp_f32 v127, v127
    v_mfma_f32_32x32x16_bf16 v[104:119], v[92:95], v[60:63], v[104:119]
    v_cvt_pk_bf16_f32 v136, v120, v121
    v_cvt_pk_bf16_f32 v137, v122, v123
    v_cvt_pk_bf16_f32 v138, v124, v125
    v_cvt_pk_bf16_f32 v139, v126, v127
    v_exp_f32 v128, v128
    v_exp_f32 v129, v129
    v_exp_f32 v130, v130
    v_exp_f32 v131, v131
    v_mfma_f32_32x32x16_bf16 v[208:223], v[96:99], v[136:139], v[208:223]
    v_exp_f32 v132, v132
    v_exp_f32 v133, v133
    v_exp_f32 v134, v134
    v_exp_f32 v135, v135
    v_cvt_pk_bf16_f32 v140, v128, v129
    v_cvt_pk_bf16_f32 v141, v130, v131
    v_cvt_pk_bf16_f32 v142, v132, v133
    v_cvt_pk_bf16_f32 v143, v134, v135
    v_mfma_f32_32x32x16_bf16 v[120:135], v[88:91], v[64:67], 0
    v_exp_f32 v104, v104
    v_exp_f32 v105, v105
    v_exp_f32 v106, v106
    v_exp_f32 v107, v107
    v_mfma_f32_32x32x16_bf16 v[208:223], v[100:103], v[140:143], v[208:223]
    v_exp_f32 v108, v108
    v_exp_f32 v109, v109
    v_exp_f32 v110, v110
    v_exp_f32 v111, v111
    v_mfma_f32_32x32x16_bf16 v[120:135], v[92:95], v[68:71], v[120:135]
    v_cvt_pk_bf16_f32 v136, v104, v105
    v_cvt_pk_bf16_f32 v137, v106, v107
    v_cvt_pk_bf16_f32 v138, v108, v109
    v_cvt_pk_bf16_f32 v139, v110, v111
    v_exp_f32 v112, v112
    v_exp_f32 v113, v113
    v_exp_f32 v114, v114
    v_exp_f32 v115, v115
    v_mfma_f32_32x32x16_bf16 v[224:239], v[96:99], v[136:139], v[224:239]
    v_exp_f32 v116, v116
    v_exp_f32 v117, v117
    v_exp_f32 v118, v118
    v_exp_f32 v119, v119
    v_cvt_pk_bf16_f32 v140, v112, v113
    v_cvt_pk_bf16_f32 v141, v114, v115
    v_cvt_pk_bf16_f32 v142, v116, v117
    v_cvt_pk_bf16_f32 v143, v118, v119
    s_cmp_eq_u32 s79, 0
    s_cbranch_scc1 L_main_kernel_242
    s_waitcnt vmcnt(0)
    v_mfma_f32_32x32x16_bf16 v[104:119], v[72:75], v[16:19], 0
    v_exp_f32 v120, v120
    v_exp_f32 v121, v121
    v_exp_f32 v122, v122
    v_exp_f32 v123, v123
    v_mfma_f32_32x32x16_bf16 v[224:239], v[100:103], v[140:143], v[224:239]
    v_exp_f32 v124, v124
    v_exp_f32 v125, v125
    v_exp_f32 v126, v126
    v_exp_f32 v127, v127
    v_mfma_f32_32x32x16_bf16 v[104:119], v[76:79], v[20:23], v[104:119]
    v_cvt_pk_bf16_f32 v136, v120, v121
    v_cvt_pk_bf16_f32 v137, v122, v123
    v_cvt_pk_bf16_f32 v138, v124, v125
    v_cvt_pk_bf16_f32 v139, v126, v127
    v_exp_f32 v128, v128
    v_exp_f32 v129, v129
    v_exp_f32 v130, v130
    v_exp_f32 v131, v131
    v_mfma_f32_32x32x16_bf16 v[240:255], v[96:99], v[136:139], v[240:255]
    v_exp_f32 v132, v132
    v_exp_f32 v133, v133
    v_exp_f32 v134, v134
    v_exp_f32 v135, v135
    v_cvt_pk_bf16_f32 v140, v128, v129
    v_cvt_pk_bf16_f32 v141, v130, v131
    v_cvt_pk_bf16_f32 v142, v132, v133
    v_cvt_pk_bf16_f32 v143, v134, v135
    s_nop 1
    v_mfma_f32_32x32x16_bf16 v[240:255], v[100:103], v[140:143], v[240:255]
    s_add_u32 s98, s98, 4
    s_branch LKd_main_kernel_230
L_main_kernel_242:
    v_exp_f32 v120, v120
    v_exp_f32 v121, v121
    v_exp_f32 v122, v122
    v_exp_f32 v123, v123
    v_mfma_f32_32x32x16_bf16 v[224:239], v[100:103], v[140:143], v[224:239]
    v_exp_f32 v124, v124
    v_exp_f32 v125, v125
    v_exp_f32 v126, v126
    v_exp_f32 v127, v127
    v_cvt_pk_bf16_f32 v136, v120, v121
    v_cvt_pk_bf16_f32 v137, v122, v123
    v_cvt_pk_bf16_f32 v138, v124, v125
    v_cvt_pk_bf16_f32 v139, v126, v127
    v_exp_f32 v128, v128
    v_exp_f32 v129, v129
    v_exp_f32 v130, v130
    v_exp_f32 v131, v131
    v_mfma_f32_32x32x16_bf16 v[240:255], v[96:99], v[136:139], v[240:255]
    v_exp_f32 v132, v132
    v_exp_f32 v133, v133
    v_exp_f32 v134, v134
    v_exp_f32 v135, v135
    v_cvt_pk_bf16_f32 v140, v128, v129
    v_cvt_pk_bf16_f32 v141, v130, v131
    v_cvt_pk_bf16_f32 v142, v132, v133
    v_cvt_pk_bf16_f32 v143, v134, v135
    s_nop 1
    v_mfma_f32_32x32x16_bf16 v[240:255], v[100:103], v[140:143], v[240:255]
    s_cmp_ge_u32 s98, 56
    s_cbranch_scc1 LKe_main_kernel_227
    s_cmp_lt_u32 s98, s96
    s_cbranch_scc1 Lgo_main_kernel_243
    s_mov_b32 s70, 2097152
    v_lshlrev_b32 v8, 3, v1
    v_and_b32 v8, 0x780, v8
Lgl_main_kernel_244:
    s_min_u32 s96, s96, 48
    s_lshl_b32 s97, s96, 7
    s_add_u32 s97, s97, 97714176
    s_mov_b64 exec, 0xffff
    buffer_load_dword v9, v8, s[12:15], s97 offen sc1
    s_mov_b64 exec, -1
    s_sub_u32 s70, s70, 1
    s_cbranch_scc1 Lexit_main_kernel
    s_waitcnt vmcnt(0)
    v_cmp_ne_u32 vcc, 4, v9
    s_nop 0
    s_or_b32 s97, vcc_lo, 0x10000
    s_ff1_i32_b32 s97, s97
    s_add_u32 s96, s96, s97
    s_cmp_eq_u32 s97, 16
    s_cselect_b32 s97, 1, 0
    s_cmp_ge_u32 s96, 64
    s_cselect_b32 s96, 0x100, s96
    s_cbranch_scc1 Lgo_main_kernel_243
    s_cmp_eq_u32 s97, 1
    s_cbranch_scc1 Lgl_main_kernel_244
    s_cmp_lt_u32 s98, s96
    s_cbranch_scc1 Lgo_main_kernel_243
    s_add_u32 s97, s96, 1
    s_cmp_gt_u32 s98, s97
    s_cbranch_scc1 Lgf_main_kernel_245
    s_sleep 2
    s_branch Lgl_main_kernel_244
Lgf_main_kernel_245:
    s_sleep 40
    s_branch Lgl_main_kernel_244
Lgo_main_kernel_243:
    buffer_load_dwordx4 v[72:75], v1, s[12:15], s67 offen offset:0 sc1
    buffer_load_dwordx4 v[76:79], v1, s[12:15], s67 offen offset:1024 sc1
    buffer_load_dwordx4 v[80:83], v1, s[12:15], s68 offen offset:0 sc1
    buffer_load_dwordx4 v[84:87], v1, s[12:15], s68 offen offset:1024 sc1
    s_add_u32 s67, s67, 8192
    s_add_u32 s68, s68, 8192
L_main_kernel_241:
    s_add_u32 s98, s98, 4
    s_branch LK_main_kernel_226
LKe_main_kernel_227:
LBr_main_kernel_246:
    s_mul_i32 s46, s3, 28672
    s_add_u32 s46, s46, 36864
    v_add_u32 v7, s46, v1
    ds_write_b128 v7, v[144:147] offset:0
    ds_write_b128 v7, v[148:151] offset:1024
    ds_write_b128 v7, v[152:155] offset:2048
    ds_write_b128 v7, v[156:159] offset:3072
    ds_write_b128 v7, v[160:163] offset:4096
    ds_write_b128 v7, v[164:167] offset:5120
    ds_write_b128 v7, v[168:171] offset:6144
    ds_write_b128 v7, v[172:175] offset:7168
    ds_write_b128 v7, v[176:179] offset:8192
    ds_write_b128 v7, v[180:183] offset:9216
    ds_write_b128 v7, v[184:187] offset:10240
    ds_write_b128 v7, v[188:191] offset:11264
    ds_write_b128 v7, v[192:195] offset:12288
    ds_write_b128 v7, v[196:199] offset:13312
    ds_write_b128 v7, v[200:203] offset:14336
    ds_write_b128 v7, v[204:207] offset:15360
    ds_write_b128 v7, v[208:211] offset:16384
    ds_write_b128 v7, v[212:215] offset:17408
    ds_write_b128 v7, v[216:219] offset:18432
    ds_write_b128 v7, v[220:223] offset:19456
    ds_write_b128 v7, v[224:227] offset:20480
    ds_write_b128 v7, v[228:231] offset:21504
    ds_write_b128 v7, v[232:235] offset:22528
    ds_write_b128 v7, v[236:239] offset:23552
    ds_write_b128 v7, v[240:243] offset:24576
    ds_write_b128 v7, v[244:247] offset:25600
    ds_write_b128 v7, v[248:251] offset:26624
    ds_write_b128 v7, v[252:255] offset:27648
    v_add_u32 v9, s61, v2
    v_mov_b32 v8, 4096
    v_cmp_gt_u32 vcc, 14, v2
    s_nop 1
    v_cndmask_b32 v4, v8, v9, vcc
    v_mov_b32 v8, 2048
    v_cmp_lt_u32 s[72:73], v4, v8
    v_min_u32 v4, 2047, v4
    v_mov_b32 v9, v6
    v_lshrrev_b32 v14, 4, v4
    v_mul_u32_u24 v14, 14336, v14
    v_and_b32 v6, 15, v4
    v_lshl_add_u32 v14, v6, 4, v14
    v_lshl_add_u32 v14, v3, 8, v14
    v_mov_b32 v6, v9
    s_lshl_b32 s46, s69, 10
    v_add_u32 v14, s46, v14
    s_waitcnt lgkmcnt(0)
    s_add_u32 s46, s62, 65536
    buffer_load_dwordx4 v[160:163], v1, s[4:7], s46 offen offset:0 sc1
    buffer_load_dwordx4 v[164:167], v1, s[4:7], s46 offen offset:1024 sc1
    buffer_load_dwordx4 v[168:171], v1, s[4:7], s46 offen offset:2048 sc1
    buffer_load_dwordx4 v[172:175], v1, s[4:7], s46 offen offset:3072 sc1
    s_add_u32 s46, s62, 69632
    buffer_load_dwordx4 v[176:179], v1, s[4:7], s46 offen offset:0 sc1
    buffer_load_dwordx4 v[180:183], v1, s[4:7], s46 offen offset:1024 sc1
    buffer_load_dwordx4 v[184:187], v1, s[4:7], s46 offen offset:2048 sc1
    buffer_load_dwordx4 v[188:191], v1, s[4:7], s46 offen offset:3072 sc1
    s_add_u32 s46, s62, 73728
    buffer_load_dwordx4 v[192:195], v1, s[4:7], s46 offen offset:0 sc1
    buffer_load_dwordx4 v[196:199], v1, s[4:7], s46 offen offset:1024 sc1
    buffer_load_dwordx4 v[200:203], v1, s[4:7], s46 offen offset:2048 sc1
    buffer_load_dwordx4 v[204:207], v1, s[4:7], s46 offen offset:3072 sc1
    s_add_u32 s46, s62, 77824
    buffer_load_dwordx4 v[208:211], v1, s[4:7], s46 offen offset:0 sc1
    buffer_load_dwordx4 v[212:215], v1, s[4:7], s46 offen offset:1024 sc1
    buffer_load_dwordx4 v[216:219], v1, s[4:7], s46 offen offset:2048 sc1
    buffer_load_dwordx4 v[220:223], v1, s[4:7], s46 offen offset:3072 sc1
    s_add_u32 s46, s62, 81920
    buffer_load_dwordx4 v[224:227], v1, s[4:7], s46 offen offset:0 sc1
    buffer_load_dwordx4 v[228:231], v1, s[4:7], s46 offen offset:1024 sc1
    buffer_load_dwordx4 v[232:235], v1, s[4:7], s46 offen offset:2048 sc1
    buffer_load_dwordx4 v[236:239], v1, s[4:7], s46 offen offset:3072 sc1
    s_add_u32 s46, s62, 86016
    buffer_load_dwordx4 v[240:243], v1, s[4:7], s46 offen offset:0 sc1
    buffer_load_dwordx4 v[244:247], v1, s[4:7], s46 offen offset:1024 sc1
    buffer_load_dwordx4 v[248:251], v1, s[4:7], s46 offen offset:2048 sc1
    buffer_load_dwordx4 v[252:255], v1, s[4:7], s46 offen offset:3072 sc1
    s_barrier
    v_lshrrev_b32 v8, 5, v0
    v_bfe_u32 v5, v0, 4, 1
    v_mul_u32_u24 v5, 912, v5
    v_mul_u32_u24 v10, 56, v2
    v_add_u32 v5, v5, v10
    v_lshl_add_u32 v5, v8, 3, v5
    v_mov_b32 v11, 30976
    v_cmp_eq_u32 s[74:75], 1, v8
    s_add_u32 s80, s3, 4
    s_cmp_lt_u32 s80, 7
    s_cselect_b32 s80, s80, s3
    s_mov_b32 s46, s3
    s_lshl_b32 s47, s46, 12
    s_add_u32 s47, s47, 36864
    v_add_u32 v7, s47, v1
    ds_read_b128 v[64:67], v7 offset:0
    ds_read_b128 v[68:71], v7 offset:1024
    ds_read_b128 v[72:75], v7 offset:2048
    ds_read_b128 v[76:79], v7 offset:3072
    v_add_u32 v7, 28672, v7
    ds_read_b128 v[80:83], v7 offset:0
    ds_read_b128 v[84:87], v7 offset:1024
    ds_read_b128 v[88:91], v7 offset:2048
    ds_read_b128 v[92:95], v7 offset:3072
    v_add_u32 v7, 28672, v7
    ds_read_b128 v[96:99], v7 offset:0
    ds_read_b128 v[100:103], v7 offset:1024
    ds_read_b128 v[104:107], v7 offset:2048
    ds_read_b128 v[108:111], v7 offset:3072
    s_waitcnt lgkmcnt(4)
    v_add_u32 v7, 28672, v7
    ds_read_b128 v[112:115], v7 offset:0
    ds_read_b128 v[116:119], v7 offset:1024
    ds_read_b128 v[120:123], v7 offset:2048
    ds_read_b128 v[124:127], v7 offset:3072
    v_pk_add_f32 v[64:65], v[64:65], v[80:81]
    v_pk_add_f32 v[66:67], v[66:67], v[82:83]
    v_pk_add_f32 v[68:69], v[68:69], v[84:85]
    v_pk_add_f32 v[70:71], v[70:71], v[86:87]
    v_pk_add_f32 v[72:73], v[72:73], v[88:89]
    v_pk_add_f32 v[74:75], v[74:75], v[90:91]
    v_pk_add_f32 v[76:77], v[76:77], v[92:93]
    v_pk_add_f32 v[78:79], v[78:79], v[94:95]
    s_waitcnt lgkmcnt(0)
    v_pk_add_f32 v[96:97], v[96:97], v[112:113]
    v_pk_add_f32 v[98:99], v[98:99], v[114:115]
    v_pk_add_f32 v[100:101], v[100:101], v[116:117]
    v_pk_add_f32 v[102:103], v[102:103], v[118:119]
    v_pk_add_f32 v[104:105], v[104:105], v[120:121]
    v_pk_add_f32 v[106:107], v[106:107], v[122:123]
    v_pk_add_f32 v[108:109], v[108:109], v[124:125]
    v_pk_add_f32 v[110:111], v[110:111], v[126:127]
    v_pk_add_f32 v[32:33], v[64:65], v[96:97]
    v_pk_add_f32 v[34:35], v[66:67], v[98:99]
    v_pk_add_f32 v[36:37], v[68:69], v[100:101]
    v_pk_add_f32 v[38:39], v[70:71], v[102:103]
    v_pk_add_f32 v[40:41], v[72:73], v[104:105]
    v_pk_add_f32 v[42:43], v[74:75], v[106:107]
    v_pk_add_f32 v[44:45], v[76:77], v[108:109]
    v_pk_add_f32 v[46:47], v[78:79], v[110:111]
    s_lshl_b32 s47, s46, 11
    v_add_u32 v7, s47, v6
    ds_read_b128 v[16:19], v7 offset:0
    ds_read_b128 v[20:23], v7 offset:32
    s_mov_b32 s46, s80
    s_lshl_b32 s47, s46, 12
    s_add_u32 s47, s47, 36864
    v_add_u32 v7, s47, v1
    ds_read_b128 v[64:67], v7 offset:0
    ds_read_b128 v[68:71], v7 offset:1024
    ds_read_b128 v[72:75], v7 offset:2048
    ds_read_b128 v[76:79], v7 offset:3072
    v_add_u32 v7, 28672, v7
    ds_read_b128 v[80:83], v7 offset:0
    ds_read_b128 v[84:87], v7 offset:1024
    ds_read_b128 v[88:91], v7 offset:2048
    ds_read_b128 v[92:95], v7 offset:3072
    v_add_u32 v7, 28672, v7
    ds_read_b128 v[96:99], v7 offset:0
    ds_read_b128 v[100:103], v7 offset:1024
    ds_read_b128 v[104:107], v7 offset:2048
    ds_read_b128 v[108:111], v7 offset:3072
    s_waitcnt lgkmcnt(4)
    v_add_u32 v7, 28672, v7
    ds_read_b128 v[112:115], v7 offset:0
    ds_read_b128 v[116:119], v7 offset:1024
    ds_read_b128 v[120:123], v7 offset:2048
    ds_read_b128 v[124:127], v7 offset:3072
    v_pk_add_f32 v[64:65], v[64:65], v[80:81]
    v_pk_add_f32 v[66:67], v[66:67], v[82:83]
    v_pk_add_f32 v[68:69], v[68:69], v[84:85]
    v_pk_add_f32 v[70:71], v[70:71], v[86:87]
    v_pk_add_f32 v[72:73], v[72:73], v[88:89]
    v_pk_add_f32 v[74:75], v[74:75], v[90:91]
    v_pk_add_f32 v[76:77], v[76:77], v[92:93]
    v_pk_add_f32 v[78:79], v[78:79], v[94:95]
    s_waitcnt lgkmcnt(0)
    v_pk_add_f32 v[96:97], v[96:97], v[112:113]
    v_pk_add_f32 v[98:99], v[98:99], v[114:115]
    v_pk_add_f32 v[100:101], v[100:101], v[116:117]
    v_pk_add_f32 v[102:103], v[102:103], v[118:119]
    v_pk_add_f32 v[104:105], v[104:105], v[120:121]
    v_pk_add_f32 v[106:107], v[106:107], v[122:123]
    v_pk_add_f32 v[108:109], v[108:109], v[124:125]
    v_pk_add_f32 v[110:111], v[110:111], v[126:127]
    v_pk_add_f32 v[48:49], v[64:65], v[96:97]
    v_pk_add_f32 v[50:51], v[66:67], v[98:99]
    v_pk_add_f32 v[52:53], v[68:69], v[100:101]
    v_pk_add_f32 v[54:55], v[70:71], v[102:103]
    v_pk_add_f32 v[56:57], v[72:73], v[104:105]
    v_pk_add_f32 v[58:59], v[74:75], v[106:107]
    v_pk_add_f32 v[60:61], v[76:77], v[108:109]
    v_pk_add_f32 v[62:63], v[78:79], v[110:111]
    s_lshl_b32 s47, s46, 11
    v_add_u32 v7, s47, v6
    ds_read_b128 v[24:27], v7 offset:0
    ds_read_b128 v[28:31], v7 offset:32
    s_cmp_eq_u32 s78, 1
    s_cbranch_scc1 L_main_kernel_249
    s_mov_b32 s98, 56
    s_mov_b32 s67, 88858624
    s_mov_b32 s68, 88993792
    v_lshlrev_b32 v8, 3, v1
    s_add_u32 s46, s62, 90112
    buffer_load_dword v9, v8, s[4:7], s46 offen
    s_add_u32 s46, s62, 98304
    buffer_load_dword v9, v8, s[4:7], s46 offen
    s_add_u32 s46, s62, 106496
    buffer_load_dword v9, v8, s[4:7], s46 offen
    s_mul_i32 s53, s100, 9363
    s_lshr_b32 s53, s53, 16
    s_mul_i32 s54, s53, 7
    s_sub_u32 s54, s100, s54
    s_and_b32 s55, s53, 15
    s_lshr_b32 s53, s53, 4
    s_cmp_eq_u32 s53, 0
    s_cselect_b32 s57, 0, 6422528
    s_mul_i32 s58, s55, 28
    s_lshl_b32 s59, s54, 2
    s_add_u32 s58, s58, s59
    s_add_u32 s58, s58, s3
    s_mul_i32 s58, s58, 14336
    s_add_u32 s57, s57, s58
    buffer_load_dword v9, v8, s[4:7], s57 offen
    s_add_u32 s57, s57, 6144
    buffer_load_dword v9, v8, s[4:7], s57 offen
    s_getpc_b64 s[82:83]
Lpc_main_kernel_250:
    s_add_u32 s82, s82, L_main_kernel_249-Lpc_main_kernel_250
    s_addc_u32 s83, s83, 0
    global_load_dword v9, v8, s[82:83]
    s_getpc_b64 s[82:83]
Lpc_main_kernel_251:
    s_add_u32 s82, s82, Ltop_main_kernel_167-Lpc_main_kernel_251
    s_addc_u32 s83, s83, -1
    global_load_dword v9, v8, s[82:83]
    s_mov_b32 s96, 56
    s_cmp_lt_u32 s98, s96
    s_cbranch_scc1 L_main_kernel_252
    v_mov_b32 v10, 36672
    s_cmp_lg_u32 s3, 0
    s_cbranch_scc1 L_main_kernel_253
    s_cmp_lt_u32 s98, s96
    s_cbranch_scc1 Lgo_main_kernel_254
    s_mov_b32 s70, 2097152
    v_lshlrev_b32 v8, 3, v1
    v_and_b32 v8, 0x780, v8
Lgl_main_kernel_255:
    s_min_u32 s96, s96, 48
    s_lshl_b32 s97, s96, 7
    s_add_u32 s97, s97, 97714176
    s_mov_b64 exec, 0xffff
    buffer_load_dword v9, v8, s[12:15], s97 offen sc1
    s_mov_b64 exec, -1
    s_sub_u32 s70, s70, 1
    s_cbranch_scc1 Lexit_main_kernel
    s_waitcnt vmcnt(0)
    v_cmp_ne_u32 vcc, 4, v9
    s_nop 0
    s_or_b32 s97, vcc_lo, 0x10000
    s_ff1_i32_b32 s97, s97
    s_add_u32 s96, s96, s97
    s_cmp_eq_u32 s97, 16
    s_cselect_b32 s97, 1, 0
    s_cmp_ge_u32 s96, 64
    s_cselect_b32 s96, 0x100, s96
    s_cbranch_scc1 Lgo_main_kernel_254
    s_cmp_eq_u32 s97, 1
    s_cbranch_scc1 Lgl_main_kernel_255
    s_cmp_lt_u32 s98, s96
    s_cbranch_scc1 Lgo_main_kernel_254
    s_add_u32 s97, s96, 1
    s_cmp_gt_u32 s98, s97
    s_cbranch_scc1 Lgf_main_kernel_256
    s_sleep 1
    s_branch Lgl_main_kernel_255
Lgf_main_kernel_256:
    s_sleep 16
    s_branch Lgl_main_kernel_255
Lgo_main_kernel_254:
    v_mov_b32 v8, s96
    ds_write_b32 v10, v8
    s_waitcnt lgkmcnt(0)
L_main_kernel_253:
    s_barrier
    ds_read_b32 v8, v10
    s_waitcnt lgkmcnt(0)
    v_readfirstlane_b32 s96, v8
    s_barrier
L_main_kernel_252:
    buffer_load_dwordx4 v[64:67], v1, s[12:15], s67 offen offset:0 sc1
    buffer_load_dwordx4 v[68:71], v1, s[12:15], s67 offen offset:1024 sc1
    buffer_load_dwordx4 v[72:75], v1, s[12:15], s68 offen offset:0 sc1
    buffer_load_dwordx4 v[76:79], v1, s[12:15], s68 offen offset:1024 sc1
    s_add_u32 s67, s67, 2048
    s_add_u32 s68, s68, 2048
    s_add_u32 s98, s98, 1
    s_waitcnt lgkmcnt(0)
LK_main_kernel_257:
    s_cmp_lt_u32 s98, s96
    s_cselect_b32 s79, 1, 0
    s_cmp_lt_u32 s98, 64
    s_cselect_b32 s79, s79, 0
    s_cmp_eq_u32 s79, 0
    s_cbranch_scc1 L_main_kernel_263
    buffer_load_dwordx4 v[80:83], v1, s[12:15], s67 offen offset:0 sc1
    buffer_load_dwordx4 v[84:87], v1, s[12:15], s67 offen offset:1024 sc1
    buffer_load_dwordx4 v[88:91], v1, s[12:15], s68 offen offset:0 sc1
    buffer_load_dwordx4 v[92:95], v1, s[12:15], s68 offen offset:1024 sc1
    s_add_u32 s67, s67, 2048
    s_add_u32 s68, s68, 2048
    s_waitcnt vmcnt(4)
    s_branch L_main_kernel_264
LKd_main_kernel_261:
    s_cmp_lt_u32 s98, s96
    s_cselect_b32 s79, 1, 0
    s_cmp_lt_u32 s98, 64
    s_cselect_b32 s79, s79, 0
    s_cmp_eq_u32 s79, 0
    s_cbranch_scc1 LKw_main_kernel_259
    buffer_load_dwordx4 v[80:83], v1, s[12:15], s67 offen offset:0 sc1
    buffer_load_dwordx4 v[84:87], v1, s[12:15], s67 offen offset:1024 sc1
    buffer_load_dwordx4 v[88:91], v1, s[12:15], s68 offen offset:0 sc1
    buffer_load_dwordx4 v[92:95], v1, s[12:15], s68 offen offset:1024 sc1
    s_add_u32 s67, s67, 2048
    s_add_u32 s68, s68, 2048
    s_branch LKw_main_kernel_259
L_main_kernel_263:
    s_waitcnt vmcnt(0)
L_main_kernel_264:
    v_mfma_f32_32x32x16_bf16 v[96:111], v[64:67], v[16:19], 0
    v_mfma_f32_32x32x16_bf16 v[96:111], v[68:71], v[20:23], v[96:111]
LKw_main_kernel_259:
    v_mfma_f32_32x32x16_bf16 v[112:127], v[64:67], v[24:27], 0
    s_nop 4
    v_exp_f32 v96, v96
    v_exp_f32 v97, v97
    v_exp_f32 v98, v98
    v_exp_f32 v99, v99
    v_exp_f32 v100, v100
    v_exp_f32 v101, v101
    v_exp_f32 v102, v102
    v_exp_f32 v103, v103
    v_mfma_f32_32x32x16_bf16 v[112:127], v[68:71], v[28:31], v[112:127]
    v_cvt_pk_bf16_f32 v128, v96, v97
    v_cvt_pk_bf16_f32 v129, v98, v99
    v_cvt_pk_bf16_f32 v130, v100, v101
    v_cvt_pk_bf16_f32 v131, v102, v103
    v_exp_f32 v104, v104
    v_exp_f32 v105, v105
    v_exp_f32 v106, v106
    v_exp_f32 v107, v107
    v_mfma_f32_32x32x16_bf16 v[32:47], v[72:75], v[128:131], v[32:47]
    v_exp_f32 v108, v108
    v_exp_f32 v109, v109
    v_exp_f32 v110, v110
    v_exp_f32 v111, v111
    v_cvt_pk_bf16_f32 v132, v104, v105
    v_cvt_pk_bf16_f32 v133, v106, v107
    v_cvt_pk_bf16_f32 v134, v108, v109
    v_cvt_pk_bf16_f32 v135, v110, v111
    s_cmp_eq_u32 s79, 0
    s_cbranch_scc1 L_main_kernel_266
    s_waitcnt vmcnt(0)
    v_mfma_f32_32x32x16_bf16 v[96:111], v[80:83], v[16:19], 0
    v_exp_f32 v112, v112
    v_exp_f32 v113, v113
    v_exp_f32 v114, v114
    v_exp_f32 v115, v115
    v_mfma_f32_32x32x16_bf16 v[32:47], v[76:79], v[132:135], v[32:47]
    v_exp_f32 v116, v116
    v_exp_f32 v117, v117
    v_exp_f32 v118, v118
    v_exp_f32 v119, v119
    v_mfma_f32_32x32x16_bf16 v[96:111], v[84:87], v[20:23], v[96:111]
    v_cvt_pk_bf16_f32 v128, v112, v113
    v_cvt_pk_bf16_f32 v129, v114, v115
    v_cvt_pk_bf16_f32 v130, v116, v117
    v_cvt_pk_bf16_f32 v131, v118, v119
    v_exp_f32 v120, v120
    v_exp_f32 v121, v121
    v_exp_f32 v122, v122
    v_exp_f32 v123, v123
    v_mfma_f32_32x32x16_bf16 v[48:63], v[72:75], v[128:131], v[48:63]
    v_exp_f32 v124, v124
    v_exp_f32 v125, v125
    v_exp_f32 v126, v126
    v_exp_f32 v127, v127
    v_cvt_pk_bf16_f32 v132, v120, v121
    v_cvt_pk_bf16_f32 v133, v122, v123
    v_cvt_pk_bf16_f32 v134, v124, v125
    v_cvt_pk_bf16_f32 v135, v126, v127
    s_nop 1
    v_mfma_f32_32x32x16_bf16 v[48:63], v[76:79], v[132:135], v[48:63]
    s_add_u32 s98, s98, 1
    s_branch LKd_main_kernel_262
L_main_kernel_266:
    v_exp_f32 v112, v112
    v_exp_f32 v113, v113
    v_exp_f32 v114, v114
    v_exp_f32 v115, v115
    v_mfma_f32_32x32x16_bf16 v[32:47], v[76:79], v[132:135], v[32:47]
    v_exp_f32 v116, v116
    v_exp_f32 v117, v117
    v_exp_f32 v118, v118
    v_exp_f32 v119, v119
    v_cvt_pk_bf16_f32 v128, v112, v113
    v_cvt_pk_bf16_f32 v129, v114, v115
    v_cvt_pk_bf16_f32 v130, v116, v117
    v_cvt_pk_bf16_f32 v131, v118, v119
    v_exp_f32 v120, v120
    v_exp_f32 v121, v121
    v_exp_f32 v122, v122
    v_exp_f32 v123, v123
    v_mfma_f32_32x32x16_bf16 v[48:63], v[72:75], v[128:131], v[48:63]
    v_exp_f32 v124, v124
    v_exp_f32 v125, v125
    v_exp_f32 v126, v126
    v_exp_f32 v127, v127
    v_cvt_pk_bf16_f32 v132, v120, v121
    v_cvt_pk_bf16_f32 v133, v122, v123
    v_cvt_pk_bf16_f32 v134, v124, v125
    v_cvt_pk_bf16_f32 v135, v126, v127
    s_nop 1
    v_mfma_f32_32x32x16_bf16 v[48:63], v[76:79], v[132:135], v[48:63]
    s_cmp_lt_u32 s98, s96
    s_cbranch_scc1 L_main_kernel_267
    v_mov_b32 v10, 36672
    s_cmp_lg_u32 s3, 0
    s_cbranch_scc1 L_main_kernel_268
    s_cmp_lt_u32 s98, s96
    s_cbranch_scc1 Lgo_main_kernel_269
    s_mov_b32 s70, 2097152
    v_lshlrev_b32 v8, 3, v1
    v_and_b32 v8, 0x780, v8
Lgl_main_kernel_270:
    s_min_u32 s96, s96, 48
    s_lshl_b32 s97, s96, 7
    s_add_u32 s97, s97, 97714176
    s_mov_b64 exec, 0xffff
    buffer_load_dword v9, v8, s[12:15], s97 offen sc1
    s_mov_b64 exec, -1
    s_sub_u32 s70, s70, 1
    s_cbranch_scc1 Lexit_main_kernel
    s_waitcnt vmcnt(0)
    v_cmp_ne_u32 vcc, 4, v9
    s_nop 0
    s_or_b32 s97, vcc_lo, 0x10000
    s_ff1_i32_b32 s97, s97
    s_add_u32 s96, s96, s97
    s_cmp_eq_u32 s97, 16
    s_cselect_b32 s97, 1, 0
    s_cmp_ge_u32 s96, 64
    s_cselect_b32 s96, 0x100, s96
    s_cbranch_scc1 Lgo_main_kernel_269
    s_cmp_eq_u32 s97, 1
    s_cbranch_scc1 Lgl_main_kernel_270
    s_cmp_lt_u32 s98, s96
    s_cbranch_scc1 Lgo_main_kernel_269
    s_add_u32 s97, s96, 1
    s_cmp_gt_u32 s98, s97
    s_cbranch_scc1 Lgf_main_kernel_271
    s_sleep 1
    s_branch Lgl_main_kernel_270
Lgf_main_kernel_271:
    s_sleep 16
    s_branch Lgl_main_kernel_270
Lgo_main_kernel_269:
    v_mov_b32 v8, s96
    ds_write_b32 v10, v8
    s_waitcnt lgkmcnt(0)
L_main_kernel_268:
    s_barrier
    ds_read_b32 v8, v10
    s_waitcnt lgkmcnt(0)
    v_readfirstlane_b32 s96, v8
    s_barrier
L_main_kernel_267:
    buffer_load_dwordx4 v[80:83], v1, s[12:15], s67 offen offset:0 sc1
    buffer_load_dwordx4 v[84:87], v1, s[12:15], s67 offen offset:1024 sc1
    buffer_load_dwordx4 v[88:91], v1, s[12:15], s68 offen offset:0 sc1
    buffer_load_dwordx4 v[92:95], v1, s[12:15], s68 offen offset:1024 sc1
    s_add_u32 s67, s67, 2048
    s_add_u32 s68, s68, 2048
L_main_kernel_265:
    s_add_u32 s98, s98, 1
    s_cmp_lt_u32 s98, s96
    s_cselect_b32 s79, 1, 0
    s_cmp_lt_u32 s98, 64
    s_cselect_b32 s79, s79, 0
    s_cmp_eq_u32 s79, 0
    s_cbranch_scc1 L_main_kernel_272
    buffer_load_dwordx4 v[64:67], v1, s[12:15], s67 offen offset:0 sc1
    buffer_load_dwordx4 v[68:71], v1, s[12:15], s67 offen offset:1024 sc1
    buffer_load_dwordx4 v[72:75], v1, s[12:15], s68 offen offset:0 sc1
    buffer_load_dwordx4 v[76:79], v1, s[12:15], s68 offen offset:1024 sc1
    s_add_u32 s67, s67, 2048
    s_add_u32 s68, s68, 2048
    s_waitcnt vmcnt(4)
    s_branch L_main_kernel_273
LKd_main_kernel_262:
    s_cmp_lt_u32 s98, s96
    s_cselect_b32 s79, 1, 0
    s_cmp_lt_u32 s98, 64
    s_cselect_b32 s79, s79, 0
    s_cmp_eq_u32 s79, 0
    s_cbranch_scc1 LKw_main_kernel_260
    buffer_load_dwordx4 v[64:67], v1, s[12:15], s67 offen offset:0 sc1
    buffer_load_dwordx4 v[68:71], v1, s[12:15], s67 offen offset:1024 sc1
    buffer_load_dwordx4 v[72:75], v1, s[12:15], s68 offen offset:0 sc1
    buffer_load_dwordx4 v[76:79], v1, s[12:15], s68 offen offset:1024 sc1
    s_add_u32 s67, s67, 2048
    s_add_u32 s68, s68, 2048
    s_branch LKw_main_kernel_260
L_main_kernel_272:
    s_waitcnt vmcnt(0)
L_main_kernel_273:
    v_mfma_f32_32x32x16_bf16 v[96:111], v[80:83], v[16:19], 0
    v_mfma_f32_32x32x16_bf16 v[96:111], v[84:87], v[20:23], v[96:111]
LKw_main_kernel_260:
    v_mfma_f32_32x32x16_bf16 v[112:127], v[80:83], v[24:27], 0
    s_nop 4
    v_exp_f32 v96, v96
    v_exp_f32 v97, v97
    v_exp_f32 v98, v98
    v_exp_f32 v99, v99
    v_exp_f32 v100, v100
    v_exp_f32 v101, v101
    v_exp_f32 v102, v102
    v_exp_f32 v103, v103
    v_mfma_f32_32x32x16_bf16 v[112:127], v[84:87], v[28:31], v[112:127]
    v_cvt_pk_bf16_f32 v128, v96, v97
    v_cvt_pk_bf16_f32 v129, v98, v99
    v_cvt_pk_bf16_f32 v130, v100, v101
    v_cvt_pk_bf16_f32 v131, v102, v103
    v_exp_f32 v104, v104
    v_exp_f32 v105, v105
    v_exp_f32 v106, v106
    v_exp_f32 v107, v107
    v_mfma_f32_32x32x16_bf16 v[32:47], v[88:91], v[128:131], v[32:47]
    v_exp_f32 v108, v108
    v_exp_f32 v109, v109
    v_exp_f32 v110, v110
    v_exp_f32 v111, v111
    v_cvt_pk_bf16_f32 v132, v104, v105
    v_cvt_pk_bf16_f32 v133, v106, v107
    v_cvt_pk_bf16_f32 v134, v108, v109
    v_cvt_pk_bf16_f32 v135, v110, v111
    s_cmp_eq_u32 s79, 0
    s_cbranch_scc1 L_main_kernel_275
    s_waitcnt vmcnt(0)
    v_mfma_f32_32x32x16_bf16 v[96:111], v[64:67], v[16:19], 0
    v_exp_f32 v112, v112
    v_exp_f32 v113, v113
    v_exp_f32 v114, v114
    v_exp_f32 v115, v115
    v_mfma_f32_32x32x16_bf16 v[32:47], v[92:95], v[132:135], v[32:47]
    v_exp_f32 v116, v116
    v_exp_f32 v117, v117
    v_exp_f32 v118, v118
    v_exp_f32 v119, v119
    v_mfma_f32_32x32x16_bf16 v[96:111], v[68:71], v[20:23], v[96:111]
    v_cvt_pk_bf16_f32 v128, v112, v113
    v_cvt_pk_bf16_f32 v129, v114, v115
    v_cvt_pk_bf16_f32 v130, v116, v117
    v_cvt_pk_bf16_f32 v131, v118, v119
    v_exp_f32 v120, v120
    v_exp_f32 v121, v121
    v_exp_f32 v122, v122
    v_exp_f32 v123, v123
    v_mfma_f32_32x32x16_bf16 v[48:63], v[88:91], v[128:131], v[48:63]
    v_exp_f32 v124, v124
    v_exp_f32 v125, v125
    v_exp_f32 v126, v126
    v_exp_f32 v127, v127
    v_cvt_pk_bf16_f32 v132, v120, v121
    v_cvt_pk_bf16_f32 v133, v122, v123
    v_cvt_pk_bf16_f32 v134, v124, v125
    v_cvt_pk_bf16_f32 v135, v126, v127
    s_nop 1
    v_mfma_f32_32x32x16_bf16 v[48:63], v[92:95], v[132:135], v[48:63]
    s_add_u32 s98, s98, 1
    s_branch LKd_main_kernel_261
L_main_kernel_275:
    v_exp_f32 v112, v112
    v_exp_f32 v113, v113
    v_exp_f32 v114, v114
    v_exp_f32 v115, v115
    v_mfma_f32_32x32x16_bf16 v[32:47], v[92:95], v[132:135], v[32:47]
    v_exp_f32 v116, v116
    v_exp_f32 v117, v117
    v_exp_f32 v118, v118
    v_exp_f32 v119, v119
    v_cvt_pk_bf16_f32 v128, v112, v113
    v_cvt_pk_bf16_f32 v129, v114, v115
    v_cvt_pk_bf16_f32 v130, v116, v117
    v_cvt_pk_bf16_f32 v131, v118, v119
    v_exp_f32 v120, v120
    v_exp_f32 v121, v121
    v_exp_f32 v122, v122
    v_exp_f32 v123, v123
    v_mfma_f32_32x32x16_bf16 v[48:63], v[88:91], v[128:131], v[48:63]
    v_exp_f32 v124, v124
    v_exp_f32 v125, v125
    v_exp_f32 v126, v126
    v_exp_f32 v127, v127
    v_cvt_pk_bf16_f32 v132, v120, v121
    v_cvt_pk_bf16_f32 v133, v122, v123
    v_cvt_pk_bf16_f32 v134, v124, v125
    v_cvt_pk_bf16_f32 v135, v126, v127
    s_nop 1
    v_mfma_f32_32x32x16_bf16 v[48:63], v[92:95], v[132:135], v[48:63]
    s_cmp_ge_u32 s98, 64
    s_cbranch_scc1 LKe_main_kernel_258
    s_cmp_lt_u32 s98, s96
    s_cbranch_scc1 L_main_kernel_276
    v_mov_b32 v10, 36672
    s_cmp_lg_u32 s3, 0
    s_cbranch_scc1 L_main_kernel_277
    s_cmp_lt_u32 s98, s96
    s_cbranch_scc1 Lgo_main_kernel_278
    s_mov_b32 s70, 2097152
    v_lshlrev_b32 v8, 3, v1
    v_and_b32 v8, 0x780, v8
Lgl_main_kernel_279:
    s_min_u32 s96, s96, 48
    s_lshl_b32 s97, s96, 7
    s_add_u32 s97, s97, 97714176
    s_mov_b64 exec, 0xffff
    buffer_load_dword v9, v8, s[12:15], s97 offen sc1
    s_mov_b64 exec, -1
    s_sub_u32 s70, s70, 1
    s_cbranch_scc1 Lexit_main_kernel
    s_waitcnt vmcnt(0)
    v_cmp_ne_u32 vcc, 4, v9
    s_nop 0
    s_or_b32 s97, vcc_lo, 0x10000
    s_ff1_i32_b32 s97, s97
    s_add_u32 s96, s96, s97
    s_cmp_eq_u32 s97, 16
    s_cselect_b32 s97, 1, 0
    s_cmp_ge_u32 s96, 64
    s_cselect_b32 s96, 0x100, s96
    s_cbranch_scc1 Lgo_main_kernel_278
    s_cmp_eq_u32 s97, 1
    s_cbranch_scc1 Lgl_main_kernel_279
    s_cmp_lt_u32 s98, s96
    s_cbranch_scc1 Lgo_main_kernel_278
    s_add_u32 s97, s96, 1
    s_cmp_gt_u32 s98, s97
    s_cbranch_scc1 Lgf_main_kernel_280
    s_sleep 1
    s_branch Lgl_main_kernel_279
Lgf_main_kernel_280:
    s_sleep 16
    s_branch Lgl_main_kernel_279
Lgo_main_kernel_278:
    v_mov_b32 v8, s96
    ds_write_b32 v10, v8
    s_waitcnt lgkmcnt(0)
L_main_kernel_277:
    s_barrier
    ds_read_b32 v8, v10
    s_waitcnt lgkmcnt(0)
    v_readfirstlane_b32 s96, v8
    s_barrier
L_main_kernel_276:
    buffer_load_dwordx4 v[64:67], v1, s[12:15], s67 offen offset:0 sc1
    buffer_load_dwordx4 v[68:71], v1, s[12:15], s67 offen offset:1024 sc1
    buffer_load_dwordx4 v[72:75], v1, s[12:15], s68 offen offset:0 sc1
    buffer_load_dwordx4 v[76:79], v1, s[12:15], s68 offen offset:1024 sc1
    s_add_u32 s67, s67, 2048
    s_add_u32 s68, s68, 2048
L_main_kernel_274:
    s_add_u32 s98, s98, 1
    s_branch LK_main_kernel_257
LKe_main_kernel_258:
L_main_kernel_249:
    s_mov_b32 s48, 19267584
    buffer_load_dwordx4 v[80:83], v14, s[12:15], s48 offen offset:0 sc1
    buffer_load_dwordx4 v[84:87], v14, s[12:15], s48 offen offset:1024 sc1
    buffer_load_dwordx4 v[88:91], v14, s[12:15], s48 offen offset:2048 sc1
    buffer_load_dwordx4 v[92:95], v14, s[12:15], s48 offen offset:3072 sc1
    s_mov_b32 s46, s3
    v_mov_b32 v12, v44
    v_mov_b32 v13, v44
    s_nop 1
    v_permlane32_swap_b32 v12, v13
    s_nop 0
    v_cmp_nle_f32 vcc, 0x21800000, v13
    v_mov_b32 v12, 0x5d800000
    v_cmp_nle_f32 s[76:77], v13, v12
    s_nop 0
    s_or_b64 vcc, vcc, s[76:77]
    s_cbranch_vccz L_main_kernel_281
    v_mov_b32 v12, 36608
    v_mov_b32 v15, 1
    ds_write_b32 v12, v15
L_main_kernel_281:
    v_rcp_f32 v13, v13
    s_mul_i32 s47, s46, 1824
    s_add_u32 s47, s47, 16384
    v_add_u32 v10, s47, v5
    v_mul_f32 v32, v32, v13
    v_mul_f32 v33, v33, v13
    v_mul_f32 v34, v34, v13
    v_mul_f32 v35, v35, v13
    v_cvt_pk_bf16_f32 v32, v32, v33
    v_cvt_pk_bf16_f32 v33, v34, v35
    ds_write_b64 v10, v[32:33] offset:0
    v_mul_f32 v36, v36, v13
    v_mul_f32 v37, v37, v13
    v_mul_f32 v38, v38, v13
    v_mul_f32 v39, v39, v13
    v_cvt_pk_bf16_f32 v36, v36, v37
    v_cvt_pk_bf16_f32 v37, v38, v39
    ds_write_b64 v10, v[36:37] offset:16
    v_mul_f32 v40, v40, v13
    v_mul_f32 v41, v41, v13
    v_mul_f32 v42, v42, v13
    v_mul_f32 v43, v43, v13
    v_cvt_pk_bf16_f32 v40, v40, v41
    v_cvt_pk_bf16_f32 v41, v42, v43
    ds_write_b64 v10, v[40:41] offset:32
    v_mul_f32 v44, v44, v13
    v_mul_f32 v45, v45, v13
    v_mul_f32 v46, v46, v13
    v_mul_f32 v47, v47, v13
    v_cvt_pk_bf16_f32 v44, v44, v45
    v_cvt_pk_bf16_f32 v45, v46, v47
    v_add_u32 v10, 48, v10
    v_cndmask_b32 v10, v10, v11, s[74:75]
    ds_write_b64 v10, v[44:45]
    s_mov_b32 s46, s80
    v_mov_b32 v12, v60
    v_mov_b32 v13, v60
    s_nop 1
    v_permlane32_swap_b32 v12, v13
    s_nop 0
    v_cmp_nle_f32 vcc, 0x21800000, v13
    v_mov_b32 v12, 0x5d800000
    v_cmp_nle_f32 s[76:77], v13, v12
    s_nop 0
    s_or_b64 vcc, vcc, s[76:77]
    s_cbranch_vccz L_main_kernel_282
    v_mov_b32 v12, 36608
    v_mov_b32 v15, 1
    ds_write_b32 v12, v15
L_main_kernel_282:
    v_rcp_f32 v13, v13
    s_mul_i32 s47, s46, 1824
    s_add_u32 s47, s47, 16384
    v_add_u32 v10, s47, v5
    v_mul_f32 v48, v48, v13
    v_mul_f32 v49, v49, v13
    v_mul_f32 v50, v50, v13
    v_mul_f32 v51, v51, v13
    v_cvt_pk_bf16_f32 v48, v48, v49
    v_cvt_pk_bf16_f32 v49, v50, v51
    ds_write_b64 v10, v[48:49] offset:0
    v_mul_f32 v52, v52, v13
    v_mul_f32 v53, v53, v13
    v_mul_f32 v54, v54, v13
    v_mul_f32 v55, v55, v13
    v_cvt_pk_bf16_f32 v52, v52, v53
    v_cvt_pk_bf16_f32 v53, v54, v55
    ds_write_b64 v10, v[52:53] offset:16
    v_mul_f32 v56, v56, v13
    v_mul_f32 v57, v57, v13
    v_mul_f32 v58, v58, v13
    v_mul_f32 v59, v59, v13
    v_cvt_pk_bf16_f32 v56, v56, v57
    v_cvt_pk_bf16_f32 v57, v58, v59
    ds_write_b64 v10, v[56:57] offset:32
    v_mul_f32 v60, v60, v13
    v_mul_f32 v61, v61, v13
    v_mul_f32 v62, v62, v13
    v_mul_f32 v63, v63, v13
    v_cvt_pk_bf16_f32 v60, v60, v61
    v_cvt_pk_bf16_f32 v61, v62, v63
    v_add_u32 v10, 48, v10
    v_cndmask_b32 v10, v10, v11, s[74:75]
    ds_write_b64 v10, v[60:61]
    s_waitcnt lgkmcnt(0)
    s_barrier
    v_mov_b32 v12, 36608
    ds_read_b32 v12, v12
    s_waitcnt lgkmcnt(0)
    v_readfirstlane_b32 s46, v12
    s_nop 0
    s_andn2_b32 s46, s46, s78
    s_cmp_eq_u32 s46, 1
    s_cbranch_scc1 LBs_main_kernel_247
    s_add_u32 s8, s44, 13705216
    s_addc_u32 s9, s45, 0
    s_cmp_eq_u32 s0, 0
    s_cselect_b32 s8, s8, s40
    s_cselect_b32 s9, s9, s41
    s_and_b32 s9, s9, 0xffff
    s_mov_b32 s10, 1835008
    s_mov_b32 s11, 0x20000
    v_mul_u32_u24 v7, 912, v2
    v_lshl_add_u32 v7, v3, 4, v7
    ds_read_b128 v[16:19], v7 offset:16384
    ds_read_b128 v[20:23], v7 offset:16448
    ds_read_b128 v[24:27], v7 offset:16512
    ds_read_b128 v[28:31], v7 offset:16576
    ds_read_b128 v[32:35], v7 offset:16640
    ds_read_b128 v[36:39], v7 offset:16704
    ds_read_b128 v[40:43], v7 offset:16768
    ds_read_b128 v[44:47], v7 offset:16832
    ds_read_b128 v[48:51], v7 offset:16896
    ds_read_b128 v[52:55], v7 offset:16960
    ds_read_b128 v[56:59], v7 offset:17024
    ds_read_b128 v[60:63], v7 offset:17088
    ds_read_b128 v[64:67], v7 offset:17152
    ds_read_b128 v[68:71], v7 offset:17216
    s_waitcnt vmcnt(0) lgkmcnt(0)
    v_mfma_f32_16x16x32_bf16 v[96:99], a[0:3], v[16:19], 0
    v_mfma_f32_16x16x32_bf16 v[96:99], a[4:7], v[20:23], v[96:99]
    v_mfma_f32_16x16x32_bf16 v[96:99], a[8:11], v[24:27], v[96:99]
    v_mfma_f32_16x16x32_bf16 v[96:99], a[12:15], v[28:31], v[96:99]
    v_mfma_f32_16x16x32_bf16 v[96:99], a[16:19], v[32:35], v[96:99]
    v_mfma_f32_16x16x32_bf16 v[96:99], a[20:23], v[36:39], v[96:99]
    v_mfma_f32_16x16x32_bf16 v[96:99], a[24:27], v[40:43], v[96:99]
    v_mfma_f32_16x16x32_bf16 v[96:99], a[28:31], v[44:47], v[96:99]
    v_mfma_f32_16x16x32_bf16 v[96:99], a[32:35], v[48:51], v[96:99]
    v_mfma_f32_16x16x32_bf16 v[96:99], a[36:39], v[52:55], v[96:99]
    v_mfma_f32_16x16x32_bf16 v[96:99], a[40:43], v[56:59], v[96:99]
    v_mfma_f32_16x16x32_bf16 v[96:99], a[44:47], v[60:63], v[96:99]
    v_mfma_f32_16x16x32_bf16 v[96:99], a[48:51], v[64:67], v[96:99]
    v_mfma_f32_16x16x32_bf16 v[96:99], a[52:55], v[68:71], v[96:99]
    v_mfma_f32_16x16x32_bf16 v[100:103], a[56:59], v[16:19], 0
    v_mfma_f32_16x16x32_bf16 v[100:103], a[60:63], v[20:23], v[100:103]
    v_mfma_f32_16x16x32_bf16 v[100:103], a[64:67], v[24:27], v[100:103]
    v_mfma_f32_16x16x32_bf16 v[100:103], a[68:71], v[28:31], v[100:103]
    v_mfma_f32_16x16x32_bf16 v[100:103], a[72:75], v[32:35], v[100:103]
    v_mfma_f32_16x16x32_bf16 v[100:103], a[76:79], v[36:39], v[100:103]
    v_mfma_f32_16x16x32_bf16 v[100:103], a[80:83], v[40:43], v[100:103]
    v_mfma_f32_16x16x32_bf16 v[100:103], a[84:87], v[44:47], v[100:103]
    v_mfma_f32_16x16x32_bf16 v[100:103], a[88:91], v[48:51], v[100:103]
    v_mfma_f32_16x16x32_bf16 v[100:103], a[92:95], v[52:55], v[100:103]
    v_mfma_f32_16x16x32_bf16 v[100:103], a[96:99], v[56:59], v[100:103]
    v_mfma_f32_16x16x32_bf16 v[100:103], a[100:103], v[60:63], v[100:103]
    v_mfma_f32_16x16x32_bf16 v[100:103], a[104:107], v[64:67], v[100:103]
    v_mfma_f32_16x16x32_bf16 v[100:103], a[108:111], v[68:71], v[100:103]
    s_add_u32 s46, s62, 90112
    buffer_load_dwordx4 a[0:3], v1, s[4:7], s46 offen offset:0 sc1
    buffer_load_dwordx4 a[4:7], v1, s[4:7], s46 offen offset:1024 sc1
    buffer_load_dwordx4 a[8:11], v1, s[4:7], s46 offen offset:2048 sc1
    buffer_load_dwordx4 a[12:15], v1, s[4:7], s46 offen offset:3072 sc1
    s_add_u32 s46, s62, 94208
    buffer_load_dwordx4 a[16:19], v1, s[4:7], s46 offen offset:0 sc1
    buffer_load_dwordx4 a[20:23], v1, s[4:7], s46 offen offset:1024 sc1
    buffer_load_dwordx4 a[24:27], v1, s[4:7], s46 offen offset:2048 sc1
    buffer_load_dwordx4 a[28:31], v1, s[4:7], s46 offen offset:3072 sc1
    s_add_u32 s46, s62, 98304
    buffer_load_dwordx4 a[32:35], v1, s[4:7], s46 offen offset:0 sc1
    buffer_load_dwordx4 a[36:39], v1, s[4:7], s46 offen offset:1024 sc1
    buffer_load_dwordx4 a[40:43], v1, s[4:7], s46 offen offset:2048 sc1
    buffer_load_dwordx4 a[44:47], v1, s[4:7], s46 offen offset:3072 sc1
    s_add_u32 s46, s62, 102400
    buffer_load_dwordx4 a[48:51], v1, s[4:7], s46 offen offset:0 sc1
    buffer_load_dwordx4 a[52:55], v1, s[4:7], s46 offen offset:1024 sc1
    buffer_load_dwordx4 a[56:59], v1, s[4:7], s46 offen offset:2048 sc1
    buffer_load_dwordx4 a[60:63], v1, s[4:7], s46 offen offset:3072 sc1
    s_add_u32 s46, s62, 106496
    buffer_load_dwordx4 a[64:67], v1, s[4:7], s46 offen offset:0 sc1
    buffer_load_dwordx4 a[68:71], v1, s[4:7], s46 offen offset:1024 sc1
    buffer_load_dwordx4 a[72:75], v1, s[4:7], s46 offen offset:2048 sc1
    buffer_load_dwordx4 a[76:79], v1, s[4:7], s46 offen offset:3072 sc1
    s_add_u32 s46, s62, 110592
    buffer_load_dwordx4 a[80:83], v1, s[4:7], s46 offen offset:0 sc1
    buffer_load_dwordx4 a[84:87], v1, s[4:7], s46 offen offset:1024 sc1
    buffer_load_dwordx4 a[88:91], v1, s[4:7], s46 offen offset:2048 sc1
    buffer_load_dwordx4 a[92:95], v1, s[4:7], s46 offen offset:3072 sc1
    v_mfma_f32_16x16x32_bf16 v[104:107], a[112:115], v[16:19], 0
    v_mfma_f32_16x16x32_bf16 v[104:107], a[116:119], v[20:23], v[104:107]
    v_mfma_f32_16x16x32_bf16 v[104:107], a[120:123], v[24:27], v[104:107]
    v_mfma_f32_16x16x32_bf16 v[104:107], a[124:127], v[28:31], v[104:107]
    v_mfma_f32_16x16x32_bf16 v[104:107], a[128:131], v[32:35], v[104:107]
    v_mfma_f32_16x16x32_bf16 v[104:107], a[132:135], v[36:39], v[104:107]
    v_mfma_f32_16x16x32_bf16 v[104:107], a[136:139], v[40:43], v[104:107]
    v_mfma_f32_16x16x32_bf16 v[104:107], a[140:143], v[44:47], v[104:107]
    v_mfma_f32_16x16x32_bf16 v[104:107], a[144:147], v[48:51], v[104:107]
    v_mfma_f32_16x16x32_bf16 v[104:107], a[148:151], v[52:55], v[104:107]
    v_mfma_f32_16x16x32_bf16 v[104:107], a[152:155], v[56:59], v[104:107]
    v_mfma_f32_16x16x32_bf16 v[104:107], a[156:159], v[60:63], v[104:107]
    v_mfma_f32_16x16x32_bf16 v[104:107], a[160:163], v[64:67], v[104:107]
    v_mfma_f32_16x16x32_bf16 v[104:107], a[164:167], v[68:71], v[104:107]
    v_mfma_f32_16x16x32_bf16 v[108:111], a[168:171], v[16:19], 0
    v_mfma_f32_16x16x32_bf16 v[108:111], a[172:175], v[20:23], v[108:111]
    v_mfma_f32_16x16x32_bf16 v[108:111], a[176:179], v[24:27], v[108:111]
    v_mfma_f32_16x16x32_bf16 v[108:111], a[180:183], v[28:31], v[108:111]
    v_mfma_f32_16x16x32_bf16 v[108:111], a[184:187], v[32:35], v[108:111]
    v_mfma_f32_16x16x32_bf16 v[108:111], a[188:191], v[36:39], v[108:111]
    v_mfma_f32_16x16x32_bf16 v[108:111], a[192:195], v[40:43], v[108:111]
    v_mfma_f32_16x16x32_bf16 v[108:111], a[196:199], v[44:47], v[108:111]
    v_mfma_f32_16x16x32_bf16 v[108:111], a[200:203], v[48:51], v[108:111]
    v_mfma_f32_16x16x32_bf16 v[108:111], a[204:207], v[52:55], v[108:111]
    v_mfma_f32_16x16x32_bf16 v[108:111], a[208:211], v[56:59], v[108:111]
    v_mfma_f32_16x16x32_bf16 v[108:111], a[212:215], v[60:63], v[108:111]
    v_mfma_f32_16x16x32_bf16 v[108:111], a[216:219], v[64:67], v[108:111]
    v_mfma_f32_16x16x32_bf16 v[108:111], a[220:223], v[68:71], v[108:111]
    v_mfma_f32_16x16x32_bf16 v[112:115], a[224:227], v[16:19], 0
    v_mfma_f32_16x16x32_bf16 v[112:115], a[228:231], v[20:23], v[112:115]
    v_mfma_f32_16x16x32_bf16 v[112:115], a[232:235], v[24:27], v[112:115]
    v_mfma_f32_16x16x32_bf16 v[112:115], a[236:239], v[28:31], v[112:115]
    v_mfma_f32_16x16x32_bf16 v[112:115], a[240:243], v[32:35], v[112:115]
    v_mfma_f32_16x16x32_bf16 v[112:115], a[244:247], v[36:39], v[112:115]
    v_mfma_f32_16x16x32_bf16 v[112:115], a[248:251], v[40:43], v[112:115]
    v_mfma_f32_16x16x32_bf16 v[112:115], a[252:255], v[44:47], v[112:115]
    v_mfma_f32_16x16x32_bf16 v[112:115], v[160:163], v[48:51], v[112:115]
    v_mfma_f32_16x16x32_bf16 v[112:115], v[164:167], v[52:55], v[112:115]
    v_mfma_f32_16x16x32_bf16 v[112:115], v[168:171], v[56:59], v[112:115]
    v_mfma_f32_16x16x32_bf16 v[112:115], v[172:175], v[60:63], v[112:115]
    v_mfma_f32_16x16x32_bf16 v[112:115], v[176:179], v[64:67], v[112:115]
    v_mfma_f32_16x16x32_bf16 v[112:115], v[180:183], v[68:71], v[112:115]
    v_mfma_f32_16x16x32_bf16 v[116:119], v[184:187], v[16:19], 0
    v_mfma_f32_16x16x32_bf16 v[116:119], v[188:191], v[20:23], v[116:119]
    v_mfma_f32_16x16x32_bf16 v[116:119], v[192:195], v[24:27], v[116:119]
    v_mfma_f32_16x16x32_bf16 v[116:119], v[196:199], v[28:31], v[116:119]
    v_mfma_f32_16x16x32_bf16 v[116:119], v[200:203], v[32:35], v[116:119]
    v_mfma_f32_16x16x32_bf16 v[116:119], v[204:207], v[36:39], v[116:119]
    v_mfma_f32_16x16x32_bf16 v[116:119], v[208:211], v[40:43], v[116:119]
    v_mfma_f32_16x16x32_bf16 v[116:119], v[212:215], v[44:47], v[116:119]
    v_mfma_f32_16x16x32_bf16 v[116:119], v[216:219], v[48:51], v[116:119]
    v_mfma_f32_16x16x32_bf16 v[116:119], v[220:223], v[52:55], v[116:119]
    v_mfma_f32_16x16x32_bf16 v[116:119], v[224:227], v[56:59], v[116:119]
    v_mfma_f32_16x16x32_bf16 v[116:119], v[228:231], v[60:63], v[116:119]
    v_mfma_f32_16x16x32_bf16 v[116:119], v[232:235], v[64:67], v[116:119]
    v_mfma_f32_16x16x32_bf16 v[116:119], v[236:239], v[68:71], v[116:119]
    s_cmp_ge_u32 s3, 2
    s_cbranch_scc1 L_main_kernel_283
    s_waitcnt vmcnt(0)
    v_mfma_f32_16x16x32_bf16 v[120:123], v[240:243], v[16:19], 0
    v_mfma_f32_16x16x32_bf16 v[120:123], v[244:247], v[20:23], v[120:123]
    v_mfma_f32_16x16x32_bf16 v[120:123], v[248:251], v[24:27], v[120:123]
    v_mfma_f32_16x16x32_bf16 v[120:123], v[252:255], v[28:31], v[120:123]
    v_mfma_f32_16x16x32_bf16 v[120:123], a[0:3], v[32:35], v[120:123]
    v_mfma_f32_16x16x32_bf16 v[120:123], a[4:7], v[36:39], v[120:123]
    v_mfma_f32_16x16x32_bf16 v[120:123], a[8:11], v[40:43], v[120:123]
    v_mfma_f32_16x16x32_bf16 v[120:123], a[12:15], v[44:47], v[120:123]
    v_mfma_f32_16x16x32_bf16 v[120:123], a[16:19], v[48:51], v[120:123]
    v_mfma_f32_16x16x32_bf16 v[120:123], a[20:23], v[52:55], v[120:123]
    v_mfma_f32_16x16x32_bf16 v[120:123], a[24:27], v[56:59], v[120:123]
    v_mfma_f32_16x16x32_bf16 v[120:123], a[28:31], v[60:63], v[120:123]
    v_mfma_f32_16x16x32_bf16 v[120:123], a[32:35], v[64:67], v[120:123]
    v_mfma_f32_16x16x32_bf16 v[120:123], a[36:39], v[68:71], v[120:123]
    v_mfma_f32_16x16x32_bf16 v[124:127], a[40:43], v[16:19], 0
    v_mfma_f32_16x16x32_bf16 v[124:127], a[44:47], v[20:23], v[124:127]
    v_mfma_f32_16x16x32_bf16 v[124:127], a[48:51], v[24:27], v[124:127]
    v_mfma_f32_16x16x32_bf16 v[124:127], a[52:55], v[28:31], v[124:127]
    v_mfma_f32_16x16x32_bf16 v[124:127], a[56:59], v[32:35], v[124:127]
    v_mfma_f32_16x16x32_bf16 v[124:127], a[60:63], v[36:39], v[124:127]
    v_mfma_f32_16x16x32_bf16 v[124:127], a[64:67], v[40:43], v[124:127]
    v_mfma_f32_16x16x32_bf16 v[124:127], a[68:71], v[44:47], v[124:127]
    v_mfma_f32_16x16x32_bf16 v[124:127], a[72:75], v[48:51], v[124:127]
    v_mfma_f32_16x16x32_bf16 v[124:127], a[76:79], v[52:55], v[124:127]
    v_mfma_f32_16x16x32_bf16 v[124:127], a[80:83], v[56:59], v[124:127]
    v_mfma_f32_16x16x32_bf16 v[124:127], a[84:87], v[60:63], v[124:127]
    v_mfma_f32_16x16x32_bf16 v[124:127], a[88:91], v[64:67], v[124:127]
    v_mfma_f32_16x16x32_bf16 v[124:127], a[92:95], v[68:71], v[124:127]
L_main_kernel_283:
    s_cmp_eq_u32 s0, 1
    s_cbranch_scc1 L_main_kernel_284
    s_mul_i32 s53, s100, 9363
    s_lshr_b32 s53, s53, 16
    s_mul_i32 s54, s53, 7
    s_sub_u32 s54, s100, s54
    s_and_b32 s55, s53, 15
    s_lshr_b32 s53, s53, 4
    s_cmp_eq_u32 s53, 0
    s_cselect_b32 s57, 0, 6422528
    s_mul_i32 s58, s55, 28
    s_lshl_b32 s59, s54, 2
    s_add_u32 s58, s58, s59
    s_add_u32 s58, s58, s3
    s_mul_i32 s58, s58, 14336
    s_add_u32 s57, s57, s58
    buffer_load_dwordx4 v[128:131], v1, s[4:7], s57 offen offset:0 sc1
    buffer_load_dwordx4 v[132:135], v1, s[4:7], s57 offen offset:1024 sc1
    buffer_load_dwordx4 v[136:139], v1, s[4:7], s57 offen offset:2048 sc1
    buffer_load_dwordx4 v[140:143], v1, s[4:7], s57 offen offset:3072 sc1
    s_add_u32 s57, s57, 4096
    buffer_load_dwordx4 v[144:147], v1, s[4:7], s57 offen offset:0 sc1
    buffer_load_dwordx4 v[148:151], v1, s[4:7], s57 offen offset:1024 sc1
    buffer_load_dwordx4 v[152:155], v1, s[4:7], s57 offen offset:2048 sc1
    buffer_load_dwordx4 v[156:159], v1, s[4:7], s57 offen offset:3072 sc1
    s_add_u32 s57, s57, 4096
    buffer_load_dwordx4 v[160:163], v1, s[4:7], s57 offen offset:0 sc1
    buffer_load_dwordx4 v[164:167], v1, s[4:7], s57 offen offset:1024 sc1
    buffer_load_dwordx4 v[168:171], v1, s[4:7], s57 offen offset:2048 sc1
    buffer_load_dwordx4 v[172:175], v1, s[4:7], s57 offen offset:3072 sc1
    s_add_u32 s57, s57, 4096
    buffer_load_dwordx4 v[176:179], v1, s[4:7], s57 offen offset:0 sc1
    buffer_load_dwordx4 v[180:183], v1, s[4:7], s57 offen offset:1024 sc1
L_main_kernel_284:
    v_mov_b32 v9, 0x7fffffff
    v_cndmask_b32 v5, v9, v14, s[72:73]
    v_mul_u32_u24 v8, 896, v4
    v_lshl_add_u32 v8, v3, 4, v8
    s_lshl_b32 s46, s69, 6
    v_add_u32 v8, s46, v8
    v_cndmask_b32 v8, v9, v8, s[72:73]
    s_cmp_eq_u32 s0, 0
    s_cselect_b64 vcc, -1, 0
    s_cselect_b32 s50, 1024, 64
    v_cndmask_b32 v8, v8, v5, vcc
    s_lshl_b32 s51, s50, 1
    s_add_u32 s52, s51, s50
    s_lshl_b32 s46, s3, 2
    v_lshlrev_b32 v11, 4, v2
    v_add_u32 v10, s46, v11
    s_mov_b32 s49, 97779712
    v_mov_b32 v16, 0
    v_lshlrev_b32 v20, 16, v80
    v_and_b32 v21, 0xffff0000, v80
    v_add_f32 v96, v96, v20
    v_add_f32 v97, v97, v21
    v_cvt_pk_bf16_f32 v80, v96, v97
    v_lshlrev_b32 v20, 16, v81
    v_and_b32 v21, 0xffff0000, v81
    v_add_f32 v98, v98, v20
    v_add_f32 v99, v99, v21
    v_cvt_pk_bf16_f32 v81, v98, v99
    v_add_f32 v20, v96, v97
    v_add_f32 v21, v98, v99
    v_add_f32 v16, v16, v20
    v_add_f32 v16, v16, v21
    v_lshlrev_b32 v20, 16, v82
    v_and_b32 v21, 0xffff0000, v82
    v_add_f32 v100, v100, v20
    v_add_f32 v101, v101, v21
    v_cvt_pk_bf16_f32 v82, v100, v101
    v_lshlrev_b32 v20, 16, v83
    v_and_b32 v21, 0xffff0000, v83
    v_add_f32 v102, v102, v20
    v_add_f32 v103, v103, v21
    v_cvt_pk_bf16_f32 v83, v102, v103
    v_add_f32 v20, v100, v101
    v_add_f32 v21, v102, v103
    v_add_f32 v16, v16, v20
    v_add_f32 v16, v16, v21
    buffer_store_dwordx4 v[80:83], v8, s[8:11], 0 offen sc1
    v_lshlrev_b32 v20, 16, v84
    v_and_b32 v21, 0xffff0000, v84
    v_add_f32 v104, v104, v20
    v_add_f32 v105, v105, v21
    v_cvt_pk_bf16_f32 v84, v104, v105
    v_lshlrev_b32 v20, 16, v85
    v_and_b32 v21, 0xffff0000, v85
    v_add_f32 v106, v106, v20
    v_add_f32 v107, v107, v21
    v_cvt_pk_bf16_f32 v85, v106, v107
    v_add_f32 v20, v104, v105
    v_add_f32 v21, v106, v107
    v_add_f32 v16, v16, v20
    v_add_f32 v16, v16, v21
    v_lshlrev_b32 v20, 16, v86
    v_and_b32 v21, 0xffff0000, v86
    v_add_f32 v108, v108, v20
    v_add_f32 v109, v109, v21
    v_cvt_pk_bf16_f32 v86, v108, v109
    v_lshlrev_b32 v20, 16, v87
    v_and_b32 v21, 0xffff0000, v87
    v_add_f32 v110, v110, v20
    v_add_f32 v111, v111, v21
    v_cvt_pk_bf16_f32 v87, v110, v111
    v_add_f32 v20, v108, v109
    v_add_f32 v21, v110, v111
    v_add_f32 v16, v16, v20
    v_add_f32 v16, v16, v21
    buffer_store_dwordx4 v[84:87], v8, s[8:11], s50 offen sc1
    v_lshlrev_b32 v20, 16, v88
    v_and_b32 v21, 0xffff0000, v88
    v_add_f32 v112, v112, v20
    v_add_f32 v113, v113, v21
    v_cvt_pk_bf16_f32 v88, v112, v113
    v_lshlrev_b32 v20, 16, v89
    v_and_b32 v21, 0xffff0000, v89
    v_add_f32 v114, v114, v20
    v_add_f32 v115, v115, v21
    v_cvt_pk_bf16_f32 v89, v114, v115
    v_add_f32 v20, v112, v113
    v_add_f32 v21, v114, v115
    v_add_f32 v16, v16, v20
    v_add_f32 v16, v16, v21
    v_lshlrev_b32 v20, 16, v90
    v_and_b32 v21, 0xffff0000, v90
    v_add_f32 v116, v116, v20
    v_add_f32 v117, v117, v21
    v_cvt_pk_bf16_f32 v90, v116, v117
    v_lshlrev_b32 v20, 16, v91
    v_and_b32 v21, 0xffff0000, v91
    v_add_f32 v118, v118, v20
    v_add_f32 v119, v119, v21
    v_cvt_pk_bf16_f32 v91, v118, v119
    v_add_f32 v20, v116, v117
    v_add_f32 v21, v118, v119
    v_add_f32 v16, v16, v20
    v_add_f32 v16, v16, v21
    buffer_store_dwordx4 v[88:91], v8, s[8:11], s51 offen sc1
    s_cmp_ge_u32 s3, 2
    s_cbranch_scc1 L_main_kernel_285
    v_lshlrev_b32 v20, 16, v92
    v_and_b32 v21, 0xffff0000, v92
    v_add_f32 v120, v120, v20
    v_add_f32 v121, v121, v21
    v_cvt_pk_bf16_f32 v92, v120, v121
    v_lshlrev_b32 v20, 16, v93
    v_and_b32 v21, 0xffff0000, v93
    v_add_f32 v122, v122, v20
    v_add_f32 v123, v123, v21
    v_cvt_pk_bf16_f32 v93, v122, v123
    v_add_f32 v20, v120, v121
    v_add_f32 v21, v122, v123
    v_add_f32 v16, v16, v20
    v_add_f32 v16, v16, v21
    v_lshlrev_b32 v20, 16, v94
    v_and_b32 v21, 0xffff0000, v94
    v_add_f32 v124, v124, v20
    v_add_f32 v125, v125, v21
    v_cvt_pk_bf16_f32 v94, v124, v125
    v_lshlrev_b32 v20, 16, v95
    v_and_b32 v21, 0xffff0000, v95
    v_add_f32 v126, v126, v20
    v_add_f32 v127, v127, v21
    v_cvt_pk_bf16_f32 v95, v126, v127
    v_add_f32 v20, v124, v125
    v_add_f32 v21, v126, v127
    v_add_f32 v16, v16, v20
    v_add_f32 v16, v16, v21
    buffer_store_dwordx4 v[92:95], v8, s[8:11], s52 offen sc1
L_main_kernel_285:
    s_cmp_eq_u32 s0, 1
    s_cbranch_scc1 LBf_main_kernel_248
    v_mov_b32 v20, v16
    s_nop 1
    v_permlane16_swap_b32 v16, v20
    s_nop 0
    v_add_f32 v16, v16, v20
    v_mov_b32 v20, v16
    s_nop 1
    v_permlane32_swap_b32 v16, v20
    s_nop 0
    v_add_f32 v16, v16, v20
    ds_write_b32 v10, v16 offset:31488
    s_waitcnt lgkmcnt(0)
    s_barrier
    ds_read_b128 v[24:27], v11 offset:31488
    s_waitcnt lgkmcnt(0)
    v_add_f32 v24, v24, v25
    v_add_f32 v26, v26, v27
    v_add_f32 v16, v24, v26
    v_mul_f32 v18, 0x3b124925, v16
    v_mov_b32 v16, 0
    v_sub_f32 v96, v96, v18
    v_fmac_f32 v16, v96, v96
    v_sub_f32 v97, v97, v18
    v_fmac_f32 v16, v97, v97
    v_sub_f32 v98, v98, v18
    v_fmac_f32 v16, v98, v98
    v_sub_f32 v99, v99, v18
    v_fmac_f32 v16, v99, v99
    v_sub_f32 v100, v100, v18
    v_fmac_f32 v16, v100, v100
    v_sub_f32 v101, v101, v18
    v_fmac_f32 v16, v101, v101
    v_sub_f32 v102, v102, v18
    v_fmac_f32 v16, v102, v102
    v_sub_f32 v103, v103, v18
    v_fmac_f32 v16, v103, v103
    v_sub_f32 v104, v104, v18
    v_fmac_f32 v16, v104, v104
    v_sub_f32 v105, v105, v18
    v_fmac_f32 v16, v105, v105
    v_sub_f32 v106, v106, v18
    v_fmac_f32 v16, v106, v106
    v_sub_f32 v107, v107, v18
    v_fmac_f32 v16, v107, v107
    v_sub_f32 v108, v108, v18
    v_fmac_f32 v16, v108, v108
    v_sub_f32 v109, v109, v18
    v_fmac_f32 v16, v109, v109
    v_sub_f32 v110, v110, v18
    v_fmac_f32 v16, v110, v110
    v_sub_f32 v111, v111, v18
    v_fmac_f32 v16, v111, v111
    v_sub_f32 v112, v112, v18
    v_fmac_f32 v16, v112, v112
    v_sub_f32 v113, v113, v18
    v_fmac_f32 v16, v113, v113
    v_sub_f32 v114, v114, v18
    v_fmac_f32 v16, v114, v114
    v_sub_f32 v115, v115, v18
    v_fmac_f32 v16, v115, v115
    v_sub_f32 v116, v116, v18
    v_fmac_f32 v16, v116, v116
    v_sub_f32 v117, v117, v18
    v_fmac_f32 v16, v117, v117
    v_sub_f32 v118, v118, v18
    v_fmac_f32 v16, v118, v118
    v_sub_f32 v119, v119, v18
    v_fmac_f32 v16, v119, v119
    s_cmp_ge_u32 s3, 2
    s_cbranch_scc1 L_main_kernel_286
    v_sub_f32 v120, v120, v18
    v_fmac_f32 v16, v120, v120
    v_sub_f32 v121, v121, v18
    v_fmac_f32 v16, v121, v121
    v_sub_f32 v122, v122, v18
    v_fmac_f32 v16, v122, v122
    v_sub_f32 v123, v123, v18
    v_fmac_f32 v16, v123, v123
    v_sub_f32 v124, v124, v18
    v_fmac_f32 v16, v124, v124
    v_sub_f32 v125, v125, v18
    v_fmac_f32 v16, v125, v125
    v_sub_f32 v126, v126, v18
    v_fmac_f32 v16, v126, v126
    v_sub_f32 v127, v127, v18
    v_fmac_f32 v16, v127, v127
L_main_kernel_286:
    v_mov_b32 v20, v16
    s_nop 1
    v_permlane16_swap_b32 v16, v20
    s_nop 0
    v_add_f32 v16, v16, v20
    v_mov_b32 v20, v16
    s_nop 1
    v_permlane32_swap_b32 v16, v20
    s_nop 0
    v_add_f32 v16, v16, v20
    ds_write_b32 v10, v16 offset:32000
    s_waitcnt lgkmcnt(0)
    s_barrier
    ds_read_b128 v[24:27], v11 offset:32000
    s_waitcnt lgkmcnt(0)
    v_add_f32 v24, v24, v25
    v_add_f32 v26, v26, v27
    v_add_f32 v16, v24, v26
    v_mov_b32 v18, 0x3727c5ac
    v_fmac_f32 v18, 0x3b124925, v16
    v_rsq_f32 v18, v18
    s_nop 0
    v_mul_f32 v96, v96, v18
    v_mul_f32 v97, v97, v18
    v_mul_f32 v98, v98, v18
    v_mul_f32 v99, v99, v18
    v_cvt_pk_bf16_f32 v24, v96, v97
    v_cvt_pk_bf16_f32 v25, v98, v99
    v_mul_f32 v100, v100, v18
    v_mul_f32 v101, v101, v18
    v_mul_f32 v102, v102, v18
    v_mul_f32 v103, v103, v18
    v_cvt_pk_bf16_f32 v26, v100, v101
    v_cvt_pk_bf16_f32 v27, v102, v103
    buffer_store_dwordx4 v[24:27], v5, s[4:7], s49 offen offset:0 sc1
    v_mul_f32 v104, v104, v18
    v_mul_f32 v105, v105, v18
    v_mul_f32 v106, v106, v18
    v_mul_f32 v107, v107, v18
    v_cvt_pk_bf16_f32 v28, v104, v105
    v_cvt_pk_bf16_f32 v29, v106, v107
    v_mul_f32 v108, v108, v18
    v_mul_f32 v109, v109, v18
    v_mul_f32 v110, v110, v18
    v_mul_f32 v111, v111, v18
    v_cvt_pk_bf16_f32 v30, v108, v109
    v_cvt_pk_bf16_f32 v31, v110, v111
    buffer_store_dwordx4 v[28:31], v5, s[4:7], s49 offen offset:1024 sc1
    v_mul_f32 v112, v112, v18
    v_mul_f32 v113, v113, v18
    v_mul_f32 v114, v114, v18
    v_mul_f32 v115, v115, v18
    v_cvt_pk_bf16_f32 v24, v112, v113
    v_cvt_pk_bf16_f32 v25, v114, v115
    v_mul_f32 v116, v116, v18
    v_mul_f32 v117, v117, v18
    v_mul_f32 v118, v118, v18
    v_mul_f32 v119, v119, v18
    v_cvt_pk_bf16_f32 v26, v116, v117
    v_cvt_pk_bf16_f32 v27, v118, v119
    buffer_store_dwordx4 v[24:27], v5, s[4:7], s49 offen offset:2048 sc1
    s_cmp_ge_u32 s3, 2
    s_cbranch_scc1 L_main_kernel_287
    v_mul_f32 v120, v120, v18
    v_mul_f32 v121, v121, v18
    v_mul_f32 v122, v122, v18
    v_mul_f32 v123, v123, v18
    v_cvt_pk_bf16_f32 v28, v120, v121
    v_cvt_pk_bf16_f32 v29, v122, v123
    v_mul_f32 v124, v124, v18
    v_mul_f32 v125, v125, v18
    v_mul_f32 v126, v126, v18
    v_mul_f32 v127, v127, v18
    v_cvt_pk_bf16_f32 v30, v124, v125
    v_cvt_pk_bf16_f32 v31, v126, v127
    buffer_store_dwordx4 v[28:31], v5, s[4:7], s49 offen offset:3072 sc1
L_main_kernel_287:
    s_waitcnt vmcnt(0)
    s_barrier
    s_cmp_lg_u32 s3, 0
    s_cbranch_scc1 L_main_kernel_288
    s_add_u32 s47, s61, 14
    s_min_u32 s47, s47, 1064
    s_min_u32 s46, s61, 1064
    s_lshr_b32 s48, s46, 5
    s_add_u32 s49, s48, 1
    s_lshl_b32 s50, s49, 5
    s_min_u32 s50, s50, s47
    s_sub_u32 s51, s50, s46
    s_sub_u32 s52, s47, s50
    v_mov_b32 v12, s48
    v_mov_b32 v13, s51
    v_writelane_b32 v12, s49, 1
    v_writelane_b32 v13, s52, 1
    v_lshlrev_b32 v12, 7, v12
    s_mov_b32 s46, 179904512
    s_mov_b64 exec, 3
    buffer_atomic_add v13, v12, s[4:7], s46 offen sc1
    s_mov_b64 exec, -1
L_main_kernel_288:
    s_cmp_eq_u32 s0, 1
    s_cbranch_scc1 L_main_kernel_289
    s_mul_i32 s58, s3, 14336
    s_add_u32 s58, s58, 32768
    v_add_u32 v2, s58, v1
    s_waitcnt vmcnt(1)
    s_barrier
    ds_write_b128 v2, v[128:131] offset:0
    ds_write_b128 v2, v[132:135] offset:1024
    ds_write_b128 v2, v[136:139] offset:2048
    ds_write_b128 v2, v[140:143] offset:3072
    ds_write_b128 v2, v[144:147] offset:4096
    ds_write_b128 v2, v[148:151] offset:5120
    ds_write_b128 v2, v[152:155] offset:6144
    ds_write_b128 v2, v[156:159] offset:7168
    ds_write_b128 v2, v[160:163] offset:8192
    ds_write_b128 v2, v[164:167] offset:9216
    ds_write_b128 v2, v[168:171] offset:10240
    ds_write_b128 v2, v[172:175] offset:11264
    ds_write_b128 v2, v[176:179] offset:12288
    ds_write_b128 v2, v[180:183] offset:13312
    s_nop 0
    v_add_u32 v2, 32768, v1
    s_waitcnt lgkmcnt(0)
    s_barrier
    ds_read_b128 a[0:3], v2 offset:0
    ds_read_b128 a[4:7], v2 offset:1024
    ds_read_b128 a[8:11], v2 offset:2048
    ds_read_b128 a[12:15], v2 offset:3072
    ds_read_b128 a[16:19], v2 offset:4096
    ds_read_b128 a[20:23], v2 offset:5120
    ds_read_b128 a[24:27], v2 offset:6144
    ds_read_b128 a[28:31], v2 offset:7168
    ds_read_b128 a[32:35], v2 offset:8192
    ds_read_b128 a[36:39], v2 offset:9216
    ds_read_b128 a[40:43], v2 offset:10240
    ds_read_b128 a[44:47], v2 offset:11264
    s_waitcnt lgkmcnt(4)
    ds_read_b128 a[48:51], v2 offset:12288
    ds_read_b128 a[52:55], v2 offset:13312
    ds_read_b128 a[56:59], v2 offset:14336
    ds_read_b128 a[60:63], v2 offset:15360
    ds_read_b128 a[64:67], v2 offset:16384
    ds_read_b128 a[68:71], v2 offset:17408
    ds_read_b128 a[72:75], v2 offset:18432
    ds_read_b128 a[76:79], v2 offset:19456
    ds_read_b128 a[80:83], v2 offset:20480
    ds_read_b128 a[84:87], v2 offset:21504
    ds_read_b128 a[88:91], v2 offset:22528
    ds_read_b128 a[92:95], v2 offset:23552
    s_waitcnt lgkmcnt(4)
    ds_read_b128 a[96:99], v2 offset:24576
    ds_read_b128 a[100:103], v2 offset:25600
    ds_read_b128 a[104:107], v2 offset:26624
    ds_read_b128 a[108:111], v2 offset:27648
    ds_read_b128 a[112:115], v2 offset:28672
    ds_read_b128 a[116:119], v2 offset:29696
    ds_read_b128 a[120:123], v2 offset:30720
    ds_read_b128 a[124:127], v2 offset:31744
    ds_read_b128 a[128:131], v2 offset:32768
    ds_read_b128 a[132:135], v2 offset:33792
    ds_read_b128 a[136:139], v2 offset:34816
    ds_read_b128 a[140:143], v2 offset:35840
    s_waitcnt lgkmcnt(4)
    ds_read_b128 a[144:147], v2 offset:36864
    ds_read_b128 a[148:151], v2 offset:37888
    ds_read_b128 a[152:155], v2 offset:38912
    ds_read_b128 a[156:159], v2 offset:39936
    ds_read_b128 a[160:163], v2 offset:40960
    ds_read_b128 a[164:167], v2 offset:41984
    ds_read_b128 a[168:171], v2 offset:43008
    ds_read_b128 a[172:175], v2 offset:44032
    ds_read_b128 a[176:179], v2 offset:45056
    ds_read_b128 a[180:183], v2 offset:46080
    ds_read_b128 a[184:187], v2 offset:47104
    ds_read_b128 a[188:191], v2 offset:48128
    s_waitcnt lgkmcnt(4)
    ds_read_b128 a[192:195], v2 offset:49152
    ds_read_b128 a[196:199], v2 offset:50176
    ds_read_b128 a[200:203], v2 offset:51200
    ds_read_b128 a[204:207], v2 offset:52224
    ds_read_b128 a[208:211], v2 offset:53248
    ds_read_b128 a[212:215], v2 offset:54272
    ds_read_b128 a[216:219], v2 offset:55296
    ds_read_b128 a[220:223], v2 offset:56320
L_main_kernel_289:
    s_branch LBf_main_kernel_248
LBs_main_kernel_247:
    s_waitcnt vmcnt(0) lgkmcnt(0)
    s_barrier
    s_mov_b32 s78, 1
    ds_read_b128 v[16:19], v6 offset:0
    ds_read_b128 v[20:23], v6 offset:32
    ds_read_b128 v[24:27], v6 offset:2048
    ds_read_b128 v[28:31], v6 offset:2080
    ds_read_b128 v[32:35], v6 offset:4096
    ds_read_b128 v[36:39], v6 offset:4128
    ds_read_b128 v[40:43], v6 offset:6144
    ds_read_b128 v[44:47], v6 offset:6176
    ds_read_b128 v[48:51], v6 offset:8192
    ds_read_b128 v[52:55], v6 offset:8224
    ds_read_b128 v[56:59], v6 offset:10240
    ds_read_b128 v[60:63], v6 offset:10272
    ds_read_b128 v[64:67], v6 offset:12288
    ds_read_b128 v[68:71], v6 offset:12320
    v_mov_b32 v120, 0xff61b1e6
    v_mov_b32 v121, 0xff61b1e6
    v_mov_b32 v122, 0xff61b1e6
    v_mov_b32 v123, 0xff61b1e6
    v_mov_b32 v124, 0xff61b1e6
    v_mov_b32 v125, 0xff61b1e6
    v_mov_b32 v126, 0xff61b1e6
    s_mov_b32 s67, s65
    s_mov_b32 s68, s66
    s_mov_b32 s70, 16
LM_main_kernel_290:
    buffer_load_dwordx4 v[72:75], v1, s[12:15], s67 offen sc1
    buffer_load_dwordx4 v[76:79], v1, s[12:15], s67 offen offset:1024 sc1
    buffer_load_dwordx4 v[80:83], v1, s[12:15], s68 offen sc1
    buffer_load_dwordx4 v[84:87], v1, s[12:15], s68 offen offset:1024 sc1
    s_add_u32 s67, s67, 8192
    s_add_u32 s68, s68, 8192
    s_waitcnt vmcnt(0) lgkmcnt(0)
    v_mfma_f32_32x32x16_bf16 v[104:119], v[72:75], v[16:19], 0
    v_mfma_f32_32x32x16_bf16 v[104:119], v[76:79], v[20:23], v[104:119]
    s_nop 11
    v_max3_f32 v120, v120, v104, v105
    v_max3_f32 v120, v120, v106, v107
    v_max3_f32 v120, v120, v108, v109
    v_max3_f32 v120, v120, v110, v111
    v_max3_f32 v120, v120, v112, v113
    v_max3_f32 v120, v120, v114, v115
    v_max3_f32 v120, v120, v116, v117
    v_max3_f32 v120, v120, v118, v119
    v_mfma_f32_32x32x16_bf16 v[104:119], v[72:75], v[24:27], 0
    v_mfma_f32_32x32x16_bf16 v[104:119], v[76:79], v[28:31], v[104:119]
    s_nop 11
    v_max3_f32 v121, v121, v104, v105
    v_max3_f32 v121, v121, v106, v107
    v_max3_f32 v121, v121, v108, v109
    v_max3_f32 v121, v121, v110, v111
    v_max3_f32 v121, v121, v112, v113
    v_max3_f32 v121, v121, v114, v115
    v_max3_f32 v121, v121, v116, v117
    v_max3_f32 v121, v121, v118, v119
    v_mfma_f32_32x32x16_bf16 v[104:119], v[72:75], v[32:35], 0
    v_mfma_f32_32x32x16_bf16 v[104:119], v[76:79], v[36:39], v[104:119]
    s_nop 11
    v_max3_f32 v122, v122, v104, v105
    v_max3_f32 v122, v122, v106, v107
    v_max3_f32 v122, v122, v108, v109
    v_max3_f32 v122, v122, v110, v111
    v_max3_f32 v122, v122, v112, v113
    v_max3_f32 v122, v122, v114, v115
    v_max3_f32 v122, v122, v116, v117
    v_max3_f32 v122, v122, v118, v119
    v_mfma_f32_32x32x16_bf16 v[104:119], v[72:75], v[40:43], 0
    v_mfma_f32_32x32x16_bf16 v[104:119], v[76:79], v[44:47], v[104:119]
    s_nop 11
    v_max3_f32 v123, v123, v104, v105
    v_max3_f32 v123, v123, v106, v107
    v_max3_f32 v123, v123, v108, v109
    v_max3_f32 v123, v123, v110, v111
    v_max3_f32 v123, v123, v112, v113
    v_max3_f32 v123, v123, v114, v115
    v_max3_f32 v123, v123, v116, v117
    v_max3_f32 v123, v123, v118, v119
    v_mfma_f32_32x32x16_bf16 v[104:119], v[72:75], v[48:51], 0
    v_mfma_f32_32x32x16_bf16 v[104:119], v[76:79], v[52:55], v[104:119]
    s_nop 11
    v_max3_f32 v124, v124, v104, v105
    v_max3_f32 v124, v124, v106, v107
    v_max3_f32 v124, v124, v108, v109
    v_max3_f32 v124, v124, v110, v111
    v_max3_f32 v124, v124, v112, v113
    v_max3_f32 v124, v124, v114, v115
    v_max3_f32 v124, v124, v116, v117
    v_max3_f32 v124, v124, v118, v119
    v_mfma_f32_32x32x16_bf16 v[104:119], v[72:75], v[56:59], 0
    v_mfma_f32_32x32x16_bf16 v[104:119], v[76:79], v[60:63], v[104:119]
    s_nop 11
    v_max3_f32 v125, v125, v104, v105
    v_max3_f32 v125, v125, v106, v107
    v_max3_f32 v125, v125, v108, v109
    v_max3_f32 v125, v125, v110, v111
    v_max3_f32 v125, v125, v112, v113
    v_max3_f32 v125, v125, v114, v115
    v_max3_f32 v125, v125, v116, v117
    v_max3_f32 v125, v125, v118, v119
    v_mfma_f32_32x32x16_bf16 v[104:119], v[72:75], v[64:67], 0
    v_mfma_f32_32x32x16_bf16 v[104:119], v[76:79], v[68:71], v[104:119]
    s_nop 11
    v_max3_f32 v126, v126, v104, v105
    v_max3_f32 v126, v126, v106, v107
    v_max3_f32 v126, v126, v108, v109
    v_max3_f32 v126, v126, v110, v111
    v_max3_f32 v126, v126, v112, v113
    v_max3_f32 v126, v126, v114, v115
    v_max3_f32 v126, v126, v116, v117
    v_max3_f32 v126, v126, v118, v119
    s_sub_u32 s70, s70, 1
    s_cmp_lg_u32 s70, 0
    s_cbranch_scc1 LM_main_kernel_290
    v_and_b32 v7, 31, v0
    v_lshlrev_b32 v7, 2, v7
    s_lshl_b32 s46, s3, 10
    v_add_u32 v12, s46, v7
    v_mov_b32 v13, v120
    s_nop 1
    v_permlane32_swap_b32 v120, v13
    s_nop 0
    v_max_f32 v120, v120, v13
    ds_write_b32 v12, v120 offset:32512
    v_mov_b32 v13, v121
    s_nop 1
    v_permlane32_swap_b32 v121, v13
    s_nop 0
    v_max_f32 v121, v121, v13
    ds_write_b32 v12, v121 offset:32640
    v_mov_b32 v13, v122
    s_nop 1
    v_permlane32_swap_b32 v122, v13
    s_nop 0
    v_max_f32 v122, v122, v13
    ds_write_b32 v12, v122 offset:32768
    v_mov_b32 v13, v123
    s_nop 1
    v_permlane32_swap_b32 v123, v13
    s_nop 0
    v_max_f32 v123, v123, v13
    ds_write_b32 v12, v123 offset:32896
    v_mov_b32 v13, v124
    s_nop 1
    v_permlane32_swap_b32 v124, v13
    s_nop 0
    v_max_f32 v124, v124, v13
    ds_write_b32 v12, v124 offset:33024
    v_mov_b32 v13, v125
    s_nop 1
    v_permlane32_swap_b32 v125, v13
    s_nop 0
    v_max_f32 v125, v125, v13
    ds_write_b32 v12, v125 offset:33152
    v_mov_b32 v13, v126
    s_nop 1
    v_permlane32_swap_b32 v126, v13
    s_nop 0
    v_max_f32 v126, v126, v13
    ds_write_b32 v12, v126 offset:33280
    s_waitcnt lgkmcnt(0)
    s_barrier
    ds_read_b32 v104, v7 offset:32512
    ds_read_b32 v105, v7 offset:33536
    ds_read_b32 v106, v7 offset:34560
    ds_read_b32 v107, v7 offset:35584
    s_waitcnt lgkmcnt(0)
    v_max3_f32 v120, v104, v105, v106
    v_max_f32 v120, v120, v107
    ds_read_b32 v104, v7 offset:32640
    ds_read_b32 v105, v7 offset:33664
    ds_read_b32 v106, v7 offset:34688
    ds_read_b32 v107, v7 offset:35712
    s_waitcnt lgkmcnt(0)
    v_max3_f32 v121, v104, v105, v106
    v_max_f32 v121, v121, v107
    ds_read_b32 v104, v7 offset:32768
    ds_read_b32 v105, v7 offset:33792
    ds_read_b32 v106, v7 offset:34816
    ds_read_b32 v107, v7 offset:35840
    s_waitcnt lgkmcnt(0)
    v_max3_f32 v122, v104, v105, v106
    v_max_f32 v122, v122, v107
    ds_read_b32 v104, v7 offset:32896
    ds_read_b32 v105, v7 offset:33920
    ds_read_b32 v106, v7 offset:34944
    ds_read_b32 v107, v7 offset:35968
    s_waitcnt lgkmcnt(0)
    v_max3_f32 v123, v104, v105, v106
    v_max_f32 v123, v123, v107
    ds_read_b32 v104, v7 offset:33024
    ds_read_b32 v105, v7 offset:34048
    ds_read_b32 v106, v7 offset:35072
    ds_read_b32 v107, v7 offset:36096
    s_waitcnt lgkmcnt(0)
    v_max3_f32 v124, v104, v105, v106
    v_max_f32 v124, v124, v107
    ds_read_b32 v104, v7 offset:33152
    ds_read_b32 v105, v7 offset:34176
    ds_read_b32 v106, v7 offset:35200
    ds_read_b32 v107, v7 offset:36224
    s_waitcnt lgkmcnt(0)
    v_max3_f32 v125, v104, v105, v106
    v_max_f32 v125, v125, v107
    ds_read_b32 v104, v7 offset:33280
    ds_read_b32 v105, v7 offset:34304
    ds_read_b32 v106, v7 offset:35328
    ds_read_b32 v107, v7 offset:36352
    s_waitcnt lgkmcnt(0)
    v_max3_f32 v126, v104, v105, v106
    v_max_f32 v126, v126, v107
    v_mov_b64 v[144:145], 0
    v_mov_b64 v[146:147], 0
    v_mov_b64 v[148:149], 0
    v_mov_b64 v[150:151], 0
    v_mov_b64 v[152:153], 0
    v_mov_b64 v[154:155], 0
    v_mov_b64 v[156:157], 0
    v_mov_b64 v[158:159], 0
    v_mov_b64 v[160:161], 0
    v_mov_b64 v[162:163], 0
    v_mov_b64 v[164:165], 0
    v_mov_b64 v[166:167], 0
    v_mov_b64 v[168:169], 0
    v_mov_b64 v[170:171], 0
    v_mov_b64 v[172:173], 0
    v_mov_b64 v[174:175], 0
    v_mov_b64 v[176:177], 0
    v_mov_b64 v[178:179], 0
    v_mov_b64 v[180:181], 0
    v_mov_b64 v[182:183], 0
    v_mov_b64 v[184:185], 0
    v_mov_b64 v[186:187], 0
    v_mov_b64 v[188:189], 0
    v_mov_b64 v[190:191], 0
    v_mov_b64 v[192:193], 0
    v_mov_b64 v[194:195], 0
    v_mov_b64 v[196:197], 0
    v_mov_b64 v[198:199], 0
    v_mov_b64 v[200:201], 0
    v_mov_b64 v[202:203], 0
    v_mov_b64 v[204:205], 0
    v_mov_b64 v[206:207], 0
    v_mov_b64 v[208:209], 0
    v_mov_b64 v[210:211], 0
    v_mov_b64 v[212:213], 0
    v_mov_b64 v[214:215], 0
    v_mov_b64 v[216:217], 0
    v_mov_b64 v[218:219], 0
    v_mov_b64 v[220:221], 0
    v_mov_b64 v[222:223], 0
    v_mov_b64 v[224:225], 0
    v_mov_b64 v[226:227], 0
    v_mov_b64 v[228:229], 0
    v_mov_b64 v[230:231], 0
    v_mov_b64 v[232:233], 0
    v_mov_b64 v[234:235], 0
    v_mov_b64 v[236:237], 0
    v_mov_b64 v[238:239], 0
    v_mov_b64 v[240:241], 0
    v_mov_b64 v[242:243], 0
    v_mov_b64 v[244:245], 0
    v_mov_b64 v[246:247], 0
    v_mov_b64 v[248:249], 0
    v_mov_b64 v[250:251], 0
    v_mov_b64 v[252:253], 0
    v_mov_b64 v[254:255], 0
    s_mov_b32 s67, s65
    s_mov_b32 s68, s66
    s_mov_b32 s70, 16
LK_main_kernel_291:
    buffer_load_dwordx4 v[72:75], v1, s[12:15], s67 offen sc1
    buffer_load_dwordx4 v[76:79], v1, s[12:15], s67 offen offset:1024 sc1
    buffer_load_dwordx4 v[80:83], v1, s[12:15], s68 offen sc1
    buffer_load_dwordx4 v[84:87], v1, s[12:15], s68 offen offset:1024 sc1
    s_add_u32 s67, s67, 8192
    s_add_u32 s68, s68, 8192
    s_waitcnt vmcnt(0)
    v_sub_f32 v104, 0, v120
    v_sub_f32 v105, 0, v120
    v_sub_f32 v106, 0, v120
    v_sub_f32 v107, 0, v120
    v_sub_f32 v108, 0, v120
    v_sub_f32 v109, 0, v120
    v_sub_f32 v110, 0, v120
    v_sub_f32 v111, 0, v120
    v_sub_f32 v112, 0, v120
    v_sub_f32 v113, 0, v120
    v_sub_f32 v114, 0, v120
    v_sub_f32 v115, 0, v120
    v_sub_f32 v116, 0, v120
    v_sub_f32 v117, 0, v120
    v_sub_f32 v118, 0, v120
    v_sub_f32 v119, 0, v120
    s_nop 1
    v_mfma_f32_32x32x16_bf16 v[104:119], v[72:75], v[16:19], v[104:119]
    v_mfma_f32_32x32x16_bf16 v[104:119], v[76:79], v[20:23], v[104:119]
    s_nop 11
    v_exp_f32 v104, v104
    v_exp_f32 v105, v105
    v_exp_f32 v106, v106
    v_exp_f32 v107, v107
    v_exp_f32 v108, v108
    v_exp_f32 v109, v109
    v_exp_f32 v110, v110
    v_exp_f32 v111, v111
    v_cvt_pk_bf16_f32 v136, v104, v105
    v_cvt_pk_bf16_f32 v137, v106, v107
    v_cvt_pk_bf16_f32 v138, v108, v109
    v_cvt_pk_bf16_f32 v139, v110, v111
    s_nop 1
    v_mfma_f32_32x32x16_bf16 v[144:159], v[80:83], v[136:139], v[144:159]
    v_exp_f32 v112, v112
    v_exp_f32 v113, v113
    v_exp_f32 v114, v114
    v_exp_f32 v115, v115
    v_exp_f32 v116, v116
    v_exp_f32 v117, v117
    v_exp_f32 v118, v118
    v_exp_f32 v119, v119
    v_cvt_pk_bf16_f32 v140, v112, v113
    v_cvt_pk_bf16_f32 v141, v114, v115
    v_cvt_pk_bf16_f32 v142, v116, v117
    v_cvt_pk_bf16_f32 v143, v118, v119
    s_nop 1
    v_mfma_f32_32x32x16_bf16 v[144:159], v[84:87], v[140:143], v[144:159]
    v_sub_f32 v104, 0, v121
    v_sub_f32 v105, 0, v121
    v_sub_f32 v106, 0, v121
    v_sub_f32 v107, 0, v121
    v_sub_f32 v108, 0, v121
    v_sub_f32 v109, 0, v121
    v_sub_f32 v110, 0, v121
    v_sub_f32 v111, 0, v121
    v_sub_f32 v112, 0, v121
    v_sub_f32 v113, 0, v121
    v_sub_f32 v114, 0, v121
    v_sub_f32 v115, 0, v121
    v_sub_f32 v116, 0, v121
    v_sub_f32 v117, 0, v121
    v_sub_f32 v118, 0, v121
    v_sub_f32 v119, 0, v121
    s_nop 1
    v_mfma_f32_32x32x16_bf16 v[104:119], v[72:75], v[24:27], v[104:119]
    v_mfma_f32_32x32x16_bf16 v[104:119], v[76:79], v[28:31], v[104:119]
    s_nop 11
    v_exp_f32 v104, v104
    v_exp_f32 v105, v105
    v_exp_f32 v106, v106
    v_exp_f32 v107, v107
    v_exp_f32 v108, v108
    v_exp_f32 v109, v109
    v_exp_f32 v110, v110
    v_exp_f32 v111, v111
    v_cvt_pk_bf16_f32 v136, v104, v105
    v_cvt_pk_bf16_f32 v137, v106, v107
    v_cvt_pk_bf16_f32 v138, v108, v109
    v_cvt_pk_bf16_f32 v139, v110, v111
    s_nop 1
    v_mfma_f32_32x32x16_bf16 v[160:175], v[80:83], v[136:139], v[160:175]
    v_exp_f32 v112, v112
    v_exp_f32 v113, v113
    v_exp_f32 v114, v114
    v_exp_f32 v115, v115
    v_exp_f32 v116, v116
    v_exp_f32 v117, v117
    v_exp_f32 v118, v118
    v_exp_f32 v119, v119
    v_cvt_pk_bf16_f32 v140, v112, v113
    v_cvt_pk_bf16_f32 v141, v114, v115
    v_cvt_pk_bf16_f32 v142, v116, v117
    v_cvt_pk_bf16_f32 v143, v118, v119
    s_nop 1
    v_mfma_f32_32x32x16_bf16 v[160:175], v[84:87], v[140:143], v[160:175]
    v_sub_f32 v104, 0, v122
    v_sub_f32 v105, 0, v122
    v_sub_f32 v106, 0, v122
    v_sub_f32 v107, 0, v122
    v_sub_f32 v108, 0, v122
    v_sub_f32 v109, 0, v122
    v_sub_f32 v110, 0, v122
    v_sub_f32 v111, 0, v122
    v_sub_f32 v112, 0, v122
    v_sub_f32 v113, 0, v122
    v_sub_f32 v114, 0, v122
    v_sub_f32 v115, 0, v122
    v_sub_f32 v116, 0, v122
    v_sub_f32 v117, 0, v122
    v_sub_f32 v118, 0, v122
    v_sub_f32 v119, 0, v122
    s_nop 1
    v_mfma_f32_32x32x16_bf16 v[104:119], v[72:75], v[32:35], v[104:119]
    v_mfma_f32_32x32x16_bf16 v[104:119], v[76:79], v[36:39], v[104:119]
    s_nop 11
    v_exp_f32 v104, v104
    v_exp_f32 v105, v105
    v_exp_f32 v106, v106
    v_exp_f32 v107, v107
    v_exp_f32 v108, v108
    v_exp_f32 v109, v109
    v_exp_f32 v110, v110
    v_exp_f32 v111, v111
    v_cvt_pk_bf16_f32 v136, v104, v105
    v_cvt_pk_bf16_f32 v137, v106, v107
    v_cvt_pk_bf16_f32 v138, v108, v109
    v_cvt_pk_bf16_f32 v139, v110, v111
    s_nop 1
    v_mfma_f32_32x32x16_bf16 v[176:191], v[80:83], v[136:139], v[176:191]
    v_exp_f32 v112, v112
    v_exp_f32 v113, v113
    v_exp_f32 v114, v114
    v_exp_f32 v115, v115
    v_exp_f32 v116, v116
    v_exp_f32 v117, v117
    v_exp_f32 v118, v118
    v_exp_f32 v119, v119
    v_cvt_pk_bf16_f32 v140, v112, v113
    v_cvt_pk_bf16_f32 v141, v114, v115
    v_cvt_pk_bf16_f32 v142, v116, v117
    v_cvt_pk_bf16_f32 v143, v118, v119
    s_nop 1
    v_mfma_f32_32x32x16_bf16 v[176:191], v[84:87], v[140:143], v[176:191]
    v_sub_f32 v104, 0, v123
    v_sub_f32 v105, 0, v123
    v_sub_f32 v106, 0, v123
    v_sub_f32 v107, 0, v123
    v_sub_f32 v108, 0, v123
    v_sub_f32 v109, 0, v123
    v_sub_f32 v110, 0, v123
    v_sub_f32 v111, 0, v123
    v_sub_f32 v112, 0, v123
    v_sub_f32 v113, 0, v123
    v_sub_f32 v114, 0, v123
    v_sub_f32 v115, 0, v123
    v_sub_f32 v116, 0, v123
    v_sub_f32 v117, 0, v123
    v_sub_f32 v118, 0, v123
    v_sub_f32 v119, 0, v123
    s_nop 1
    v_mfma_f32_32x32x16_bf16 v[104:119], v[72:75], v[40:43], v[104:119]
    v_mfma_f32_32x32x16_bf16 v[104:119], v[76:79], v[44:47], v[104:119]
    s_nop 11
    v_exp_f32 v104, v104
    v_exp_f32 v105, v105
    v_exp_f32 v106, v106
    v_exp_f32 v107, v107
    v_exp_f32 v108, v108
    v_exp_f32 v109, v109
    v_exp_f32 v110, v110
    v_exp_f32 v111, v111
    v_cvt_pk_bf16_f32 v136, v104, v105
    v_cvt_pk_bf16_f32 v137, v106, v107
    v_cvt_pk_bf16_f32 v138, v108, v109
    v_cvt_pk_bf16_f32 v139, v110, v111
    s_nop 1
    v_mfma_f32_32x32x16_bf16 v[192:207], v[80:83], v[136:139], v[192:207]
    v_exp_f32 v112, v112
    v_exp_f32 v113, v113
    v_exp_f32 v114, v114
    v_exp_f32 v115, v115
    v_exp_f32 v116, v116
    v_exp_f32 v117, v117
    v_exp_f32 v118, v118
    v_exp_f32 v119, v119
    v_cvt_pk_bf16_f32 v140, v112, v113
    v_cvt_pk_bf16_f32 v141, v114, v115
    v_cvt_pk_bf16_f32 v142, v116, v117
    v_cvt_pk_bf16_f32 v143, v118, v119
    s_nop 1
    v_mfma_f32_32x32x16_bf16 v[192:207], v[84:87], v[140:143], v[192:207]
    v_sub_f32 v104, 0, v124
    v_sub_f32 v105, 0, v124
    v_sub_f32 v106, 0, v124
    v_sub_f32 v107, 0, v124
    v_sub_f32 v108, 0, v124
    v_sub_f32 v109, 0, v124
    v_sub_f32 v110, 0, v124
    v_sub_f32 v111, 0, v124
    v_sub_f32 v112, 0, v124
    v_sub_f32 v113, 0, v124
    v_sub_f32 v114, 0, v124
    v_sub_f32 v115, 0, v124
    v_sub_f32 v116, 0, v124
    v_sub_f32 v117, 0, v124
    v_sub_f32 v118, 0, v124
    v_sub_f32 v119, 0, v124
    s_nop 1
    v_mfma_f32_32x32x16_bf16 v[104:119], v[72:75], v[48:51], v[104:119]
    v_mfma_f32_32x32x16_bf16 v[104:119], v[76:79], v[52:55], v[104:119]
    s_nop 11
    v_exp_f32 v104, v104
    v_exp_f32 v105, v105
    v_exp_f32 v106, v106
    v_exp_f32 v107, v107
    v_exp_f32 v108, v108
    v_exp_f32 v109, v109
    v_exp_f32 v110, v110
    v_exp_f32 v111, v111
    v_cvt_pk_bf16_f32 v136, v104, v105
    v_cvt_pk_bf16_f32 v137, v106, v107
    v_cvt_pk_bf16_f32 v138, v108, v109
    v_cvt_pk_bf16_f32 v139, v110, v111
    s_nop 1
    v_mfma_f32_32x32x16_bf16 v[208:223], v[80:83], v[136:139], v[208:223]
    v_exp_f32 v112, v112
    v_exp_f32 v113, v113
    v_exp_f32 v114, v114
    v_exp_f32 v115, v115
    v_exp_f32 v116, v116
    v_exp_f32 v117, v117
    v_exp_f32 v118, v118
    v_exp_f32 v119, v119
    v_cvt_pk_bf16_f32 v140, v112, v113
    v_cvt_pk_bf16_f32 v141, v114, v115
    v_cvt_pk_bf16_f32 v142, v116, v117
    v_cvt_pk_bf16_f32 v143, v118, v119
    s_nop 1
    v_mfma_f32_32x32x16_bf16 v[208:223], v[84:87], v[140:143], v[208:223]
    v_sub_f32 v104, 0, v125
    v_sub_f32 v105, 0, v125
    v_sub_f32 v106, 0, v125
    v_sub_f32 v107, 0, v125
    v_sub_f32 v108, 0, v125
    v_sub_f32 v109, 0, v125
    v_sub_f32 v110, 0, v125
    v_sub_f32 v111, 0, v125
    v_sub_f32 v112, 0, v125
    v_sub_f32 v113, 0, v125
    v_sub_f32 v114, 0, v125
    v_sub_f32 v115, 0, v125
    v_sub_f32 v116, 0, v125
    v_sub_f32 v117, 0, v125
    v_sub_f32 v118, 0, v125
    v_sub_f32 v119, 0, v125
    s_nop 1
    v_mfma_f32_32x32x16_bf16 v[104:119], v[72:75], v[56:59], v[104:119]
    v_mfma_f32_32x32x16_bf16 v[104:119], v[76:79], v[60:63], v[104:119]
    s_nop 11
    v_exp_f32 v104, v104
    v_exp_f32 v105, v105
    v_exp_f32 v106, v106
    v_exp_f32 v107, v107
    v_exp_f32 v108, v108
    v_exp_f32 v109, v109
    v_exp_f32 v110, v110
    v_exp_f32 v111, v111
    v_cvt_pk_bf16_f32 v136, v104, v105
    v_cvt_pk_bf16_f32 v137, v106, v107
    v_cvt_pk_bf16_f32 v138, v108, v109
    v_cvt_pk_bf16_f32 v139, v110, v111
    s_nop 1
    v_mfma_f32_32x32x16_bf16 v[224:239], v[80:83], v[136:139], v[224:239]
    v_exp_f32 v112, v112
    v_exp_f32 v113, v113
    v_exp_f32 v114, v114
    v_exp_f32 v115, v115
    v_exp_f32 v116, v116
    v_exp_f32 v117, v117
    v_exp_f32 v118, v118
    v_exp_f32 v119, v119
    v_cvt_pk_bf16_f32 v140, v112, v113
    v_cvt_pk_bf16_f32 v141, v114, v115
    v_cvt_pk_bf16_f32 v142, v116, v117
    v_cvt_pk_bf16_f32 v143, v118, v119
    s_nop 1
    v_mfma_f32_32x32x16_bf16 v[224:239], v[84:87], v[140:143], v[224:239]
    v_sub_f32 v104, 0, v126
    v_sub_f32 v105, 0, v126
    v_sub_f32 v106, 0, v126
    v_sub_f32 v107, 0, v126
    v_sub_f32 v108, 0, v126
    v_sub_f32 v109, 0, v126
    v_sub_f32 v110, 0, v126
    v_sub_f32 v111, 0, v126
    v_sub_f32 v112, 0, v126
    v_sub_f32 v113, 0, v126
    v_sub_f32 v114, 0, v126
    v_sub_f32 v115, 0, v126
    v_sub_f32 v116, 0, v126
    v_sub_f32 v117, 0, v126
    v_sub_f32 v118, 0, v126
    v_sub_f32 v119, 0, v126
    s_nop 1
    v_mfma_f32_32x32x16_bf16 v[104:119], v[72:75], v[64:67], v[104:119]
    v_mfma_f32_32x32x16_bf16 v[104:119], v[76:79], v[68:71], v[104:119]
    s_nop 11
    v_exp_f32 v104, v104
    v_exp_f32 v105, v105
    v_exp_f32 v106, v106
    v_exp_f32 v107, v107
    v_exp_f32 v108, v108
    v_exp_f32 v109, v109
    v_exp_f32 v110, v110
    v_exp_f32 v111, v111
    v_cvt_pk_bf16_f32 v136, v104, v105
    v_cvt_pk_bf16_f32 v137, v106, v107
    v_cvt_pk_bf16_f32 v138, v108, v109
    v_cvt_pk_bf16_f32 v139, v110, v111
    s_nop 1
    v_mfma_f32_32x32x16_bf16 v[240:255], v[80:83], v[136:139], v[240:255]
    v_exp_f32 v112, v112
    v_exp_f32 v113, v113
    v_exp_f32 v114, v114
    v_exp_f32 v115, v115
    v_exp_f32 v116, v116
    v_exp_f32 v117, v117
    v_exp_f32 v118, v118
    v_exp_f32 v119, v119
    v_cvt_pk_bf16_f32 v140, v112, v113
    v_cvt_pk_bf16_f32 v141, v114, v115
    v_cvt_pk_bf16_f32 v142, v116, v117
    v_cvt_pk_bf16_f32 v143, v118, v119
    s_nop 1
    v_mfma_f32_32x32x16_bf16 v[240:255], v[84:87], v[140:143], v[240:255]
    s_sub_u32 s70, s70, 1
    s_cmp_lg_u32 s70, 0
    s_cbranch_scc1 LK_main_kernel_291
    s_branch LBr_main_kernel_246
LBf_main_kernel_248:
    s_branch Lnx_main_kernel_187
Lq_main_kernel_190:
    s_cmp_ge_u32 s100, 80
    s_cbranch_scc1 L2_main_kernel_192
    s_cmp_ge_u32 s100, 64
    s_cbranch_scc1 L4_main_kernel_191
    s_mov_b32 s60, s100
    v_lshlrev_b32 v1, 4, v0
    v_and_b32 v2, 15, v0
    v_lshrrev_b32 v3, 4, v0
    s_mul_i32 s46, s3, 100352
    s_add_u32 s46, s46, 12845056
    buffer_load_dwordx4 a[0:3], v1, s[4:7], s46 offen offset:0 sc1
    buffer_load_dwordx4 a[4:7], v1, s[4:7], s46 offen offset:1024 sc1
    buffer_load_dwordx4 a[8:11], v1, s[4:7], s46 offen offset:2048 sc1
    buffer_load_dwordx4 a[12:15], v1, s[4:7], s46 offen offset:3072 sc1
    s_add_u32 s46, s46, 4096
    buffer_load_dwordx4 a[16:19], v1, s[4:7], s46 offen offset:0 sc1
    buffer_load_dwordx4 a[20:23], v1, s[4:7], s46 offen offset:1024 sc1
    buffer_load_dwordx4 a[24:27], v1, s[4:7], s46 offen offset:2048 sc1
    buffer_load_dwordx4 a[28:31], v1, s[4:7], s46 offen offset:3072 sc1
    s_add_u32 s46, s46, 4096
    buffer_load_dwordx4 a[32:35], v1, s[4:7], s46 offen offset:0 sc1
    buffer_load_dwordx4 a[36:39], v1, s[4:7], s46 offen offset:1024 sc1
    buffer_load_dwordx4 a[40:43], v1, s[4:7], s46 offen offset:2048 sc1
    buffer_load_dwordx4 a[44:47], v1, s[4:7], s46 offen offset:3072 sc1
    s_add_u32 s46, s46, 4096
    buffer_load_dwordx4 a[48:51], v1, s[4:7], s46 offen offset:0 sc1
    buffer_load_dwordx4 a[52:55], v1, s[4:7], s46 offen offset:1024 sc1
    buffer_load_dwordx4 a[56:59], v1, s[4:7], s46 offen offset:2048 sc1
    buffer_load_dwordx4 a[60:63], v1, s[4:7], s46 offen offset:3072 sc1
    s_add_u32 s46, s46, 4096
    buffer_load_dwordx4 a[64:67], v1, s[4:7], s46 offen offset:0 sc1
    buffer_load_dwordx4 a[68:71], v1, s[4:7], s46 offen offset:1024 sc1
    buffer_load_dwordx4 a[72:75], v1, s[4:7], s46 offen offset:2048 sc1
    buffer_load_dwordx4 a[76:79], v1, s[4:7], s46 offen offset:3072 sc1
    s_add_u32 s46, s46, 4096
    buffer_load_dwordx4 a[80:83], v1, s[4:7], s46 offen offset:0 sc1
    buffer_load_dwordx4 a[84:87], v1, s[4:7], s46 offen offset:1024 sc1
    buffer_load_dwordx4 a[88:91], v1, s[4:7], s46 offen offset:2048 sc1
    buffer_load_dwordx4 a[92:95], v1, s[4:7], s46 offen offset:3072 sc1
    s_add_u32 s46, s46, 4096
    buffer_load_dwordx4 a[96:99], v1, s[4:7], s46 offen offset:0 sc1
    buffer_load_dwordx4 a[100:103], v1, s[4:7], s46 offen offset:1024 sc1
    buffer_load_dwordx4 a[104:107], v1, s[4:7], s46 offen offset:2048 sc1
    buffer_load_dwordx4 a[108:111], v1, s[4:7], s46 offen offset:3072 sc1
    s_add_u32 s46, s46, 4096
    buffer_load_dwordx4 a[112:115], v1, s[4:7], s46 offen offset:0 sc1
    buffer_load_dwordx4 a[116:119], v1, s[4:7], s46 offen offset:1024 sc1
    buffer_load_dwordx4 a[120:123], v1, s[4:7], s46 offen offset:2048 sc1
    buffer_load_dwordx4 a[124:127], v1, s[4:7], s46 offen offset:3072 sc1
    s_add_u32 s46, s46, 4096
    buffer_load_dwordx4 a[128:131], v1, s[4:7], s46 offen offset:0 sc1
    buffer_load_dwordx4 a[132:135], v1, s[4:7], s46 offen offset:1024 sc1
    buffer_load_dwordx4 a[136:139], v1, s[4:7], s46 offen offset:2048 sc1
    buffer_load_dwordx4 a[140:143], v1, s[4:7], s46 offen offset:3072 sc1
    s_add_u32 s46, s46, 4096
    buffer_load_dwordx4 a[144:147], v1, s[4:7], s46 offen offset:0 sc1
    buffer_load_dwordx4 a[148:151], v1, s[4:7], s46 offen offset:1024 sc1
    buffer_load_dwordx4 a[152:155], v1, s[4:7], s46 offen offset:2048 sc1
    buffer_load_dwordx4 a[156:159], v1, s[4:7], s46 offen offset:3072 sc1
    s_add_u32 s46, s46, 4096
    buffer_load_dwordx4 a[160:163], v1, s[4:7], s46 offen offset:0 sc1
    buffer_load_dwordx4 a[164:167], v1, s[4:7], s46 offen offset:1024 sc1
    buffer_load_dwordx4 a[168:171], v1, s[4:7], s46 offen offset:2048 sc1
    buffer_load_dwordx4 a[172:175], v1, s[4:7], s46 offen offset:3072 sc1
    s_add_u32 s46, s46, 4096
    buffer_load_dwordx4 a[176:179], v1, s[4:7], s46 offen offset:0 sc1
    buffer_load_dwordx4 a[180:183], v1, s[4:7], s46 offen offset:1024 sc1
    buffer_load_dwordx4 a[184:187], v1, s[4:7], s46 offen offset:2048 sc1
    buffer_load_dwordx4 a[188:191], v1, s[4:7], s46 offen offset:3072 sc1
    s_add_u32 s46, s46, 4096
    buffer_load_dwordx4 a[192:195], v1, s[4:7], s46 offen offset:0 sc1
    buffer_load_dwordx4 a[196:199], v1, s[4:7], s46 offen offset:1024 sc1
    buffer_load_dwordx4 a[200:203], v1, s[4:7], s46 offen offset:2048 sc1
    buffer_load_dwordx4 a[204:207], v1, s[4:7], s46 offen offset:3072 sc1
    s_add_u32 s46, s46, 4096
    buffer_load_dwordx4 a[208:211], v1, s[4:7], s46 offen offset:0 sc1
    buffer_load_dwordx4 a[212:215], v1, s[4:7], s46 offen offset:1024 sc1
    buffer_load_dwordx4 a[216:219], v1, s[4:7], s46 offen offset:2048 sc1
    buffer_load_dwordx4 a[220:223], v1, s[4:7], s46 offen offset:3072 sc1
    s_add_u32 s46, s46, 4096
    buffer_load_dwordx4 a[224:227], v1, s[4:7], s46 offen offset:0 sc1
    buffer_load_dwordx4 a[228:231], v1, s[4:7], s46 offen offset:1024 sc1
    buffer_load_dwordx4 a[232:235], v1, s[4:7], s46 offen offset:2048 sc1
    buffer_load_dwordx4 a[236:239], v1, s[4:7], s46 offen offset:3072 sc1
    s_add_u32 s46, s46, 4096
    buffer_load_dwordx4 a[240:243], v1, s[4:7], s46 offen offset:0 sc1
    buffer_load_dwordx4 a[244:247], v1, s[4:7], s46 offen offset:1024 sc1
    buffer_load_dwordx4 a[248:251], v1, s[4:7], s46 offen offset:2048 sc1
    buffer_load_dwordx4 a[252:255], v1, s[4:7], s46 offen offset:3072 sc1
    s_add_u32 s46, s46, 4096
    buffer_load_dwordx4 v[120:123], v1, s[4:7], s46 offen offset:0 sc1
    buffer_load_dwordx4 v[124:127], v1, s[4:7], s46 offen offset:1024 sc1
    buffer_load_dwordx4 v[128:131], v1, s[4:7], s46 offen offset:2048 sc1
    buffer_load_dwordx4 v[132:135], v1, s[4:7], s46 offen offset:3072 sc1
    s_add_u32 s46, s46, 4096
    buffer_load_dwordx4 v[136:139], v1, s[4:7], s46 offen offset:0 sc1
    buffer_load_dwordx4 v[140:143], v1, s[4:7], s46 offen offset:1024 sc1
    buffer_load_dwordx4 v[144:147], v1, s[4:7], s46 offen offset:2048 sc1
    buffer_load_dwordx4 v[148:151], v1, s[4:7], s46 offen offset:3072 sc1
    s_add_u32 s46, s46, 4096
    buffer_load_dwordx4 v[152:155], v1, s[4:7], s46 offen offset:0 sc1
    buffer_load_dwordx4 v[156:159], v1, s[4:7], s46 offen offset:1024 sc1
    buffer_load_dwordx4 v[160:163], v1, s[4:7], s46 offen offset:2048 sc1
    buffer_load_dwordx4 v[164:167], v1, s[4:7], s46 offen offset:3072 sc1
    s_add_u32 s46, s46, 4096
    buffer_load_dwordx4 v[168:171], v1, s[4:7], s46 offen offset:0 sc1
    buffer_load_dwordx4 v[172:175], v1, s[4:7], s46 offen offset:1024 sc1
    buffer_load_dwordx4 v[176:179], v1, s[4:7], s46 offen offset:2048 sc1
    buffer_load_dwordx4 v[180:183], v1, s[4:7], s46 offen offset:3072 sc1
    s_add_u32 s46, s46, 4096
    buffer_load_dwordx4 v[184:187], v1, s[4:7], s46 offen offset:0 sc1
    buffer_load_dwordx4 v[188:191], v1, s[4:7], s46 offen offset:1024 sc1
    buffer_load_dwordx4 v[192:195], v1, s[4:7], s46 offen offset:2048 sc1
    buffer_load_dwordx4 v[196:199], v1, s[4:7], s46 offen offset:3072 sc1
    s_add_u32 s46, s46, 4096
    buffer_load_dwordx4 v[200:203], v1, s[4:7], s46 offen offset:0 sc1
    buffer_load_dwordx4 v[204:207], v1, s[4:7], s46 offen offset:1024 sc1
    buffer_load_dwordx4 v[208:211], v1, s[4:7], s46 offen offset:2048 sc1
    buffer_load_dwordx4 v[212:215], v1, s[4:7], s46 offen offset:3072 sc1
    s_add_u32 s46, s46, 4096
    buffer_load_dwordx4 v[216:219], v1, s[4:7], s46 offen offset:0 sc1
    buffer_load_dwordx4 v[220:223], v1, s[4:7], s46 offen offset:1024 sc1
    buffer_load_dwordx4 v[224:227], v1, s[4:7], s46 offen offset:2048 sc1
    buffer_load_dwordx4 v[228:231], v1, s[4:7], s46 offen offset:3072 sc1
    s_add_u32 s46, s46, 4096
    buffer_load_dwordx4 v[232:235], v1, s[4:7], s46 offen offset:0 sc1
    buffer_load_dwordx4 v[236:239], v1, s[4:7], s46 offen offset:1024 sc1
    buffer_load_dwordx4 v[240:243], v1, s[4:7], s46 offen offset:2048 sc1
    buffer_load_dwordx4 v[244:247], v1, s[4:7], s46 offen offset:3072 sc1
    s_add_u32 s46, s46, 4096
    buffer_load_dwordx4 v[248:251], v1, s[4:7], s46 offen offset:0 sc1
    buffer_load_dwordx4 v[252:255], v1, s[4:7], s46 offen offset:1024 sc1
    s_mul_i32 s61, s60, 12
    s_add_u32 s61, s61, 1064
    v_min_u32 v4, 11, v2
    v_add_u32 v4, s61, v4
    v_min_u32 v4, 1791, v4
    v_lshrrev_b32 v5, 4, v4
    v_mul_u32_u24 v5, 14336, v5
    v_and_b32 v6, 15, v4
    v_lshl_add_u32 v5, v6, 4, v5
    v_lshl_add_u32 v5, v3, 8, v5
    v_mov_b64 v[8:9], 0
    v_mov_b64 v[10:11], 0
    s_lshl_b32 s46, s3, 12
    v_add_u32 v7, s46, v1
    ds_write_b128 v7, v[8:11] offset:0
    ds_write_b128 v7, v[8:11] offset:1024
    ds_write_b128 v7, v[8:11] offset:2048
    ds_write_b128 v7, v[8:11] offset:3072
    s_nop 0
    v_mov_b32 v7, 36608
    ds_write_b32 v7, v8
    v_lshrrev_b32 v12, 5, v4
    v_lshlrev_b32 v12, 7, v12
    s_mov_b32 s49, 97714176
    s_lshr_b32 s50, s61, 5
    s_min_u32 s50, s50, 61
    s_waitcnt vmcnt(0)
    s_cmp_lg_u32 s3, 0
    s_cbranch_scc1 Lwo_main_kernel_293
    s_mov_b32 s47, 2097152
    s_mov_b32 s46, 97768448
Lwf_main_kernel_294:
    v_mov_b32 v13, 0
    buffer_load_dword v13, v13, s[12:15], s46 offen sc1
    s_sub_u32 s47, s47, 1
    s_cbranch_scc1 Lexit_main_kernel
    s_waitcnt vmcnt(0)
    v_cmp_gt_i32 vcc, s50, v13
    s_cbranch_vccz Lwn_main_kernel_295
    s_sleep 48
    s_branch Lwf_main_kernel_294
Lwn_main_kernel_295:
Lwc_main_kernel_292:
    buffer_load_dword v13, v12, s[12:15], s49 offen sc1
    s_sub_u32 s47, s47, 1
    s_cbranch_scc1 Lexit_main_kernel
    s_waitcnt vmcnt(0)
    v_cmp_ne_u32 vcc, 4, v13
    s_cbranch_vccz Lwo_main_kernel_293
    s_sleep 1
    s_branch Lwc_main_kernel_292
Lwo_main_kernel_293:
    s_barrier
    s_mov_b32 s48, 17432576
    s_mov_b32 s70, 2097152
    s_waitcnt lgkmcnt(0)
    s_barrier
    s_mul_i32 s63, s3, 112
    v_lshlrev_b32 v6, 2, v3
    v_add_u32 v6, s63, v6
    v_lshlrev_b32 v7, 10, v2
    v_add_u32 v8, 0, v6
    v_mul_u32_u24 v9, 2341, v8
    v_lshrrev_b32 v9, 16, v9
    v_lshl_add_u32 v8, v8, 1, v7
    v_lshl_add_u32 v100, v9, 3, v8
    v_add_u32 v8, 16, v6
    v_mul_u32_u24 v9, 2341, v8
    v_lshrrev_b32 v9, 16, v9
    v_lshl_add_u32 v8, v8, 1, v7
    v_lshl_add_u32 v101, v9, 3, v8
    v_add_u32 v8, 32, v6
    v_mul_u32_u24 v9, 2341, v8
    v_lshrrev_b32 v9, 16, v9
    v_lshl_add_u32 v8, v8, 1, v7
    v_lshl_add_u32 v102, v9, 3, v8
    v_add_u32 v8, 48, v6
    v_mul_u32_u24 v9, 2341, v8
    v_lshrrev_b32 v9, 16, v9
    v_lshl_add_u32 v8, v8, 1, v7
    v_lshl_add_u32 v103, v9, 3, v8
    v_add_u32 v8, 64, v6
    v_mul_u32_u24 v9, 2341, v8
    v_lshrrev_b32 v9, 16, v9
    v_lshl_add_u32 v8, v8, 1, v7
    v_lshl_add_u32 v104, v9, 3, v8
    v_add_u32 v8, 80, v6
    v_mul_u32_u24 v9, 2341, v8
    v_lshrrev_b32 v9, 16, v9
    v_lshl_add_u32 v8, v8, 1, v7
    v_lshl_add_u32 v105, v9, 3, v8
    v_add_u32 v8, 96, v6
    v_mul_u32_u24 v9, 2341, v8
    v_lshrrev_b32 v9, 16, v9
    v_lshl_add_u32 v8, v8, 1, v7
    v_lshl_add_u32 v106, v9, 3, v8
    s_mov_b32 s64, 0x3e8b97f6
Lx_main_kernel_296:
    buffer_load_dwordx4 v[16:19], v5, s[12:15], s48 offen offset:0 sc1
    buffer_load_dwordx4 v[20:23], v5, s[12:15], s48 offen offset:1024 sc1
    buffer_load_dwordx4 v[24:27], v5, s[12:15], s48 offen offset:2048 sc1
    buffer_load_dwordx4 v[28:31], v5, s[12:15], s48 offen offset:3072 sc1
    s_add_u32 s47, s48, 4096
    buffer_load_dwordx4 v[32:35], v5, s[12:15], s47 offen offset:0 sc1
    buffer_load_dwordx4 v[36:39], v5, s[12:15], s47 offen offset:1024 sc1
    buffer_load_dwordx4 v[40:43], v5, s[12:15], s47 offen offset:2048 sc1
    buffer_load_dwordx4 v[44:47], v5, s[12:15], s47 offen offset:3072 sc1
    s_add_u32 s47, s47, 4096
    buffer_load_dwordx4 v[48:51], v5, s[12:15], s47 offen offset:0 sc1
    buffer_load_dwordx4 v[52:55], v5, s[12:15], s47 offen offset:1024 sc1
    buffer_load_dwordx4 v[56:59], v5, s[12:15], s47 offen offset:2048 sc1
    buffer_load_dwordx4 v[60:63], v5, s[12:15], s47 offen offset:3072 sc1
    s_add_u32 s47, s47, 4096
    buffer_load_dwordx4 v[64:67], v5, s[12:15], s47 offen offset:0 sc1
    buffer_load_dwordx4 v[68:71], v5, s[12:15], s47 offen offset:1024 sc1
    s_waitcnt vmcnt(13)
    v_mfma_f32_16x16x32_bf16 v[72:75], a[0:3], v[16:19], 0
    v_mfma_f32_16x16x32_bf16 v[76:79], a[56:59], v[16:19], 0
    v_mfma_f32_16x16x32_bf16 v[80:83], a[112:115], v[16:19], 0
    v_mfma_f32_16x16x32_bf16 v[84:87], a[168:171], v[16:19], 0
    v_mfma_f32_16x16x32_bf16 v[88:91], a[224:227], v[16:19], 0
    v_mfma_f32_16x16x32_bf16 v[92:95], v[144:147], v[16:19], 0
    v_mfma_f32_16x16x32_bf16 v[96:99], v[200:203], v[16:19], 0
    s_waitcnt vmcnt(12)
    v_mfma_f32_16x16x32_bf16 v[72:75], a[4:7], v[20:23], v[72:75]
    v_mfma_f32_16x16x32_bf16 v[76:79], a[60:63], v[20:23], v[76:79]
    v_mfma_f32_16x16x32_bf16 v[80:83], a[116:119], v[20:23], v[80:83]
    v_mfma_f32_16x16x32_bf16 v[84:87], a[172:175], v[20:23], v[84:87]
    v_mfma_f32_16x16x32_bf16 v[88:91], a[228:231], v[20:23], v[88:91]
    v_mfma_f32_16x16x32_bf16 v[92:95], v[148:151], v[20:23], v[92:95]
    v_mfma_f32_16x16x32_bf16 v[96:99], v[204:207], v[20:23], v[96:99]
    s_waitcnt vmcnt(11)
    v_mfma_f32_16x16x32_bf16 v[72:75], a[8:11], v[24:27], v[72:75]
    v_mfma_f32_16x16x32_bf16 v[76:79], a[64:67], v[24:27], v[76:79]
    v_mfma_f32_16x16x32_bf16 v[80:83], a[120:123], v[24:27], v[80:83]
    v_mfma_f32_16x16x32_bf16 v[84:87], a[176:179], v[24:27], v[84:87]
    v_mfma_f32_16x16x32_bf16 v[88:91], a[232:235], v[24:27], v[88:91]
    v_mfma_f32_16x16x32_bf16 v[92:95], v[152:155], v[24:27], v[92:95]
    v_mfma_f32_16x16x32_bf16 v[96:99], v[208:211], v[24:27], v[96:99]
    s_waitcnt vmcnt(10)
    v_mfma_f32_16x16x32_bf16 v[72:75], a[12:15], v[28:31], v[72:75]
    v_mfma_f32_16x16x32_bf16 v[76:79], a[68:71], v[28:31], v[76:79]
    v_mfma_f32_16x16x32_bf16 v[80:83], a[124:127], v[28:31], v[80:83]
    v_mfma_f32_16x16x32_bf16 v[84:87], a[180:183], v[28:31], v[84:87]
    v_mfma_f32_16x16x32_bf16 v[88:91], a[236:239], v[28:31], v[88:91]
    v_mfma_f32_16x16x32_bf16 v[92:95], v[156:159], v[28:31], v[92:95]
    v_mfma_f32_16x16x32_bf16 v[96:99], v[212:215], v[28:31], v[96:99]
    s_waitcnt vmcnt(9)
    v_mfma_f32_16x16x32_bf16 v[72:75], a[16:19], v[32:35], v[72:75]
    v_mfma_f32_16x16x32_bf16 v[76:79], a[72:75], v[32:35], v[76:79]
    v_mfma_f32_16x16x32_bf16 v[80:83], a[128:131], v[32:35], v[80:83]
    v_mfma_f32_16x16x32_bf16 v[84:87], a[184:187], v[32:35], v[84:87]
    v_mfma_f32_16x16x32_bf16 v[88:91], a[240:243], v[32:35], v[88:91]
    v_mfma_f32_16x16x32_bf16 v[92:95], v[160:163], v[32:35], v[92:95]
    v_mfma_f32_16x16x32_bf16 v[96:99], v[216:219], v[32:35], v[96:99]
    s_waitcnt vmcnt(8)
    v_mfma_f32_16x16x32_bf16 v[72:75], a[20:23], v[36:39], v[72:75]
    v_mfma_f32_16x16x32_bf16 v[76:79], a[76:79], v[36:39], v[76:79]
    v_mfma_f32_16x16x32_bf16 v[80:83], a[132:135], v[36:39], v[80:83]
    v_mfma_f32_16x16x32_bf16 v[84:87], a[188:191], v[36:39], v[84:87]
    v_mfma_f32_16x16x32_bf16 v[88:91], a[244:247], v[36:39], v[88:91]
    v_mfma_f32_16x16x32_bf16 v[92:95], v[164:167], v[36:39], v[92:95]
    v_mfma_f32_16x16x32_bf16 v[96:99], v[220:223], v[36:39], v[96:99]
    s_waitcnt vmcnt(7)
    v_mfma_f32_16x16x32_bf16 v[72:75], a[24:27], v[40:43], v[72:75]
    v_mfma_f32_16x16x32_bf16 v[76:79], a[80:83], v[40:43], v[76:79]
    v_mfma_f32_16x16x32_bf16 v[80:83], a[136:139], v[40:43], v[80:83]
    v_mfma_f32_16x16x32_bf16 v[84:87], a[192:195], v[40:43], v[84:87]
    v_mfma_f32_16x16x32_bf16 v[88:91], a[248:251], v[40:43], v[88:91]
    v_mfma_f32_16x16x32_bf16 v[92:95], v[168:171], v[40:43], v[92:95]
    v_mfma_f32_16x16x32_bf16 v[96:99], v[224:227], v[40:43], v[96:99]
    s_waitcnt vmcnt(6)
    v_mfma_f32_16x16x32_bf16 v[72:75], a[28:31], v[44:47], v[72:75]
    v_mfma_f32_16x16x32_bf16 v[76:79], a[84:87], v[44:47], v[76:79]
    v_mfma_f32_16x16x32_bf16 v[80:83], a[140:143], v[44:47], v[80:83]
    v_mfma_f32_16x16x32_bf16 v[84:87], a[196:199], v[44:47], v[84:87]
    v_mfma_f32_16x16x32_bf16 v[88:91], a[252:255], v[44:47], v[88:91]
    v_mfma_f32_16x16x32_bf16 v[92:95], v[172:175], v[44:47], v[92:95]
    v_mfma_f32_16x16x32_bf16 v[96:99], v[228:231], v[44:47], v[96:99]
    s_waitcnt vmcnt(5)
    v_mfma_f32_16x16x32_bf16 v[72:75], a[32:35], v[48:51], v[72:75]
    v_mfma_f32_16x16x32_bf16 v[76:79], a[88:91], v[48:51], v[76:79]
    v_mfma_f32_16x16x32_bf16 v[80:83], a[144:147], v[48:51], v[80:83]
    v_mfma_f32_16x16x32_bf16 v[84:87], a[200:203], v[48:51], v[84:87]
    v_mfma_f32_16x16x32_bf16 v[88:91], v[120:123], v[48:51], v[88:91]
    v_mfma_f32_16x16x32_bf16 v[92:95], v[176:179], v[48:51], v[92:95]
    v_mfma_f32_16x16x32_bf16 v[96:99], v[232:235], v[48:51], v[96:99]
    s_waitcnt vmcnt(4)
    v_mfma_f32_16x16x32_bf16 v[72:75], a[36:39], v[52:55], v[72:75]
    v_mfma_f32_16x16x32_bf16 v[76:79], a[92:95], v[52:55], v[76:79]
    v_mfma_f32_16x16x32_bf16 v[80:83], a[148:151], v[52:55], v[80:83]
    v_mfma_f32_16x16x32_bf16 v[84:87], a[204:207], v[52:55], v[84:87]
    v_mfma_f32_16x16x32_bf16 v[88:91], v[124:127], v[52:55], v[88:91]
    v_mfma_f32_16x16x32_bf16 v[92:95], v[180:183], v[52:55], v[92:95]
    v_mfma_f32_16x16x32_bf16 v[96:99], v[236:239], v[52:55], v[96:99]
    s_waitcnt vmcnt(3)
    v_mfma_f32_16x16x32_bf16 v[72:75], a[40:43], v[56:59], v[72:75]
    v_mfma_f32_16x16x32_bf16 v[76:79], a[96:99], v[56:59], v[76:79]
    v_mfma_f32_16x16x32_bf16 v[80:83], a[152:155], v[56:59], v[80:83]
    v_mfma_f32_16x16x32_bf16 v[84:87], a[208:211], v[56:59], v[84:87]
    v_mfma_f32_16x16x32_bf16 v[88:91], v[128:131], v[56:59], v[88:91]
    v_mfma_f32_16x16x32_bf16 v[92:95], v[184:187], v[56:59], v[92:95]
    v_mfma_f32_16x16x32_bf16 v[96:99], v[240:243], v[56:59], v[96:99]
    s_waitcnt vmcnt(2)
    v_mfma_f32_16x16x32_bf16 v[72:75], a[44:47], v[60:63], v[72:75]
    v_mfma_f32_16x16x32_bf16 v[76:79], a[100:103], v[60:63], v[76:79]
    v_mfma_f32_16x16x32_bf16 v[80:83], a[156:159], v[60:63], v[80:83]
    v_mfma_f32_16x16x32_bf16 v[84:87], a[212:215], v[60:63], v[84:87]
    v_mfma_f32_16x16x32_bf16 v[88:91], v[132:135], v[60:63], v[88:91]
    v_mfma_f32_16x16x32_bf16 v[92:95], v[188:191], v[60:63], v[92:95]
    v_mfma_f32_16x16x32_bf16 v[96:99], v[244:247], v[60:63], v[96:99]
    s_waitcnt vmcnt(1)
    v_mfma_f32_16x16x32_bf16 v[72:75], a[48:51], v[64:67], v[72:75]
    v_mfma_f32_16x16x32_bf16 v[76:79], a[104:107], v[64:67], v[76:79]
    v_mfma_f32_16x16x32_bf16 v[80:83], a[160:163], v[64:67], v[80:83]
    v_mfma_f32_16x16x32_bf16 v[84:87], a[216:219], v[64:67], v[84:87]
    v_mfma_f32_16x16x32_bf16 v[88:91], v[136:139], v[64:67], v[88:91]
    v_mfma_f32_16x16x32_bf16 v[92:95], v[192:195], v[64:67], v[92:95]
    v_mfma_f32_16x16x32_bf16 v[96:99], v[248:251], v[64:67], v[96:99]
    s_waitcnt vmcnt(0)
    v_mfma_f32_16x16x32_bf16 v[72:75], a[52:55], v[68:71], v[72:75]
    v_mfma_f32_16x16x32_bf16 v[76:79], a[108:111], v[68:71], v[76:79]
    v_mfma_f32_16x16x32_bf16 v[80:83], a[164:167], v[68:71], v[80:83]
    v_mfma_f32_16x16x32_bf16 v[84:87], a[220:223], v[68:71], v[84:87]
    v_mfma_f32_16x16x32_bf16 v[88:91], v[140:143], v[68:71], v[88:91]
    v_mfma_f32_16x16x32_bf16 v[92:95], v[196:199], v[68:71], v[92:95]
    v_mfma_f32_16x16x32_bf16 v[96:99], v[252:255], v[68:71], v[96:99]
    s_lshl_b32 s65, s3, 11
    s_add_u32 s66, s65, 88879104
    s_add_u32 s65, s65, 88743936
    s_mov_b32 s67, s65
    s_mov_b32 s68, s66
    s_mov_b32 s78, 0
    s_mov_b32 s96, 0
    s_mov_b32 s98, s3
    v_mul_f32 v72, s64, v72
    v_mul_f32 v73, s64, v73
    v_mul_f32 v74, s64, v74
    v_mul_f32 v75, s64, v75
    v_cvt_pk_bf16_f32 v72, v72, v73
    v_cvt_pk_bf16_f32 v73, v74, v75
    ds_write_b64 v100, v[72:73] offset:0
    v_mul_f32 v76, s64, v76
    v_mul_f32 v77, s64, v77
    v_mul_f32 v78, s64, v78
    v_mul_f32 v79, s64, v79
    v_cvt_pk_bf16_f32 v76, v76, v77
    v_cvt_pk_bf16_f32 v77, v78, v79
    ds_write_b64 v101, v[76:77] offset:0
    v_mul_f32 v80, s64, v80
    v_mul_f32 v81, s64, v81
    v_mul_f32 v82, s64, v82
    v_mul_f32 v83, s64, v83
    v_cvt_pk_bf16_f32 v80, v80, v81
    v_cvt_pk_bf16_f32 v81, v82, v83
    ds_write_b64 v102, v[80:81] offset:0
    v_mul_f32 v84, s64, v84
    v_mul_f32 v85, s64, v85
    v_mul_f32 v86, s64, v86
    v_mul_f32 v87, s64, v87
    v_cvt_pk_bf16_f32 v84, v84, v85
    v_cvt_pk_bf16_f32 v85, v86, v87
    ds_write_b64 v103, v[84:85] offset:0
    v_mul_f32 v88, s64, v88
    v_mul_f32 v89, s64, v89
    v_mul_f32 v90, s64, v90
    v_mul_f32 v91, s64, v91
    v_cvt_pk_bf16_f32 v88, v88, v89
    v_cvt_pk_bf16_f32 v89, v90, v91
    ds_write_b64 v104, v[88:89] offset:0
    v_mul_f32 v92, s64, v92
    v_mul_f32 v93, s64, v93
    v_mul_f32 v94, s64, v94
    v_mul_f32 v95, s64, v95
    v_cvt_pk_bf16_f32 v92, v92, v93
    v_cvt_pk_bf16_f32 v93, v94, v95
    ds_write_b64 v105, v[92:93] offset:0
    v_mul_f32 v96, s64, v96
    v_mul_f32 v97, s64, v97
    v_mul_f32 v98, s64, v98
    v_mul_f32 v99, s64, v99
    v_cvt_pk_bf16_f32 v96, v96, v97
    v_cvt_pk_bf16_f32 v97, v98, v99
    ds_write_b64 v106, v[96:97] offset:0
    s_lshl_b32 s69, s3, 2
    s_cmp_eq_u32 s3, 3
    s_cselect_b32 s69, 11, s69
    s_mul_i32 s62, s69, 28672
    s_add_u32 s62, s62, 13246464
    s_add_u32 s46, s62, 0
    buffer_load_dwordx4 a[0:3], v1, s[4:7], s46 offen offset:0 sc1
    buffer_load_dwordx4 a[4:7], v1, s[4:7], s46 offen offset:1024 sc1
    buffer_load_dwordx4 a[8:11], v1, s[4:7], s46 offen offset:2048 sc1
    buffer_load_dwordx4 a[12:15], v1, s[4:7], s46 offen offset:3072 sc1
    s_add_u32 s46, s62, 4096
    buffer_load_dwordx4 a[16:19], v1, s[4:7], s46 offen offset:0 sc1
    buffer_load_dwordx4 a[20:23], v1, s[4:7], s46 offen offset:1024 sc1
    buffer_load_dwordx4 a[24:27], v1, s[4:7], s46 offen offset:2048 sc1
    buffer_load_dwordx4 a[28:31], v1, s[4:7], s46 offen offset:3072 sc1
    s_add_u32 s46, s62, 8192
    buffer_load_dwordx4 a[32:35], v1, s[4:7], s46 offen offset:0 sc1
    buffer_load_dwordx4 a[36:39], v1, s[4:7], s46 offen offset:1024 sc1
    buffer_load_dwordx4 a[40:43], v1, s[4:7], s46 offen offset:2048 sc1
    buffer_load_dwordx4 a[44:47], v1, s[4:7], s46 offen offset:3072 sc1
    s_add_u32 s46, s62, 12288
    buffer_load_dwordx4 a[48:51], v1, s[4:7], s46 offen offset:0 sc1
    buffer_load_dwordx4 a[52:55], v1, s[4:7], s46 offen offset:1024 sc1
    buffer_load_dwordx4 a[56:59], v1, s[4:7], s46 offen offset:2048 sc1
    buffer_load_dwordx4 a[60:63], v1, s[4:7], s46 offen offset:3072 sc1
    s_add_u32 s46, s62, 16384
    buffer_load_dwordx4 a[64:67], v1, s[4:7], s46 offen offset:0 sc1
    buffer_load_dwordx4 a[68:71], v1, s[4:7], s46 offen offset:1024 sc1
    buffer_load_dwordx4 a[72:75], v1, s[4:7], s46 offen offset:2048 sc1
    buffer_load_dwordx4 a[76:79], v1, s[4:7], s46 offen offset:3072 sc1
    s_add_u32 s46, s62, 20480
    buffer_load_dwordx4 a[80:83], v1, s[4:7], s46 offen offset:0 sc1
    buffer_load_dwordx4 a[84:87], v1, s[4:7], s46 offen offset:1024 sc1
    buffer_load_dwordx4 a[88:91], v1, s[4:7], s46 offen offset:2048 sc1
    buffer_load_dwordx4 a[92:95], v1, s[4:7], s46 offen offset:3072 sc1
    s_add_u32 s46, s62, 24576
    buffer_load_dwordx4 a[96:99], v1, s[4:7], s46 offen offset:0 sc1
    buffer_load_dwordx4 a[100:103], v1, s[4:7], s46 offen offset:1024 sc1
    buffer_load_dwordx4 a[104:107], v1, s[4:7], s46 offen offset:2048 sc1
    buffer_load_dwordx4 a[108:111], v1, s[4:7], s46 offen offset:3072 sc1
    s_add_u32 s46, s62, 28672
    buffer_load_dwordx4 a[112:115], v1, s[4:7], s46 offen offset:0 sc1
    buffer_load_dwordx4 a[116:119], v1, s[4:7], s46 offen offset:1024 sc1
    buffer_load_dwordx4 a[120:123], v1, s[4:7], s46 offen offset:2048 sc1
    buffer_load_dwordx4 a[124:127], v1, s[4:7], s46 offen offset:3072 sc1
    s_add_u32 s46, s62, 32768
    buffer_load_dwordx4 a[128:131], v1, s[4:7], s46 offen offset:0 sc1
    buffer_load_dwordx4 a[132:135], v1, s[4:7], s46 offen offset:1024 sc1
    buffer_load_dwordx4 a[136:139], v1, s[4:7], s46 offen offset:2048 sc1
    buffer_load_dwordx4 a[140:143], v1, s[4:7], s46 offen offset:3072 sc1
    s_add_u32 s46, s62, 36864
    buffer_load_dwordx4 a[144:147], v1, s[4:7], s46 offen offset:0 sc1
    buffer_load_dwordx4 a[148:151], v1, s[4:7], s46 offen offset:1024 sc1
    buffer_load_dwordx4 a[152:155], v1, s[4:7], s46 offen offset:2048 sc1
    buffer_load_dwordx4 a[156:159], v1, s[4:7], s46 offen offset:3072 sc1
    s_add_u32 s46, s62, 40960
    buffer_load_dwordx4 a[160:163], v1, s[4:7], s46 offen offset:0 sc1
    buffer_load_dwordx4 a[164:167], v1, s[4:7], s46 offen offset:1024 sc1
    buffer_load_dwordx4 a[168:171], v1, s[4:7], s46 offen offset:2048 sc1
    buffer_load_dwordx4 a[172:175], v1, s[4:7], s46 offen offset:3072 sc1
    s_add_u32 s46, s62, 45056
    buffer_load_dwordx4 a[176:179], v1, s[4:7], s46 offen offset:0 sc1
    buffer_load_dwordx4 a[180:183], v1, s[4:7], s46 offen offset:1024 sc1
    buffer_load_dwordx4 a[184:187], v1, s[4:7], s46 offen offset:2048 sc1
    buffer_load_dwordx4 a[188:191], v1, s[4:7], s46 offen offset:3072 sc1
    s_add_u32 s46, s62, 49152
    buffer_load_dwordx4 a[192:195], v1, s[4:7], s46 offen offset:0 sc1
    buffer_load_dwordx4 a[196:199], v1, s[4:7], s46 offen offset:1024 sc1
    buffer_load_dwordx4 a[200:203], v1, s[4:7], s46 offen offset:2048 sc1
    buffer_load_dwordx4 a[204:207], v1, s[4:7], s46 offen offset:3072 sc1
    s_add_u32 s46, s62, 53248
    buffer_load_dwordx4 a[208:211], v1, s[4:7], s46 offen offset:0 sc1
    buffer_load_dwordx4 a[212:215], v1, s[4:7], s46 offen offset:1024 sc1
    buffer_load_dwordx4 a[216:219], v1, s[4:7], s46 offen offset:2048 sc1
    buffer_load_dwordx4 a[220:223], v1, s[4:7], s46 offen offset:3072 sc1
    s_add_u32 s46, s62, 57344
    buffer_load_dwordx4 a[224:227], v1, s[4:7], s46 offen offset:0 sc1
    buffer_load_dwordx4 a[228:231], v1, s[4:7], s46 offen offset:1024 sc1
    buffer_load_dwordx4 a[232:235], v1, s[4:7], s46 offen offset:2048 sc1
    buffer_load_dwordx4 a[236:239], v1, s[4:7], s46 offen offset:3072 sc1
    s_add_u32 s46, s62, 61440
    buffer_load_dwordx4 a[240:243], v1, s[4:7], s46 offen offset:0 sc1
    buffer_load_dwordx4 a[244:247], v1, s[4:7], s46 offen offset:1024 sc1
    buffer_load_dwordx4 a[248:251], v1, s[4:7], s46 offen offset:2048 sc1
    buffer_load_dwordx4 a[252:255], v1, s[4:7], s46 offen offset:3072 sc1
    s_waitcnt lgkmcnt(0)
    s_barrier
    v_bfe_u32 v6, v0, 4, 1
    v_lshlrev_b32 v6, 10, v6
    v_lshl_add_u32 v6, v2, 6, v6
    v_lshrrev_b32 v7, 5, v0
    v_lshl_add_u32 v6, v7, 4, v6
    ds_read_b128 v[16:19], v6 offset:0
    ds_read_b128 v[20:23], v6 offset:32
    ds_read_b128 v[24:27], v6 offset:2048
    ds_read_b128 v[28:31], v6 offset:2080
    ds_read_b128 v[32:35], v6 offset:4096
    ds_read_b128 v[36:39], v6 offset:4128
    ds_read_b128 v[40:43], v6 offset:6144
    ds_read_b128 v[44:47], v6 offset:6176
    ds_read_b128 v[48:51], v6 offset:8192
    ds_read_b128 v[52:55], v6 offset:8224
    ds_read_b128 v[56:59], v6 offset:10240
    ds_read_b128 v[60:63], v6 offset:10272
    v_mov_b64 v[144:145], 0
    v_mov_b64 v[146:147], 0
    v_mov_b64 v[148:149], 0
    v_mov_b64 v[150:151], 0
    v_mov_b64 v[152:153], 0
    v_mov_b64 v[154:155], 0
    v_mov_b64 v[156:157], 0
    v_mov_b64 v[158:159], 0
    v_mov_b64 v[160:161], 0
    v_mov_b64 v[162:163], 0
    v_mov_b64 v[164:165], 0
    v_mov_b64 v[166:167], 0
    v_mov_b64 v[168:169], 0
    v_mov_b64 v[170:171], 0
    v_mov_b64 v[172:173], 0
    v_mov_b64 v[174:175], 0
    v_mov_b64 v[176:177], 0
    v_mov_b64 v[178:179], 0
    v_mov_b64 v[180:181], 0
    v_mov_b64 v[182:183], 0
    v_mov_b64 v[184:185], 0
    v_mov_b64 v[186:187], 0
    v_mov_b64 v[188:189], 0
    v_mov_b64 v[190:191], 0
    v_mov_b64 v[192:193], 0
    v_mov_b64 v[194:195], 0
    v_mov_b64 v[196:197], 0
    v_mov_b64 v[198:199], 0
    v_mov_b64 v[200:201], 0
    v_mov_b64 v[202:203], 0
    v_mov_b64 v[204:205], 0
    v_mov_b64 v[206:207], 0
    v_mov_b64 v[208:209], 0
    v_mov_b64 v[210:211], 0
    v_mov_b64 v[212:213], 0
    v_mov_b64 v[214:215], 0
    v_mov_b64 v[216:217], 0
    v_mov_b64 v[218:219], 0
    v_mov_b64 v[220:221], 0
    v_mov_b64 v[222:223], 0
    v_mov_b64 v[224:225], 0
    v_mov_b64 v[226:227], 0
    v_mov_b64 v[228:229], 0
    v_mov_b64 v[230:231], 0
    v_mov_b64 v[232:233], 0
    v_mov_b64 v[234:235], 0
    v_mov_b64 v[236:237], 0
    v_mov_b64 v[238:239], 0
    s_cmp_lt_u32 s98, s96
    s_cbranch_scc1 Lgo_main_kernel_297
    s_mov_b32 s70, 2097152
    v_lshlrev_b32 v8, 3, v1
    v_and_b32 v8, 0x780, v8
Lgl_main_kernel_298:
    s_min_u32 s96, s96, 48
    s_lshl_b32 s97, s96, 7
    s_add_u32 s97, s97, 97714176
    s_mov_b64 exec, 0xffff
    buffer_load_dword v9, v8, s[12:15], s97 offen sc1
    s_mov_b64 exec, -1
    s_sub_u32 s70, s70, 1
    s_cbranch_scc1 Lexit_main_kernel
    s_waitcnt vmcnt(0)
    v_cmp_ne_u32 vcc, 4, v9
    s_nop 0
    s_or_b32 s97, vcc_lo, 0x10000
    s_ff1_i32_b32 s97, s97
    s_add_u32 s96, s96, s97
    s_cmp_eq_u32 s97, 16
    s_cselect_b32 s97, 1, 0
    s_cmp_ge_u32 s96, 64
    s_cselect_b32 s96, 0x100, s96
    s_cbranch_scc1 Lgo_main_kernel_297
    s_cmp_eq_u32 s97, 1
    s_cbranch_scc1 Lgl_main_kernel_298
    s_cmp_lt_u32 s98, s96
    s_cbranch_scc1 Lgo_main_kernel_297
    s_add_u32 s97, s96, 1
    s_cmp_gt_u32 s98, s97
    s_cbranch_scc1 Lgf_main_kernel_299
    s_sleep 2
    s_branch Lgl_main_kernel_298
Lgf_main_kernel_299:
    s_sleep 40
    s_branch Lgl_main_kernel_298
Lgo_main_kernel_297:
    buffer_load_dwordx4 v[72:75], v1, s[12:15], s67 offen offset:0 sc1
    buffer_load_dwordx4 v[76:79], v1, s[12:15], s67 offen offset:1024 sc1
    buffer_load_dwordx4 v[80:83], v1, s[12:15], s68 offen offset:0 sc1
    buffer_load_dwordx4 v[84:87], v1, s[12:15], s68 offen offset:1024 sc1
    s_add_u32 s67, s67, 8192
    s_add_u32 s68, s68, 8192
    s_add_u32 s98, s98, 4
    s_waitcnt lgkmcnt(0)
LK_main_kernel_300:
    s_cmp_lt_u32 s98, s96
    s_cselect_b32 s79, 1, 0
    s_cmp_lt_u32 s98, 64
    s_cselect_b32 s79, s79, 0
    s_cmp_eq_u32 s79, 0
    s_cbranch_scc1 L_main_kernel_306
    buffer_load_dwordx4 v[88:91], v1, s[12:15], s67 offen offset:0 sc1
    buffer_load_dwordx4 v[92:95], v1, s[12:15], s67 offen offset:1024 sc1
    buffer_load_dwordx4 v[96:99], v1, s[12:15], s68 offen offset:0 sc1
    buffer_load_dwordx4 v[100:103], v1, s[12:15], s68 offen offset:1024 sc1
    s_add_u32 s67, s67, 8192
    s_add_u32 s68, s68, 8192
    s_waitcnt vmcnt(4)
    s_branch L_main_kernel_307
LKd_main_kernel_304:
    s_cmp_lt_u32 s98, s96
    s_cselect_b32 s79, 1, 0
    s_cmp_lt_u32 s98, 64
    s_cselect_b32 s79, s79, 0
    s_cmp_eq_u32 s79, 0
    s_cbranch_scc1 LKw_main_kernel_302
    buffer_load_dwordx4 v[88:91], v1, s[12:15], s67 offen offset:0 sc1
    buffer_load_dwordx4 v[92:95], v1, s[12:15], s67 offen offset:1024 sc1
    buffer_load_dwordx4 v[96:99], v1, s[12:15], s68 offen offset:0 sc1
    buffer_load_dwordx4 v[100:103], v1, s[12:15], s68 offen offset:1024 sc1
    s_add_u32 s67, s67, 8192
    s_add_u32 s68, s68, 8192
    s_branch LKw_main_kernel_302
L_main_kernel_306:
    s_waitcnt vmcnt(0)
L_main_kernel_307:
    v_mfma_f32_32x32x16_bf16 v[104:119], v[72:75], v[16:19], 0
    v_mfma_f32_32x32x16_bf16 v[104:119], v[76:79], v[20:23], v[104:119]
LKw_main_kernel_302:
    v_mfma_f32_32x32x16_bf16 v[120:135], v[72:75], v[24:27], 0
    s_nop 4
    v_exp_f32 v104, v104
    v_exp_f32 v105, v105
    v_exp_f32 v106, v106
    v_exp_f32 v107, v107
    v_exp_f32 v108, v108
    v_exp_f32 v109, v109
    v_exp_f32 v110, v110
    v_exp_f32 v111, v111
    v_mfma_f32_32x32x16_bf16 v[120:135], v[76:79], v[28:31], v[120:135]
    v_cvt_pk_bf16_f32 v136, v104, v105
    v_cvt_pk_bf16_f32 v137, v106, v107
    v_cvt_pk_bf16_f32 v138, v108, v109
    v_cvt_pk_bf16_f32 v139, v110, v111
    v_exp_f32 v112, v112
    v_exp_f32 v113, v113
    v_exp_f32 v114, v114
    v_exp_f32 v115, v115
    v_mfma_f32_32x32x16_bf16 v[144:159], v[80:83], v[136:139], v[144:159]
    v_exp_f32 v116, v116
    v_exp_f32 v117, v117
    v_exp_f32 v118, v118
    v_exp_f32 v119, v119
    v_cvt_pk_bf16_f32 v140, v112, v113
    v_cvt_pk_bf16_f32 v141, v114, v115
    v_cvt_pk_bf16_f32 v142, v116, v117
    v_cvt_pk_bf16_f32 v143, v118, v119
    v_mfma_f32_32x32x16_bf16 v[104:119], v[72:75], v[32:35], 0
    v_exp_f32 v120, v120
    v_exp_f32 v121, v121
    v_exp_f32 v122, v122
    v_exp_f32 v123, v123
    v_mfma_f32_32x32x16_bf16 v[144:159], v[84:87], v[140:143], v[144:159]
    v_exp_f32 v124, v124
    v_exp_f32 v125, v125
    v_exp_f32 v126, v126
    v_exp_f32 v127, v127
    v_mfma_f32_32x32x16_bf16 v[104:119], v[76:79], v[36:39], v[104:119]
    v_cvt_pk_bf16_f32 v136, v120, v121
    v_cvt_pk_bf16_f32 v137, v122, v123
    v_cvt_pk_bf16_f32 v138, v124, v125
    v_cvt_pk_bf16_f32 v139, v126, v127
    v_exp_f32 v128, v128
    v_exp_f32 v129, v129
    v_exp_f32 v130, v130
    v_exp_f32 v131, v131
    v_mfma_f32_32x32x16_bf16 v[160:175], v[80:83], v[136:139], v[160:175]
    v_exp_f32 v132, v132
    v_exp_f32 v133, v133
    v_exp_f32 v134, v134
    v_exp_f32 v135, v135
    v_cvt_pk_bf16_f32 v140, v128, v129
    v_cvt_pk_bf16_f32 v141, v130, v131
    v_cvt_pk_bf16_f32 v142, v132, v133
    v_cvt_pk_bf16_f32 v143, v134, v135
    v_mfma_f32_32x32x16_bf16 v[120:135], v[72:75], v[40:43], 0
    v_exp_f32 v104, v104
    v_exp_f32 v105, v105
    v_exp_f32 v106, v106
    v_exp_f32 v107, v107
    v_mfma_f32_32x32x16_bf16 v[160:175], v[84:87], v[140:143], v[160:175]
    v_exp_f32 v108, v108
    v_exp_f32 v109, v109
    v_exp_f32 v110, v110
    v_exp_f32 v111, v111
    v_mfma_f32_32x32x16_bf16 v[120:135], v[76:79], v[44:47], v[120:135]
    v_cvt_pk_bf16_f32 v136, v104, v105
    v_cvt_pk_bf16_f32 v137, v106, v107
    v_cvt_pk_bf16_f32 v138, v108, v109
    v_cvt_pk_bf16_f32 v139, v110, v111
    v_exp_f32 v112, v112
    v_exp_f32 v113, v113
    v_exp_f32 v114, v114
    v_exp_f32 v115, v115
    v_mfma_f32_32x32x16_bf16 v[176:191], v[80:83], v[136:139], v[176:191]
    v_exp_f32 v116, v116
    v_exp_f32 v117, v117
    v_exp_f32 v118, v118
    v_exp_f32 v119, v119
    v_cvt_pk_bf16_f32 v140, v112, v113
    v_cvt_pk_bf16_f32 v141, v114, v115
    v_cvt_pk_bf16_f32 v142, v116, v117
    v_cvt_pk_bf16_f32 v143, v118, v119
    v_mfma_f32_32x32x16_bf16 v[104:119], v[72:75], v[48:51], 0
    v_exp_f32 v120, v120
    v_exp_f32 v121, v121
    v_exp_f32 v122, v122
    v_exp_f32 v123, v123
    v_mfma_f32_32x32x16_bf16 v[176:191], v[84:87], v[140:143], v[176:191]
    v_exp_f32 v124, v124
    v_exp_f32 v125, v125
    v_exp_f32 v126, v126
    v_exp_f32 v127, v127
    v_mfma_f32_32x32x16_bf16 v[104:119], v[76:79], v[52:55], v[104:119]
    v_cvt_pk_bf16_f32 v136, v120, v121
    v_cvt_pk_bf16_f32 v137, v122, v123
    v_cvt_pk_bf16_f32 v138, v124, v125
    v_cvt_pk_bf16_f32 v139, v126, v127
    v_exp_f32 v128, v128
    v_exp_f32 v129, v129
    v_exp_f32 v130, v130
    v_exp_f32 v131, v131
    v_mfma_f32_32x32x16_bf16 v[192:207], v[80:83], v[136:139], v[192:207]
    v_exp_f32 v132, v132
    v_exp_f32 v133, v133
    v_exp_f32 v134, v134
    v_exp_f32 v135, v135
    v_cvt_pk_bf16_f32 v140, v128, v129
    v_cvt_pk_bf16_f32 v141, v130, v131
    v_cvt_pk_bf16_f32 v142, v132, v133
    v_cvt_pk_bf16_f32 v143, v134, v135
    v_mfma_f32_32x32x16_bf16 v[120:135], v[72:75], v[56:59], 0
    v_exp_f32 v104, v104
    v_exp_f32 v105, v105
    v_exp_f32 v106, v106
    v_exp_f32 v107, v107
    v_mfma_f32_32x32x16_bf16 v[192:207], v[84:87], v[140:143], v[192:207]
    v_exp_f32 v108, v108
    v_exp_f32 v109, v109
    v_exp_f32 v110, v110
    v_exp_f32 v111, v111
    v_mfma_f32_32x32x16_bf16 v[120:135], v[76:79], v[60:63], v[120:135]
    v_cvt_pk_bf16_f32 v136, v104, v105
    v_cvt_pk_bf16_f32 v137, v106, v107
    v_cvt_pk_bf16_f32 v138, v108, v109
    v_cvt_pk_bf16_f32 v139, v110, v111
    v_exp_f32 v112, v112
    v_exp_f32 v113, v113
    v_exp_f32 v114, v114
    v_exp_f32 v115, v115
    v_mfma_f32_32x32x16_bf16 v[208:223], v[80:83], v[136:139], v[208:223]
    v_exp_f32 v116, v116
    v_exp_f32 v117, v117
    v_exp_f32 v118, v118
    v_exp_f32 v119, v119
    v_cvt_pk_bf16_f32 v140, v112, v113
    v_cvt_pk_bf16_f32 v141, v114, v115
    v_cvt_pk_bf16_f32 v142, v116, v117
    v_cvt_pk_bf16_f32 v143, v118, v119
    s_cmp_eq_u32 s79, 0
    s_cbranch_scc1 L_main_kernel_309
    s_waitcnt vmcnt(0)
    v_mfma_f32_32x32x16_bf16 v[104:119], v[88:91], v[16:19], 0
    v_exp_f32 v120, v120
    v_exp_f32 v121, v121
    v_exp_f32 v122, v122
    v_exp_f32 v123, v123
    v_mfma_f32_32x32x16_bf16 v[208:223], v[84:87], v[140:143], v[208:223]
    v_exp_f32 v124, v124
    v_exp_f32 v125, v125
    v_exp_f32 v126, v126
    v_exp_f32 v127, v127
    v_mfma_f32_32x32x16_bf16 v[104:119], v[92:95], v[20:23], v[104:119]
    v_cvt_pk_bf16_f32 v136, v120, v121
    v_cvt_pk_bf16_f32 v137, v122, v123
    v_cvt_pk_bf16_f32 v138, v124, v125
    v_cvt_pk_bf16_f32 v139, v126, v127
    v_exp_f32 v128, v128
    v_exp_f32 v129, v129
    v_exp_f32 v130, v130
    v_exp_f32 v131, v131
    v_mfma_f32_32x32x16_bf16 v[224:239], v[80:83], v[136:139], v[224:239]
    v_exp_f32 v132, v132
    v_exp_f32 v133, v133
    v_exp_f32 v134, v134
    v_exp_f32 v135, v135
    v_cvt_pk_bf16_f32 v140, v128, v129
    v_cvt_pk_bf16_f32 v141, v130, v131
    v_cvt_pk_bf16_f32 v142, v132, v133
    v_cvt_pk_bf16_f32 v143, v134, v135
    s_nop 1
    v_mfma_f32_32x32x16_bf16 v[224:239], v[84:87], v[140:143], v[224:239]
    s_add_u32 s98, s98, 4
    s_branch LKd_main_kernel_305
L_main_kernel_309:
    v_exp_f32 v120, v120
    v_exp_f32 v121, v121
    v_exp_f32 v122, v122
    v_exp_f32 v123, v123
    v_mfma_f32_32x32x16_bf16 v[208:223], v[84:87], v[140:143], v[208:223]
    v_exp_f32 v124, v124
    v_exp_f32 v125, v125
    v_exp_f32 v126, v126
    v_exp_f32 v127, v127
    v_cvt_pk_bf16_f32 v136, v120, v121
    v_cvt_pk_bf16_f32 v137, v122, v123
    v_cvt_pk_bf16_f32 v138, v124, v125
    v_cvt_pk_bf16_f32 v139, v126, v127
    v_exp_f32 v128, v128
    v_exp_f32 v129, v129
    v_exp_f32 v130, v130
    v_exp_f32 v131, v131
    v_mfma_f32_32x32x16_bf16 v[224:239], v[80:83], v[136:139], v[224:239]
    v_exp_f32 v132, v132
    v_exp_f32 v133, v133
    v_exp_f32 v134, v134
    v_exp_f32 v135, v135
    v_cvt_pk_bf16_f32 v140, v128, v129
    v_cvt_pk_bf16_f32 v141, v130, v131
    v_cvt_pk_bf16_f32 v142, v132, v133
    v_cvt_pk_bf16_f32 v143, v134, v135
    s_nop 1
    v_mfma_f32_32x32x16_bf16 v[224:239], v[84:87], v[140:143], v[224:239]
    s_lshr_b32 s46, s98, 2
    s_cmp_lg_u32 s46, 13
    s_cbranch_scc1 L_main_kernel_310
    v_lshlrev_b32 v8, 3, v1
    s_getpc_b64 s[82:83]
Lpc_main_kernel_311:
    s_add_u32 s82, s82, LKe_main_kernel_301-Lpc_main_kernel_311
    s_addc_u32 s83, s83, 0
    global_load_dword v9, v8, s[82:83]
    s_getpc_b64 s[82:83]
Lpc_main_kernel_312:
    s_add_u32 s82, s82, Ltop_main_kernel_167-Lpc_main_kernel_312
    s_addc_u32 s83, s83, -1
    global_load_dword v9, v8, s[82:83]
L_main_kernel_310:
    s_cmp_lt_u32 s98, s96
    s_cbranch_scc1 Lgo_main_kernel_313
    s_mov_b32 s70, 2097152
    v_lshlrev_b32 v8, 3, v1
    v_and_b32 v8, 0x780, v8
Lgl_main_kernel_314:
    s_min_u32 s96, s96, 48
    s_lshl_b32 s97, s96, 7
    s_add_u32 s97, s97, 97714176
    s_mov_b64 exec, 0xffff
    buffer_load_dword v9, v8, s[12:15], s97 offen sc1
    s_mov_b64 exec, -1
    s_sub_u32 s70, s70, 1
    s_cbranch_scc1 Lexit_main_kernel
    s_waitcnt vmcnt(0)
    v_cmp_ne_u32 vcc, 4, v9
    s_nop 0
    s_or_b32 s97, vcc_lo, 0x10000
    s_ff1_i32_b32 s97, s97
    s_add_u32 s96, s96, s97
    s_cmp_eq_u32 s97, 16
    s_cselect_b32 s97, 1, 0
    s_cmp_ge_u32 s96, 64
    s_cselect_b32 s96, 0x100, s96
    s_cbranch_scc1 Lgo_main_kernel_313
    s_cmp_eq_u32 s97, 1
    s_cbranch_scc1 Lgl_main_kernel_314
    s_cmp_lt_u32 s98, s96
    s_cbranch_scc1 Lgo_main_kernel_313
    s_add_u32 s97, s96, 1
    s_cmp_gt_u32 s98, s97
    s_cbranch_scc1 Lgf_main_kernel_315
    s_sleep 2
    s_branch Lgl_main_kernel_314
Lgf_main_kernel_315:
    s_sleep 40
    s_branch Lgl_main_kernel_314
Lgo_main_kernel_313:
    buffer_load_dwordx4 v[88:91], v1, s[12:15], s67 offen offset:0 sc1
    buffer_load_dwordx4 v[92:95], v1, s[12:15], s67 offen offset:1024 sc1
    buffer_load_dwordx4 v[96:99], v1, s[12:15], s68 offen offset:0 sc1
    buffer_load_dwordx4 v[100:103], v1, s[12:15], s68 offen offset:1024 sc1
    s_add_u32 s67, s67, 8192
    s_add_u32 s68, s68, 8192
L_main_kernel_308:
    s_add_u32 s98, s98, 4
    s_cmp_lt_u32 s98, s96
    s_cselect_b32 s79, 1, 0
    s_cmp_lt_u32 s98, 64
    s_cselect_b32 s79, s79, 0
    s_cmp_eq_u32 s79, 0
    s_cbranch_scc1 L_main_kernel_316
    buffer_load_dwordx4 v[72:75], v1, s[12:15], s67 offen offset:0 sc1
    buffer_load_dwordx4 v[76:79], v1, s[12:15], s67 offen offset:1024 sc1
    buffer_load_dwordx4 v[80:83], v1, s[12:15], s68 offen offset:0 sc1
    buffer_load_dwordx4 v[84:87], v1, s[12:15], s68 offen offset:1024 sc1
    s_add_u32 s67, s67, 8192
    s_add_u32 s68, s68, 8192
    s_waitcnt vmcnt(4)
    s_branch L_main_kernel_317
LKd_main_kernel_305:
    s_cmp_lt_u32 s98, s96
    s_cselect_b32 s79, 1, 0
    s_cmp_lt_u32 s98, 64
    s_cselect_b32 s79, s79, 0
    s_cmp_eq_u32 s79, 0
    s_cbranch_scc1 LKw_main_kernel_303
    buffer_load_dwordx4 v[72:75], v1, s[12:15], s67 offen offset:0 sc1
    buffer_load_dwordx4 v[76:79], v1, s[12:15], s67 offen offset:1024 sc1
    buffer_load_dwordx4 v[80:83], v1, s[12:15], s68 offen offset:0 sc1
    buffer_load_dwordx4 v[84:87], v1, s[12:15], s68 offen offset:1024 sc1
    s_add_u32 s67, s67, 8192
    s_add_u32 s68, s68, 8192
    s_branch LKw_main_kernel_303
L_main_kernel_316:
    s_waitcnt vmcnt(0)
L_main_kernel_317:
    v_mfma_f32_32x32x16_bf16 v[104:119], v[88:91], v[16:19], 0
    v_mfma_f32_32x32x16_bf16 v[104:119], v[92:95], v[20:23], v[104:119]
LKw_main_kernel_303:
    v_mfma_f32_32x32x16_bf16 v[120:135], v[88:91], v[24:27], 0
    s_nop 4
    v_exp_f32 v104, v104
    v_exp_f32 v105, v105
    v_exp_f32 v106, v106
    v_exp_f32 v107, v107
    v_exp_f32 v108, v108
    v_exp_f32 v109, v109
    v_exp_f32 v110, v110
    v_exp_f32 v111, v111
    v_mfma_f32_32x32x16_bf16 v[120:135], v[92:95], v[28:31], v[120:135]
    v_cvt_pk_bf16_f32 v136, v104, v105
    v_cvt_pk_bf16_f32 v137, v106, v107
    v_cvt_pk_bf16_f32 v138, v108, v109
    v_cvt_pk_bf16_f32 v139, v110, v111
    v_exp_f32 v112, v112
    v_exp_f32 v113, v113
    v_exp_f32 v114, v114
    v_exp_f32 v115, v115
    v_mfma_f32_32x32x16_bf16 v[144:159], v[96:99], v[136:139], v[144:159]
    v_exp_f32 v116, v116
    v_exp_f32 v117, v117
    v_exp_f32 v118, v118
    v_exp_f32 v119, v119
    v_cvt_pk_bf16_f32 v140, v112, v113
    v_cvt_pk_bf16_f32 v141, v114, v115
    v_cvt_pk_bf16_f32 v142, v116, v117
    v_cvt_pk_bf16_f32 v143, v118, v119
    v_mfma_f32_32x32x16_bf16 v[104:119], v[88:91], v[32:35], 0
    v_exp_f32 v120, v120
    v_exp_f32 v121, v121
    v_exp_f32 v122, v122
    v_exp_f32 v123, v123
    v_mfma_f32_32x32x16_bf16 v[144:159], v[100:103], v[140:143], v[144:159]
    v_exp_f32 v124, v124
    v_exp_f32 v125, v125
    v_exp_f32 v126, v126
    v_exp_f32 v127, v127
    v_mfma_f32_32x32x16_bf16 v[104:119], v[92:95], v[36:39], v[104:119]
    v_cvt_pk_bf16_f32 v136, v120, v121
    v_cvt_pk_bf16_f32 v137, v122, v123
    v_cvt_pk_bf16_f32 v138, v124, v125
    v_cvt_pk_bf16_f32 v139, v126, v127
    v_exp_f32 v128, v128
    v_exp_f32 v129, v129
    v_exp_f32 v130, v130
    v_exp_f32 v131, v131
    v_mfma_f32_32x32x16_bf16 v[160:175], v[96:99], v[136:139], v[160:175]
    v_exp_f32 v132, v132
    v_exp_f32 v133, v133
    v_exp_f32 v134, v134
    v_exp_f32 v135, v135
    v_cvt_pk_bf16_f32 v140, v128, v129
    v_cvt_pk_bf16_f32 v141, v130, v131
    v_cvt_pk_bf16_f32 v142, v132, v133
    v_cvt_pk_bf16_f32 v143, v134, v135
    v_mfma_f32_32x32x16_bf16 v[120:135], v[88:91], v[40:43], 0
    v_exp_f32 v104, v104
    v_exp_f32 v105, v105
    v_exp_f32 v106, v106
    v_exp_f32 v107, v107
    v_mfma_f32_32x32x16_bf16 v[160:175], v[100:103], v[140:143], v[160:175]
    v_exp_f32 v108, v108
    v_exp_f32 v109, v109
    v_exp_f32 v110, v110
    v_exp_f32 v111, v111
    v_mfma_f32_32x32x16_bf16 v[120:135], v[92:95], v[44:47], v[120:135]
    v_cvt_pk_bf16_f32 v136, v104, v105
    v_cvt_pk_bf16_f32 v137, v106, v107
    v_cvt_pk_bf16_f32 v138, v108, v109
    v_cvt_pk_bf16_f32 v139, v110, v111
    v_exp_f32 v112, v112
    v_exp_f32 v113, v113
    v_exp_f32 v114, v114
    v_exp_f32 v115, v115
    v_mfma_f32_32x32x16_bf16 v[176:191], v[96:99], v[136:139], v[176:191]
    v_exp_f32 v116, v116
    v_exp_f32 v117, v117
    v_exp_f32 v118, v118
    v_exp_f32 v119, v119
    v_cvt_pk_bf16_f32 v140, v112, v113
    v_cvt_pk_bf16_f32 v141, v114, v115
    v_cvt_pk_bf16_f32 v142, v116, v117
    v_cvt_pk_bf16_f32 v143, v118, v119
    v_mfma_f32_32x32x16_bf16 v[104:119], v[88:91], v[48:51], 0
    v_exp_f32 v120, v120
    v_exp_f32 v121, v121
    v_exp_f32 v122, v122
    v_exp_f32 v123, v123
    v_mfma_f32_32x32x16_bf16 v[176:191], v[100:103], v[140:143], v[176:191]
    v_exp_f32 v124, v124
    v_exp_f32 v125, v125
    v_exp_f32 v126, v126
    v_exp_f32 v127, v127
    v_mfma_f32_32x32x16_bf16 v[104:119], v[92:95], v[52:55], v[104:119]
    v_cvt_pk_bf16_f32 v136, v120, v121
    v_cvt_pk_bf16_f32 v137, v122, v123
    v_cvt_pk_bf16_f32 v138, v124, v125
    v_cvt_pk_bf16_f32 v139, v126, v127
    v_exp_f32 v128, v128
    v_exp_f32 v129, v129
    v_exp_f32 v130, v130
    v_exp_f32 v131, v131
    v_mfma_f32_32x32x16_bf16 v[192:207], v[96:99], v[136:139], v[192:207]
    v_exp_f32 v132, v132
    v_exp_f32 v133, v133
    v_exp_f32 v134, v134
    v_exp_f32 v135, v135
    v_cvt_pk_bf16_f32 v140, v128, v129
    v_cvt_pk_bf16_f32 v141, v130, v131
    v_cvt_pk_bf16_f32 v142, v132, v133
    v_cvt_pk_bf16_f32 v143, v134, v135
    v_mfma_f32_32x32x16_bf16 v[120:135], v[88:91], v[56:59], 0
    v_exp_f32 v104, v104
    v_exp_f32 v105, v105
    v_exp_f32 v106, v106
    v_exp_f32 v107, v107
    v_mfma_f32_32x32x16_bf16 v[192:207], v[100:103], v[140:143], v[192:207]
    v_exp_f32 v108, v108
    v_exp_f32 v109, v109
    v_exp_f32 v110, v110
    v_exp_f32 v111, v111
    v_mfma_f32_32x32x16_bf16 v[120:135], v[92:95], v[60:63], v[120:135]
    v_cvt_pk_bf16_f32 v136, v104, v105
    v_cvt_pk_bf16_f32 v137, v106, v107
    v_cvt_pk_bf16_f32 v138, v108, v109
    v_cvt_pk_bf16_f32 v139, v110, v111
    v_exp_f32 v112, v112
    v_exp_f32 v113, v113
    v_exp_f32 v114, v114
    v_exp_f32 v115, v115
    v_mfma_f32_32x32x16_bf16 v[208:223], v[96:99], v[136:139], v[208:223]
    v_exp_f32 v116, v116
    v_exp_f32 v117, v117
    v_exp_f32 v118, v118
    v_exp_f32 v119, v119
    v_cvt_pk_bf16_f32 v140, v112, v113
    v_cvt_pk_bf16_f32 v141, v114, v115
    v_cvt_pk_bf16_f32 v142, v116, v117
    v_cvt_pk_bf16_f32 v143, v118, v119
    s_cmp_eq_u32 s79, 0
    s_cbranch_scc1 L_main_kernel_319
    s_waitcnt vmcnt(0)
    v_mfma_f32_32x32x16_bf16 v[104:119], v[72:75], v[16:19], 0
    v_exp_f32 v120, v120
    v_exp_f32 v121, v121
    v_exp_f32 v122, v122
    v_exp_f32 v123, v123
    v_mfma_f32_32x32x16_bf16 v[208:223], v[100:103], v[140:143], v[208:223]
    v_exp_f32 v124, v124
    v_exp_f32 v125, v125
    v_exp_f32 v126, v126
    v_exp_f32 v127, v127
    v_mfma_f32_32x32x16_bf16 v[104:119], v[76:79], v[20:23], v[104:119]
    v_cvt_pk_bf16_f32 v136, v120, v121
    v_cvt_pk_bf16_f32 v137, v122, v123
    v_cvt_pk_bf16_f32 v138, v124, v125
    v_cvt_pk_bf16_f32 v139, v126, v127
    v_exp_f32 v128, v128
    v_exp_f32 v129, v129
    v_exp_f32 v130, v130
    v_exp_f32 v131, v131
    v_mfma_f32_32x32x16_bf16 v[224:239], v[96:99], v[136:139], v[224:239]
    v_exp_f32 v132, v132
    v_exp_f32 v133, v133
    v_exp_f32 v134, v134
    v_exp_f32 v135, v135
    v_cvt_pk_bf16_f32 v140, v128, v129
    v_cvt_pk_bf16_f32 v141, v130, v131
    v_cvt_pk_bf16_f32 v142, v132, v133
    v_cvt_pk_bf16_f32 v143, v134, v135
    s_nop 1
    v_mfma_f32_32x32x16_bf16 v[224:239], v[100:103], v[140:143], v[224:239]
    s_add_u32 s98, s98, 4
    s_branch LKd_main_kernel_304
L_main_kernel_319:
    v_exp_f32 v120, v120
    v_exp_f32 v121, v121
    v_exp_f32 v122, v122
    v_exp_f32 v123, v123
    v_mfma_f32_32x32x16_bf16 v[208:223], v[100:103], v[140:143], v[208:223]
    v_exp_f32 v124, v124
    v_exp_f32 v125, v125
    v_exp_f32 v126, v126
    v_exp_f32 v127, v127
    v_cvt_pk_bf16_f32 v136, v120, v121
    v_cvt_pk_bf16_f32 v137, v122, v123
    v_cvt_pk_bf16_f32 v138, v124, v125
    v_cvt_pk_bf16_f32 v139, v126, v127
    v_exp_f32 v128, v128
    v_exp_f32 v129, v129
    v_exp_f32 v130, v130
    v_exp_f32 v131, v131
    v_mfma_f32_32x32x16_bf16 v[224:239], v[96:99], v[136:139], v[224:239]
    v_exp_f32 v132, v132
    v_exp_f32 v133, v133
    v_exp_f32 v134, v134
    v_exp_f32 v135, v135
    v_cvt_pk_bf16_f32 v140, v128, v129
    v_cvt_pk_bf16_f32 v141, v130, v131
    v_cvt_pk_bf16_f32 v142, v132, v133
    v_cvt_pk_bf16_f32 v143, v134, v135
    s_nop 1
    v_mfma_f32_32x32x16_bf16 v[224:239], v[100:103], v[140:143], v[224:239]
    s_cmp_ge_u32 s98, 64
    s_cbranch_scc1 LKe_main_kernel_301
    s_cmp_lt_u32 s98, s96
    s_cbranch_scc1 Lgo_main_kernel_320
    s_mov_b32 s70, 2097152
    v_lshlrev_b32 v8, 3, v1
    v_and_b32 v8, 0x780, v8
Lgl_main_kernel_321:
    s_min_u32 s96, s96, 48
    s_lshl_b32 s97, s96, 7
    s_add_u32 s97, s97, 97714176
    s_mov_b64 exec, 0xffff
    buffer_load_dword v9, v8, s[12:15], s97 offen sc1
    s_mov_b64 exec, -1
    s_sub_u32 s70, s70, 1
    s_cbranch_scc1 Lexit_main_kernel
    s_waitcnt vmcnt(0)
    v_cmp_ne_u32 vcc, 4, v9
    s_nop 0
    s_or_b32 s97, vcc_lo, 0x10000
    s_ff1_i32_b32 s97, s97
    s_add_u32 s96, s96, s97
    s_cmp_eq_u32 s97, 16
    s_cselect_b32 s97, 1, 0
    s_cmp_ge_u32 s96, 64
    s_cselect_b32 s96, 0x100, s96
    s_cbranch_scc1 Lgo_main_kernel_320
    s_cmp_eq_u32 s97, 1
    s_cbranch_scc1 Lgl_main_kernel_321
    s_cmp_lt_u32 s98, s96
    s_cbranch_scc1 Lgo_main_kernel_320
    s_add_u32 s97, s96, 1
    s_cmp_gt_u32 s98, s97
    s_cbranch_scc1 Lgf_main_kernel_322
    s_sleep 2
    s_branch Lgl_main_kernel_321
Lgf_main_kernel_322:
    s_sleep 40
    s_branch Lgl_main_kernel_321
Lgo_main_kernel_320:
    buffer_load_dwordx4 v[72:75], v1, s[12:15], s67 offen offset:0 sc1
    buffer_load_dwordx4 v[76:79], v1, s[12:15], s67 offen offset:1024 sc1
    buffer_load_dwordx4 v[80:83], v1, s[12:15], s68 offen offset:0 sc1
    buffer_load_dwordx4 v[84:87], v1, s[12:15], s68 offen offset:1024 sc1
    s_add_u32 s67, s67, 8192
    s_add_u32 s68, s68, 8192
L_main_kernel_318:
    s_add_u32 s98, s98, 4
    s_branch LK_main_kernel_300
LKe_main_kernel_301:
LBr_main_kernel_323:
    s_mul_i32 s46, s3, 24576
    s_add_u32 s46, s46, 36864
    v_add_u32 v7, s46, v1
    ds_write_b128 v7, v[144:147] offset:0
    ds_write_b128 v7, v[148:151] offset:1024
    ds_write_b128 v7, v[152:155] offset:2048
    ds_write_b128 v7, v[156:159] offset:3072
    ds_write_b128 v7, v[160:163] offset:4096
    ds_write_b128 v7, v[164:167] offset:5120
    ds_write_b128 v7, v[168:171] offset:6144
    ds_write_b128 v7, v[172:175] offset:7168
    ds_write_b128 v7, v[176:179] offset:8192
    ds_write_b128 v7, v[180:183] offset:9216
    ds_write_b128 v7, v[184:187] offset:10240
    ds_write_b128 v7, v[188:191] offset:11264
    ds_write_b128 v7, v[192:195] offset:12288
    ds_write_b128 v7, v[196:199] offset:13312
    ds_write_b128 v7, v[200:203] offset:14336
    ds_write_b128 v7, v[204:207] offset:15360
    ds_write_b128 v7, v[208:211] offset:16384
    ds_write_b128 v7, v[212:215] offset:17408
    ds_write_b128 v7, v[216:219] offset:18432
    ds_write_b128 v7, v[220:223] offset:19456
    ds_write_b128 v7, v[224:227] offset:20480
    ds_write_b128 v7, v[228:231] offset:21504
    ds_write_b128 v7, v[232:235] offset:22528
    ds_write_b128 v7, v[236:239] offset:23552
    v_add_u32 v9, s61, v2
    v_mov_b32 v8, 4096
    v_cmp_gt_u32 vcc, 1792, v9
    s_nop 1
    v_cndmask_b32 v9, v8, v9, vcc
    s_lshl_b32 s46, s60, 2
    s_add_u32 s46, s46, 1780
    v_add_u32 v8, s46, v2
    v_cmp_gt_u32 vcc, 12, v2
    s_nop 1
    v_cndmask_b32 v4, v8, v9, vcc
    v_mov_b32 v8, 2048
    v_cmp_lt_u32 s[72:73], v4, v8
    v_min_u32 v4, 2047, v4
    v_mov_b32 v9, v6
    v_lshrrev_b32 v14, 4, v4
    v_mul_u32_u24 v14, 14336, v14
    v_and_b32 v6, 15, v4
    v_lshl_add_u32 v14, v6, 4, v14
    v_lshl_add_u32 v14, v3, 8, v14
    v_mov_b32 v6, v9
    s_lshl_b32 s46, s69, 10
    v_add_u32 v14, s46, v14
    s_waitcnt lgkmcnt(0)
    s_add_u32 s46, s62, 65536
    buffer_load_dwordx4 v[160:163], v1, s[4:7], s46 offen offset:0 sc1
    buffer_load_dwordx4 v[164:167], v1, s[4:7], s46 offen offset:1024 sc1
    buffer_load_dwordx4 v[168:171], v1, s[4:7], s46 offen offset:2048 sc1
    buffer_load_dwordx4 v[172:175], v1, s[4:7], s46 offen offset:3072 sc1
    s_add_u32 s46, s62, 69632
    buffer_load_dwordx4 v[176:179], v1, s[4:7], s46 offen offset:0 sc1
    buffer_load_dwordx4 v[180:183], v1, s[4:7], s46 offen offset:1024 sc1
    buffer_load_dwordx4 v[184:187], v1, s[4:7], s46 offen offset:2048 sc1
    buffer_load_dwordx4 v[188:191], v1, s[4:7], s46 offen offset:3072 sc1
    s_add_u32 s46, s62, 73728
    buffer_load_dwordx4 v[192:195], v1, s[4:7], s46 offen offset:0 sc1
    buffer_load_dwordx4 v[196:199], v1, s[4:7], s46 offen offset:1024 sc1
    buffer_load_dwordx4 v[200:203], v1, s[4:7], s46 offen offset:2048 sc1
    buffer_load_dwordx4 v[204:207], v1, s[4:7], s46 offen offset:3072 sc1
    s_add_u32 s46, s62, 77824
    buffer_load_dwordx4 v[208:211], v1, s[4:7], s46 offen offset:0 sc1
    buffer_load_dwordx4 v[212:215], v1, s[4:7], s46 offen offset:1024 sc1
    buffer_load_dwordx4 v[216:219], v1, s[4:7], s46 offen offset:2048 sc1
    buffer_load_dwordx4 v[220:223], v1, s[4:7], s46 offen offset:3072 sc1
    s_add_u32 s46, s62, 81920
    buffer_load_dwordx4 v[224:227], v1, s[4:7], s46 offen offset:0 sc1
    buffer_load_dwordx4 v[228:231], v1, s[4:7], s46 offen offset:1024 sc1
    buffer_load_dwordx4 v[232:235], v1, s[4:7], s46 offen offset:2048 sc1
    buffer_load_dwordx4 v[236:239], v1, s[4:7], s46 offen offset:3072 sc1
    s_add_u32 s46, s62, 86016
    buffer_load_dwordx4 v[240:243], v1, s[4:7], s46 offen offset:0 sc1
    buffer_load_dwordx4 v[244:247], v1, s[4:7], s46 offen offset:1024 sc1
    buffer_load_dwordx4 v[248:251], v1, s[4:7], s46 offen offset:2048 sc1
    buffer_load_dwordx4 v[252:255], v1, s[4:7], s46 offen offset:3072 sc1
    s_barrier
    v_lshrrev_b32 v8, 5, v0
    v_bfe_u32 v5, v0, 4, 1
    v_mul_u32_u24 v5, 912, v5
    v_mul_u32_u24 v10, 56, v2
    v_add_u32 v5, v5, v10
    v_lshl_add_u32 v5, v8, 3, v5
    v_mov_b32 v11, 30976
    v_cmp_eq_u32 s[74:75], 1, v8
    s_mov_b32 s48, 19267584
    buffer_load_dwordx4 v[80:83], v14, s[12:15], s48 offen offset:0 sc1
    buffer_load_dwordx4 v[84:87], v14, s[12:15], s48 offen offset:1024 sc1
    buffer_load_dwordx4 v[88:91], v14, s[12:15], s48 offen offset:2048 sc1
    buffer_load_dwordx4 v[92:95], v14, s[12:15], s48 offen offset:3072 sc1
    s_mov_b32 s46, s3
    s_lshl_b32 s47, s46, 12
    s_add_u32 s47, s47, 36864
    v_add_u32 v7, s47, v1
    ds_read_b128 v[16:19], v7 offset:0
    ds_read_b128 v[20:23], v7 offset:1024
    ds_read_b128 v[24:27], v7 offset:2048
    ds_read_b128 v[28:31], v7 offset:3072
    v_add_u32 v7, 24576, v7
    ds_read_b128 v[32:35], v7 offset:0
    ds_read_b128 v[36:39], v7 offset:1024
    ds_read_b128 v[40:43], v7 offset:2048
    ds_read_b128 v[44:47], v7 offset:3072
    v_add_u32 v7, 24576, v7
    ds_read_b128 v[48:51], v7 offset:0
    ds_read_b128 v[52:55], v7 offset:1024
    ds_read_b128 v[56:59], v7 offset:2048
    ds_read_b128 v[60:63], v7 offset:3072
    s_waitcnt lgkmcnt(4)
    v_add_u32 v7, 24576, v7
    ds_read_b128 v[64:67], v7 offset:0
    ds_read_b128 v[68:71], v7 offset:1024
    ds_read_b128 v[72:75], v7 offset:2048
    ds_read_b128 v[76:79], v7 offset:3072
    v_pk_add_f32 v[16:17], v[16:17], v[32:33]
    v_pk_add_f32 v[18:19], v[18:19], v[34:35]
    v_pk_add_f32 v[20:21], v[20:21], v[36:37]
    v_pk_add_f32 v[22:23], v[22:23], v[38:39]
    v_pk_add_f32 v[24:25], v[24:25], v[40:41]
    v_pk_add_f32 v[26:27], v[26:27], v[42:43]
    v_pk_add_f32 v[28:29], v[28:29], v[44:45]
    v_pk_add_f32 v[30:31], v[30:31], v[46:47]
    s_waitcnt lgkmcnt(0)
    v_pk_add_f32 v[48:49], v[48:49], v[64:65]
    v_pk_add_f32 v[50:51], v[50:51], v[66:67]
    v_pk_add_f32 v[52:53], v[52:53], v[68:69]
    v_pk_add_f32 v[54:55], v[54:55], v[70:71]
    v_pk_add_f32 v[56:57], v[56:57], v[72:73]
    v_pk_add_f32 v[58:59], v[58:59], v[74:75]
    v_pk_add_f32 v[60:61], v[60:61], v[76:77]
    v_pk_add_f32 v[62:63], v[62:63], v[78:79]
    v_pk_add_f32 v[16:17], v[16:17], v[48:49]
    v_pk_add_f32 v[18:19], v[18:19], v[50:51]
    v_pk_add_f32 v[20:21], v[20:21], v[52:53]
    v_pk_add_f32 v[22:23], v[22:23], v[54:55]
    v_pk_add_f32 v[24:25], v[24:25], v[56:57]
    v_pk_add_f32 v[26:27], v[26:27], v[58:59]
    v_pk_add_f32 v[28:29], v[28:29], v[60:61]
    v_pk_add_f32 v[30:31], v[30:31], v[62:63]
    v_mov_b32 v12, v28
    v_mov_b32 v13, v28
    s_nop 1
    v_permlane32_swap_b32 v12, v13
    s_nop 0
    v_cmp_nle_f32 vcc, 0x21800000, v13
    v_mov_b32 v12, 0x5d800000
    v_cmp_nle_f32 s[76:77], v13, v12
    s_nop 0
    s_or_b64 vcc, vcc, s[76:77]
    s_cbranch_vccz L_main_kernel_327
    v_mov_b32 v12, 36608
    v_mov_b32 v15, 1
    ds_write_b32 v12, v15
L_main_kernel_327:
    v_rcp_f32 v13, v13
    s_mul_i32 s47, s46, 1824
    s_add_u32 s47, s47, 16384
    v_add_u32 v10, s47, v5
    v_mul_f32 v16, v16, v13
    v_mul_f32 v17, v17, v13
    v_mul_f32 v18, v18, v13
    v_mul_f32 v19, v19, v13
    v_cvt_pk_bf16_f32 v16, v16, v17
    v_cvt_pk_bf16_f32 v17, v18, v19
    ds_write_b64 v10, v[16:17] offset:0
    v_mul_f32 v20, v20, v13
    v_mul_f32 v21, v21, v13
    v_mul_f32 v22, v22, v13
    v_mul_f32 v23, v23, v13
    v_cvt_pk_bf16_f32 v20, v20, v21
    v_cvt_pk_bf16_f32 v21, v22, v23
    ds_write_b64 v10, v[20:21] offset:16
    v_mul_f32 v24, v24, v13
    v_mul_f32 v25, v25, v13
    v_mul_f32 v26, v26, v13
    v_mul_f32 v27, v27, v13
    v_cvt_pk_bf16_f32 v24, v24, v25
    v_cvt_pk_bf16_f32 v25, v26, v27
    ds_write_b64 v10, v[24:25] offset:32
    v_mul_f32 v28, v28, v13
    v_mul_f32 v29, v29, v13
    v_mul_f32 v30, v30, v13
    v_mul_f32 v31, v31, v13
    v_cvt_pk_bf16_f32 v28, v28, v29
    v_cvt_pk_bf16_f32 v29, v30, v31
    v_add_u32 v10, 48, v10
    v_cndmask_b32 v10, v10, v11, s[74:75]
    ds_write_b64 v10, v[28:29]
    s_add_u32 s46, s3, 4
    s_cmp_ge_u32 s46, 6
    s_cbranch_scc1 L_main_kernel_326
    s_lshl_b32 s47, s46, 12
    s_add_u32 s47, s47, 36864
    v_add_u32 v7, s47, v1
    ds_read_b128 v[16:19], v7 offset:0
    ds_read_b128 v[20:23], v7 offset:1024
    ds_read_b128 v[24:27], v7 offset:2048
    ds_read_b128 v[28:31], v7 offset:3072
    v_add_u32 v7, 24576, v7
    ds_read_b128 v[32:35], v7 offset:0
    ds_read_b128 v[36:39], v7 offset:1024
    ds_read_b128 v[40:43], v7 offset:2048
    ds_read_b128 v[44:47], v7 offset:3072
    v_add_u32 v7, 24576, v7
    ds_read_b128 v[48:51], v7 offset:0
    ds_read_b128 v[52:55], v7 offset:1024
    ds_read_b128 v[56:59], v7 offset:2048
    ds_read_b128 v[60:63], v7 offset:3072
    s_waitcnt lgkmcnt(4)
    v_add_u32 v7, 24576, v7
    ds_read_b128 v[64:67], v7 offset:0
    ds_read_b128 v[68:71], v7 offset:1024
    ds_read_b128 v[72:75], v7 offset:2048
    ds_read_b128 v[76:79], v7 offset:3072
    v_pk_add_f32 v[16:17], v[16:17], v[32:33]
    v_pk_add_f32 v[18:19], v[18:19], v[34:35]
    v_pk_add_f32 v[20:21], v[20:21], v[36:37]
    v_pk_add_f32 v[22:23], v[22:23], v[38:39]
    v_pk_add_f32 v[24:25], v[24:25], v[40:41]
    v_pk_add_f32 v[26:27], v[26:27], v[42:43]
    v_pk_add_f32 v[28:29], v[28:29], v[44:45]
    v_pk_add_f32 v[30:31], v[30:31], v[46:47]
    s_waitcnt lgkmcnt(0)
    v_pk_add_f32 v[48:49], v[48:49], v[64:65]
    v_pk_add_f32 v[50:51], v[50:51], v[66:67]
    v_pk_add_f32 v[52:53], v[52:53], v[68:69]
    v_pk_add_f32 v[54:55], v[54:55], v[70:71]
    v_pk_add_f32 v[56:57], v[56:57], v[72:73]
    v_pk_add_f32 v[58:59], v[58:59], v[74:75]
    v_pk_add_f32 v[60:61], v[60:61], v[76:77]
    v_pk_add_f32 v[62:63], v[62:63], v[78:79]
    v_pk_add_f32 v[16:17], v[16:17], v[48:49]
    v_pk_add_f32 v[18:19], v[18:19], v[50:51]
    v_pk_add_f32 v[20:21], v[20:21], v[52:53]
    v_pk_add_f32 v[22:23], v[22:23], v[54:55]
    v_pk_add_f32 v[24:25], v[24:25], v[56:57]
    v_pk_add_f32 v[26:27], v[26:27], v[58:59]
    v_pk_add_f32 v[28:29], v[28:29], v[60:61]
    v_pk_add_f32 v[30:31], v[30:31], v[62:63]
    v_mov_b32 v12, v28
    v_mov_b32 v13, v28
    s_nop 1
    v_permlane32_swap_b32 v12, v13
    s_nop 0
    v_cmp_nle_f32 vcc, 0x21800000, v13
    v_mov_b32 v12, 0x5d800000
    v_cmp_nle_f32 s[76:77], v13, v12
    s_nop 0
    s_or_b64 vcc, vcc, s[76:77]
    s_cbranch_vccz L_main_kernel_328
    v_mov_b32 v12, 36608
    v_mov_b32 v15, 1
    ds_write_b32 v12, v15
L_main_kernel_328:
    v_rcp_f32 v13, v13
    s_mul_i32 s47, s46, 1824
    s_add_u32 s47, s47, 16384
    v_add_u32 v10, s47, v5
    v_mul_f32 v16, v16, v13
    v_mul_f32 v17, v17, v13
    v_mul_f32 v18, v18, v13
    v_mul_f32 v19, v19, v13
    v_cvt_pk_bf16_f32 v16, v16, v17
    v_cvt_pk_bf16_f32 v17, v18, v19
    ds_write_b64 v10, v[16:17] offset:0
    v_mul_f32 v20, v20, v13
    v_mul_f32 v21, v21, v13
    v_mul_f32 v22, v22, v13
    v_mul_f32 v23, v23, v13
    v_cvt_pk_bf16_f32 v20, v20, v21
    v_cvt_pk_bf16_f32 v21, v22, v23
    ds_write_b64 v10, v[20:21] offset:16
    v_mul_f32 v24, v24, v13
    v_mul_f32 v25, v25, v13
    v_mul_f32 v26, v26, v13
    v_mul_f32 v27, v27, v13
    v_cvt_pk_bf16_f32 v24, v24, v25
    v_cvt_pk_bf16_f32 v25, v26, v27
    ds_write_b64 v10, v[24:25] offset:32
    v_mul_f32 v28, v28, v13
    v_mul_f32 v29, v29, v13
    v_mul_f32 v30, v30, v13
    v_mul_f32 v31, v31, v13
    v_cvt_pk_bf16_f32 v28, v28, v29
    v_cvt_pk_bf16_f32 v29, v30, v31
    v_add_u32 v10, 48, v10
    v_cndmask_b32 v10, v10, v11, s[74:75]
    ds_write_b64 v10, v[28:29]
L_main_kernel_326:
    s_waitcnt lgkmcnt(0)
    s_barrier
    v_mov_b32 v12, 36608
    ds_read_b32 v12, v12
    s_waitcnt lgkmcnt(0)
    v_readfirstlane_b32 s46, v12
    s_nop 0
    s_andn2_b32 s46, s46, s78
    s_cmp_eq_u32 s46, 1
    s_cbranch_scc1 LBs_main_kernel_324
    s_add_u32 s8, s44, 13705216
    s_addc_u32 s9, s45, 0
    s_cmp_eq_u32 s0, 0
    s_cselect_b32 s8, s8, s40
    s_cselect_b32 s9, s9, s41
    s_and_b32 s9, s9, 0xffff
    s_mov_b32 s10, 1835008
    s_mov_b32 s11, 0x20000
    v_mul_u32_u24 v7, 912, v2
    v_lshl_add_u32 v7, v3, 4, v7
    ds_read_b128 v[16:19], v7 offset:16384
    ds_read_b128 v[20:23], v7 offset:16448
    ds_read_b128 v[24:27], v7 offset:16512
    ds_read_b128 v[28:31], v7 offset:16576
    ds_read_b128 v[32:35], v7 offset:16640
    ds_read_b128 v[36:39], v7 offset:16704
    ds_read_b128 v[40:43], v7 offset:16768
    ds_read_b128 v[44:47], v7 offset:16832
    ds_read_b128 v[48:51], v7 offset:16896
    ds_read_b128 v[52:55], v7 offset:16960
    ds_read_b128 v[56:59], v7 offset:17024
    ds_read_b128 v[60:63], v7 offset:17088
    ds_read_b128 v[64:67], v7 offset:17152
    ds_read_b128 v[68:71], v7 offset:17216
    v_subrev_u32 v12, 1792, v4
    v_mul_u32_u24 v12, 896, v12
    v_lshl_add_u32 v12, v3, 4, v12
    s_mov_b32 s49, 97411072
    s_waitcnt lgkmcnt(0)
    s_mov_b32 s70, 2097152
    s_mov_b32 exec_lo, 0xf000f000
    s_mov_b32 exec_hi, 0xf000f000
Lad_main_kernel_329:
    buffer_load_dwordx4 v[16:19], v12, s[12:15], s49 offen offset:0 sc1
    buffer_load_dwordx4 v[20:23], v12, s[12:15], s49 offen offset:64 sc1
    buffer_load_dwordx4 v[24:27], v12, s[12:15], s49 offen offset:128 sc1
    buffer_load_dwordx4 v[28:31], v12, s[12:15], s49 offen offset:192 sc1
    buffer_load_dwordx4 v[32:35], v12, s[12:15], s49 offen offset:256 sc1
    buffer_load_dwordx4 v[36:39], v12, s[12:15], s49 offen offset:320 sc1
    buffer_load_dwordx4 v[40:43], v12, s[12:15], s49 offen offset:384 sc1
    buffer_load_dwordx4 v[44:47], v12, s[12:15], s49 offen offset:448 sc1
    buffer_load_dwordx4 v[48:51], v12, s[12:15], s49 offen offset:512 sc1
    buffer_load_dwordx4 v[52:55], v12, s[12:15], s49 offen offset:576 sc1
    buffer_load_dwordx4 v[56:59], v12, s[12:15], s49 offen offset:640 sc1
    buffer_load_dwordx4 v[60:63], v12, s[12:15], s49 offen offset:704 sc1
    buffer_load_dwordx4 v[64:67], v12, s[12:15], s49 offen offset:768 sc1
    buffer_load_dwordx4 v[68:71], v12, s[12:15], s49 offen offset:832 sc1
    s_sub_u32 s70, s70, 1
    s_cbranch_scc1 Lexit_main_kernel
    v_mov_b32 v13, 0
    s_waitcnt vmcnt(13)
    v_max3_u32 v13, v13, v16, v17
    v_max3_u32 v13, v13, v18, v19
    s_waitcnt vmcnt(12)
    v_max3_u32 v13, v13, v20, v21
    v_max3_u32 v13, v13, v22, v23
    s_waitcnt vmcnt(11)
    v_max3_u32 v13, v13, v24, v25
    v_max3_u32 v13, v13, v26, v27
    s_waitcnt vmcnt(10)
    v_max3_u32 v13, v13, v28, v29
    v_max3_u32 v13, v13, v30, v31
    s_waitcnt vmcnt(9)
    v_max3_u32 v13, v13, v32, v33
    v_max3_u32 v13, v13, v34, v35
    s_waitcnt vmcnt(8)
    v_max3_u32 v13, v13, v36, v37
    v_max3_u32 v13, v13, v38, v39
    s_waitcnt vmcnt(7)
    v_max3_u32 v13, v13, v40, v41
    v_max3_u32 v13, v13, v42, v43
    s_waitcnt vmcnt(6)
    v_max3_u32 v13, v13, v44, v45
    v_max3_u32 v13, v13, v46, v47
    s_waitcnt vmcnt(5)
    v_max3_u32 v13, v13, v48, v49
    v_max3_u32 v13, v13, v50, v51
    s_waitcnt vmcnt(4)
    v_max3_u32 v13, v13, v52, v53
    v_max3_u32 v13, v13, v54, v55
    s_waitcnt vmcnt(3)
    v_max3_u32 v13, v13, v56, v57
    v_max3_u32 v13, v13, v58, v59
    s_waitcnt vmcnt(2)
    v_max3_u32 v13, v13, v60, v61
    v_max3_u32 v13, v13, v62, v63
    s_waitcnt vmcnt(1)
    v_max3_u32 v13, v13, v64, v65
    v_max3_u32 v13, v13, v66, v67
    s_waitcnt vmcnt(0)
    v_max3_u32 v13, v13, v68, v69
    v_max3_u32 v13, v13, v70, v71
    v_cmp_eq_u32 vcc, -1, v13
    s_cbranch_vccz Lad_main_kernel_330
    s_sleep 2
    s_branch Lad_main_kernel_329
Lad_main_kernel_330:
    s_mov_b64 exec, -1
    s_waitcnt vmcnt(0) lgkmcnt(0)
    v_mfma_f32_16x16x32_bf16 v[96:99], a[0:3], v[16:19], 0
    v_mfma_f32_16x16x32_bf16 v[96:99], a[4:7], v[20:23], v[96:99]
    v_mfma_f32_16x16x32_bf16 v[96:99], a[8:11], v[24:27], v[96:99]
    v_mfma_f32_16x16x32_bf16 v[96:99], a[12:15], v[28:31], v[96:99]
    v_mfma_f32_16x16x32_bf16 v[96:99], a[16:19], v[32:35], v[96:99]
    v_mfma_f32_16x16x32_bf16 v[96:99], a[20:23], v[36:39], v[96:99]
    v_mfma_f32_16x16x32_bf16 v[96:99], a[24:27], v[40:43], v[96:99]
    v_mfma_f32_16x16x32_bf16 v[96:99], a[28:31], v[44:47], v[96:99]
    v_mfma_f32_16x16x32_bf16 v[96:99], a[32:35], v[48:51], v[96:99]
    v_mfma_f32_16x16x32_bf16 v[96:99], a[36:39], v[52:55], v[96:99]
    v_mfma_f32_16x16x32_bf16 v[96:99], a[40:43], v[56:59], v[96:99]
    v_mfma_f32_16x16x32_bf16 v[96:99], a[44:47], v[60:63], v[96:99]
    v_mfma_f32_16x16x32_bf16 v[96:99], a[48:51], v[64:67], v[96:99]
    v_mfma_f32_16x16x32_bf16 v[96:99], a[52:55], v[68:71], v[96:99]
    v_mfma_f32_16x16x32_bf16 v[100:103], a[56:59], v[16:19], 0
    v_mfma_f32_16x16x32_bf16 v[100:103], a[60:63], v[20:23], v[100:103]
    v_mfma_f32_16x16x32_bf16 v[100:103], a[64:67], v[24:27], v[100:103]
    v_mfma_f32_16x16x32_bf16 v[100:103], a[68:71], v[28:31], v[100:103]
    v_mfma_f32_16x16x32_bf16 v[100:103], a[72:75], v[32:35], v[100:103]
    v_mfma_f32_16x16x32_bf16 v[100:103], a[76:79], v[36:39], v[100:103]
    v_mfma_f32_16x16x32_bf16 v[100:103], a[80:83], v[40:43], v[100:103]
    v_mfma_f32_16x16x32_bf16 v[100:103], a[84:87], v[44:47], v[100:103]
    v_mfma_f32_16x16x32_bf16 v[100:103], a[88:91], v[48:51], v[100:103]
    v_mfma_f32_16x16x32_bf16 v[100:103], a[92:95], v[52:55], v[100:103]
    v_mfma_f32_16x16x32_bf16 v[100:103], a[96:99], v[56:59], v[100:103]
    v_mfma_f32_16x16x32_bf16 v[100:103], a[100:103], v[60:63], v[100:103]
    v_mfma_f32_16x16x32_bf16 v[100:103], a[104:107], v[64:67], v[100:103]
    v_mfma_f32_16x16x32_bf16 v[100:103], a[108:111], v[68:71], v[100:103]
    s_add_u32 s46, s62, 90112
    buffer_load_dwordx4 a[0:3], v1, s[4:7], s46 offen offset:0 sc1
    buffer_load_dwordx4 a[4:7], v1, s[4:7], s46 offen offset:1024 sc1
    buffer_load_dwordx4 a[8:11], v1, s[4:7], s46 offen offset:2048 sc1
    buffer_load_dwordx4 a[12:15], v1, s[4:7], s46 offen offset:3072 sc1
    s_add_u32 s46, s62, 94208
    buffer_load_dwordx4 a[16:19], v1, s[4:7], s46 offen offset:0 sc1
    buffer_load_dwordx4 a[20:23], v1, s[4:7], s46 offen offset:1024 sc1
    buffer_load_dwordx4 a[24:27], v1, s[4:7], s46 offen offset:2048 sc1
    buffer_load_dwordx4 a[28:31], v1, s[4:7], s46 offen offset:3072 sc1
    s_add_u32 s46, s62, 98304
    buffer_load_dwordx4 a[32:35], v1, s[4:7], s46 offen offset:0 sc1
    buffer_load_dwordx4 a[36:39], v1, s[4:7], s46 offen offset:1024 sc1
    buffer_load_dwordx4 a[40:43], v1, s[4:7], s46 offen offset:2048 sc1
    buffer_load_dwordx4 a[44:47], v1, s[4:7], s46 offen offset:3072 sc1
    s_add_u32 s46, s62, 102400
    buffer_load_dwordx4 a[48:51], v1, s[4:7], s46 offen offset:0 sc1
    buffer_load_dwordx4 a[52:55], v1, s[4:7], s46 offen offset:1024 sc1
    buffer_load_dwordx4 a[56:59], v1, s[4:7], s46 offen offset:2048 sc1
    buffer_load_dwordx4 a[60:63], v1, s[4:7], s46 offen offset:3072 sc1
    s_add_u32 s46, s62, 106496
    buffer_load_dwordx4 a[64:67], v1, s[4:7], s46 offen offset:0 sc1
    buffer_load_dwordx4 a[68:71], v1, s[4:7], s46 offen offset:1024 sc1
    buffer_load_dwordx4 a[72:75], v1, s[4:7], s46 offen offset:2048 sc1
    buffer_load_dwordx4 a[76:79], v1, s[4:7], s46 offen offset:3072 sc1
    s_add_u32 s46, s62, 110592
    buffer_load_dwordx4 a[80:83], v1, s[4:7], s46 offen offset:0 sc1
    buffer_load_dwordx4 a[84:87], v1, s[4:7], s46 offen offset:1024 sc1
    buffer_load_dwordx4 a[88:91], v1, s[4:7], s46 offen offset:2048 sc1
    buffer_load_dwordx4 a[92:95], v1, s[4:7], s46 offen offset:3072 sc1
    v_mfma_f32_16x16x32_bf16 v[104:107], a[112:115], v[16:19], 0
    v_mfma_f32_16x16x32_bf16 v[104:107], a[116:119], v[20:23], v[104:107]
    v_mfma_f32_16x16x32_bf16 v[104:107], a[120:123], v[24:27], v[104:107]
    v_mfma_f32_16x16x32_bf16 v[104:107], a[124:127], v[28:31], v[104:107]
    v_mfma_f32_16x16x32_bf16 v[104:107], a[128:131], v[32:35], v[104:107]
    v_mfma_f32_16x16x32_bf16 v[104:107], a[132:135], v[36:39], v[104:107]
    v_mfma_f32_16x16x32_bf16 v[104:107], a[136:139], v[40:43], v[104:107]
    v_mfma_f32_16x16x32_bf16 v[104:107], a[140:143], v[44:47], v[104:107]
    v_mfma_f32_16x16x32_bf16 v[104:107], a[144:147], v[48:51], v[104:107]
    v_mfma_f32_16x16x32_bf16 v[104:107], a[148:151], v[52:55], v[104:107]
    v_mfma_f32_16x16x32_bf16 v[104:107], a[152:155], v[56:59], v[104:107]
    v_mfma_f32_16x16x32_bf16 v[104:107], a[156:159], v[60:63], v[104:107]
    v_mfma_f32_16x16x32_bf16 v[104:107], a[160:163], v[64:67], v[104:107]
    v_mfma_f32_16x16x32_bf16 v[104:107], a[164:167], v[68:71], v[104:107]
    v_mfma_f32_16x16x32_bf16 v[108:111], a[168:171], v[16:19], 0
    v_mfma_f32_16x16x32_bf16 v[108:111], a[172:175], v[20:23], v[108:111]
    v_mfma_f32_16x16x32_bf16 v[108:111], a[176:179], v[24:27], v[108:111]
    v_mfma_f32_16x16x32_bf16 v[108:111], a[180:183], v[28:31], v[108:111]
    v_mfma_f32_16x16x32_bf16 v[108:111], a[184:187], v[32:35], v[108:111]
    v_mfma_f32_16x16x32_bf16 v[108:111], a[188:191], v[36:39], v[108:111]
    v_mfma_f32_16x16x32_bf16 v[108:111], a[192:195], v[40:43], v[108:111]
    v_mfma_f32_16x16x32_bf16 v[108:111], a[196:199], v[44:47], v[108:111]
    v_mfma_f32_16x16x32_bf16 v[108:111], a[200:203], v[48:51], v[108:111]
    v_mfma_f32_16x16x32_bf16 v[108:111], a[204:207], v[52:55], v[108:111]
    v_mfma_f32_16x16x32_bf16 v[108:111], a[208:211], v[56:59], v[108:111]
    v_mfma_f32_16x16x32_bf16 v[108:111], a[212:215], v[60:63], v[108:111]
    v_mfma_f32_16x16x32_bf16 v[108:111], a[216:219], v[64:67], v[108:111]
    v_mfma_f32_16x16x32_bf16 v[108:111], a[220:223], v[68:71], v[108:111]
    v_mfma_f32_16x16x32_bf16 v[112:115], a[224:227], v[16:19], 0
    v_mfma_f32_16x16x32_bf16 v[112:115], a[228:231], v[20:23], v[112:115]
    v_mfma_f32_16x16x32_bf16 v[112:115], a[232:235], v[24:27], v[112:115]
    v_mfma_f32_16x16x32_bf16 v[112:115], a[236:239], v[28:31], v[112:115]
    v_mfma_f32_16x16x32_bf16 v[112:115], a[240:243], v[32:35], v[112:115]
    v_mfma_f32_16x16x32_bf16 v[112:115], a[244:247], v[36:39], v[112:115]
    v_mfma_f32_16x16x32_bf16 v[112:115], a[248:251], v[40:43], v[112:115]
    v_mfma_f32_16x16x32_bf16 v[112:115], a[252:255], v[44:47], v[112:115]
    v_mfma_f32_16x16x32_bf16 v[112:115], v[160:163], v[48:51], v[112:115]
    v_mfma_f32_16x16x32_bf16 v[112:115], v[164:167], v[52:55], v[112:115]
    v_mfma_f32_16x16x32_bf16 v[112:115], v[168:171], v[56:59], v[112:115]
    v_mfma_f32_16x16x32_bf16 v[112:115], v[172:175], v[60:63], v[112:115]
    v_mfma_f32_16x16x32_bf16 v[112:115], v[176:179], v[64:67], v[112:115]
    v_mfma_f32_16x16x32_bf16 v[112:115], v[180:183], v[68:71], v[112:115]
    v_mfma_f32_16x16x32_bf16 v[116:119], v[184:187], v[16:19], 0
    v_mfma_f32_16x16x32_bf16 v[116:119], v[188:191], v[20:23], v[116:119]
    v_mfma_f32_16x16x32_bf16 v[116:119], v[192:195], v[24:27], v[116:119]
    v_mfma_f32_16x16x32_bf16 v[116:119], v[196:199], v[28:31], v[116:119]
    v_mfma_f32_16x16x32_bf16 v[116:119], v[200:203], v[32:35], v[116:119]
    v_mfma_f32_16x16x32_bf16 v[116:119], v[204:207], v[36:39], v[116:119]
    v_mfma_f32_16x16x32_bf16 v[116:119], v[208:211], v[40:43], v[116:119]
    v_mfma_f32_16x16x32_bf16 v[116:119], v[212:215], v[44:47], v[116:119]
    v_mfma_f32_16x16x32_bf16 v[116:119], v[216:219], v[48:51], v[116:119]
    v_mfma_f32_16x16x32_bf16 v[116:119], v[220:223], v[52:55], v[116:119]
    v_mfma_f32_16x16x32_bf16 v[116:119], v[224:227], v[56:59], v[116:119]
    v_mfma_f32_16x16x32_bf16 v[116:119], v[228:231], v[60:63], v[116:119]
    v_mfma_f32_16x16x32_bf16 v[116:119], v[232:235], v[64:67], v[116:119]
    v_mfma_f32_16x16x32_bf16 v[116:119], v[236:239], v[68:71], v[116:119]
    s_cmp_ge_u32 s3, 2
    s_cbranch_scc1 L_main_kernel_331
    s_waitcnt vmcnt(0)
    v_mfma_f32_16x16x32_bf16 v[120:123], v[240:243], v[16:19], 0
    v_mfma_f32_16x16x32_bf16 v[120:123], v[244:247], v[20:23], v[120:123]
    v_mfma_f32_16x16x32_bf16 v[120:123], v[248:251], v[24:27], v[120:123]
    v_mfma_f32_16x16x32_bf16 v[120:123], v[252:255], v[28:31], v[120:123]
    v_mfma_f32_16x16x32_bf16 v[120:123], a[0:3], v[32:35], v[120:123]
    v_mfma_f32_16x16x32_bf16 v[120:123], a[4:7], v[36:39], v[120:123]
    v_mfma_f32_16x16x32_bf16 v[120:123], a[8:11], v[40:43], v[120:123]
    v_mfma_f32_16x16x32_bf16 v[120:123], a[12:15], v[44:47], v[120:123]
    v_mfma_f32_16x16x32_bf16 v[120:123], a[16:19], v[48:51], v[120:123]
    v_mfma_f32_16x16x32_bf16 v[120:123], a[20:23], v[52:55], v[120:123]
    v_mfma_f32_16x16x32_bf16 v[120:123], a[24:27], v[56:59], v[120:123]
    v_mfma_f32_16x16x32_bf16 v[120:123], a[28:31], v[60:63], v[120:123]
    v_mfma_f32_16x16x32_bf16 v[120:123], a[32:35], v[64:67], v[120:123]
    v_mfma_f32_16x16x32_bf16 v[120:123], a[36:39], v[68:71], v[120:123]
    v_mfma_f32_16x16x32_bf16 v[124:127], a[40:43], v[16:19], 0
    v_mfma_f32_16x16x32_bf16 v[124:127], a[44:47], v[20:23], v[124:127]
    v_mfma_f32_16x16x32_bf16 v[124:127], a[48:51], v[24:27], v[124:127]
    v_mfma_f32_16x16x32_bf16 v[124:127], a[52:55], v[28:31], v[124:127]
    v_mfma_f32_16x16x32_bf16 v[124:127], a[56:59], v[32:35], v[124:127]
    v_mfma_f32_16x16x32_bf16 v[124:127], a[60:63], v[36:39], v[124:127]
    v_mfma_f32_16x16x32_bf16 v[124:127], a[64:67], v[40:43], v[124:127]
    v_mfma_f32_16x16x32_bf16 v[124:127], a[68:71], v[44:47], v[124:127]
    v_mfma_f32_16x16x32_bf16 v[124:127], a[72:75], v[48:51], v[124:127]
    v_mfma_f32_16x16x32_bf16 v[124:127], a[76:79], v[52:55], v[124:127]
    v_mfma_f32_16x16x32_bf16 v[124:127], a[80:83], v[56:59], v[124:127]
    v_mfma_f32_16x16x32_bf16 v[124:127], a[84:87], v[60:63], v[124:127]
    v_mfma_f32_16x16x32_bf16 v[124:127], a[88:91], v[64:67], v[124:127]
    v_mfma_f32_16x16x32_bf16 v[124:127], a[92:95], v[68:71], v[124:127]
L_main_kernel_331:
    s_cmp_eq_u32 s0, 1
    s_cbranch_scc1 L_main_kernel_332
    s_mul_i32 s53, s100, 9363
    s_lshr_b32 s53, s53, 16
    s_mul_i32 s54, s53, 7
    s_sub_u32 s54, s100, s54
    s_and_b32 s55, s53, 15
    s_lshr_b32 s53, s53, 4
    s_cmp_eq_u32 s53, 0
    s_cselect_b32 s57, 0, 6422528
    s_mul_i32 s58, s55, 28
    s_lshl_b32 s59, s54, 2
    s_add_u32 s58, s58, s59
    s_add_u32 s58, s58, s3
    s_mul_i32 s58, s58, 14336
    s_add_u32 s57, s57, s58
    buffer_load_dwordx4 v[128:131], v1, s[4:7], s57 offen offset:0 sc1
    buffer_load_dwordx4 v[132:135], v1, s[4:7], s57 offen offset:1024 sc1
    buffer_load_dwordx4 v[136:139], v1, s[4:7], s57 offen offset:2048 sc1
    buffer_load_dwordx4 v[140:143], v1, s[4:7], s57 offen offset:3072 sc1
    s_add_u32 s57, s57, 4096
    buffer_load_dwordx4 v[144:147], v1, s[4:7], s57 offen offset:0 sc1
    buffer_load_dwordx4 v[148:151], v1, s[4:7], s57 offen offset:1024 sc1
    buffer_load_dwordx4 v[152:155], v1, s[4:7], s57 offen offset:2048 sc1
    buffer_load_dwordx4 v[156:159], v1, s[4:7], s57 offen offset:3072 sc1
    s_add_u32 s57, s57, 4096
    buffer_load_dwordx4 v[160:163], v1, s[4:7], s57 offen offset:0 sc1
    buffer_load_dwordx4 v[164:167], v1, s[4:7], s57 offen offset:1024 sc1
    buffer_load_dwordx4 v[168:171], v1, s[4:7], s57 offen offset:2048 sc1
    buffer_load_dwordx4 v[172:175], v1, s[4:7], s57 offen offset:3072 sc1
    s_add_u32 s57, s57, 4096
    buffer_load_dwordx4 v[176:179], v1, s[4:7], s57 offen offset:0 sc1
    buffer_load_dwordx4 v[180:183], v1, s[4:7], s57 offen offset:1024 sc1
L_main_kernel_332:
    v_mov_b32 v9, 0x7fffffff
    v_cndmask_b32 v5, v9, v14, s[72:73]
    v_mul_u32_u24 v8, 896, v4
    v_lshl_add_u32 v8, v3, 4, v8
    s_lshl_b32 s46, s69, 6
    v_add_u32 v8, s46, v8
    v_cndmask_b32 v8, v9, v8, s[72:73]
    s_cmp_eq_u32 s0, 0
    s_cselect_b64 vcc, -1, 0
    s_cselect_b32 s50, 1024, 64
    v_cndmask_b32 v8, v8, v5, vcc
    s_lshl_b32 s51, s50, 1
    s_add_u32 s52, s51, s50
    s_lshl_b32 s46, s3, 2
    v_lshlrev_b32 v11, 4, v2
    v_add_u32 v10, s46, v11
    s_mov_b32 s49, 97779712
    v_mov_b32 v16, 0
    v_lshlrev_b32 v20, 16, v80
    v_and_b32 v21, 0xffff0000, v80
    v_add_f32 v96, v96, v20
    v_add_f32 v97, v97, v21
    v_cvt_pk_bf16_f32 v80, v96, v97
    v_lshlrev_b32 v20, 16, v81
    v_and_b32 v21, 0xffff0000, v81
    v_add_f32 v98, v98, v20
    v_add_f32 v99, v99, v21
    v_cvt_pk_bf16_f32 v81, v98, v99
    v_add_f32 v20, v96, v97
    v_add_f32 v21, v98, v99
    v_add_f32 v16, v16, v20
    v_add_f32 v16, v16, v21
    v_lshlrev_b32 v20, 16, v82
    v_and_b32 v21, 0xffff0000, v82
    v_add_f32 v100, v100, v20
    v_add_f32 v101, v101, v21
    v_cvt_pk_bf16_f32 v82, v100, v101
    v_lshlrev_b32 v20, 16, v83
    v_and_b32 v21, 0xffff0000, v83
    v_add_f32 v102, v102, v20
    v_add_f32 v103, v103, v21
    v_cvt_pk_bf16_f32 v83, v102, v103
    v_add_f32 v20, v100, v101
    v_add_f32 v21, v102, v103
    v_add_f32 v16, v16, v20
    v_add_f32 v16, v16, v21
    buffer_store_dwordx4 v[80:83], v8, s[8:11], 0 offen sc1
    v_lshlrev_b32 v20, 16, v84
    v_and_b32 v21, 0xffff0000, v84
    v_add_f32 v104, v104, v20
    v_add_f32 v105, v105, v21
    v_cvt_pk_bf16_f32 v84, v104, v105
    v_lshlrev_b32 v20, 16, v85
    v_and_b32 v21, 0xffff0000, v85
    v_add_f32 v106, v106, v20
    v_add_f32 v107, v107, v21
    v_cvt_pk_bf16_f32 v85, v106, v107
    v_add_f32 v20, v104, v105
    v_add_f32 v21, v106, v107
    v_add_f32 v16, v16, v20
    v_add_f32 v16, v16, v21
    v_lshlrev_b32 v20, 16, v86
    v_and_b32 v21, 0xffff0000, v86
    v_add_f32 v108, v108, v20
    v_add_f32 v109, v109, v21
    v_cvt_pk_bf16_f32 v86, v108, v109
    v_lshlrev_b32 v20, 16, v87
    v_and_b32 v21, 0xffff0000, v87
    v_add_f32 v110, v110, v20
    v_add_f32 v111, v111, v21
    v_cvt_pk_bf16_f32 v87, v110, v111
    v_add_f32 v20, v108, v109
    v_add_f32 v21, v110, v111
    v_add_f32 v16, v16, v20
    v_add_f32 v16, v16, v21
    buffer_store_dwordx4 v[84:87], v8, s[8:11], s50 offen sc1
    v_lshlrev_b32 v20, 16, v88
    v_and_b32 v21, 0xffff0000, v88
    v_add_f32 v112, v112, v20
    v_add_f32 v113, v113, v21
    v_cvt_pk_bf16_f32 v88, v112, v113
    v_lshlrev_b32 v20, 16, v89
    v_and_b32 v21, 0xffff0000, v89
    v_add_f32 v114, v114, v20
    v_add_f32 v115, v115, v21
    v_cvt_pk_bf16_f32 v89, v114, v115
    v_add_f32 v20, v112, v113
    v_add_f32 v21, v114, v115
    v_add_f32 v16, v16, v20
    v_add_f32 v16, v16, v21
    v_lshlrev_b32 v20, 16, v90
    v_and_b32 v21, 0xffff0000, v90
    v_add_f32 v116, v116, v20
    v_add_f32 v117, v117, v21
    v_cvt_pk_bf16_f32 v90, v116, v117
    v_lshlrev_b32 v20, 16, v91
    v_and_b32 v21, 0xffff0000, v91
    v_add_f32 v118, v118, v20
    v_add_f32 v119, v119, v21
    v_cvt_pk_bf16_f32 v91, v118, v119
    v_add_f32 v20, v116, v117
    v_add_f32 v21, v118, v119
    v_add_f32 v16, v16, v20
    v_add_f32 v16, v16, v21
    buffer_store_dwordx4 v[88:91], v8, s[8:11], s51 offen sc1
    s_cmp_ge_u32 s3, 2
    s_cbranch_scc1 L_main_kernel_333
    v_lshlrev_b32 v20, 16, v92
    v_and_b32 v21, 0xffff0000, v92
    v_add_f32 v120, v120, v20
    v_add_f32 v121, v121, v21
    v_cvt_pk_bf16_f32 v92, v120, v121
    v_lshlrev_b32 v20, 16, v93
    v_and_b32 v21, 0xffff0000, v93
    v_add_f32 v122, v122, v20
    v_add_f32 v123, v123, v21
    v_cvt_pk_bf16_f32 v93, v122, v123
    v_add_f32 v20, v120, v121
    v_add_f32 v21, v122, v123
    v_add_f32 v16, v16, v20
    v_add_f32 v16, v16, v21
    v_lshlrev_b32 v20, 16, v94
    v_and_b32 v21, 0xffff0000, v94
    v_add_f32 v124, v124, v20
    v_add_f32 v125, v125, v21
    v_cvt_pk_bf16_f32 v94, v124, v125
    v_lshlrev_b32 v20, 16, v95
    v_and_b32 v21, 0xffff0000, v95
    v_add_f32 v126, v126, v20
    v_add_f32 v127, v127, v21
    v_cvt_pk_bf16_f32 v95, v126, v127
    v_add_f32 v20, v124, v125
    v_add_f32 v21, v126, v127
    v_add_f32 v16, v16, v20
    v_add_f32 v16, v16, v21
    buffer_store_dwordx4 v[92:95], v8, s[8:11], s52 offen sc1
L_main_kernel_333:
    s_cmp_eq_u32 s0, 1
    s_cbranch_scc1 LBf_main_kernel_325
    v_mov_b32 v20, v16
    s_nop 1
    v_permlane16_swap_b32 v16, v20
    s_nop 0
    v_add_f32 v16, v16, v20
    v_mov_b32 v20, v16
    s_nop 1
    v_permlane32_swap_b32 v16, v20
    s_nop 0
    v_add_f32 v16, v16, v20
    ds_write_b32 v10, v16 offset:31488
    s_waitcnt lgkmcnt(0)
    s_barrier
    ds_read_b128 v[24:27], v11 offset:31488
    s_waitcnt lgkmcnt(0)
    v_add_f32 v24, v24, v25
    v_add_f32 v26, v26, v27
    v_add_f32 v16, v24, v26
    v_mul_f32 v18, 0x3b124925, v16
    v_mov_b32 v16, 0
    v_sub_f32 v96, v96, v18
    v_fmac_f32 v16, v96, v96
    v_sub_f32 v97, v97, v18
    v_fmac_f32 v16, v97, v97
    v_sub_f32 v98, v98, v18
    v_fmac_f32 v16, v98, v98
    v_sub_f32 v99, v99, v18
    v_fmac_f32 v16, v99, v99
    v_sub_f32 v100, v100, v18
    v_fmac_f32 v16, v100, v100
    v_sub_f32 v101, v101, v18
    v_fmac_f32 v16, v101, v101
    v_sub_f32 v102, v102, v18
    v_fmac_f32 v16, v102, v102
    v_sub_f32 v103, v103, v18
    v_fmac_f32 v16, v103, v103
    v_sub_f32 v104, v104, v18
    v_fmac_f32 v16, v104, v104
    v_sub_f32 v105, v105, v18
    v_fmac_f32 v16, v105, v105
    v_sub_f32 v106, v106, v18
    v_fmac_f32 v16, v106, v106
    v_sub_f32 v107, v107, v18
    v_fmac_f32 v16, v107, v107
    v_sub_f32 v108, v108, v18
    v_fmac_f32 v16, v108, v108
    v_sub_f32 v109, v109, v18
    v_fmac_f32 v16, v109, v109
    v_sub_f32 v110, v110, v18
    v_fmac_f32 v16, v110, v110
    v_sub_f32 v111, v111, v18
    v_fmac_f32 v16, v111, v111
    v_sub_f32 v112, v112, v18
    v_fmac_f32 v16, v112, v112
    v_sub_f32 v113, v113, v18
    v_fmac_f32 v16, v113, v113
    v_sub_f32 v114, v114, v18
    v_fmac_f32 v16, v114, v114
    v_sub_f32 v115, v115, v18
    v_fmac_f32 v16, v115, v115
    v_sub_f32 v116, v116, v18
    v_fmac_f32 v16, v116, v116
    v_sub_f32 v117, v117, v18
    v_fmac_f32 v16, v117, v117
    v_sub_f32 v118, v118, v18
    v_fmac_f32 v16, v118, v118
    v_sub_f32 v119, v119, v18
    v_fmac_f32 v16, v119, v119
    s_cmp_ge_u32 s3, 2
    s_cbranch_scc1 L_main_kernel_334
    v_sub_f32 v120, v120, v18
    v_fmac_f32 v16, v120, v120
    v_sub_f32 v121, v121, v18
    v_fmac_f32 v16, v121, v121
    v_sub_f32 v122, v122, v18
    v_fmac_f32 v16, v122, v122
    v_sub_f32 v123, v123, v18
    v_fmac_f32 v16, v123, v123
    v_sub_f32 v124, v124, v18
    v_fmac_f32 v16, v124, v124
    v_sub_f32 v125, v125, v18
    v_fmac_f32 v16, v125, v125
    v_sub_f32 v126, v126, v18
    v_fmac_f32 v16, v126, v126
    v_sub_f32 v127, v127, v18
    v_fmac_f32 v16, v127, v127
L_main_kernel_334:
    v_mov_b32 v20, v16
    s_nop 1
    v_permlane16_swap_b32 v16, v20
    s_nop 0
    v_add_f32 v16, v16, v20
    v_mov_b32 v20, v16
    s_nop 1
    v_permlane32_swap_b32 v16, v20
    s_nop 0
    v_add_f32 v16, v16, v20
    ds_write_b32 v10, v16 offset:32000
    s_waitcnt lgkmcnt(0)
    s_barrier
    ds_read_b128 v[24:27], v11 offset:32000
    s_waitcnt lgkmcnt(0)
    v_add_f32 v24, v24, v25
    v_add_f32 v26, v26, v27
    v_add_f32 v16, v24, v26
    v_mov_b32 v18, 0x3727c5ac
    v_fmac_f32 v18, 0x3b124925, v16
    v_rsq_f32 v18, v18
    s_nop 0
    v_mul_f32 v96, v96, v18
    v_mul_f32 v97, v97, v18
    v_mul_f32 v98, v98, v18
    v_mul_f32 v99, v99, v18
    v_cvt_pk_bf16_f32 v24, v96, v97
    v_cvt_pk_bf16_f32 v25, v98, v99
    v_mul_f32 v100, v100, v18
    v_mul_f32 v101, v101, v18
    v_mul_f32 v102, v102, v18
    v_mul_f32 v103, v103, v18
    v_cvt_pk_bf16_f32 v26, v100, v101
    v_cvt_pk_bf16_f32 v27, v102, v103
    buffer_store_dwordx4 v[24:27], v5, s[4:7], s49 offen offset:0 sc1
    v_mul_f32 v104, v104, v18
    v_mul_f32 v105, v105, v18
    v_mul_f32 v106, v106, v18
    v_mul_f32 v107, v107, v18
    v_cvt_pk_bf16_f32 v28, v104, v105
    v_cvt_pk_bf16_f32 v29, v106, v107
    v_mul_f32 v108, v108, v18
    v_mul_f32 v109, v109, v18
    v_mul_f32 v110, v110, v18
    v_mul_f32 v111, v111, v18
    v_cvt_pk_bf16_f32 v30, v108, v109
    v_cvt_pk_bf16_f32 v31, v110, v111
    buffer_store_dwordx4 v[28:31], v5, s[4:7], s49 offen offset:1024 sc1
    v_mul_f32 v112, v112, v18
    v_mul_f32 v113, v113, v18
    v_mul_f32 v114, v114, v18
    v_mul_f32 v115, v115, v18
    v_cvt_pk_bf16_f32 v24, v112, v113
    v_cvt_pk_bf16_f32 v25, v114, v115
    v_mul_f32 v116, v116, v18
    v_mul_f32 v117, v117, v18
    v_mul_f32 v118, v118, v18
    v_mul_f32 v119, v119, v18
    v_cvt_pk_bf16_f32 v26, v116, v117
    v_cvt_pk_bf16_f32 v27, v118, v119
    buffer_store_dwordx4 v[24:27], v5, s[4:7], s49 offen offset:2048 sc1
    s_cmp_ge_u32 s3, 2
    s_cbranch_scc1 L_main_kernel_335
    v_mul_f32 v120, v120, v18
    v_mul_f32 v121, v121, v18
    v_mul_f32 v122, v122, v18
    v_mul_f32 v123, v123, v18
    v_cvt_pk_bf16_f32 v28, v120, v121
    v_cvt_pk_bf16_f32 v29, v122, v123
    v_mul_f32 v124, v124, v18
    v_mul_f32 v125, v125, v18
    v_mul_f32 v126, v126, v18
    v_mul_f32 v127, v127, v18
    v_cvt_pk_bf16_f32 v30, v124, v125
    v_cvt_pk_bf16_f32 v31, v126, v127
    buffer_store_dwordx4 v[28:31], v5, s[4:7], s49 offen offset:3072 sc1
L_main_kernel_335:
    s_waitcnt vmcnt(0)
    s_barrier
    s_cmp_lg_u32 s3, 0
    s_cbranch_scc1 L_main_kernel_336
    s_add_u32 s47, s61, 12
    s_min_u32 s47, s47, 1792
    s_min_u32 s46, s61, 1792
    s_lshr_b32 s48, s46, 5
    s_add_u32 s49, s48, 1
    s_lshl_b32 s50, s49, 5
    s_min_u32 s50, s50, s47
    s_sub_u32 s51, s50, s46
    s_sub_u32 s52, s47, s50
    v_mov_b32 v12, s48
    v_mov_b32 v13, s51
    v_writelane_b32 v12, s49, 1
    v_writelane_b32 v13, s52, 1
    s_lshr_b32 s48, s60, 3
    s_add_u32 s48, s48, 56
    v_writelane_b32 v12, s48, 2
    v_writelane_b32 v13, 4, 2
    v_lshlrev_b32 v12, 7, v12
    s_mov_b32 s46, 179904512
    s_mov_b64 exec, 7
    buffer_atomic_add v13, v12, s[4:7], s46 offen sc1
    s_mov_b64 exec, -1
L_main_kernel_336:
    s_cmp_eq_u32 s0, 1
    s_cbranch_scc1 L_main_kernel_337
    s_mul_i32 s58, s3, 14336
    s_add_u32 s58, s58, 32768
    v_add_u32 v2, s58, v1
    s_waitcnt vmcnt(1)
    s_barrier
    ds_write_b128 v2, v[128:131] offset:0
    ds_write_b128 v2, v[132:135] offset:1024
    ds_write_b128 v2, v[136:139] offset:2048
    ds_write_b128 v2, v[140:143] offset:3072
    ds_write_b128 v2, v[144:147] offset:4096
    ds_write_b128 v2, v[148:151] offset:5120
    ds_write_b128 v2, v[152:155] offset:6144
    ds_write_b128 v2, v[156:159] offset:7168
    ds_write_b128 v2, v[160:163] offset:8192
    ds_write_b128 v2, v[164:167] offset:9216
    ds_write_b128 v2, v[168:171] offset:10240
    ds_write_b128 v2, v[172:175] offset:11264
    ds_write_b128 v2, v[176:179] offset:12288
    ds_write_b128 v2, v[180:183] offset:13312
    s_nop 0
    v_add_u32 v2, 32768, v1
    s_waitcnt lgkmcnt(0)
    s_barrier
    ds_read_b128 a[0:3], v2 offset:0
    ds_read_b128 a[4:7], v2 offset:1024
    ds_read_b128 a[8:11], v2 offset:2048
    ds_read_b128 a[12:15], v2 offset:3072
    ds_read_b128 a[16:19], v2 offset:4096
    ds_read_b128 a[20:23], v2 offset:5120
    ds_read_b128 a[24:27], v2 offset:6144
    ds_read_b128 a[28:31], v2 offset:7168
    ds_read_b128 a[32:35], v2 offset:8192
    ds_read_b128 a[36:39], v2 offset:9216
    ds_read_b128 a[40:43], v2 offset:10240
    ds_read_b128 a[44:47], v2 offset:11264
    s_waitcnt lgkmcnt(4)
    ds_read_b128 a[48:51], v2 offset:12288
    ds_read_b128 a[52:55], v2 offset:13312
    ds_read_b128 a[56:59], v2 offset:14336
    ds_read_b128 a[60:63], v2 offset:15360
    ds_read_b128 a[64:67], v2 offset:16384
    ds_read_b128 a[68:71], v2 offset:17408
    ds_read_b128 a[72:75], v2 offset:18432
    ds_read_b128 a[76:79], v2 offset:19456
    ds_read_b128 a[80:83], v2 offset:20480
    ds_read_b128 a[84:87], v2 offset:21504
    ds_read_b128 a[88:91], v2 offset:22528
    ds_read_b128 a[92:95], v2 offset:23552
    s_waitcnt lgkmcnt(4)
    ds_read_b128 a[96:99], v2 offset:24576
    ds_read_b128 a[100:103], v2 offset:25600
    ds_read_b128 a[104:107], v2 offset:26624
    ds_read_b128 a[108:111], v2 offset:27648
    ds_read_b128 a[112:115], v2 offset:28672
    ds_read_b128 a[116:119], v2 offset:29696
    ds_read_b128 a[120:123], v2 offset:30720
    ds_read_b128 a[124:127], v2 offset:31744
    ds_read_b128 a[128:131], v2 offset:32768
    ds_read_b128 a[132:135], v2 offset:33792
    ds_read_b128 a[136:139], v2 offset:34816
    ds_read_b128 a[140:143], v2 offset:35840
    s_waitcnt lgkmcnt(4)
    ds_read_b128 a[144:147], v2 offset:36864
    ds_read_b128 a[148:151], v2 offset:37888
    ds_read_b128 a[152:155], v2 offset:38912
    ds_read_b128 a[156:159], v2 offset:39936
    ds_read_b128 a[160:163], v2 offset:40960
    ds_read_b128 a[164:167], v2 offset:41984
    ds_read_b128 a[168:171], v2 offset:43008
    ds_read_b128 a[172:175], v2 offset:44032
    ds_read_b128 a[176:179], v2 offset:45056
    ds_read_b128 a[180:183], v2 offset:46080
    ds_read_b128 a[184:187], v2 offset:47104
    ds_read_b128 a[188:191], v2 offset:48128
    s_waitcnt lgkmcnt(4)
    ds_read_b128 a[192:195], v2 offset:49152
    ds_read_b128 a[196:199], v2 offset:50176
    ds_read_b128 a[200:203], v2 offset:51200
    ds_read_b128 a[204:207], v2 offset:52224
    ds_read_b128 a[208:211], v2 offset:53248
    ds_read_b128 a[212:215], v2 offset:54272
    ds_read_b128 a[216:219], v2 offset:55296
    ds_read_b128 a[220:223], v2 offset:56320
L_main_kernel_337:
    s_branch LBf_main_kernel_325
LBs_main_kernel_324:
    s_waitcnt vmcnt(0) lgkmcnt(0)
    s_barrier
    s_mov_b32 s78, 1
    ds_read_b128 v[16:19], v6 offset:0
    ds_read_b128 v[20:23], v6 offset:32
    ds_read_b128 v[24:27], v6 offset:2048
    ds_read_b128 v[28:31], v6 offset:2080
    ds_read_b128 v[32:35], v6 offset:4096
    ds_read_b128 v[36:39], v6 offset:4128
    ds_read_b128 v[40:43], v6 offset:6144
    ds_read_b128 v[44:47], v6 offset:6176
    ds_read_b128 v[48:51], v6 offset:8192
    ds_read_b128 v[52:55], v6 offset:8224
    ds_read_b128 v[56:59], v6 offset:10240
    ds_read_b128 v[60:63], v6 offset:10272
    v_mov_b32 v120, 0xff61b1e6
    v_mov_b32 v121, 0xff61b1e6
    v_mov_b32 v122, 0xff61b1e6
    v_mov_b32 v123, 0xff61b1e6
    v_mov_b32 v124, 0xff61b1e6
    v_mov_b32 v125, 0xff61b1e6
    s_mov_b32 s67, s65
    s_mov_b32 s68, s66
    s_mov_b32 s70, 16
LM_main_kernel_338:
    buffer_load_dwordx4 v[72:75], v1, s[12:15], s67 offen sc1
    buffer_load_dwordx4 v[76:79], v1, s[12:15], s67 offen offset:1024 sc1
    buffer_load_dwordx4 v[80:83], v1, s[12:15], s68 offen sc1
    buffer_load_dwordx4 v[84:87], v1, s[12:15], s68 offen offset:1024 sc1
    s_add_u32 s67, s67, 8192
    s_add_u32 s68, s68, 8192
    s_waitcnt vmcnt(0) lgkmcnt(0)
    v_mfma_f32_32x32x16_bf16 v[104:119], v[72:75], v[16:19], 0
    v_mfma_f32_32x32x16_bf16 v[104:119], v[76:79], v[20:23], v[104:119]
    s_nop 11
    v_max3_f32 v120, v120, v104, v105
    v_max3_f32 v120, v120, v106, v107
    v_max3_f32 v120, v120, v108, v109
    v_max3_f32 v120, v120, v110, v111
    v_max3_f32 v120, v120, v112, v113
    v_max3_f32 v120, v120, v114, v115
    v_max3_f32 v120, v120, v116, v117
    v_max3_f32 v120, v120, v118, v119
    v_mfma_f32_32x32x16_bf16 v[104:119], v[72:75], v[24:27], 0
    v_mfma_f32_32x32x16_bf16 v[104:119], v[76:79], v[28:31], v[104:119]
    s_nop 11
    v_max3_f32 v121, v121, v104, v105
    v_max3_f32 v121, v121, v106, v107
    v_max3_f32 v121, v121, v108, v109
    v_max3_f32 v121, v121, v110, v111
    v_max3_f32 v121, v121, v112, v113
    v_max3_f32 v121, v121, v114, v115
    v_max3_f32 v121, v121, v116, v117
    v_max3_f32 v121, v121, v118, v119
    v_mfma_f32_32x32x16_bf16 v[104:119], v[72:75], v[32:35], 0
    v_mfma_f32_32x32x16_bf16 v[104:119], v[76:79], v[36:39], v[104:119]
    s_nop 11
    v_max3_f32 v122, v122, v104, v105
    v_max3_f32 v122, v122, v106, v107
    v_max3_f32 v122, v122, v108, v109
    v_max3_f32 v122, v122, v110, v111
    v_max3_f32 v122, v122, v112, v113
    v_max3_f32 v122, v122, v114, v115
    v_max3_f32 v122, v122, v116, v117
    v_max3_f32 v122, v122, v118, v119
    v_mfma_f32_32x32x16_bf16 v[104:119], v[72:75], v[40:43], 0
    v_mfma_f32_32x32x16_bf16 v[104:119], v[76:79], v[44:47], v[104:119]
    s_nop 11
    v_max3_f32 v123, v123, v104, v105
    v_max3_f32 v123, v123, v106, v107
    v_max3_f32 v123, v123, v108, v109
    v_max3_f32 v123, v123, v110, v111
    v_max3_f32 v123, v123, v112, v113
    v_max3_f32 v123, v123, v114, v115
    v_max3_f32 v123, v123, v116, v117
    v_max3_f32 v123, v123, v118, v119
    v_mfma_f32_32x32x16_bf16 v[104:119], v[72:75], v[48:51], 0
    v_mfma_f32_32x32x16_bf16 v[104:119], v[76:79], v[52:55], v[104:119]
    s_nop 11
    v_max3_f32 v124, v124, v104, v105
    v_max3_f32 v124, v124, v106, v107
    v_max3_f32 v124, v124, v108, v109
    v_max3_f32 v124, v124, v110, v111
    v_max3_f32 v124, v124, v112, v113
    v_max3_f32 v124, v124, v114, v115
    v_max3_f32 v124, v124, v116, v117
    v_max3_f32 v124, v124, v118, v119
    v_mfma_f32_32x32x16_bf16 v[104:119], v[72:75], v[56:59], 0
    v_mfma_f32_32x32x16_bf16 v[104:119], v[76:79], v[60:63], v[104:119]
    s_nop 11
    v_max3_f32 v125, v125, v104, v105
    v_max3_f32 v125, v125, v106, v107
    v_max3_f32 v125, v125, v108, v109
    v_max3_f32 v125, v125, v110, v111
    v_max3_f32 v125, v125, v112, v113
    v_max3_f32 v125, v125, v114, v115
    v_max3_f32 v125, v125, v116, v117
    v_max3_f32 v125, v125, v118, v119
    s_sub_u32 s70, s70, 1
    s_cmp_lg_u32 s70, 0
    s_cbranch_scc1 LM_main_kernel_338
    v_and_b32 v7, 31, v0
    v_lshlrev_b32 v7, 2, v7
    s_lshl_b32 s46, s3, 10
    v_add_u32 v12, s46, v7
    v_mov_b32 v13, v120
    s_nop 1
    v_permlane32_swap_b32 v120, v13
    s_nop 0
    v_max_f32 v120, v120, v13
    ds_write_b32 v12, v120 offset:32512
    v_mov_b32 v13, v121
    s_nop 1
    v_permlane32_swap_b32 v121, v13
    s_nop 0
    v_max_f32 v121, v121, v13
    ds_write_b32 v12, v121 offset:32640
    v_mov_b32 v13, v122
    s_nop 1
    v_permlane32_swap_b32 v122, v13
    s_nop 0
    v_max_f32 v122, v122, v13
    ds_write_b32 v12, v122 offset:32768
    v_mov_b32 v13, v123
    s_nop 1
    v_permlane32_swap_b32 v123, v13
    s_nop 0
    v_max_f32 v123, v123, v13
    ds_write_b32 v12, v123 offset:32896
    v_mov_b32 v13, v124
    s_nop 1
    v_permlane32_swap_b32 v124, v13
    s_nop 0
    v_max_f32 v124, v124, v13
    ds_write_b32 v12, v124 offset:33024
    v_mov_b32 v13, v125
    s_nop 1
    v_permlane32_swap_b32 v125, v13
    s_nop 0
    v_max_f32 v125, v125, v13
    ds_write_b32 v12, v125 offset:33152
    s_waitcnt lgkmcnt(0)
    s_barrier
    ds_read_b32 v104, v7 offset:32512
    ds_read_b32 v105, v7 offset:33536
    ds_read_b32 v106, v7 offset:34560
    ds_read_b32 v107, v7 offset:35584
    s_waitcnt lgkmcnt(0)
    v_max3_f32 v120, v104, v105, v106
    v_max_f32 v120, v120, v107
    ds_read_b32 v104, v7 offset:32640
    ds_read_b32 v105, v7 offset:33664
    ds_read_b32 v106, v7 offset:34688
    ds_read_b32 v107, v7 offset:35712
    s_waitcnt lgkmcnt(0)
    v_max3_f32 v121, v104, v105, v106
    v_max_f32 v121, v121, v107
    ds_read_b32 v104, v7 offset:32768
    ds_read_b32 v105, v7 offset:33792
    ds_read_b32 v106, v7 offset:34816
    ds_read_b32 v107, v7 offset:35840
    s_waitcnt lgkmcnt(0)
    v_max3_f32 v122, v104, v105, v106
    v_max_f32 v122, v122, v107
    ds_read_b32 v104, v7 offset:32896
    ds_read_b32 v105, v7 offset:33920
    ds_read_b32 v106, v7 offset:34944
    ds_read_b32 v107, v7 offset:35968
    s_waitcnt lgkmcnt(0)
    v_max3_f32 v123, v104, v105, v106
    v_max_f32 v123, v123, v107
    ds_read_b32 v104, v7 offset:33024
    ds_read_b32 v105, v7 offset:34048
    ds_read_b32 v106, v7 offset:35072
    ds_read_b32 v107, v7 offset:36096
    s_waitcnt lgkmcnt(0)
    v_max3_f32 v124, v104, v105, v106
    v_max_f32 v124, v124, v107
    ds_read_b32 v104, v7 offset:33152
    ds_read_b32 v105, v7 offset:34176
    ds_read_b32 v106, v7 offset:35200
    ds_read_b32 v107, v7 offset:36224
    s_waitcnt lgkmcnt(0)
    v_max3_f32 v125, v104, v105, v106
    v_max_f32 v125, v125, v107
    v_mov_b64 v[144:145], 0
    v_mov_b64 v[146:147], 0
    v_mov_b64 v[148:149], 0
    v_mov_b64 v[150:151], 0
    v_mov_b64 v[152:153], 0
    v_mov_b64 v[154:155], 0
    v_mov_b64 v[156:157], 0
    v_mov_b64 v[158:159], 0
    v_mov_b64 v[160:161], 0
    v_mov_b64 v[162:163], 0
    v_mov_b64 v[164:165], 0
    v_mov_b64 v[166:167], 0
    v_mov_b64 v[168:169], 0
    v_mov_b64 v[170:171], 0
    v_mov_b64 v[172:173], 0
    v_mov_b64 v[174:175], 0
    v_mov_b64 v[176:177], 0
    v_mov_b64 v[178:179], 0
    v_mov_b64 v[180:181], 0
    v_mov_b64 v[182:183], 0
    v_mov_b64 v[184:185], 0
    v_mov_b64 v[186:187], 0
    v_mov_b64 v[188:189], 0
    v_mov_b64 v[190:191], 0
    v_mov_b64 v[192:193], 0
    v_mov_b64 v[194:195], 0
    v_mov_b64 v[196:197], 0
    v_mov_b64 v[198:199], 0
    v_mov_b64 v[200:201], 0
    v_mov_b64 v[202:203], 0
    v_mov_b64 v[204:205], 0
    v_mov_b64 v[206:207], 0
    v_mov_b64 v[208:209], 0
    v_mov_b64 v[210:211], 0
    v_mov_b64 v[212:213], 0
    v_mov_b64 v[214:215], 0
    v_mov_b64 v[216:217], 0
    v_mov_b64 v[218:219], 0
    v_mov_b64 v[220:221], 0
    v_mov_b64 v[222:223], 0
    v_mov_b64 v[224:225], 0
    v_mov_b64 v[226:227], 0
    v_mov_b64 v[228:229], 0
    v_mov_b64 v[230:231], 0
    v_mov_b64 v[232:233], 0
    v_mov_b64 v[234:235], 0
    v_mov_b64 v[236:237], 0
    v_mov_b64 v[238:239], 0
    s_mov_b32 s67, s65
    s_mov_b32 s68, s66
    s_mov_b32 s70, 16
LK_main_kernel_339:
    buffer_load_dwordx4 v[72:75], v1, s[12:15], s67 offen sc1
    buffer_load_dwordx4 v[76:79], v1, s[12:15], s67 offen offset:1024 sc1
    buffer_load_dwordx4 v[80:83], v1, s[12:15], s68 offen sc1
    buffer_load_dwordx4 v[84:87], v1, s[12:15], s68 offen offset:1024 sc1
    s_add_u32 s67, s67, 8192
    s_add_u32 s68, s68, 8192
    s_waitcnt vmcnt(0)
    v_sub_f32 v104, 0, v120
    v_sub_f32 v105, 0, v120
    v_sub_f32 v106, 0, v120
    v_sub_f32 v107, 0, v120
    v_sub_f32 v108, 0, v120
    v_sub_f32 v109, 0, v120
    v_sub_f32 v110, 0, v120
    v_sub_f32 v111, 0, v120
    v_sub_f32 v112, 0, v120
    v_sub_f32 v113, 0, v120
    v_sub_f32 v114, 0, v120
    v_sub_f32 v115, 0, v120
    v_sub_f32 v116, 0, v120
    v_sub_f32 v117, 0, v120
    v_sub_f32 v118, 0, v120
    v_sub_f32 v119, 0, v120
    s_nop 1
    v_mfma_f32_32x32x16_bf16 v[104:119], v[72:75], v[16:19], v[104:119]
    v_mfma_f32_32x32x16_bf16 v[104:119], v[76:79], v[20:23], v[104:119]
    s_nop 11
    v_exp_f32 v104, v104
    v_exp_f32 v105, v105
    v_exp_f32 v106, v106
    v_exp_f32 v107, v107
    v_exp_f32 v108, v108
    v_exp_f32 v109, v109
    v_exp_f32 v110, v110
    v_exp_f32 v111, v111
    v_cvt_pk_bf16_f32 v136, v104, v105
    v_cvt_pk_bf16_f32 v137, v106, v107
    v_cvt_pk_bf16_f32 v138, v108, v109
    v_cvt_pk_bf16_f32 v139, v110, v111
    s_nop 1
    v_mfma_f32_32x32x16_bf16 v[144:159], v[80:83], v[136:139], v[144:159]
    v_exp_f32 v112, v112
    v_exp_f32 v113, v113
    v_exp_f32 v114, v114
    v_exp_f32 v115, v115
    v_exp_f32 v116, v116
    v_exp_f32 v117, v117
    v_exp_f32 v118, v118
    v_exp_f32 v119, v119
    v_cvt_pk_bf16_f32 v140, v112, v113
    v_cvt_pk_bf16_f32 v141, v114, v115
    v_cvt_pk_bf16_f32 v142, v116, v117
    v_cvt_pk_bf16_f32 v143, v118, v119
    s_nop 1
    v_mfma_f32_32x32x16_bf16 v[144:159], v[84:87], v[140:143], v[144:159]
    v_sub_f32 v104, 0, v121
    v_sub_f32 v105, 0, v121
    v_sub_f32 v106, 0, v121
    v_sub_f32 v107, 0, v121
    v_sub_f32 v108, 0, v121
    v_sub_f32 v109, 0, v121
    v_sub_f32 v110, 0, v121
    v_sub_f32 v111, 0, v121
    v_sub_f32 v112, 0, v121
    v_sub_f32 v113, 0, v121
    v_sub_f32 v114, 0, v121
    v_sub_f32 v115, 0, v121
    v_sub_f32 v116, 0, v121
    v_sub_f32 v117, 0, v121
    v_sub_f32 v118, 0, v121
    v_sub_f32 v119, 0, v121
    s_nop 1
    v_mfma_f32_32x32x16_bf16 v[104:119], v[72:75], v[24:27], v[104:119]
    v_mfma_f32_32x32x16_bf16 v[104:119], v[76:79], v[28:31], v[104:119]
    s_nop 11
    v_exp_f32 v104, v104
    v_exp_f32 v105, v105
    v_exp_f32 v106, v106
    v_exp_f32 v107, v107
    v_exp_f32 v108, v108
    v_exp_f32 v109, v109
    v_exp_f32 v110, v110
    v_exp_f32 v111, v111
    v_cvt_pk_bf16_f32 v136, v104, v105
    v_cvt_pk_bf16_f32 v137, v106, v107
    v_cvt_pk_bf16_f32 v138, v108, v109
    v_cvt_pk_bf16_f32 v139, v110, v111
    s_nop 1
    v_mfma_f32_32x32x16_bf16 v[160:175], v[80:83], v[136:139], v[160:175]
    v_exp_f32 v112, v112
    v_exp_f32 v113, v113
    v_exp_f32 v114, v114
    v_exp_f32 v115, v115
    v_exp_f32 v116, v116
    v_exp_f32 v117, v117
    v_exp_f32 v118, v118
    v_exp_f32 v119, v119
    v_cvt_pk_bf16_f32 v140, v112, v113
    v_cvt_pk_bf16_f32 v141, v114, v115
    v_cvt_pk_bf16_f32 v142, v116, v117
    v_cvt_pk_bf16_f32 v143, v118, v119
    s_nop 1
    v_mfma_f32_32x32x16_bf16 v[160:175], v[84:87], v[140:143], v[160:175]
    v_sub_f32 v104, 0, v122
    v_sub_f32 v105, 0, v122
    v_sub_f32 v106, 0, v122
    v_sub_f32 v107, 0, v122
    v_sub_f32 v108, 0, v122
    v_sub_f32 v109, 0, v122
    v_sub_f32 v110, 0, v122
    v_sub_f32 v111, 0, v122
    v_sub_f32 v112, 0, v122
    v_sub_f32 v113, 0, v122
    v_sub_f32 v114, 0, v122
    v_sub_f32 v115, 0, v122
    v_sub_f32 v116, 0, v122
    v_sub_f32 v117, 0, v122
    v_sub_f32 v118, 0, v122
    v_sub_f32 v119, 0, v122
    s_nop 1
    v_mfma_f32_32x32x16_bf16 v[104:119], v[72:75], v[32:35], v[104:119]
    v_mfma_f32_32x32x16_bf16 v[104:119], v[76:79], v[36:39], v[104:119]
    s_nop 11
    v_exp_f32 v104, v104
    v_exp_f32 v105, v105
    v_exp_f32 v106, v106
    v_exp_f32 v107, v107
    v_exp_f32 v108, v108
    v_exp_f32 v109, v109
    v_exp_f32 v110, v110
    v_exp_f32 v111, v111
    v_cvt_pk_bf16_f32 v136, v104, v105
    v_cvt_pk_bf16_f32 v137, v106, v107
    v_cvt_pk_bf16_f32 v138, v108, v109
    v_cvt_pk_bf16_f32 v139, v110, v111
    s_nop 1
    v_mfma_f32_32x32x16_bf16 v[176:191], v[80:83], v[136:139], v[176:191]
    v_exp_f32 v112, v112
    v_exp_f32 v113, v113
    v_exp_f32 v114, v114
    v_exp_f32 v115, v115
    v_exp_f32 v116, v116
    v_exp_f32 v117, v117
    v_exp_f32 v118, v118
    v_exp_f32 v119, v119
    v_cvt_pk_bf16_f32 v140, v112, v113
    v_cvt_pk_bf16_f32 v141, v114, v115
    v_cvt_pk_bf16_f32 v142, v116, v117
    v_cvt_pk_bf16_f32 v143, v118, v119
    s_nop 1
    v_mfma_f32_32x32x16_bf16 v[176:191], v[84:87], v[140:143], v[176:191]
    v_sub_f32 v104, 0, v123
    v_sub_f32 v105, 0, v123
    v_sub_f32 v106, 0, v123
    v_sub_f32 v107, 0, v123
    v_sub_f32 v108, 0, v123
    v_sub_f32 v109, 0, v123
    v_sub_f32 v110, 0, v123
    v_sub_f32 v111, 0, v123
    v_sub_f32 v112, 0, v123
    v_sub_f32 v113, 0, v123
    v_sub_f32 v114, 0, v123
    v_sub_f32 v115, 0, v123
    v_sub_f32 v116, 0, v123
    v_sub_f32 v117, 0, v123
    v_sub_f32 v118, 0, v123
    v_sub_f32 v119, 0, v123
    s_nop 1
    v_mfma_f32_32x32x16_bf16 v[104:119], v[72:75], v[40:43], v[104:119]
    v_mfma_f32_32x32x16_bf16 v[104:119], v[76:79], v[44:47], v[104:119]
    s_nop 11
    v_exp_f32 v104, v104
    v_exp_f32 v105, v105
    v_exp_f32 v106, v106
    v_exp_f32 v107, v107
    v_exp_f32 v108, v108
    v_exp_f32 v109, v109
    v_exp_f32 v110, v110
    v_exp_f32 v111, v111
    v_cvt_pk_bf16_f32 v136, v104, v105
    v_cvt_pk_bf16_f32 v137, v106, v107
    v_cvt_pk_bf16_f32 v138, v108, v109
    v_cvt_pk_bf16_f32 v139, v110, v111
    s_nop 1
    v_mfma_f32_32x32x16_bf16 v[192:207], v[80:83], v[136:139], v[192:207]
    v_exp_f32 v112, v112
    v_exp_f32 v113, v113
    v_exp_f32 v114, v114
    v_exp_f32 v115, v115
    v_exp_f32 v116, v116
    v_exp_f32 v117, v117
    v_exp_f32 v118, v118
    v_exp_f32 v119, v119
    v_cvt_pk_bf16_f32 v140, v112, v113
    v_cvt_pk_bf16_f32 v141, v114, v115
    v_cvt_pk_bf16_f32 v142, v116, v117
    v_cvt_pk_bf16_f32 v143, v118, v119
    s_nop 1
    v_mfma_f32_32x32x16_bf16 v[192:207], v[84:87], v[140:143], v[192:207]
    v_sub_f32 v104, 0, v124
    v_sub_f32 v105, 0, v124
    v_sub_f32 v106, 0, v124
    v_sub_f32 v107, 0, v124
    v_sub_f32 v108, 0, v124
    v_sub_f32 v109, 0, v124
    v_sub_f32 v110, 0, v124
    v_sub_f32 v111, 0, v124
    v_sub_f32 v112, 0, v124
    v_sub_f32 v113, 0, v124
    v_sub_f32 v114, 0, v124
    v_sub_f32 v115, 0, v124
    v_sub_f32 v116, 0, v124
    v_sub_f32 v117, 0, v124
    v_sub_f32 v118, 0, v124
    v_sub_f32 v119, 0, v124
    s_nop 1
    v_mfma_f32_32x32x16_bf16 v[104:119], v[72:75], v[48:51], v[104:119]
    v_mfma_f32_32x32x16_bf16 v[104:119], v[76:79], v[52:55], v[104:119]
    s_nop 11
    v_exp_f32 v104, v104
    v_exp_f32 v105, v105
    v_exp_f32 v106, v106
    v_exp_f32 v107, v107
    v_exp_f32 v108, v108
    v_exp_f32 v109, v109
    v_exp_f32 v110, v110
    v_exp_f32 v111, v111
    v_cvt_pk_bf16_f32 v136, v104, v105
    v_cvt_pk_bf16_f32 v137, v106, v107
    v_cvt_pk_bf16_f32 v138, v108, v109
    v_cvt_pk_bf16_f32 v139, v110, v111
    s_nop 1
    v_mfma_f32_32x32x16_bf16 v[208:223], v[80:83], v[136:139], v[208:223]
    v_exp_f32 v112, v112
    v_exp_f32 v113, v113
    v_exp_f32 v114, v114
    v_exp_f32 v115, v115
    v_exp_f32 v116, v116
    v_exp_f32 v117, v117
    v_exp_f32 v118, v118
    v_exp_f32 v119, v119
    v_cvt_pk_bf16_f32 v140, v112, v113
    v_cvt_pk_bf16_f32 v141, v114, v115
    v_cvt_pk_bf16_f32 v142, v116, v117
    v_cvt_pk_bf16_f32 v143, v118, v119
    s_nop 1
    v_mfma_f32_32x32x16_bf16 v[208:223], v[84:87], v[140:143], v[208:223]
    v_sub_f32 v104, 0, v125
    v_sub_f32 v105, 0, v125
    v_sub_f32 v106, 0, v125
    v_sub_f32 v107, 0, v125
    v_sub_f32 v108, 0, v125
    v_sub_f32 v109, 0, v125
    v_sub_f32 v110, 0, v125
    v_sub_f32 v111, 0, v125
    v_sub_f32 v112, 0, v125
    v_sub_f32 v113, 0, v125
    v_sub_f32 v114, 0, v125
    v_sub_f32 v115, 0, v125
    v_sub_f32 v116, 0, v125
    v_sub_f32 v117, 0, v125
    v_sub_f32 v118, 0, v125
    v_sub_f32 v119, 0, v125
    s_nop 1
    v_mfma_f32_32x32x16_bf16 v[104:119], v[72:75], v[56:59], v[104:119]
    v_mfma_f32_32x32x16_bf16 v[104:119], v[76:79], v[60:63], v[104:119]
    s_nop 11
    v_exp_f32 v104, v104
    v_exp_f32 v105, v105
    v_exp_f32 v106, v106
    v_exp_f32 v107, v107
    v_exp_f32 v108, v108
    v_exp_f32 v109, v109
    v_exp_f32 v110, v110
    v_exp_f32 v111, v111
    v_cvt_pk_bf16_f32 v136, v104, v105
    v_cvt_pk_bf16_f32 v137, v106, v107
    v_cvt_pk_bf16_f32 v138, v108, v109
    v_cvt_pk_bf16_f32 v139, v110, v111
    s_nop 1
    v_mfma_f32_32x32x16_bf16 v[224:239], v[80:83], v[136:139], v[224:239]
    v_exp_f32 v112, v112
    v_exp_f32 v113, v113
    v_exp_f32 v114, v114
    v_exp_f32 v115, v115
    v_exp_f32 v116, v116
    v_exp_f32 v117, v117
    v_exp_f32 v118, v118
    v_exp_f32 v119, v119
    v_cvt_pk_bf16_f32 v140, v112, v113
    v_cvt_pk_bf16_f32 v141, v114, v115
    v_cvt_pk_bf16_f32 v142, v116, v117
    v_cvt_pk_bf16_f32 v143, v118, v119
    s_nop 1
    v_mfma_f32_32x32x16_bf16 v[224:239], v[84:87], v[140:143], v[224:239]
    s_sub_u32 s70, s70, 1
    s_cmp_lg_u32 s70, 0
    s_cbranch_scc1 LK_main_kernel_339
    s_branch LBr_main_kernel_323
LBf_main_kernel_325:
    s_branch Lnx_main_kernel_187
L4_main_kernel_191:
    s_sub_u32 s60, s100, 64
    v_lshlrev_b32 v1, 4, v0
    v_and_b32 v2, 15, v0
    v_lshrrev_b32 v3, 4, v0
    s_mul_i32 s46, s3, 100352
    s_add_u32 s46, s46, 12845056
    buffer_load_dwordx4 a[0:3], v1, s[4:7], s46 offen offset:0 sc1
    buffer_load_dwordx4 a[4:7], v1, s[4:7], s46 offen offset:1024 sc1
    buffer_load_dwordx4 a[8:11], v1, s[4:7], s46 offen offset:2048 sc1
    buffer_load_dwordx4 a[12:15], v1, s[4:7], s46 offen offset:3072 sc1
    s_add_u32 s46, s46, 4096
    buffer_load_dwordx4 a[16:19], v1, s[4:7], s46 offen offset:0 sc1
    buffer_load_dwordx4 a[20:23], v1, s[4:7], s46 offen offset:1024 sc1
    buffer_load_dwordx4 a[24:27], v1, s[4:7], s46 offen offset:2048 sc1
    buffer_load_dwordx4 a[28:31], v1, s[4:7], s46 offen offset:3072 sc1
    s_add_u32 s46, s46, 4096
    buffer_load_dwordx4 a[32:35], v1, s[4:7], s46 offen offset:0 sc1
    buffer_load_dwordx4 a[36:39], v1, s[4:7], s46 offen offset:1024 sc1
    buffer_load_dwordx4 a[40:43], v1, s[4:7], s46 offen offset:2048 sc1
    buffer_load_dwordx4 a[44:47], v1, s[4:7], s46 offen offset:3072 sc1
    s_add_u32 s46, s46, 4096
    buffer_load_dwordx4 a[48:51], v1, s[4:7], s46 offen offset:0 sc1
    buffer_load_dwordx4 a[52:55], v1, s[4:7], s46 offen offset:1024 sc1
    buffer_load_dwordx4 a[56:59], v1, s[4:7], s46 offen offset:2048 sc1
    buffer_load_dwordx4 a[60:63], v1, s[4:7], s46 offen offset:3072 sc1
    s_add_u32 s46, s46, 4096
    buffer_load_dwordx4 a[64:67], v1, s[4:7], s46 offen offset:0 sc1
    buffer_load_dwordx4 a[68:71], v1, s[4:7], s46 offen offset:1024 sc1
    buffer_load_dwordx4 a[72:75], v1, s[4:7], s46 offen offset:2048 sc1
    buffer_load_dwordx4 a[76:79], v1, s[4:7], s46 offen offset:3072 sc1
    s_add_u32 s46, s46, 4096
    buffer_load_dwordx4 a[80:83], v1, s[4:7], s46 offen offset:0 sc1
    buffer_load_dwordx4 a[84:87], v1, s[4:7], s46 offen offset:1024 sc1
    buffer_load_dwordx4 a[88:91], v1, s[4:7], s46 offen offset:2048 sc1
    buffer_load_dwordx4 a[92:95], v1, s[4:7], s46 offen offset:3072 sc1
    s_add_u32 s46, s46, 4096
    buffer_load_dwordx4 a[96:99], v1, s[4:7], s46 offen offset:0 sc1
    buffer_load_dwordx4 a[100:103], v1, s[4:7], s46 offen offset:1024 sc1
    buffer_load_dwordx4 a[104:107], v1, s[4:7], s46 offen offset:2048 sc1
    buffer_load_dwordx4 a[108:111], v1, s[4:7], s46 offen offset:3072 sc1
    s_add_u32 s46, s46, 4096
    buffer_load_dwordx4 a[112:115], v1, s[4:7], s46 offen offset:0 sc1
    buffer_load_dwordx4 a[116:119], v1, s[4:7], s46 offen offset:1024 sc1
    buffer_load_dwordx4 a[120:123], v1, s[4:7], s46 offen offset:2048 sc1
    buffer_load_dwordx4 a[124:127], v1, s[4:7], s46 offen offset:3072 sc1
    s_add_u32 s46, s46, 4096
    buffer_load_dwordx4 a[128:131], v1, s[4:7], s46 offen offset:0 sc1
    buffer_load_dwordx4 a[132:135], v1, s[4:7], s46 offen offset:1024 sc1
    buffer_load_dwordx4 a[136:139], v1, s[4:7], s46 offen offset:2048 sc1
    buffer_load_dwordx4 a[140:143], v1, s[4:7], s46 offen offset:3072 sc1
    s_add_u32 s46, s46, 4096
    buffer_load_dwordx4 a[144:147], v1, s[4:7], s46 offen offset:0 sc1
    buffer_load_dwordx4 a[148:151], v1, s[4:7], s46 offen offset:1024 sc1
    buffer_load_dwordx4 a[152:155], v1, s[4:7], s46 offen offset:2048 sc1
    buffer_load_dwordx4 a[156:159], v1, s[4:7], s46 offen offset:3072 sc1
    s_add_u32 s46, s46, 4096
    buffer_load_dwordx4 a[160:163], v1, s[4:7], s46 offen offset:0 sc1
    buffer_load_dwordx4 a[164:167], v1, s[4:7], s46 offen offset:1024 sc1
    buffer_load_dwordx4 a[168:171], v1, s[4:7], s46 offen offset:2048 sc1
    buffer_load_dwordx4 a[172:175], v1, s[4:7], s46 offen offset:3072 sc1
    s_add_u32 s46, s46, 4096
    buffer_load_dwordx4 a[176:179], v1, s[4:7], s46 offen offset:0 sc1
    buffer_load_dwordx4 a[180:183], v1, s[4:7], s46 offen offset:1024 sc1
    buffer_load_dwordx4 a[184:187], v1, s[4:7], s46 offen offset:2048 sc1
    buffer_load_dwordx4 a[188:191], v1, s[4:7], s46 offen offset:3072 sc1
    s_add_u32 s46, s46, 4096
    buffer_load_dwordx4 a[192:195], v1, s[4:7], s46 offen offset:0 sc1
    buffer_load_dwordx4 a[196:199], v1, s[4:7], s46 offen offset:1024 sc1
    buffer_load_dwordx4 a[200:203], v1, s[4:7], s46 offen offset:2048 sc1
    buffer_load_dwordx4 a[204:207], v1, s[4:7], s46 offen offset:3072 sc1
    s_add_u32 s46, s46, 4096
    buffer_load_dwordx4 a[208:211], v1, s[4:7], s46 offen offset:0 sc1
    buffer_load_dwordx4 a[212:215], v1, s[4:7], s46 offen offset:1024 sc1
    buffer_load_dwordx4 a[216:219], v1, s[4:7], s46 offen offset:2048 sc1
    buffer_load_dwordx4 a[220:223], v1, s[4:7], s46 offen offset:3072 sc1
    s_add_u32 s46, s46, 4096
    buffer_load_dwordx4 a[224:227], v1, s[4:7], s46 offen offset:0 sc1
    buffer_load_dwordx4 a[228:231], v1, s[4:7], s46 offen offset:1024 sc1
    buffer_load_dwordx4 a[232:235], v1, s[4:7], s46 offen offset:2048 sc1
    buffer_load_dwordx4 a[236:239], v1, s[4:7], s46 offen offset:3072 sc1
    s_add_u32 s46, s46, 4096
    buffer_load_dwordx4 a[240:243], v1, s[4:7], s46 offen offset:0 sc1
    buffer_load_dwordx4 a[244:247], v1, s[4:7], s46 offen offset:1024 sc1
    buffer_load_dwordx4 a[248:251], v1, s[4:7], s46 offen offset:2048 sc1
    buffer_load_dwordx4 a[252:255], v1, s[4:7], s46 offen offset:3072 sc1
    s_add_u32 s46, s46, 4096
    buffer_load_dwordx4 v[120:123], v1, s[4:7], s46 offen offset:0 sc1
    buffer_load_dwordx4 v[124:127], v1, s[4:7], s46 offen offset:1024 sc1
    buffer_load_dwordx4 v[128:131], v1, s[4:7], s46 offen offset:2048 sc1
    buffer_load_dwordx4 v[132:135], v1, s[4:7], s46 offen offset:3072 sc1
    s_add_u32 s46, s46, 4096
    buffer_load_dwordx4 v[136:139], v1, s[4:7], s46 offen offset:0 sc1
    buffer_load_dwordx4 v[140:143], v1, s[4:7], s46 offen offset:1024 sc1
    buffer_load_dwordx4 v[144:147], v1, s[4:7], s46 offen offset:2048 sc1
    buffer_load_dwordx4 v[148:151], v1, s[4:7], s46 offen offset:3072 sc1
    s_add_u32 s46, s46, 4096
    buffer_load_dwordx4 v[152:155], v1, s[4:7], s46 offen offset:0 sc1
    buffer_load_dwordx4 v[156:159], v1, s[4:7], s46 offen offset:1024 sc1
    buffer_load_dwordx4 v[160:163], v1, s[4:7], s46 offen offset:2048 sc1
    buffer_load_dwordx4 v[164:167], v1, s[4:7], s46 offen offset:3072 sc1
    s_add_u32 s46, s46, 4096
    buffer_load_dwordx4 v[168:171], v1, s[4:7], s46 offen offset:0 sc1
    buffer_load_dwordx4 v[172:175], v1, s[4:7], s46 offen offset:1024 sc1
    buffer_load_dwordx4 v[176:179], v1, s[4:7], s46 offen offset:2048 sc1
    buffer_load_dwordx4 v[180:183], v1, s[4:7], s46 offen offset:3072 sc1
    s_add_u32 s46, s46, 4096
    buffer_load_dwordx4 v[184:187], v1, s[4:7], s46 offen offset:0 sc1
    buffer_load_dwordx4 v[188:191], v1, s[4:7], s46 offen offset:1024 sc1
    buffer_load_dwordx4 v[192:195], v1, s[4:7], s46 offen offset:2048 sc1
    buffer_load_dwordx4 v[196:199], v1, s[4:7], s46 offen offset:3072 sc1
    s_add_u32 s46, s46, 4096
    buffer_load_dwordx4 v[200:203], v1, s[4:7], s46 offen offset:0 sc1
    buffer_load_dwordx4 v[204:207], v1, s[4:7], s46 offen offset:1024 sc1
    buffer_load_dwordx4 v[208:211], v1, s[4:7], s46 offen offset:2048 sc1
    buffer_load_dwordx4 v[212:215], v1, s[4:7], s46 offen offset:3072 sc1
    s_add_u32 s46, s46, 4096
    buffer_load_dwordx4 v[216:219], v1, s[4:7], s46 offen offset:0 sc1
    buffer_load_dwordx4 v[220:223], v1, s[4:7], s46 offen offset:1024 sc1
    buffer_load_dwordx4 v[224:227], v1, s[4:7], s46 offen offset:2048 sc1
    buffer_load_dwordx4 v[228:231], v1, s[4:7], s46 offen offset:3072 sc1
    s_add_u32 s46, s46, 4096
    buffer_load_dwordx4 v[232:235], v1, s[4:7], s46 offen offset:0 sc1
    buffer_load_dwordx4 v[236:239], v1, s[4:7], s46 offen offset:1024 sc1
    buffer_load_dwordx4 v[240:243], v1, s[4:7], s46 offen offset:2048 sc1
    buffer_load_dwordx4 v[244:247], v1, s[4:7], s46 offen offset:3072 sc1
    s_add_u32 s46, s46, 4096
    buffer_load_dwordx4 v[248:251], v1, s[4:7], s46 offen offset:0 sc1
    buffer_load_dwordx4 v[252:255], v1, s[4:7], s46 offen offset:1024 sc1
    s_mul_i32 s61, s60, 8
    s_add_u32 s61, s61, 1792
    v_min_u32 v4, 7, v2
    v_add_u32 v4, s61, v4
    v_lshrrev_b32 v5, 4, v4
    v_mul_u32_u24 v5, 14336, v5
    v_and_b32 v6, 15, v4
    v_lshl_add_u32 v5, v6, 4, v5
    v_lshl_add_u32 v5, v3, 8, v5
    v_mov_b64 v[8:9], 0
    v_mov_b64 v[10:11], 0
    s_lshl_b32 s46, s3, 12
    v_add_u32 v7, s46, v1
    ds_write_b128 v7, v[8:11] offset:0
    ds_write_b128 v7, v[8:11] offset:1024
    ds_write_b128 v7, v[8:11] offset:2048
    ds_write_b128 v7, v[8:11] offset:3072
    s_nop 0
    v_mov_b32 v7, 36608
    ds_write_b32 v7, v8
    v_lshrrev_b32 v12, 5, v4
    v_lshlrev_b32 v12, 7, v12
    s_mov_b32 s49, 97714176
    s_lshr_b32 s50, s61, 5
    s_min_u32 s50, s50, 61
    s_waitcnt vmcnt(0)
    s_mov_b32 s49, 97768448
    v_mov_b32 v12, 0
    s_cmp_lg_u32 s3, 0
    s_cbranch_scc1 Lwo_main_kernel_341
    s_mov_b32 s47, 2097152
Lwc_main_kernel_340:
    buffer_load_dword v13, v12, s[12:15], s49 offen sc1
    s_sub_u32 s47, s47, 1
    s_cbranch_scc1 Lexit_main_kernel
    s_waitcnt vmcnt(0)
    v_cmp_gt_u32 vcc, s50, v13
    s_cbranch_vccz Lwo_main_kernel_341
    s_sleep 24
    s_branch Lwc_main_kernel_340
Lwo_main_kernel_341:
    s_barrier
    s_mov_b32 s96, 0
    s_lshr_b32 s98, s61, 5
    s_cmp_lt_u32 s98, s96
    s_cbranch_scc1 Lgo_main_kernel_342
    s_mov_b32 s70, 2097152
    v_lshlrev_b32 v8, 3, v1
    v_and_b32 v8, 0x780, v8
Lgl_main_kernel_343:
    s_min_u32 s96, s96, 48
    s_lshl_b32 s97, s96, 7
    s_add_u32 s97, s97, 97714176
    s_mov_b64 exec, 0xffff
    buffer_load_dword v9, v8, s[12:15], s97 offen sc1
    s_mov_b64 exec, -1
    s_sub_u32 s70, s70, 1
    s_cbranch_scc1 Lexit_main_kernel
    s_waitcnt vmcnt(0)
    v_cmp_ne_u32 vcc, 4, v9
    s_nop 0
    s_or_b32 s97, vcc_lo, 0x10000
    s_ff1_i32_b32 s97, s97
    s_add_u32 s96, s96, s97
    s_cmp_eq_u32 s97, 16
    s_cselect_b32 s97, 1, 0
    s_cmp_ge_u32 s96, 64
    s_cselect_b32 s96, 0x100, s96
    s_cbranch_scc1 Lgo_main_kernel_342
    s_cmp_eq_u32 s97, 1
    s_cbranch_scc1 Lgl_main_kernel_343
    s_cmp_lt_u32 s98, s96
    s_cbranch_scc1 Lgo_main_kernel_342
    s_add_u32 s97, s96, 1
    s_cmp_gt_u32 s98, s97
    s_cbranch_scc1 Lgf_main_kernel_344
    s_sleep 1
    s_branch Lgl_main_kernel_343
Lgf_main_kernel_344:
    s_sleep 8
    s_branch Lgl_main_kernel_343
Lgo_main_kernel_342:
    s_mov_b32 s48, 17432576
    s_mov_b32 s70, 2097152
    s_waitcnt lgkmcnt(0)
    s_barrier
    s_mul_i32 s63, s3, 112
    v_lshlrev_b32 v6, 2, v3
    v_add_u32 v6, s63, v6
    v_lshlrev_b32 v7, 10, v2
    v_add_u32 v8, 0, v6
    v_mul_u32_u24 v9, 2341, v8
    v_lshrrev_b32 v9, 16, v9
    v_lshl_add_u32 v8, v8, 1, v7
    v_lshl_add_u32 v100, v9, 3, v8
    v_add_u32 v8, 16, v6
    v_mul_u32_u24 v9, 2341, v8
    v_lshrrev_b32 v9, 16, v9
    v_lshl_add_u32 v8, v8, 1, v7
    v_lshl_add_u32 v101, v9, 3, v8
    v_add_u32 v8, 32, v6
    v_mul_u32_u24 v9, 2341, v8
    v_lshrrev_b32 v9, 16, v9
    v_lshl_add_u32 v8, v8, 1, v7
    v_lshl_add_u32 v102, v9, 3, v8
    v_add_u32 v8, 48, v6
    v_mul_u32_u24 v9, 2341, v8
    v_lshrrev_b32 v9, 16, v9
    v_lshl_add_u32 v8, v8, 1, v7
    v_lshl_add_u32 v103, v9, 3, v8
    v_add_u32 v8, 64, v6
    v_mul_u32_u24 v9, 2341, v8
    v_lshrrev_b32 v9, 16, v9
    v_lshl_add_u32 v8, v8, 1, v7
    v_lshl_add_u32 v104, v9, 3, v8
    v_add_u32 v8, 80, v6
    v_mul_u32_u24 v9, 2341, v8
    v_lshrrev_b32 v9, 16, v9
    v_lshl_add_u32 v8, v8, 1, v7
    v_lshl_add_u32 v105, v9, 3, v8
    v_add_u32 v8, 96, v6
    v_mul_u32_u24 v9, 2341, v8
    v_lshrrev_b32 v9, 16, v9
    v_lshl_add_u32 v8, v8, 1, v7
    v_lshl_add_u32 v106, v9, 3, v8
    s_mov_b32 s64, 0x3e8b97f6
Lx_main_kernel_345:
    buffer_load_dwordx4 v[16:19], v5, s[12:15], s48 offen offset:0 sc1
    buffer_load_dwordx4 v[20:23], v5, s[12:15], s48 offen offset:1024 sc1
    buffer_load_dwordx4 v[24:27], v5, s[12:15], s48 offen offset:2048 sc1
    buffer_load_dwordx4 v[28:31], v5, s[12:15], s48 offen offset:3072 sc1
    s_add_u32 s47, s48, 4096
    buffer_load_dwordx4 v[32:35], v5, s[12:15], s47 offen offset:0 sc1
    buffer_load_dwordx4 v[36:39], v5, s[12:15], s47 offen offset:1024 sc1
    buffer_load_dwordx4 v[40:43], v5, s[12:15], s47 offen offset:2048 sc1
    buffer_load_dwordx4 v[44:47], v5, s[12:15], s47 offen offset:3072 sc1
    s_add_u32 s47, s47, 4096
    buffer_load_dwordx4 v[48:51], v5, s[12:15], s47 offen offset:0 sc1
    buffer_load_dwordx4 v[52:55], v5, s[12:15], s47 offen offset:1024 sc1
    buffer_load_dwordx4 v[56:59], v5, s[12:15], s47 offen offset:2048 sc1
    buffer_load_dwordx4 v[60:63], v5, s[12:15], s47 offen offset:3072 sc1
    s_add_u32 s47, s47, 4096
    buffer_load_dwordx4 v[64:67], v5, s[12:15], s47 offen offset:0 sc1
    buffer_load_dwordx4 v[68:71], v5, s[12:15], s47 offen offset:1024 sc1
    s_waitcnt vmcnt(13)
    v_mfma_f32_16x16x32_bf16 v[72:75], a[0:3], v[16:19], 0
    v_mfma_f32_16x16x32_bf16 v[76:79], a[56:59], v[16:19], 0
    v_mfma_f32_16x16x32_bf16 v[80:83], a[112:115], v[16:19], 0
    v_mfma_f32_16x16x32_bf16 v[84:87], a[168:171], v[16:19], 0
    v_mfma_f32_16x16x32_bf16 v[88:91], a[224:227], v[16:19], 0
    v_mfma_f32_16x16x32_bf16 v[92:95], v[144:147], v[16:19], 0
    v_mfma_f32_16x16x32_bf16 v[96:99], v[200:203], v[16:19], 0
    s_waitcnt vmcnt(12)
    v_mfma_f32_16x16x32_bf16 v[72:75], a[4:7], v[20:23], v[72:75]
    v_mfma_f32_16x16x32_bf16 v[76:79], a[60:63], v[20:23], v[76:79]
    v_mfma_f32_16x16x32_bf16 v[80:83], a[116:119], v[20:23], v[80:83]
    v_mfma_f32_16x16x32_bf16 v[84:87], a[172:175], v[20:23], v[84:87]
    v_mfma_f32_16x16x32_bf16 v[88:91], a[228:231], v[20:23], v[88:91]
    v_mfma_f32_16x16x32_bf16 v[92:95], v[148:151], v[20:23], v[92:95]
    v_mfma_f32_16x16x32_bf16 v[96:99], v[204:207], v[20:23], v[96:99]
    s_waitcnt vmcnt(11)
    v_mfma_f32_16x16x32_bf16 v[72:75], a[8:11], v[24:27], v[72:75]
    v_mfma_f32_16x16x32_bf16 v[76:79], a[64:67], v[24:27], v[76:79]
    v_mfma_f32_16x16x32_bf16 v[80:83], a[120:123], v[24:27], v[80:83]
    v_mfma_f32_16x16x32_bf16 v[84:87], a[176:179], v[24:27], v[84:87]
    v_mfma_f32_16x16x32_bf16 v[88:91], a[232:235], v[24:27], v[88:91]
    v_mfma_f32_16x16x32_bf16 v[92:95], v[152:155], v[24:27], v[92:95]
    v_mfma_f32_16x16x32_bf16 v[96:99], v[208:211], v[24:27], v[96:99]
    s_waitcnt vmcnt(10)
    v_mfma_f32_16x16x32_bf16 v[72:75], a[12:15], v[28:31], v[72:75]
    v_mfma_f32_16x16x32_bf16 v[76:79], a[68:71], v[28:31], v[76:79]
    v_mfma_f32_16x16x32_bf16 v[80:83], a[124:127], v[28:31], v[80:83]
    v_mfma_f32_16x16x32_bf16 v[84:87], a[180:183], v[28:31], v[84:87]
    v_mfma_f32_16x16x32_bf16 v[88:91], a[236:239], v[28:31], v[88:91]
    v_mfma_f32_16x16x32_bf16 v[92:95], v[156:159], v[28:31], v[92:95]
    v_mfma_f32_16x16x32_bf16 v[96:99], v[212:215], v[28:31], v[96:99]
    s_waitcnt vmcnt(9)
    v_mfma_f32_16x16x32_bf16 v[72:75], a[16:19], v[32:35], v[72:75]
    v_mfma_f32_16x16x32_bf16 v[76:79], a[72:75], v[32:35], v[76:79]
    v_mfma_f32_16x16x32_bf16 v[80:83], a[128:131], v[32:35], v[80:83]
    v_mfma_f32_16x16x32_bf16 v[84:87], a[184:187], v[32:35], v[84:87]
    v_mfma_f32_16x16x32_bf16 v[88:91], a[240:243], v[32:35], v[88:91]
    v_mfma_f32_16x16x32_bf16 v[92:95], v[160:163], v[32:35], v[92:95]
    v_mfma_f32_16x16x32_bf16 v[96:99], v[216:219], v[32:35], v[96:99]
    s_waitcnt vmcnt(8)
    v_mfma_f32_16x16x32_bf16 v[72:75], a[20:23], v[36:39], v[72:75]
    v_mfma_f32_16x16x32_bf16 v[76:79], a[76:79], v[36:39], v[76:79]
    v_mfma_f32_16x16x32_bf16 v[80:83], a[132:135], v[36:39], v[80:83]
    v_mfma_f32_16x16x32_bf16 v[84:87], a[188:191], v[36:39], v[84:87]
    v_mfma_f32_16x16x32_bf16 v[88:91], a[244:247], v[36:39], v[88:91]
    v_mfma_f32_16x16x32_bf16 v[92:95], v[164:167], v[36:39], v[92:95]
    v_mfma_f32_16x16x32_bf16 v[96:99], v[220:223], v[36:39], v[96:99]
    s_waitcnt vmcnt(7)
    v_mfma_f32_16x16x32_bf16 v[72:75], a[24:27], v[40:43], v[72:75]
    v_mfma_f32_16x16x32_bf16 v[76:79], a[80:83], v[40:43], v[76:79]
    v_mfma_f32_16x16x32_bf16 v[80:83], a[136:139], v[40:43], v[80:83]
    v_mfma_f32_16x16x32_bf16 v[84:87], a[192:195], v[40:43], v[84:87]
    v_mfma_f32_16x16x32_bf16 v[88:91], a[248:251], v[40:43], v[88:91]
    v_mfma_f32_16x16x32_bf16 v[92:95], v[168:171], v[40:43], v[92:95]
    v_mfma_f32_16x16x32_bf16 v[96:99], v[224:227], v[40:43], v[96:99]
    s_waitcnt vmcnt(6)
    v_mfma_f32_16x16x32_bf16 v[72:75], a[28:31], v[44:47], v[72:75]
    v_mfma_f32_16x16x32_bf16 v[76:79], a[84:87], v[44:47], v[76:79]
    v_mfma_f32_16x16x32_bf16 v[80:83], a[140:143], v[44:47], v[80:83]
    v_mfma_f32_16x16x32_bf16 v[84:87], a[196:199], v[44:47], v[84:87]
    v_mfma_f32_16x16x32_bf16 v[88:91], a[252:255], v[44:47], v[88:91]
    v_mfma_f32_16x16x32_bf16 v[92:95], v[172:175], v[44:47], v[92:95]
    v_mfma_f32_16x16x32_bf16 v[96:99], v[228:231], v[44:47], v[96:99]
    s_waitcnt vmcnt(5)
    v_mfma_f32_16x16x32_bf16 v[72:75], a[32:35], v[48:51], v[72:75]
    v_mfma_f32_16x16x32_bf16 v[76:79], a[88:91], v[48:51], v[76:79]
    v_mfma_f32_16x16x32_bf16 v[80:83], a[144:147], v[48:51], v[80:83]
    v_mfma_f32_16x16x32_bf16 v[84:87], a[200:203], v[48:51], v[84:87]
    v_mfma_f32_16x16x32_bf16 v[88:91], v[120:123], v[48:51], v[88:91]
    v_mfma_f32_16x16x32_bf16 v[92:95], v[176:179], v[48:51], v[92:95]
    v_mfma_f32_16x16x32_bf16 v[96:99], v[232:235], v[48:51], v[96:99]
    s_waitcnt vmcnt(4)
    v_mfma_f32_16x16x32_bf16 v[72:75], a[36:39], v[52:55], v[72:75]
    v_mfma_f32_16x16x32_bf16 v[76:79], a[92:95], v[52:55], v[76:79]
    v_mfma_f32_16x16x32_bf16 v[80:83], a[148:151], v[52:55], v[80:83]
    v_mfma_f32_16x16x32_bf16 v[84:87], a[204:207], v[52:55], v[84:87]
    v_mfma_f32_16x16x32_bf16 v[88:91], v[124:127], v[52:55], v[88:91]
    v_mfma_f32_16x16x32_bf16 v[92:95], v[180:183], v[52:55], v[92:95]
    v_mfma_f32_16x16x32_bf16 v[96:99], v[236:239], v[52:55], v[96:99]
    s_waitcnt vmcnt(3)
    v_mfma_f32_16x16x32_bf16 v[72:75], a[40:43], v[56:59], v[72:75]
    v_mfma_f32_16x16x32_bf16 v[76:79], a[96:99], v[56:59], v[76:79]
    v_mfma_f32_16x16x32_bf16 v[80:83], a[152:155], v[56:59], v[80:83]
    v_mfma_f32_16x16x32_bf16 v[84:87], a[208:211], v[56:59], v[84:87]
    v_mfma_f32_16x16x32_bf16 v[88:91], v[128:131], v[56:59], v[88:91]
    v_mfma_f32_16x16x32_bf16 v[92:95], v[184:187], v[56:59], v[92:95]
    v_mfma_f32_16x16x32_bf16 v[96:99], v[240:243], v[56:59], v[96:99]
    s_waitcnt vmcnt(2)
    v_mfma_f32_16x16x32_bf16 v[72:75], a[44:47], v[60:63], v[72:75]
    v_mfma_f32_16x16x32_bf16 v[76:79], a[100:103], v[60:63], v[76:79]
    v_mfma_f32_16x16x32_bf16 v[80:83], a[156:159], v[60:63], v[80:83]
    v_mfma_f32_16x16x32_bf16 v[84:87], a[212:215], v[60:63], v[84:87]
    v_mfma_f32_16x16x32_bf16 v[88:91], v[132:135], v[60:63], v[88:91]
    v_mfma_f32_16x16x32_bf16 v[92:95], v[188:191], v[60:63], v[92:95]
    v_mfma_f32_16x16x32_bf16 v[96:99], v[244:247], v[60:63], v[96:99]
    s_waitcnt vmcnt(1)
    v_mfma_f32_16x16x32_bf16 v[72:75], a[48:51], v[64:67], v[72:75]
    v_mfma_f32_16x16x32_bf16 v[76:79], a[104:107], v[64:67], v[76:79]
    v_mfma_f32_16x16x32_bf16 v[80:83], a[160:163], v[64:67], v[80:83]
    v_mfma_f32_16x16x32_bf16 v[84:87], a[216:219], v[64:67], v[84:87]
    v_mfma_f32_16x16x32_bf16 v[88:91], v[136:139], v[64:67], v[88:91]
    v_mfma_f32_16x16x32_bf16 v[92:95], v[192:195], v[64:67], v[92:95]
    v_mfma_f32_16x16x32_bf16 v[96:99], v[248:251], v[64:67], v[96:99]
    s_waitcnt vmcnt(0)
    v_mfma_f32_16x16x32_bf16 v[72:75], a[52:55], v[68:71], v[72:75]
    v_mfma_f32_16x16x32_bf16 v[76:79], a[108:111], v[68:71], v[76:79]
    v_mfma_f32_16x16x32_bf16 v[80:83], a[164:167], v[68:71], v[80:83]
    v_mfma_f32_16x16x32_bf16 v[84:87], a[220:223], v[68:71], v[84:87]
    v_mfma_f32_16x16x32_bf16 v[88:91], v[140:143], v[68:71], v[88:91]
    v_mfma_f32_16x16x32_bf16 v[92:95], v[196:199], v[68:71], v[92:95]
    v_mfma_f32_16x16x32_bf16 v[96:99], v[252:255], v[68:71], v[96:99]
    s_lshl_b32 s65, s3, 11
    s_add_u32 s66, s65, 88879104
    s_add_u32 s65, s65, 88743936
    s_mov_b32 s67, s65
    s_mov_b32 s68, s66
    s_mov_b32 s78, 0
    s_add_u32 s98, s3, 48
    buffer_load_dwordx4 v[208:211], v1, s[12:15], s67 offen sc1
    buffer_load_dwordx4 v[212:215], v1, s[12:15], s67 offen offset:1024 sc1
    buffer_load_dwordx4 v[216:219], v1, s[12:15], s68 offen sc1
    buffer_load_dwordx4 v[220:223], v1, s[12:15], s68 offen offset:1024 sc1
    s_add_u32 s67, s67, 8192
    s_add_u32 s68, s68, 8192
    buffer_load_dwordx4 v[224:227], v1, s[12:15], s67 offen sc1
    buffer_load_dwordx4 v[228:231], v1, s[12:15], s67 offen offset:1024 sc1
    buffer_load_dwordx4 v[232:235], v1, s[12:15], s68 offen sc1
    buffer_load_dwordx4 v[236:239], v1, s[12:15], s68 offen offset:1024 sc1
    s_add_u32 s67, s67, 8192
    s_add_u32 s68, s68, 8192
    buffer_load_dwordx4 v[240:243], v1, s[12:15], s67 offen sc1
    buffer_load_dwordx4 v[244:247], v1, s[12:15], s67 offen offset:1024 sc1
    buffer_load_dwordx4 v[248:251], v1, s[12:15], s68 offen sc1
    buffer_load_dwordx4 v[252:255], v1, s[12:15], s68 offen offset:1024 sc1
    s_add_u32 s67, s67, 8192
    s_add_u32 s68, s68, 8192
    v_mul_f32 v72, s64, v72
    v_mul_f32 v73, s64, v73
    v_mul_f32 v74, s64, v74
    v_mul_f32 v75, s64, v75
    v_cvt_pk_bf16_f32 v72, v72, v73
    v_cvt_pk_bf16_f32 v73, v74, v75
    ds_write_b64 v100, v[72:73] offset:0
    v_mul_f32 v76, s64, v76
    v_mul_f32 v77, s64, v77
    v_mul_f32 v78, s64, v78
    v_mul_f32 v79, s64, v79
    v_cvt_pk_bf16_f32 v76, v76, v77
    v_cvt_pk_bf16_f32 v77, v78, v79
    ds_write_b64 v101, v[76:77] offset:0
    v_mul_f32 v80, s64, v80
    v_mul_f32 v81, s64, v81
    v_mul_f32 v82, s64, v82
    v_mul_f32 v83, s64, v83
    v_cvt_pk_bf16_f32 v80, v80, v81
    v_cvt_pk_bf16_f32 v81, v82, v83
    ds_write_b64 v102, v[80:81] offset:0
    v_mul_f32 v84, s64, v84
    v_mul_f32 v85, s64, v85
    v_mul_f32 v86, s64, v86
    v_mul_f32 v87, s64, v87
    v_cvt_pk_bf16_f32 v84, v84, v85
    v_cvt_pk_bf16_f32 v85, v86, v87
    ds_write_b64 v103, v[84:85] offset:0
    v_mul_f32 v88, s64, v88
    v_mul_f32 v89, s64, v89
    v_mul_f32 v90, s64, v90
    v_mul_f32 v91, s64, v91
    v_cvt_pk_bf16_f32 v88, v88, v89
    v_cvt_pk_bf16_f32 v89, v90, v91
    ds_write_b64 v104, v[88:89] offset:0
    v_mul_f32 v92, s64, v92
    v_mul_f32 v93, s64, v93
    v_mul_f32 v94, s64, v94
    v_mul_f32 v95, s64, v95
    v_cvt_pk_bf16_f32 v92, v92, v93
    v_cvt_pk_bf16_f32 v93, v94, v95
    ds_write_b64 v105, v[92:93] offset:0
    v_mul_f32 v96, s64, v96
    v_mul_f32 v97, s64, v97
    v_mul_f32 v98, s64, v98
    v_mul_f32 v99, s64, v99
    v_cvt_pk_bf16_f32 v96, v96, v97
    v_cvt_pk_bf16_f32 v97, v98, v99
    ds_write_b64 v106, v[96:97] offset:0
    s_waitcnt lgkmcnt(0)
    s_barrier
    v_bfe_u32 v6, v0, 4, 1
    v_lshlrev_b32 v6, 10, v6
    v_lshl_add_u32 v6, v2, 6, v6
    v_lshrrev_b32 v7, 5, v0
    v_lshl_add_u32 v6, v7, 4, v6
    ds_read_b128 v[16:19], v6 offset:0
    ds_read_b128 v[20:23], v6 offset:32
    ds_read_b128 v[24:27], v6 offset:2048
    ds_read_b128 v[28:31], v6 offset:2080
    ds_read_b128 v[32:35], v6 offset:4096
    ds_read_b128 v[36:39], v6 offset:4128
    ds_read_b128 v[40:43], v6 offset:6144
    ds_read_b128 v[44:47], v6 offset:6176
    v_mov_b64 v[144:145], 0
    v_mov_b64 v[146:147], 0
    v_mov_b64 v[148:149], 0
    v_mov_b64 v[150:151], 0
    v_mov_b64 v[152:153], 0
    v_mov_b64 v[154:155], 0
    v_mov_b64 v[156:157], 0
    v_mov_b64 v[158:159], 0
    v_mov_b64 v[160:161], 0
    v_mov_b64 v[162:163], 0
    v_mov_b64 v[164:165], 0
    v_mov_b64 v[166:167], 0
    v_mov_b64 v[168:169], 0
    v_mov_b64 v[170:171], 0
    v_mov_b64 v[172:173], 0
    v_mov_b64 v[174:175], 0
    v_mov_b64 v[176:177], 0
    v_mov_b64 v[178:179], 0
    v_mov_b64 v[180:181], 0
    v_mov_b64 v[182:183], 0
    v_mov_b64 v[184:185], 0
    v_mov_b64 v[186:187], 0
    v_mov_b64 v[188:189], 0
    v_mov_b64 v[190:191], 0
    v_mov_b64 v[192:193], 0
    v_mov_b64 v[194:195], 0
    v_mov_b64 v[196:197], 0
    v_mov_b64 v[198:199], 0
    v_mov_b64 v[200:201], 0
    v_mov_b64 v[202:203], 0
    v_mov_b64 v[204:205], 0
    v_mov_b64 v[206:207], 0
    s_waitcnt vmcnt(8) lgkmcnt(0)
    v_mfma_f32_32x32x16_bf16 v[104:119], v[208:211], v[16:19], 0
    v_mfma_f32_32x32x16_bf16 v[104:119], v[212:215], v[20:23], v[104:119]
    v_mfma_f32_32x32x16_bf16 v[120:135], v[208:211], v[24:27], 0
    s_nop 4
    v_exp_f32 v104, v104
    v_exp_f32 v105, v105
    v_exp_f32 v106, v106
    v_exp_f32 v107, v107
    v_exp_f32 v108, v108
    v_exp_f32 v109, v109
    v_exp_f32 v110, v110
    v_exp_f32 v111, v111
    v_mfma_f32_32x32x16_bf16 v[120:135], v[212:215], v[28:31], v[120:135]
    v_cvt_pk_bf16_f32 v136, v104, v105
    v_cvt_pk_bf16_f32 v137, v106, v107
    v_cvt_pk_bf16_f32 v138, v108, v109
    v_cvt_pk_bf16_f32 v139, v110, v111
    v_exp_f32 v112, v112
    v_exp_f32 v113, v113
    v_exp_f32 v114, v114
    v_exp_f32 v115, v115
    v_mfma_f32_32x32x16_bf16 v[144:159], v[216:219], v[136:139], v[144:159]
    v_exp_f32 v116, v116
    v_exp_f32 v117, v117
    v_exp_f32 v118, v118
    v_exp_f32 v119, v119
    v_cvt_pk_bf16_f32 v140, v112, v113
    v_cvt_pk_bf16_f32 v141, v114, v115
    v_cvt_pk_bf16_f32 v142, v116, v117
    v_cvt_pk_bf16_f32 v143, v118, v119
    v_mfma_f32_32x32x16_bf16 v[104:119], v[208:211], v[32:35], 0
    v_exp_f32 v120, v120
    v_exp_f32 v121, v121
    v_exp_f32 v122, v122
    v_exp_f32 v123, v123
    v_mfma_f32_32x32x16_bf16 v[144:159], v[220:223], v[140:143], v[144:159]
    v_exp_f32 v124, v124
    v_exp_f32 v125, v125
    v_exp_f32 v126, v126
    v_exp_f32 v127, v127
    v_mfma_f32_32x32x16_bf16 v[104:119], v[212:215], v[36:39], v[104:119]
    v_cvt_pk_bf16_f32 v136, v120, v121
    v_cvt_pk_bf16_f32 v137, v122, v123
    v_cvt_pk_bf16_f32 v138, v124, v125
    v_cvt_pk_bf16_f32 v139, v126, v127
    v_exp_f32 v128, v128
    v_exp_f32 v129, v129
    v_exp_f32 v130, v130
    v_exp_f32 v131, v131
    v_mfma_f32_32x32x16_bf16 v[160:175], v[216:219], v[136:139], v[160:175]
    v_exp_f32 v132, v132
    v_exp_f32 v133, v133
    v_exp_f32 v134, v134
    v_exp_f32 v135, v135
    v_cvt_pk_bf16_f32 v140, v128, v129
    v_cvt_pk_bf16_f32 v141, v130, v131
    v_cvt_pk_bf16_f32 v142, v132, v133
    v_cvt_pk_bf16_f32 v143, v134, v135
    v_mfma_f32_32x32x16_bf16 v[120:135], v[208:211], v[40:43], 0
    v_exp_f32 v104, v104
    v_exp_f32 v105, v105
    v_exp_f32 v106, v106
    v_exp_f32 v107, v107
    v_mfma_f32_32x32x16_bf16 v[160:175], v[220:223], v[140:143], v[160:175]
    v_exp_f32 v108, v108
    v_exp_f32 v109, v109
    v_exp_f32 v110, v110
    v_exp_f32 v111, v111
    v_mfma_f32_32x32x16_bf16 v[120:135], v[212:215], v[44:47], v[120:135]
    v_cvt_pk_bf16_f32 v136, v104, v105
    v_cvt_pk_bf16_f32 v137, v106, v107
    v_cvt_pk_bf16_f32 v138, v108, v109
    v_cvt_pk_bf16_f32 v139, v110, v111
    v_exp_f32 v112, v112
    v_exp_f32 v113, v113
    v_exp_f32 v114, v114
    v_exp_f32 v115, v115
    v_mfma_f32_32x32x16_bf16 v[176:191], v[216:219], v[136:139], v[176:191]
    v_exp_f32 v116, v116
    v_exp_f32 v117, v117
    v_exp_f32 v118, v118
    v_exp_f32 v119, v119
    v_cvt_pk_bf16_f32 v140, v112, v113
    v_cvt_pk_bf16_f32 v141, v114, v115
    v_cvt_pk_bf16_f32 v142, v116, v117
    v_cvt_pk_bf16_f32 v143, v118, v119
    s_waitcnt vmcnt(4)
    v_mfma_f32_32x32x16_bf16 v[104:119], v[224:227], v[16:19], 0
    v_exp_f32 v120, v120
    v_exp_f32 v121, v121
    v_exp_f32 v122, v122
    v_exp_f32 v123, v123
    v_mfma_f32_32x32x16_bf16 v[176:191], v[220:223], v[140:143], v[176:191]
    v_exp_f32 v124, v124
    v_exp_f32 v125, v125
    v_exp_f32 v126, v126
    v_exp_f32 v127, v127
    v_mfma_f32_32x32x16_bf16 v[104:119], v[228:231], v[20:23], v[104:119]
    v_cvt_pk_bf16_f32 v136, v120, v121
    v_cvt_pk_bf16_f32 v137, v122, v123
    v_cvt_pk_bf16_f32 v138, v124, v125
    v_cvt_pk_bf16_f32 v139, v126, v127
    v_exp_f32 v128, v128
    v_exp_f32 v129, v129
    v_exp_f32 v130, v130
    v_exp_f32 v131, v131
    v_mfma_f32_32x32x16_bf16 v[192:207], v[216:219], v[136:139], v[192:207]
    v_exp_f32 v132, v132
    v_exp_f32 v133, v133
    v_exp_f32 v134, v134
    v_exp_f32 v135, v135
    v_cvt_pk_bf16_f32 v140, v128, v129
    v_cvt_pk_bf16_f32 v141, v130, v131
    v_cvt_pk_bf16_f32 v142, v132, v133
    v_cvt_pk_bf16_f32 v143, v134, v135
    v_mfma_f32_32x32x16_bf16 v[120:135], v[224:227], v[24:27], 0
    v_exp_f32 v104, v104
    v_exp_f32 v105, v105
    v_exp_f32 v106, v106
    v_exp_f32 v107, v107
    v_mfma_f32_32x32x16_bf16 v[192:207], v[220:223], v[140:143], v[192:207]
    buffer_load_dwordx4 v[208:211], v1, s[12:15], s67 offen sc1
    buffer_load_dwordx4 v[212:215], v1, s[12:15], s67 offen offset:1024 sc1
    buffer_load_dwordx4 v[216:219], v1, s[12:15], s68 offen sc1
    buffer_load_dwordx4 v[220:223], v1, s[12:15], s68 offen offset:1024 sc1
    s_add_u32 s67, s67, 8192
    s_add_u32 s68, s68, 8192
    v_exp_f32 v108, v108
    v_exp_f32 v109, v109
    v_exp_f32 v110, v110
    v_exp_f32 v111, v111
    v_mfma_f32_32x32x16_bf16 v[120:135], v[228:231], v[28:31], v[120:135]
    v_cvt_pk_bf16_f32 v136, v104, v105
    v_cvt_pk_bf16_f32 v137, v106, v107
    v_cvt_pk_bf16_f32 v138, v108, v109
    v_cvt_pk_bf16_f32 v139, v110, v111
    v_exp_f32 v112, v112
    v_exp_f32 v113, v113
    v_exp_f32 v114, v114
    v_exp_f32 v115, v115
    v_mfma_f32_32x32x16_bf16 v[144:159], v[232:235], v[136:139], v[144:159]
    v_exp_f32 v116, v116
    v_exp_f32 v117, v117
    v_exp_f32 v118, v118
    v_exp_f32 v119, v119
    v_cvt_pk_bf16_f32 v140, v112, v113
    v_cvt_pk_bf16_f32 v141, v114, v115
    v_cvt_pk_bf16_f32 v142, v116, v117
    v_cvt_pk_bf16_f32 v143, v118, v119
    v_mfma_f32_32x32x16_bf16 v[104:119], v[224:227], v[32:35], 0
    v_exp_f32 v120, v120
    v_exp_f32 v121, v121
    v_exp_f32 v122, v122
    v_exp_f32 v123, v123
    v_mfma_f32_32x32x16_bf16 v[144:159], v[236:239], v[140:143], v[144:159]
    v_exp_f32 v124, v124
    v_exp_f32 v125, v125
    v_exp_f32 v126, v126
    v_exp_f32 v127, v127
    v_mfma_f32_32x32x16_bf16 v[104:119], v[228:231], v[36:39], v[104:119]
    v_cvt_pk_bf16_f32 v136, v120, v121
    v_cvt_pk_bf16_f32 v137, v122, v123
    v_cvt_pk_bf16_f32 v138, v124, v125
    v_cvt_pk_bf16_f32 v139, v126, v127
    v_exp_f32 v128, v128
    v_exp_f32 v129, v129
    v_exp_f32 v130, v130
    v_exp_f32 v131, v131
    v_mfma_f32_32x32x16_bf16 v[160:175], v[232:235], v[136:139], v[160:175]
    v_exp_f32 v132, v132
    v_exp_f32 v133, v133
    v_exp_f32 v134, v134
    v_exp_f32 v135, v135
    v_cvt_pk_bf16_f32 v140, v128, v129
    v_cvt_pk_bf16_f32 v141, v130, v131
    v_cvt_pk_bf16_f32 v142, v132, v133
    v_cvt_pk_bf16_f32 v143, v134, v135
    v_mfma_f32_32x32x16_bf16 v[120:135], v[224:227], v[40:43], 0
    v_exp_f32 v104, v104
    v_exp_f32 v105, v105
    v_exp_f32 v106, v106
    v_exp_f32 v107, v107
    v_mfma_f32_32x32x16_bf16 v[160:175], v[236:239], v[140:143], v[160:175]
    v_exp_f32 v108, v108
    v_exp_f32 v109, v109
    v_exp_f32 v110, v110
    v_exp_f32 v111, v111
    v_mfma_f32_32x32x16_bf16 v[120:135], v[228:231], v[44:47], v[120:135]
    v_cvt_pk_bf16_f32 v136, v104, v105
    v_cvt_pk_bf16_f32 v137, v106, v107
    v_cvt_pk_bf16_f32 v138, v108, v109
    v_cvt_pk_bf16_f32 v139, v110, v111
    v_exp_f32 v112, v112
    v_exp_f32 v113, v113
    v_exp_f32 v114, v114
    v_exp_f32 v115, v115
    v_mfma_f32_32x32x16_bf16 v[176:191], v[232:235], v[136:139], v[176:191]
    v_exp_f32 v116, v116
    v_exp_f32 v117, v117
    v_exp_f32 v118, v118
    v_exp_f32 v119, v119
    v_cvt_pk_bf16_f32 v140, v112, v113
    v_cvt_pk_bf16_f32 v141, v114, v115
    v_cvt_pk_bf16_f32 v142, v116, v117
    v_cvt_pk_bf16_f32 v143, v118, v119
    s_waitcnt vmcnt(4)
    v_mfma_f32_32x32x16_bf16 v[104:119], v[240:243], v[16:19], 0
    v_exp_f32 v120, v120
    v_exp_f32 v121, v121
    v_exp_f32 v122, v122
    v_exp_f32 v123, v123
    v_mfma_f32_32x32x16_bf16 v[176:191], v[236:239], v[140:143], v[176:191]
    v_exp_f32 v124, v124
    v_exp_f32 v125, v125
    v_exp_f32 v126, v126
    v_exp_f32 v127, v127
    v_mfma_f32_32x32x16_bf16 v[104:119], v[244:247], v[20:23], v[104:119]
    v_cvt_pk_bf16_f32 v136, v120, v121
    v_cvt_pk_bf16_f32 v137, v122, v123
    v_cvt_pk_bf16_f32 v138, v124, v125
    v_cvt_pk_bf16_f32 v139, v126, v127
    v_exp_f32 v128, v128
    v_exp_f32 v129, v129
    v_exp_f32 v130, v130
    v_exp_f32 v131, v131
    v_mfma_f32_32x32x16_bf16 v[192:207], v[232:235], v[136:139], v[192:207]
    v_exp_f32 v132, v132
    v_exp_f32 v133, v133
    v_exp_f32 v134, v134
    v_exp_f32 v135, v135
    v_cvt_pk_bf16_f32 v140, v128, v129
    v_cvt_pk_bf16_f32 v141, v130, v131
    v_cvt_pk_bf16_f32 v142, v132, v133
    v_cvt_pk_bf16_f32 v143, v134, v135
    v_mfma_f32_32x32x16_bf16 v[120:135], v[240:243], v[24:27], 0
    v_exp_f32 v104, v104
    v_exp_f32 v105, v105
    v_exp_f32 v106, v106
    v_exp_f32 v107, v107
    v_mfma_f32_32x32x16_bf16 v[192:207], v[236:239], v[140:143], v[192:207]
    buffer_load_dwordx4 v[224:227], v1, s[12:15], s67 offen sc1
    buffer_load_dwordx4 v[228:231], v1, s[12:15], s67 offen offset:1024 sc1
    buffer_load_dwordx4 v[232:235], v1, s[12:15], s68 offen sc1
    buffer_load_dwordx4 v[236:239], v1, s[12:15], s68 offen offset:1024 sc1
    s_add_u32 s67, s67, 8192
    s_add_u32 s68, s68, 8192
    v_exp_f32 v108, v108
    v_exp_f32 v109, v109
    v_exp_f32 v110, v110
    v_exp_f32 v111, v111
    v_mfma_f32_32x32x16_bf16 v[120:135], v[244:247], v[28:31], v[120:135]
    v_cvt_pk_bf16_f32 v136, v104, v105
    v_cvt_pk_bf16_f32 v137, v106, v107
    v_cvt_pk_bf16_f32 v138, v108, v109
    v_cvt_pk_bf16_f32 v139, v110, v111
    v_exp_f32 v112, v112
    v_exp_f32 v113, v113
    v_exp_f32 v114, v114
    v_exp_f32 v115, v115
    v_mfma_f32_32x32x16_bf16 v[144:159], v[248:251], v[136:139], v[144:159]
    v_exp_f32 v116, v116
    v_exp_f32 v117, v117
    v_exp_f32 v118, v118
    v_exp_f32 v119, v119
    v_cvt_pk_bf16_f32 v140, v112, v113
    v_cvt_pk_bf16_f32 v141, v114, v115
    v_cvt_pk_bf16_f32 v142, v116, v117
    v_cvt_pk_bf16_f32 v143, v118, v119
    v_mfma_f32_32x32x16_bf16 v[104:119], v[240:243], v[32:35], 0
    v_exp_f32 v120, v120
    v_exp_f32 v121, v121
    v_exp_f32 v122, v122
    v_exp_f32 v123, v123
    v_mfma_f32_32x32x16_bf16 v[144:159], v[252:255], v[140:143], v[144:159]
    v_exp_f32 v124, v124
    v_exp_f32 v125, v125
    v_exp_f32 v126, v126
    v_exp_f32 v127, v127
    v_mfma_f32_32x32x16_bf16 v[104:119], v[244:247], v[36:39], v[104:119]
    v_cvt_pk_bf16_f32 v136, v120, v121
    v_cvt_pk_bf16_f32 v137, v122, v123
    v_cvt_pk_bf16_f32 v138, v124, v125
    v_cvt_pk_bf16_f32 v139, v126, v127
    v_exp_f32 v128, v128
    v_exp_f32 v129, v129
    v_exp_f32 v130, v130
    v_exp_f32 v131, v131
    v_mfma_f32_32x32x16_bf16 v[160:175], v[248:251], v[136:139], v[160:175]
    v_exp_f32 v132, v132
    v_exp_f32 v133, v133
    v_exp_f32 v134, v134
    v_exp_f32 v135, v135
    v_cvt_pk_bf16_f32 v140, v128, v129
    v_cvt_pk_bf16_f32 v141, v130, v131
    v_cvt_pk_bf16_f32 v142, v132, v133
    v_cvt_pk_bf16_f32 v143, v134, v135
    v_mfma_f32_32x32x16_bf16 v[120:135], v[240:243], v[40:43], 0
    v_exp_f32 v104, v104
    v_exp_f32 v105, v105
    v_exp_f32 v106, v106
    v_exp_f32 v107, v107
    v_mfma_f32_32x32x16_bf16 v[160:175], v[252:255], v[140:143], v[160:175]
    v_exp_f32 v108, v108
    v_exp_f32 v109, v109
    v_exp_f32 v110, v110
    v_exp_f32 v111, v111
    v_mfma_f32_32x32x16_bf16 v[120:135], v[244:247], v[44:47], v[120:135]
    v_cvt_pk_bf16_f32 v136, v104, v105
    v_cvt_pk_bf16_f32 v137, v106, v107
    v_cvt_pk_bf16_f32 v138, v108, v109
    v_cvt_pk_bf16_f32 v139, v110, v111
    v_exp_f32 v112, v112
    v_exp_f32 v113, v113
    v_exp_f32 v114, v114
    v_exp_f32 v115, v115
    v_mfma_f32_32x32x16_bf16 v[176:191], v[248:251], v[136:139], v[176:191]
    v_exp_f32 v116, v116
    v_exp_f32 v117, v117
    v_exp_f32 v118, v118
    v_exp_f32 v119, v119
    v_cvt_pk_bf16_f32 v140, v112, v113
    v_cvt_pk_bf16_f32 v141, v114, v115
    v_cvt_pk_bf16_f32 v142, v116, v117
    v_cvt_pk_bf16_f32 v143, v118, v119
    s_waitcnt vmcnt(4)
    v_mfma_f32_32x32x16_bf16 v[104:119], v[208:211], v[16:19], 0
    v_exp_f32 v120, v120
    v_exp_f32 v121, v121
    v_exp_f32 v122, v122
    v_exp_f32 v123, v123
    v_mfma_f32_32x32x16_bf16 v[176:191], v[252:255], v[140:143], v[176:191]
    v_exp_f32 v124, v124
    v_exp_f32 v125, v125
    v_exp_f32 v126, v126
    v_exp_f32 v127, v127
    v_mfma_f32_32x32x16_bf16 v[104:119], v[212:215], v[20:23], v[104:119]
    v_cvt_pk_bf16_f32 v136, v120, v121
    v_cvt_pk_bf16_f32 v137, v122, v123
    v_cvt_pk_bf16_f32 v138, v124, v125
    v_cvt_pk_bf16_f32 v139, v126, v127
    v_exp_f32 v128, v128
    v_exp_f32 v129, v129
    v_exp_f32 v130, v130
    v_exp_f32 v131, v131
    v_mfma_f32_32x32x16_bf16 v[192:207], v[248:251], v[136:139], v[192:207]
    v_exp_f32 v132, v132
    v_exp_f32 v133, v133
    v_exp_f32 v134, v134
    v_exp_f32 v135, v135
    v_cvt_pk_bf16_f32 v140, v128, v129
    v_cvt_pk_bf16_f32 v141, v130, v131
    v_cvt_pk_bf16_f32 v142, v132, v133
    v_cvt_pk_bf16_f32 v143, v134, v135
    v_mfma_f32_32x32x16_bf16 v[120:135], v[208:211], v[24:27], 0
    v_exp_f32 v104, v104
    v_exp_f32 v105, v105
    v_exp_f32 v106, v106
    v_exp_f32 v107, v107
    v_mfma_f32_32x32x16_bf16 v[192:207], v[252:255], v[140:143], v[192:207]
    buffer_load_dwordx4 v[240:243], v1, s[12:15], s67 offen sc1
    buffer_load_dwordx4 v[244:247], v1, s[12:15], s67 offen offset:1024 sc1
    buffer_load_dwordx4 v[248:251], v1, s[12:15], s68 offen sc1
    buffer_load_dwordx4 v[252:255], v1, s[12:15], s68 offen offset:1024 sc1
    s_add_u32 s67, s67, 8192
    s_add_u32 s68, s68, 8192
    v_exp_f32 v108, v108
    v_exp_f32 v109, v109
    v_exp_f32 v110, v110
    v_exp_f32 v111, v111
    v_mfma_f32_32x32x16_bf16 v[120:135], v[212:215], v[28:31], v[120:135]
    v_cvt_pk_bf16_f32 v136, v104, v105
    v_cvt_pk_bf16_f32 v137, v106, v107
    v_cvt_pk_bf16_f32 v138, v108, v109
    v_cvt_pk_bf16_f32 v139, v110, v111
    v_exp_f32 v112, v112
    v_exp_f32 v113, v113
    v_exp_f32 v114, v114
    v_exp_f32 v115, v115
    v_mfma_f32_32x32x16_bf16 v[144:159], v[216:219], v[136:139], v[144:159]
    v_exp_f32 v116, v116
    v_exp_f32 v117, v117
    v_exp_f32 v118, v118
    v_exp_f32 v119, v119
    v_cvt_pk_bf16_f32 v140, v112, v113
    v_cvt_pk_bf16_f32 v141, v114, v115
    v_cvt_pk_bf16_f32 v142, v116, v117
    v_cvt_pk_bf16_f32 v143, v118, v119
    v_mfma_f32_32x32x16_bf16 v[104:119], v[208:211], v[32:35], 0
    v_exp_f32 v120, v120
    v_exp_f32 v121, v121
    v_exp_f32 v122, v122
    v_exp_f32 v123, v123
    v_mfma_f32_32x32x16_bf16 v[144:159], v[220:223], v[140:143], v[144:159]
    v_exp_f32 v124, v124
    v_exp_f32 v125, v125
    v_exp_f32 v126, v126
    v_exp_f32 v127, v127
    v_mfma_f32_32x32x16_bf16 v[104:119], v[212:215], v[36:39], v[104:119]
    v_cvt_pk_bf16_f32 v136, v120, v121
    v_cvt_pk_bf16_f32 v137, v122, v123
    v_cvt_pk_bf16_f32 v138, v124, v125
    v_cvt_pk_bf16_f32 v139, v126, v127
    v_exp_f32 v128, v128
    v_exp_f32 v129, v129
    v_exp_f32 v130, v130
    v_exp_f32 v131, v131
    v_mfma_f32_32x32x16_bf16 v[160:175], v[216:219], v[136:139], v[160:175]
    v_exp_f32 v132, v132
    v_exp_f32 v133, v133
    v_exp_f32 v134, v134
    v_exp_f32 v135, v135
    v_cvt_pk_bf16_f32 v140, v128, v129
    v_cvt_pk_bf16_f32 v141, v130, v131
    v_cvt_pk_bf16_f32 v142, v132, v133
    v_cvt_pk_bf16_f32 v143, v134, v135
    v_mfma_f32_32x32x16_bf16 v[120:135], v[208:211], v[40:43], 0
    v_exp_f32 v104, v104
    v_exp_f32 v105, v105
    v_exp_f32 v106, v106
    v_exp_f32 v107, v107
    v_mfma_f32_32x32x16_bf16 v[160:175], v[220:223], v[140:143], v[160:175]
    v_exp_f32 v108, v108
    v_exp_f32 v109, v109
    v_exp_f32 v110, v110
    v_exp_f32 v111, v111
    v_mfma_f32_32x32x16_bf16 v[120:135], v[212:215], v[44:47], v[120:135]
    v_cvt_pk_bf16_f32 v136, v104, v105
    v_cvt_pk_bf16_f32 v137, v106, v107
    v_cvt_pk_bf16_f32 v138, v108, v109
    v_cvt_pk_bf16_f32 v139, v110, v111
    v_exp_f32 v112, v112
    v_exp_f32 v113, v113
    v_exp_f32 v114, v114
    v_exp_f32 v115, v115
    v_mfma_f32_32x32x16_bf16 v[176:191], v[216:219], v[136:139], v[176:191]
    v_exp_f32 v116, v116
    v_exp_f32 v117, v117
    v_exp_f32 v118, v118
    v_exp_f32 v119, v119
    v_cvt_pk_bf16_f32 v140, v112, v113
    v_cvt_pk_bf16_f32 v141, v114, v115
    v_cvt_pk_bf16_f32 v142, v116, v117
    v_cvt_pk_bf16_f32 v143, v118, v119
    s_waitcnt vmcnt(4)
    v_mfma_f32_32x32x16_bf16 v[104:119], v[224:227], v[16:19], 0
    v_exp_f32 v120, v120
    v_exp_f32 v121, v121
    v_exp_f32 v122, v122
    v_exp_f32 v123, v123
    v_mfma_f32_32x32x16_bf16 v[176:191], v[220:223], v[140:143], v[176:191]
    v_exp_f32 v124, v124
    v_exp_f32 v125, v125
    v_exp_f32 v126, v126
    v_exp_f32 v127, v127
    v_mfma_f32_32x32x16_bf16 v[104:119], v[228:231], v[20:23], v[104:119]
    v_cvt_pk_bf16_f32 v136, v120, v121
    v_cvt_pk_bf16_f32 v137, v122, v123
    v_cvt_pk_bf16_f32 v138, v124, v125
    v_cvt_pk_bf16_f32 v139, v126, v127
    v_exp_f32 v128, v128
    v_exp_f32 v129, v129
    v_exp_f32 v130, v130
    v_exp_f32 v131, v131
    v_mfma_f32_32x32x16_bf16 v[192:207], v[216:219], v[136:139], v[192:207]
    v_exp_f32 v132, v132
    v_exp_f32 v133, v133
    v_exp_f32 v134, v134
    v_exp_f32 v135, v135
    v_cvt_pk_bf16_f32 v140, v128, v129
    v_cvt_pk_bf16_f32 v141, v130, v131
    v_cvt_pk_bf16_f32 v142, v132, v133
    v_cvt_pk_bf16_f32 v143, v134, v135
    v_mfma_f32_32x32x16_bf16 v[120:135], v[224:227], v[24:27], 0
    v_exp_f32 v104, v104
    v_exp_f32 v105, v105
    v_exp_f32 v106, v106
    v_exp_f32 v107, v107
    v_mfma_f32_32x32x16_bf16 v[192:207], v[220:223], v[140:143], v[192:207]
    buffer_load_dwordx4 v[208:211], v1, s[12:15], s67 offen sc1
    buffer_load_dwordx4 v[212:215], v1, s[12:15], s67 offen offset:1024 sc1
    buffer_load_dwordx4 v[216:219], v1, s[12:15], s68 offen sc1
    buffer_load_dwordx4 v[220:223], v1, s[12:15], s68 offen offset:1024 sc1
    s_add_u32 s67, s67, 8192
    s_add_u32 s68, s68, 8192
    v_exp_f32 v108, v108
    v_exp_f32 v109, v109
    v_exp_f32 v110, v110
    v_exp_f32 v111, v111
    v_mfma_f32_32x32x16_bf16 v[120:135], v[228:231], v[28:31], v[120:135]
    v_cvt_pk_bf16_f32 v136, v104, v105
    v_cvt_pk_bf16_f32 v137, v106, v107
    v_cvt_pk_bf16_f32 v138, v108, v109
    v_cvt_pk_bf16_f32 v139, v110, v111
    v_exp_f32 v112, v112
    v_exp_f32 v113, v113
    v_exp_f32 v114, v114
    v_exp_f32 v115, v115
    v_mfma_f32_32x32x16_bf16 v[144:159], v[232:235], v[136:139], v[144:159]
    v_exp_f32 v116, v116
    v_exp_f32 v117, v117
    v_exp_f32 v118, v118
    v_exp_f32 v119, v119
    v_cvt_pk_bf16_f32 v140, v112, v113
    v_cvt_pk_bf16_f32 v141, v114, v115
    v_cvt_pk_bf16_f32 v142, v116, v117
    v_cvt_pk_bf16_f32 v143, v118, v119
    v_mfma_f32_32x32x16_bf16 v[104:119], v[224:227], v[32:35], 0
    v_exp_f32 v120, v120
    v_exp_f32 v121, v121
    v_exp_f32 v122, v122
    v_exp_f32 v123, v123
    v_mfma_f32_32x32x16_bf16 v[144:159], v[236:239], v[140:143], v[144:159]
    v_exp_f32 v124, v124
    v_exp_f32 v125, v125
    v_exp_f32 v126, v126
    v_exp_f32 v127, v127
    v_mfma_f32_32x32x16_bf16 v[104:119], v[228:231], v[36:39], v[104:119]
    v_cvt_pk_bf16_f32 v136, v120, v121
    v_cvt_pk_bf16_f32 v137, v122, v123
    v_cvt_pk_bf16_f32 v138, v124, v125
    v_cvt_pk_bf16_f32 v139, v126, v127
    v_exp_f32 v128, v128
    v_exp_f32 v129, v129
    v_exp_f32 v130, v130
    v_exp_f32 v131, v131
    v_mfma_f32_32x32x16_bf16 v[160:175], v[232:235], v[136:139], v[160:175]
    v_exp_f32 v132, v132
    v_exp_f32 v133, v133
    v_exp_f32 v134, v134
    v_exp_f32 v135, v135
    v_cvt_pk_bf16_f32 v140, v128, v129
    v_cvt_pk_bf16_f32 v141, v130, v131
    v_cvt_pk_bf16_f32 v142, v132, v133
    v_cvt_pk_bf16_f32 v143, v134, v135
    v_mfma_f32_32x32x16_bf16 v[120:135], v[224:227], v[40:43], 0
    v_exp_f32 v104, v104
    v_exp_f32 v105, v105
    v_exp_f32 v106, v106
    v_exp_f32 v107, v107
    v_mfma_f32_32x32x16_bf16 v[160:175], v[236:239], v[140:143], v[160:175]
    v_exp_f32 v108, v108
    v_exp_f32 v109, v109
    v_exp_f32 v110, v110
    v_exp_f32 v111, v111
    v_mfma_f32_32x32x16_bf16 v[120:135], v[228:231], v[44:47], v[120:135]
    v_cvt_pk_bf16_f32 v136, v104, v105
    v_cvt_pk_bf16_f32 v137, v106, v107
    v_cvt_pk_bf16_f32 v138, v108, v109
    v_cvt_pk_bf16_f32 v139, v110, v111
    v_exp_f32 v112, v112
    v_exp_f32 v113, v113
    v_exp_f32 v114, v114
    v_exp_f32 v115, v115
    v_mfma_f32_32x32x16_bf16 v[176:191], v[232:235], v[136:139], v[176:191]
    v_exp_f32 v116, v116
    v_exp_f32 v117, v117
    v_exp_f32 v118, v118
    v_exp_f32 v119, v119
    v_cvt_pk_bf16_f32 v140, v112, v113
    v_cvt_pk_bf16_f32 v141, v114, v115
    v_cvt_pk_bf16_f32 v142, v116, v117
    v_cvt_pk_bf16_f32 v143, v118, v119
    s_waitcnt vmcnt(4)
    v_mfma_f32_32x32x16_bf16 v[104:119], v[240:243], v[16:19], 0
    v_exp_f32 v120, v120
    v_exp_f32 v121, v121
    v_exp_f32 v122, v122
    v_exp_f32 v123, v123
    v_mfma_f32_32x32x16_bf16 v[176:191], v[236:239], v[140:143], v[176:191]
    v_exp_f32 v124, v124
    v_exp_f32 v125, v125
    v_exp_f32 v126, v126
    v_exp_f32 v127, v127
    v_mfma_f32_32x32x16_bf16 v[104:119], v[244:247], v[20:23], v[104:119]
    v_cvt_pk_bf16_f32 v136, v120, v121
    v_cvt_pk_bf16_f32 v137, v122, v123
    v_cvt_pk_bf16_f32 v138, v124, v125
    v_cvt_pk_bf16_f32 v139, v126, v127
    v_exp_f32 v128, v128
    v_exp_f32 v129, v129
    v_exp_f32 v130, v130
    v_exp_f32 v131, v131
    v_mfma_f32_32x32x16_bf16 v[192:207], v[232:235], v[136:139], v[192:207]
    v_exp_f32 v132, v132
    v_exp_f32 v133, v133
    v_exp_f32 v134, v134
    v_exp_f32 v135, v135
    v_cvt_pk_bf16_f32 v140, v128, v129
    v_cvt_pk_bf16_f32 v141, v130, v131
    v_cvt_pk_bf16_f32 v142, v132, v133
    v_cvt_pk_bf16_f32 v143, v134, v135
    v_mfma_f32_32x32x16_bf16 v[120:135], v[240:243], v[24:27], 0
    v_exp_f32 v104, v104
    v_exp_f32 v105, v105
    v_exp_f32 v106, v106
    v_exp_f32 v107, v107
    v_mfma_f32_32x32x16_bf16 v[192:207], v[236:239], v[140:143], v[192:207]
    buffer_load_dwordx4 v[224:227], v1, s[12:15], s67 offen sc1
    buffer_load_dwordx4 v[228:231], v1, s[12:15], s67 offen offset:1024 sc1
    buffer_load_dwordx4 v[232:235], v1, s[12:15], s68 offen sc1
    buffer_load_dwordx4 v[236:239], v1, s[12:15], s68 offen offset:1024 sc1
    s_add_u32 s67, s67, 8192
    s_add_u32 s68, s68, 8192
    v_exp_f32 v108, v108
    v_exp_f32 v109, v109
    v_exp_f32 v110, v110
    v_exp_f32 v111, v111
    v_mfma_f32_32x32x16_bf16 v[120:135], v[244:247], v[28:31], v[120:135]
    v_cvt_pk_bf16_f32 v136, v104, v105
    v_cvt_pk_bf16_f32 v137, v106, v107
    v_cvt_pk_bf16_f32 v138, v108, v109
    v_cvt_pk_bf16_f32 v139, v110, v111
    v_exp_f32 v112, v112
    v_exp_f32 v113, v113
    v_exp_f32 v114, v114
    v_exp_f32 v115, v115
    v_mfma_f32_32x32x16_bf16 v[144:159], v[248:251], v[136:139], v[144:159]
    v_exp_f32 v116, v116
    v_exp_f32 v117, v117
    v_exp_f32 v118, v118
    v_exp_f32 v119, v119
    v_cvt_pk_bf16_f32 v140, v112, v113
    v_cvt_pk_bf16_f32 v141, v114, v115
    v_cvt_pk_bf16_f32 v142, v116, v117
    v_cvt_pk_bf16_f32 v143, v118, v119
    v_mfma_f32_32x32x16_bf16 v[104:119], v[240:243], v[32:35], 0
    v_exp_f32 v120, v120
    v_exp_f32 v121, v121
    v_exp_f32 v122, v122
    v_exp_f32 v123, v123
    v_mfma_f32_32x32x16_bf16 v[144:159], v[252:255], v[140:143], v[144:159]
    v_exp_f32 v124, v124
    v_exp_f32 v125, v125
    v_exp_f32 v126, v126
    v_exp_f32 v127, v127
    v_mfma_f32_32x32x16_bf16 v[104:119], v[244:247], v[36:39], v[104:119]
    v_cvt_pk_bf16_f32 v136, v120, v121
    v_cvt_pk_bf16_f32 v137, v122, v123
    v_cvt_pk_bf16_f32 v138, v124, v125
    v_cvt_pk_bf16_f32 v139, v126, v127
    v_exp_f32 v128, v128
    v_exp_f32 v129, v129
    v_exp_f32 v130, v130
    v_exp_f32 v131, v131
    v_mfma_f32_32x32x16_bf16 v[160:175], v[248:251], v[136:139], v[160:175]
    v_exp_f32 v132, v132
    v_exp_f32 v133, v133
    v_exp_f32 v134, v134
    v_exp_f32 v135, v135
    v_cvt_pk_bf16_f32 v140, v128, v129
    v_cvt_pk_bf16_f32 v141, v130, v131
    v_cvt_pk_bf16_f32 v142, v132, v133
    v_cvt_pk_bf16_f32 v143, v134, v135
    v_mfma_f32_32x32x16_bf16 v[120:135], v[240:243], v[40:43], 0
    v_exp_f32 v104, v104
    v_exp_f32 v105, v105
    v_exp_f32 v106, v106
    v_exp_f32 v107, v107
    v_mfma_f32_32x32x16_bf16 v[160:175], v[252:255], v[140:143], v[160:175]
    v_exp_f32 v108, v108
    v_exp_f32 v109, v109
    v_exp_f32 v110, v110
    v_exp_f32 v111, v111
    v_mfma_f32_32x32x16_bf16 v[120:135], v[244:247], v[44:47], v[120:135]
    v_cvt_pk_bf16_f32 v136, v104, v105
    v_cvt_pk_bf16_f32 v137, v106, v107
    v_cvt_pk_bf16_f32 v138, v108, v109
    v_cvt_pk_bf16_f32 v139, v110, v111
    v_exp_f32 v112, v112
    v_exp_f32 v113, v113
    v_exp_f32 v114, v114
    v_exp_f32 v115, v115
    v_mfma_f32_32x32x16_bf16 v[176:191], v[248:251], v[136:139], v[176:191]
    v_exp_f32 v116, v116
    v_exp_f32 v117, v117
    v_exp_f32 v118, v118
    v_exp_f32 v119, v119
    v_cvt_pk_bf16_f32 v140, v112, v113
    v_cvt_pk_bf16_f32 v141, v114, v115
    v_cvt_pk_bf16_f32 v142, v116, v117
    v_cvt_pk_bf16_f32 v143, v118, v119
    s_waitcnt vmcnt(4)
    v_mfma_f32_32x32x16_bf16 v[104:119], v[208:211], v[16:19], 0
    v_exp_f32 v120, v120
    v_exp_f32 v121, v121
    v_exp_f32 v122, v122
    v_exp_f32 v123, v123
    v_mfma_f32_32x32x16_bf16 v[176:191], v[252:255], v[140:143], v[176:191]
    v_exp_f32 v124, v124
    v_exp_f32 v125, v125
    v_exp_f32 v126, v126
    v_exp_f32 v127, v127
    v_mfma_f32_32x32x16_bf16 v[104:119], v[212:215], v[20:23], v[104:119]
    v_cvt_pk_bf16_f32 v136, v120, v121
    v_cvt_pk_bf16_f32 v137, v122, v123
    v_cvt_pk_bf16_f32 v138, v124, v125
    v_cvt_pk_bf16_f32 v139, v126, v127
    v_exp_f32 v128, v128
    v_exp_f32 v129, v129
    v_exp_f32 v130, v130
    v_exp_f32 v131, v131
    v_mfma_f32_32x32x16_bf16 v[192:207], v[248:251], v[136:139], v[192:207]
    v_exp_f32 v132, v132
    v_exp_f32 v133, v133
    v_exp_f32 v134, v134
    v_exp_f32 v135, v135
    v_cvt_pk_bf16_f32 v140, v128, v129
    v_cvt_pk_bf16_f32 v141, v130, v131
    v_cvt_pk_bf16_f32 v142, v132, v133
    v_cvt_pk_bf16_f32 v143, v134, v135
    v_mfma_f32_32x32x16_bf16 v[120:135], v[208:211], v[24:27], 0
    v_exp_f32 v104, v104
    v_exp_f32 v105, v105
    v_exp_f32 v106, v106
    v_exp_f32 v107, v107
    v_mfma_f32_32x32x16_bf16 v[192:207], v[252:255], v[140:143], v[192:207]
    buffer_load_dwordx4 v[240:243], v1, s[12:15], s67 offen sc1
    buffer_load_dwordx4 v[244:247], v1, s[12:15], s67 offen offset:1024 sc1
    buffer_load_dwordx4 v[248:251], v1, s[12:15], s68 offen sc1
    buffer_load_dwordx4 v[252:255], v1, s[12:15], s68 offen offset:1024 sc1
    s_add_u32 s67, s67, 8192
    s_add_u32 s68, s68, 8192
    v_exp_f32 v108, v108
    v_exp_f32 v109, v109
    v_exp_f32 v110, v110
    v_exp_f32 v111, v111
    v_mfma_f32_32x32x16_bf16 v[120:135], v[212:215], v[28:31], v[120:135]
    v_cvt_pk_bf16_f32 v136, v104, v105
    v_cvt_pk_bf16_f32 v137, v106, v107
    v_cvt_pk_bf16_f32 v138, v108, v109
    v_cvt_pk_bf16_f32 v139, v110, v111
    v_exp_f32 v112, v112
    v_exp_f32 v113, v113
    v_exp_f32 v114, v114
    v_exp_f32 v115, v115
    v_mfma_f32_32x32x16_bf16 v[144:159], v[216:219], v[136:139], v[144:159]
    v_exp_f32 v116, v116
    v_exp_f32 v117, v117
    v_exp_f32 v118, v118
    v_exp_f32 v119, v119
    v_cvt_pk_bf16_f32 v140, v112, v113
    v_cvt_pk_bf16_f32 v141, v114, v115
    v_cvt_pk_bf16_f32 v142, v116, v117
    v_cvt_pk_bf16_f32 v143, v118, v119
    v_mfma_f32_32x32x16_bf16 v[104:119], v[208:211], v[32:35], 0
    v_exp_f32 v120, v120
    v_exp_f32 v121, v121
    v_exp_f32 v122, v122
    v_exp_f32 v123, v123
    v_mfma_f32_32x32x16_bf16 v[144:159], v[220:223], v[140:143], v[144:159]
    v_exp_f32 v124, v124
    v_exp_f32 v125, v125
    v_exp_f32 v126, v126
    v_exp_f32 v127, v127
    v_mfma_f32_32x32x16_bf16 v[104:119], v[212:215], v[36:39], v[104:119]
    v_cvt_pk_bf16_f32 v136, v120, v121
    v_cvt_pk_bf16_f32 v137, v122, v123
    v_cvt_pk_bf16_f32 v138, v124, v125
    v_cvt_pk_bf16_f32 v139, v126, v127
    v_exp_f32 v128, v128
    v_exp_f32 v129, v129
    v_exp_f32 v130, v130
    v_exp_f32 v131, v131
    v_mfma_f32_32x32x16_bf16 v[160:175], v[216:219], v[136:139], v[160:175]
    v_exp_f32 v132, v132
    v_exp_f32 v133, v133
    v_exp_f32 v134, v134
    v_exp_f32 v135, v135
    v_cvt_pk_bf16_f32 v140, v128, v129
    v_cvt_pk_bf16_f32 v141, v130, v131
    v_cvt_pk_bf16_f32 v142, v132, v133
    v_cvt_pk_bf16_f32 v143, v134, v135
    v_mfma_f32_32x32x16_bf16 v[120:135], v[208:211], v[40:43], 0
    v_exp_f32 v104, v104
    v_exp_f32 v105, v105
    v_exp_f32 v106, v106
    v_exp_f32 v107, v107
    v_mfma_f32_32x32x16_bf16 v[160:175], v[220:223], v[140:143], v[160:175]
    v_exp_f32 v108, v108
    v_exp_f32 v109, v109
    v_exp_f32 v110, v110
    v_exp_f32 v111, v111
    v_mfma_f32_32x32x16_bf16 v[120:135], v[212:215], v[44:47], v[120:135]
    v_cvt_pk_bf16_f32 v136, v104, v105
    v_cvt_pk_bf16_f32 v137, v106, v107
    v_cvt_pk_bf16_f32 v138, v108, v109
    v_cvt_pk_bf16_f32 v139, v110, v111
    v_exp_f32 v112, v112
    v_exp_f32 v113, v113
    v_exp_f32 v114, v114
    v_exp_f32 v115, v115
    v_mfma_f32_32x32x16_bf16 v[176:191], v[216:219], v[136:139], v[176:191]
    v_exp_f32 v116, v116
    v_exp_f32 v117, v117
    v_exp_f32 v118, v118
    v_exp_f32 v119, v119
    v_cvt_pk_bf16_f32 v140, v112, v113
    v_cvt_pk_bf16_f32 v141, v114, v115
    v_cvt_pk_bf16_f32 v142, v116, v117
    v_cvt_pk_bf16_f32 v143, v118, v119
    s_waitcnt vmcnt(4)
    v_mfma_f32_32x32x16_bf16 v[104:119], v[224:227], v[16:19], 0
    v_exp_f32 v120, v120
    v_exp_f32 v121, v121
    v_exp_f32 v122, v122
    v_exp_f32 v123, v123
    v_mfma_f32_32x32x16_bf16 v[176:191], v[220:223], v[140:143], v[176:191]
    v_exp_f32 v124, v124
    v_exp_f32 v125, v125
    v_exp_f32 v126, v126
    v_exp_f32 v127, v127
    v_mfma_f32_32x32x16_bf16 v[104:119], v[228:231], v[20:23], v[104:119]
    v_cvt_pk_bf16_f32 v136, v120, v121
    v_cvt_pk_bf16_f32 v137, v122, v123
    v_cvt_pk_bf16_f32 v138, v124, v125
    v_cvt_pk_bf16_f32 v139, v126, v127
    v_exp_f32 v128, v128
    v_exp_f32 v129, v129
    v_exp_f32 v130, v130
    v_exp_f32 v131, v131
    v_mfma_f32_32x32x16_bf16 v[192:207], v[216:219], v[136:139], v[192:207]
    v_exp_f32 v132, v132
    v_exp_f32 v133, v133
    v_exp_f32 v134, v134
    v_exp_f32 v135, v135
    v_cvt_pk_bf16_f32 v140, v128, v129
    v_cvt_pk_bf16_f32 v141, v130, v131
    v_cvt_pk_bf16_f32 v142, v132, v133
    v_cvt_pk_bf16_f32 v143, v134, v135
    v_mfma_f32_32x32x16_bf16 v[120:135], v[224:227], v[24:27], 0
    v_exp_f32 v104, v104
    v_exp_f32 v105, v105
    v_exp_f32 v106, v106
    v_exp_f32 v107, v107
    v_mfma_f32_32x32x16_bf16 v[192:207], v[220:223], v[140:143], v[192:207]
    buffer_load_dwordx4 v[208:211], v1, s[12:15], s67 offen sc1
    buffer_load_dwordx4 v[212:215], v1, s[12:15], s67 offen offset:1024 sc1
    buffer_load_dwordx4 v[216:219], v1, s[12:15], s68 offen sc1
    buffer_load_dwordx4 v[220:223], v1, s[12:15], s68 offen offset:1024 sc1
    s_add_u32 s67, s67, 8192
    s_add_u32 s68, s68, 8192
    v_exp_f32 v108, v108
    v_exp_f32 v109, v109
    v_exp_f32 v110, v110
    v_exp_f32 v111, v111
    v_mfma_f32_32x32x16_bf16 v[120:135], v[228:231], v[28:31], v[120:135]
    v_cvt_pk_bf16_f32 v136, v104, v105
    v_cvt_pk_bf16_f32 v137, v106, v107
    v_cvt_pk_bf16_f32 v138, v108, v109
    v_cvt_pk_bf16_f32 v139, v110, v111
    v_exp_f32 v112, v112
    v_exp_f32 v113, v113
    v_exp_f32 v114, v114
    v_exp_f32 v115, v115
    v_mfma_f32_32x32x16_bf16 v[144:159], v[232:235], v[136:139], v[144:159]
    v_exp_f32 v116, v116
    v_exp_f32 v117, v117
    v_exp_f32 v118, v118
    v_exp_f32 v119, v119
    v_cvt_pk_bf16_f32 v140, v112, v113
    v_cvt_pk_bf16_f32 v141, v114, v115
    v_cvt_pk_bf16_f32 v142, v116, v117
    v_cvt_pk_bf16_f32 v143, v118, v119
    v_mfma_f32_32x32x16_bf16 v[104:119], v[224:227], v[32:35], 0
    v_exp_f32 v120, v120
    v_exp_f32 v121, v121
    v_exp_f32 v122, v122
    v_exp_f32 v123, v123
    v_mfma_f32_32x32x16_bf16 v[144:159], v[236:239], v[140:143], v[144:159]
    v_exp_f32 v124, v124
    v_exp_f32 v125, v125
    v_exp_f32 v126, v126
    v_exp_f32 v127, v127
    v_mfma_f32_32x32x16_bf16 v[104:119], v[228:231], v[36:39], v[104:119]
    v_cvt_pk_bf16_f32 v136, v120, v121
    v_cvt_pk_bf16_f32 v137, v122, v123
    v_cvt_pk_bf16_f32 v138, v124, v125
    v_cvt_pk_bf16_f32 v139, v126, v127
    v_exp_f32 v128, v128
    v_exp_f32 v129, v129
    v_exp_f32 v130, v130
    v_exp_f32 v131, v131
    v_mfma_f32_32x32x16_bf16 v[160:175], v[232:235], v[136:139], v[160:175]
    v_exp_f32 v132, v132
    v_exp_f32 v133, v133
    v_exp_f32 v134, v134
    v_exp_f32 v135, v135
    v_cvt_pk_bf16_f32 v140, v128, v129
    v_cvt_pk_bf16_f32 v141, v130, v131
    v_cvt_pk_bf16_f32 v142, v132, v133
    v_cvt_pk_bf16_f32 v143, v134, v135
    v_mfma_f32_32x32x16_bf16 v[120:135], v[224:227], v[40:43], 0
    v_exp_f32 v104, v104
    v_exp_f32 v105, v105
    v_exp_f32 v106, v106
    v_exp_f32 v107, v107
    v_mfma_f32_32x32x16_bf16 v[160:175], v[236:239], v[140:143], v[160:175]
    v_exp_f32 v108, v108
    v_exp_f32 v109, v109
    v_exp_f32 v110, v110
    v_exp_f32 v111, v111
    v_mfma_f32_32x32x16_bf16 v[120:135], v[228:231], v[44:47], v[120:135]
    v_cvt_pk_bf16_f32 v136, v104, v105
    v_cvt_pk_bf16_f32 v137, v106, v107
    v_cvt_pk_bf16_f32 v138, v108, v109
    v_cvt_pk_bf16_f32 v139, v110, v111
    v_exp_f32 v112, v112
    v_exp_f32 v113, v113
    v_exp_f32 v114, v114
    v_exp_f32 v115, v115
    v_mfma_f32_32x32x16_bf16 v[176:191], v[232:235], v[136:139], v[176:191]
    v_exp_f32 v116, v116
    v_exp_f32 v117, v117
    v_exp_f32 v118, v118
    v_exp_f32 v119, v119
    v_cvt_pk_bf16_f32 v140, v112, v113
    v_cvt_pk_bf16_f32 v141, v114, v115
    v_cvt_pk_bf16_f32 v142, v116, v117
    v_cvt_pk_bf16_f32 v143, v118, v119
    s_waitcnt vmcnt(4)
    v_mfma_f32_32x32x16_bf16 v[104:119], v[240:243], v[16:19], 0
    v_exp_f32 v120, v120
    v_exp_f32 v121, v121
    v_exp_f32 v122, v122
    v_exp_f32 v123, v123
    v_mfma_f32_32x32x16_bf16 v[176:191], v[236:239], v[140:143], v[176:191]
    v_exp_f32 v124, v124
    v_exp_f32 v125, v125
    v_exp_f32 v126, v126
    v_exp_f32 v127, v127
    v_mfma_f32_32x32x16_bf16 v[104:119], v[244:247], v[20:23], v[104:119]
    v_cvt_pk_bf16_f32 v136, v120, v121
    v_cvt_pk_bf16_f32 v137, v122, v123
    v_cvt_pk_bf16_f32 v138, v124, v125
    v_cvt_pk_bf16_f32 v139, v126, v127
    v_exp_f32 v128, v128
    v_exp_f32 v129, v129
    v_exp_f32 v130, v130
    v_exp_f32 v131, v131
    v_mfma_f32_32x32x16_bf16 v[192:207], v[232:235], v[136:139], v[192:207]
    v_exp_f32 v132, v132
    v_exp_f32 v133, v133
    v_exp_f32 v134, v134
    v_exp_f32 v135, v135
    v_cvt_pk_bf16_f32 v140, v128, v129
    v_cvt_pk_bf16_f32 v141, v130, v131
    v_cvt_pk_bf16_f32 v142, v132, v133
    v_cvt_pk_bf16_f32 v143, v134, v135
    v_mfma_f32_32x32x16_bf16 v[120:135], v[240:243], v[24:27], 0
    v_exp_f32 v104, v104
    v_exp_f32 v105, v105
    v_exp_f32 v106, v106
    v_exp_f32 v107, v107
    v_mfma_f32_32x32x16_bf16 v[192:207], v[236:239], v[140:143], v[192:207]
    buffer_load_dwordx4 v[224:227], v1, s[12:15], s67 offen sc1
    buffer_load_dwordx4 v[228:231], v1, s[12:15], s67 offen offset:1024 sc1
    buffer_load_dwordx4 v[232:235], v1, s[12:15], s68 offen sc1
    buffer_load_dwordx4 v[236:239], v1, s[12:15], s68 offen offset:1024 sc1
    s_add_u32 s67, s67, 8192
    s_add_u32 s68, s68, 8192
    v_exp_f32 v108, v108
    v_exp_f32 v109, v109
    v_exp_f32 v110, v110
    v_exp_f32 v111, v111
    v_mfma_f32_32x32x16_bf16 v[120:135], v[244:247], v[28:31], v[120:135]
    v_cvt_pk_bf16_f32 v136, v104, v105
    v_cvt_pk_bf16_f32 v137, v106, v107
    v_cvt_pk_bf16_f32 v138, v108, v109
    v_cvt_pk_bf16_f32 v139, v110, v111
    v_exp_f32 v112, v112
    v_exp_f32 v113, v113
    v_exp_f32 v114, v114
    v_exp_f32 v115, v115
    v_mfma_f32_32x32x16_bf16 v[144:159], v[248:251], v[136:139], v[144:159]
    v_exp_f32 v116, v116
    v_exp_f32 v117, v117
    v_exp_f32 v118, v118
    v_exp_f32 v119, v119
    v_cvt_pk_bf16_f32 v140, v112, v113
    v_cvt_pk_bf16_f32 v141, v114, v115
    v_cvt_pk_bf16_f32 v142, v116, v117
    v_cvt_pk_bf16_f32 v143, v118, v119
    v_mfma_f32_32x32x16_bf16 v[104:119], v[240:243], v[32:35], 0
    v_exp_f32 v120, v120
    v_exp_f32 v121, v121
    v_exp_f32 v122, v122
    v_exp_f32 v123, v123
    v_mfma_f32_32x32x16_bf16 v[144:159], v[252:255], v[140:143], v[144:159]
    v_exp_f32 v124, v124
    v_exp_f32 v125, v125
    v_exp_f32 v126, v126
    v_exp_f32 v127, v127
    v_mfma_f32_32x32x16_bf16 v[104:119], v[244:247], v[36:39], v[104:119]
    v_cvt_pk_bf16_f32 v136, v120, v121
    v_cvt_pk_bf16_f32 v137, v122, v123
    v_cvt_pk_bf16_f32 v138, v124, v125
    v_cvt_pk_bf16_f32 v139, v126, v127
    v_exp_f32 v128, v128
    v_exp_f32 v129, v129
    v_exp_f32 v130, v130
    v_exp_f32 v131, v131
    v_mfma_f32_32x32x16_bf16 v[160:175], v[248:251], v[136:139], v[160:175]
    v_exp_f32 v132, v132
    v_exp_f32 v133, v133
    v_exp_f32 v134, v134
    v_exp_f32 v135, v135
    v_cvt_pk_bf16_f32 v140, v128, v129
    v_cvt_pk_bf16_f32 v141, v130, v131
    v_cvt_pk_bf16_f32 v142, v132, v133
    v_cvt_pk_bf16_f32 v143, v134, v135
    v_mfma_f32_32x32x16_bf16 v[120:135], v[240:243], v[40:43], 0
    v_exp_f32 v104, v104
    v_exp_f32 v105, v105
    v_exp_f32 v106, v106
    v_exp_f32 v107, v107
    v_mfma_f32_32x32x16_bf16 v[160:175], v[252:255], v[140:143], v[160:175]
    v_exp_f32 v108, v108
    v_exp_f32 v109, v109
    v_exp_f32 v110, v110
    v_exp_f32 v111, v111
    v_mfma_f32_32x32x16_bf16 v[120:135], v[244:247], v[44:47], v[120:135]
    v_cvt_pk_bf16_f32 v136, v104, v105
    v_cvt_pk_bf16_f32 v137, v106, v107
    v_cvt_pk_bf16_f32 v138, v108, v109
    v_cvt_pk_bf16_f32 v139, v110, v111
    v_exp_f32 v112, v112
    v_exp_f32 v113, v113
    v_exp_f32 v114, v114
    v_exp_f32 v115, v115
    v_mfma_f32_32x32x16_bf16 v[176:191], v[248:251], v[136:139], v[176:191]
    v_exp_f32 v116, v116
    v_exp_f32 v117, v117
    v_exp_f32 v118, v118
    v_exp_f32 v119, v119
    v_cvt_pk_bf16_f32 v140, v112, v113
    v_cvt_pk_bf16_f32 v141, v114, v115
    v_cvt_pk_bf16_f32 v142, v116, v117
    v_cvt_pk_bf16_f32 v143, v118, v119
    s_waitcnt vmcnt(4)
    v_mfma_f32_32x32x16_bf16 v[104:119], v[208:211], v[16:19], 0
    v_exp_f32 v120, v120
    v_exp_f32 v121, v121
    v_exp_f32 v122, v122
    v_exp_f32 v123, v123
    v_mfma_f32_32x32x16_bf16 v[176:191], v[252:255], v[140:143], v[176:191]
    v_exp_f32 v124, v124
    v_exp_f32 v125, v125
    v_exp_f32 v126, v126
    v_exp_f32 v127, v127
    v_mfma_f32_32x32x16_bf16 v[104:119], v[212:215], v[20:23], v[104:119]
    v_cvt_pk_bf16_f32 v136, v120, v121
    v_cvt_pk_bf16_f32 v137, v122, v123
    v_cvt_pk_bf16_f32 v138, v124, v125
    v_cvt_pk_bf16_f32 v139, v126, v127
    v_exp_f32 v128, v128
    v_exp_f32 v129, v129
    v_exp_f32 v130, v130
    v_exp_f32 v131, v131
    v_mfma_f32_32x32x16_bf16 v[192:207], v[248:251], v[136:139], v[192:207]
    v_exp_f32 v132, v132
    v_exp_f32 v133, v133
    v_exp_f32 v134, v134
    v_exp_f32 v135, v135
    v_cvt_pk_bf16_f32 v140, v128, v129
    v_cvt_pk_bf16_f32 v141, v130, v131
    v_cvt_pk_bf16_f32 v142, v132, v133
    v_cvt_pk_bf16_f32 v143, v134, v135
    v_mfma_f32_32x32x16_bf16 v[120:135], v[208:211], v[24:27], 0
    v_exp_f32 v104, v104
    v_exp_f32 v105, v105
    v_exp_f32 v106, v106
    v_exp_f32 v107, v107
    v_mfma_f32_32x32x16_bf16 v[192:207], v[252:255], v[140:143], v[192:207]
    buffer_load_dwordx4 v[240:243], v1, s[12:15], s67 offen sc1
    buffer_load_dwordx4 v[244:247], v1, s[12:15], s67 offen offset:1024 sc1
    buffer_load_dwordx4 v[248:251], v1, s[12:15], s68 offen sc1
    buffer_load_dwordx4 v[252:255], v1, s[12:15], s68 offen offset:1024 sc1
    s_add_u32 s67, s67, 8192
    s_add_u32 s68, s68, 8192
    v_exp_f32 v108, v108
    v_exp_f32 v109, v109
    v_exp_f32 v110, v110
    v_exp_f32 v111, v111
    v_mfma_f32_32x32x16_bf16 v[120:135], v[212:215], v[28:31], v[120:135]
    v_cvt_pk_bf16_f32 v136, v104, v105
    v_cvt_pk_bf16_f32 v137, v106, v107
    v_cvt_pk_bf16_f32 v138, v108, v109
    v_cvt_pk_bf16_f32 v139, v110, v111
    v_exp_f32 v112, v112
    v_exp_f32 v113, v113
    v_exp_f32 v114, v114
    v_exp_f32 v115, v115
    v_mfma_f32_32x32x16_bf16 v[144:159], v[216:219], v[136:139], v[144:159]
    v_exp_f32 v116, v116
    v_exp_f32 v117, v117
    v_exp_f32 v118, v118
    v_exp_f32 v119, v119
    v_cvt_pk_bf16_f32 v140, v112, v113
    v_cvt_pk_bf16_f32 v141, v114, v115
    v_cvt_pk_bf16_f32 v142, v116, v117
    v_cvt_pk_bf16_f32 v143, v118, v119
    v_mfma_f32_32x32x16_bf16 v[104:119], v[208:211], v[32:35], 0
    v_exp_f32 v120, v120
    v_exp_f32 v121, v121
    v_exp_f32 v122, v122
    v_exp_f32 v123, v123
    v_mfma_f32_32x32x16_bf16 v[144:159], v[220:223], v[140:143], v[144:159]
    v_exp_f32 v124, v124
    v_exp_f32 v125, v125
    v_exp_f32 v126, v126
    v_exp_f32 v127, v127
    v_mfma_f32_32x32x16_bf16 v[104:119], v[212:215], v[36:39], v[104:119]
    v_cvt_pk_bf16_f32 v136, v120, v121
    v_cvt_pk_bf16_f32 v137, v122, v123
    v_cvt_pk_bf16_f32 v138, v124, v125
    v_cvt_pk_bf16_f32 v139, v126, v127
    v_exp_f32 v128, v128
    v_exp_f32 v129, v129
    v_exp_f32 v130, v130
    v_exp_f32 v131, v131
    v_mfma_f32_32x32x16_bf16 v[160:175], v[216:219], v[136:139], v[160:175]
    v_exp_f32 v132, v132
    v_exp_f32 v133, v133
    v_exp_f32 v134, v134
    v_exp_f32 v135, v135
    v_cvt_pk_bf16_f32 v140, v128, v129
    v_cvt_pk_bf16_f32 v141, v130, v131
    v_cvt_pk_bf16_f32 v142, v132, v133
    v_cvt_pk_bf16_f32 v143, v134, v135
    v_mfma_f32_32x32x16_bf16 v[120:135], v[208:211], v[40:43], 0
    v_exp_f32 v104, v104
    v_exp_f32 v105, v105
    v_exp_f32 v106, v106
    v_exp_f32 v107, v107
    v_mfma_f32_32x32x16_bf16 v[160:175], v[220:223], v[140:143], v[160:175]
    v_exp_f32 v108, v108
    v_exp_f32 v109, v109
    v_exp_f32 v110, v110
    v_exp_f32 v111, v111
    v_mfma_f32_32x32x16_bf16 v[120:135], v[212:215], v[44:47], v[120:135]
    v_cvt_pk_bf16_f32 v136, v104, v105
    v_cvt_pk_bf16_f32 v137, v106, v107
    v_cvt_pk_bf16_f32 v138, v108, v109
    v_cvt_pk_bf16_f32 v139, v110, v111
    v_exp_f32 v112, v112
    v_exp_f32 v113, v113
    v_exp_f32 v114, v114
    v_exp_f32 v115, v115
    v_mfma_f32_32x32x16_bf16 v[176:191], v[216:219], v[136:139], v[176:191]
    v_exp_f32 v116, v116
    v_exp_f32 v117, v117
    v_exp_f32 v118, v118
    v_exp_f32 v119, v119
    v_cvt_pk_bf16_f32 v140, v112, v113
    v_cvt_pk_bf16_f32 v141, v114, v115
    v_cvt_pk_bf16_f32 v142, v116, v117
    v_cvt_pk_bf16_f32 v143, v118, v119
    s_waitcnt vmcnt(4)
    v_mfma_f32_32x32x16_bf16 v[104:119], v[224:227], v[16:19], 0
    v_exp_f32 v120, v120
    v_exp_f32 v121, v121
    v_exp_f32 v122, v122
    v_exp_f32 v123, v123
    v_mfma_f32_32x32x16_bf16 v[176:191], v[220:223], v[140:143], v[176:191]
    v_exp_f32 v124, v124
    v_exp_f32 v125, v125
    v_exp_f32 v126, v126
    v_exp_f32 v127, v127
    v_mfma_f32_32x32x16_bf16 v[104:119], v[228:231], v[20:23], v[104:119]
    v_cvt_pk_bf16_f32 v136, v120, v121
    v_cvt_pk_bf16_f32 v137, v122, v123
    v_cvt_pk_bf16_f32 v138, v124, v125
    v_cvt_pk_bf16_f32 v139, v126, v127
    v_exp_f32 v128, v128
    v_exp_f32 v129, v129
    v_exp_f32 v130, v130
    v_exp_f32 v131, v131
    v_mfma_f32_32x32x16_bf16 v[192:207], v[216:219], v[136:139], v[192:207]
    v_exp_f32 v132, v132
    v_exp_f32 v133, v133
    v_exp_f32 v134, v134
    v_exp_f32 v135, v135
    v_cvt_pk_bf16_f32 v140, v128, v129
    v_cvt_pk_bf16_f32 v141, v130, v131
    v_cvt_pk_bf16_f32 v142, v132, v133
    v_cvt_pk_bf16_f32 v143, v134, v135
    v_mfma_f32_32x32x16_bf16 v[120:135], v[224:227], v[24:27], 0
    v_exp_f32 v104, v104
    v_exp_f32 v105, v105
    v_exp_f32 v106, v106
    v_exp_f32 v107, v107
    v_mfma_f32_32x32x16_bf16 v[192:207], v[220:223], v[140:143], v[192:207]
    s_cmp_lt_u32 s98, s96
    s_cbranch_scc1 Lgo_main_kernel_346
    s_mov_b32 s70, 2097152
    v_lshlrev_b32 v8, 3, v1
    v_and_b32 v8, 0x780, v8
Lgl_main_kernel_347:
    s_min_u32 s96, s96, 48
    s_lshl_b32 s97, s96, 7
    s_add_u32 s97, s97, 97714176
    s_mov_b64 exec, 0xffff
    buffer_load_dword v9, v8, s[12:15], s97 offen sc1
    s_mov_b64 exec, -1
    s_sub_u32 s70, s70, 1
    s_cbranch_scc1 Lexit_main_kernel
    s_waitcnt vmcnt(0)
    v_cmp_ne_u32 vcc, 4, v9
    s_nop 0
    s_or_b32 s97, vcc_lo, 0x10000
    s_ff1_i32_b32 s97, s97
    s_add_u32 s96, s96, s97
    s_cmp_eq_u32 s97, 16
    s_cselect_b32 s97, 1, 0
    s_cmp_ge_u32 s96, 64
    s_cselect_b32 s96, 0x100, s96
    s_cbranch_scc1 Lgo_main_kernel_346
    s_cmp_eq_u32 s97, 1
    s_cbranch_scc1 Lgl_main_kernel_347
    s_cmp_lt_u32 s98, s96
    s_cbranch_scc1 Lgo_main_kernel_346
    s_add_u32 s97, s96, 1
    s_cmp_gt_u32 s98, s97
    s_cbranch_scc1 Lgf_main_kernel_348
    s_sleep 1
    s_branch Lgl_main_kernel_347
Lgf_main_kernel_348:
    s_sleep 40
    s_branch Lgl_main_kernel_347
Lgo_main_kernel_346:
    s_add_u32 s98, s98, 4
    buffer_load_dwordx4 v[208:211], v1, s[12:15], s67 offen sc1
    buffer_load_dwordx4 v[212:215], v1, s[12:15], s67 offen offset:1024 sc1
    buffer_load_dwordx4 v[216:219], v1, s[12:15], s68 offen sc1
    buffer_load_dwordx4 v[220:223], v1, s[12:15], s68 offen offset:1024 sc1
    s_add_u32 s67, s67, 8192
    s_add_u32 s68, s68, 8192
    v_exp_f32 v108, v108
    v_exp_f32 v109, v109
    v_exp_f32 v110, v110
    v_exp_f32 v111, v111
    v_mfma_f32_32x32x16_bf16 v[120:135], v[228:231], v[28:31], v[120:135]
    v_cvt_pk_bf16_f32 v136, v104, v105
    v_cvt_pk_bf16_f32 v137, v106, v107
    v_cvt_pk_bf16_f32 v138, v108, v109
    v_cvt_pk_bf16_f32 v139, v110, v111
    v_exp_f32 v112, v112
    v_exp_f32 v113, v113
    v_exp_f32 v114, v114
    v_exp_f32 v115, v115
    v_mfma_f32_32x32x16_bf16 v[144:159], v[232:235], v[136:139], v[144:159]
    v_exp_f32 v116, v116
    v_exp_f32 v117, v117
    v_exp_f32 v118, v118
    v_exp_f32 v119, v119
    v_cvt_pk_bf16_f32 v140, v112, v113
    v_cvt_pk_bf16_f32 v141, v114, v115
    v_cvt_pk_bf16_f32 v142, v116, v117
    v_cvt_pk_bf16_f32 v143, v118, v119
    v_mfma_f32_32x32x16_bf16 v[104:119], v[224:227], v[32:35], 0
    v_exp_f32 v120, v120
    v_exp_f32 v121, v121
    v_exp_f32 v122, v122
    v_exp_f32 v123, v123
    v_mfma_f32_32x32x16_bf16 v[144:159], v[236:239], v[140:143], v[144:159]
    v_exp_f32 v124, v124
    v_exp_f32 v125, v125
    v_exp_f32 v126, v126
    v_exp_f32 v127, v127
    v_mfma_f32_32x32x16_bf16 v[104:119], v[228:231], v[36:39], v[104:119]
    v_cvt_pk_bf16_f32 v136, v120, v121
    v_cvt_pk_bf16_f32 v137, v122, v123
    v_cvt_pk_bf16_f32 v138, v124, v125
    v_cvt_pk_bf16_f32 v139, v126, v127
    v_exp_f32 v128, v128
    v_exp_f32 v129, v129
    v_exp_f32 v130, v130
    v_exp_f32 v131, v131
    v_mfma_f32_32x32x16_bf16 v[160:175], v[232:235], v[136:139], v[160:175]
    v_exp_f32 v132, v132
    v_exp_f32 v133, v133
    v_exp_f32 v134, v134
    v_exp_f32 v135, v135
    v_cvt_pk_bf16_f32 v140, v128, v129
    v_cvt_pk_bf16_f32 v141, v130, v131
    v_cvt_pk_bf16_f32 v142, v132, v133
    v_cvt_pk_bf16_f32 v143, v134, v135
    v_mfma_f32_32x32x16_bf16 v[120:135], v[224:227], v[40:43], 0
    v_exp_f32 v104, v104
    v_exp_f32 v105, v105
    v_exp_f32 v106, v106
    v_exp_f32 v107, v107
    v_mfma_f32_32x32x16_bf16 v[160:175], v[236:239], v[140:143], v[160:175]
    v_exp_f32 v108, v108
    v_exp_f32 v109, v109
    v_exp_f32 v110, v110
    v_exp_f32 v111, v111
    v_mfma_f32_32x32x16_bf16 v[120:135], v[228:231], v[44:47], v[120:135]
    v_cvt_pk_bf16_f32 v136, v104, v105
    v_cvt_pk_bf16_f32 v137, v106, v107
    v_cvt_pk_bf16_f32 v138, v108, v109
    v_cvt_pk_bf16_f32 v139, v110, v111
    v_exp_f32 v112, v112
    v_exp_f32 v113, v113
    v_exp_f32 v114, v114
    v_exp_f32 v115, v115
    v_mfma_f32_32x32x16_bf16 v[176:191], v[232:235], v[136:139], v[176:191]
    v_exp_f32 v116, v116
    v_exp_f32 v117, v117
    v_exp_f32 v118, v118
    v_exp_f32 v119, v119
    v_cvt_pk_bf16_f32 v140, v112, v113
    v_cvt_pk_bf16_f32 v141, v114, v115
    v_cvt_pk_bf16_f32 v142, v116, v117
    v_cvt_pk_bf16_f32 v143, v118, v119
    s_waitcnt vmcnt(4)
    v_mfma_f32_32x32x16_bf16 v[104:119], v[240:243], v[16:19], 0
    v_exp_f32 v120, v120
    v_exp_f32 v121, v121
    v_exp_f32 v122, v122
    v_exp_f32 v123, v123
    v_mfma_f32_32x32x16_bf16 v[176:191], v[236:239], v[140:143], v[176:191]
    v_exp_f32 v124, v124
    v_exp_f32 v125, v125
    v_exp_f32 v126, v126
    v_exp_f32 v127, v127
    v_mfma_f32_32x32x16_bf16 v[104:119], v[244:247], v[20:23], v[104:119]
    v_cvt_pk_bf16_f32 v136, v120, v121
    v_cvt_pk_bf16_f32 v137, v122, v123
    v_cvt_pk_bf16_f32 v138, v124, v125
    v_cvt_pk_bf16_f32 v139, v126, v127
    v_exp_f32 v128, v128
    v_exp_f32 v129, v129
    v_exp_f32 v130, v130
    v_exp_f32 v131, v131
    v_mfma_f32_32x32x16_bf16 v[192:207], v[232:235], v[136:139], v[192:207]
    v_exp_f32 v132, v132
    v_exp_f32 v133, v133
    v_exp_f32 v134, v134
    v_exp_f32 v135, v135
    v_cvt_pk_bf16_f32 v140, v128, v129
    v_cvt_pk_bf16_f32 v141, v130, v131
    v_cvt_pk_bf16_f32 v142, v132, v133
    v_cvt_pk_bf16_f32 v143, v134, v135
    v_mfma_f32_32x32x16_bf16 v[120:135], v[240:243], v[24:27], 0
    v_exp_f32 v104, v104
    v_exp_f32 v105, v105
    v_exp_f32 v106, v106
    v_exp_f32 v107, v107
    v_mfma_f32_32x32x16_bf16 v[192:207], v[236:239], v[140:143], v[192:207]
    s_cmp_lt_u32 s98, s96
    s_cbranch_scc1 Lgo_main_kernel_349
    s_mov_b32 s70, 2097152
    v_lshlrev_b32 v8, 3, v1
    v_and_b32 v8, 0x780, v8
Lgl_main_kernel_350:
    s_min_u32 s96, s96, 48
    s_lshl_b32 s97, s96, 7
    s_add_u32 s97, s97, 97714176
    s_mov_b64 exec, 0xffff
    buffer_load_dword v9, v8, s[12:15], s97 offen sc1
    s_mov_b64 exec, -1
    s_sub_u32 s70, s70, 1
    s_cbranch_scc1 Lexit_main_kernel
    s_waitcnt vmcnt(0)
    v_cmp_ne_u32 vcc, 4, v9
    s_nop 0
    s_or_b32 s97, vcc_lo, 0x10000
    s_ff1_i32_b32 s97, s97
    s_add_u32 s96, s96, s97
    s_cmp_eq_u32 s97, 16
    s_cselect_b32 s97, 1, 0
    s_cmp_ge_u32 s96, 64
    s_cselect_b32 s96, 0x100, s96
    s_cbranch_scc1 Lgo_main_kernel_349
    s_cmp_eq_u32 s97, 1
    s_cbranch_scc1 Lgl_main_kernel_350
    s_cmp_lt_u32 s98, s96
    s_cbranch_scc1 Lgo_main_kernel_349
    s_add_u32 s97, s96, 1
    s_cmp_gt_u32 s98, s97
    s_cbranch_scc1 Lgf_main_kernel_351
    s_sleep 1
    s_branch Lgl_main_kernel_350
Lgf_main_kernel_351:
    s_sleep 40
    s_branch Lgl_main_kernel_350
Lgo_main_kernel_349:
    s_add_u32 s98, s98, 4
    buffer_load_dwordx4 v[224:227], v1, s[12:15], s67 offen sc1
    buffer_load_dwordx4 v[228:231], v1, s[12:15], s67 offen offset:1024 sc1
    buffer_load_dwordx4 v[232:235], v1, s[12:15], s68 offen sc1
    buffer_load_dwordx4 v[236:239], v1, s[12:15], s68 offen offset:1024 sc1
    s_add_u32 s67, s67, 8192
    s_add_u32 s68, s68, 8192
    v_exp_f32 v108, v108
    v_exp_f32 v109, v109
    v_exp_f32 v110, v110
    v_exp_f32 v111, v111
    v_mfma_f32_32x32x16_bf16 v[120:135], v[244:247], v[28:31], v[120:135]
    v_cvt_pk_bf16_f32 v136, v104, v105
    v_cvt_pk_bf16_f32 v137, v106, v107
    v_cvt_pk_bf16_f32 v138, v108, v109
    v_cvt_pk_bf16_f32 v139, v110, v111
    v_exp_f32 v112, v112
    v_exp_f32 v113, v113
    v_exp_f32 v114, v114
    v_exp_f32 v115, v115
    v_mfma_f32_32x32x16_bf16 v[144:159], v[248:251], v[136:139], v[144:159]
    v_exp_f32 v116, v116
    v_exp_f32 v117, v117
    v_exp_f32 v118, v118
    v_exp_f32 v119, v119
    v_cvt_pk_bf16_f32 v140, v112, v113
    v_cvt_pk_bf16_f32 v141, v114, v115
    v_cvt_pk_bf16_f32 v142, v116, v117
    v_cvt_pk_bf16_f32 v143, v118, v119
    v_mfma_f32_32x32x16_bf16 v[104:119], v[240:243], v[32:35], 0
    v_exp_f32 v120, v120
    v_exp_f32 v121, v121
    v_exp_f32 v122, v122
    v_exp_f32 v123, v123
    v_mfma_f32_32x32x16_bf16 v[144:159], v[252:255], v[140:143], v[144:159]
    v_exp_f32 v124, v124
    v_exp_f32 v125, v125
    v_exp_f32 v126, v126
    v_exp_f32 v127, v127
    v_mfma_f32_32x32x16_bf16 v[104:119], v[244:247], v[36:39], v[104:119]
    v_cvt_pk_bf16_f32 v136, v120, v121
    v_cvt_pk_bf16_f32 v137, v122, v123
    v_cvt_pk_bf16_f32 v138, v124, v125
    v_cvt_pk_bf16_f32 v139, v126, v127
    v_exp_f32 v128, v128
    v_exp_f32 v129, v129
    v_exp_f32 v130, v130
    v_exp_f32 v131, v131
    v_mfma_f32_32x32x16_bf16 v[160:175], v[248:251], v[136:139], v[160:175]
    v_exp_f32 v132, v132
    v_exp_f32 v133, v133
    v_exp_f32 v134, v134
    v_exp_f32 v135, v135
    v_cvt_pk_bf16_f32 v140, v128, v129
    v_cvt_pk_bf16_f32 v141, v130, v131
    v_cvt_pk_bf16_f32 v142, v132, v133
    v_cvt_pk_bf16_f32 v143, v134, v135
    v_mfma_f32_32x32x16_bf16 v[120:135], v[240:243], v[40:43], 0
    v_exp_f32 v104, v104
    v_exp_f32 v105, v105
    v_exp_f32 v106, v106
    v_exp_f32 v107, v107
    v_mfma_f32_32x32x16_bf16 v[160:175], v[252:255], v[140:143], v[160:175]
    v_exp_f32 v108, v108
    v_exp_f32 v109, v109
    v_exp_f32 v110, v110
    v_exp_f32 v111, v111
    v_mfma_f32_32x32x16_bf16 v[120:135], v[244:247], v[44:47], v[120:135]
    v_cvt_pk_bf16_f32 v136, v104, v105
    v_cvt_pk_bf16_f32 v137, v106, v107
    v_cvt_pk_bf16_f32 v138, v108, v109
    v_cvt_pk_bf16_f32 v139, v110, v111
    v_exp_f32 v112, v112
    v_exp_f32 v113, v113
    v_exp_f32 v114, v114
    v_exp_f32 v115, v115
    v_mfma_f32_32x32x16_bf16 v[176:191], v[248:251], v[136:139], v[176:191]
    v_exp_f32 v116, v116
    v_exp_f32 v117, v117
    v_exp_f32 v118, v118
    v_exp_f32 v119, v119
    v_cvt_pk_bf16_f32 v140, v112, v113
    v_cvt_pk_bf16_f32 v141, v114, v115
    v_cvt_pk_bf16_f32 v142, v116, v117
    v_cvt_pk_bf16_f32 v143, v118, v119
    s_waitcnt vmcnt(4)
    v_mfma_f32_32x32x16_bf16 v[104:119], v[208:211], v[16:19], 0
    v_exp_f32 v120, v120
    v_exp_f32 v121, v121
    v_exp_f32 v122, v122
    v_exp_f32 v123, v123
    v_mfma_f32_32x32x16_bf16 v[176:191], v[252:255], v[140:143], v[176:191]
    v_exp_f32 v124, v124
    v_exp_f32 v125, v125
    v_exp_f32 v126, v126
    v_exp_f32 v127, v127
    v_mfma_f32_32x32x16_bf16 v[104:119], v[212:215], v[20:23], v[104:119]
    v_cvt_pk_bf16_f32 v136, v120, v121
    v_cvt_pk_bf16_f32 v137, v122, v123
    v_cvt_pk_bf16_f32 v138, v124, v125
    v_cvt_pk_bf16_f32 v139, v126, v127
    v_exp_f32 v128, v128
    v_exp_f32 v129, v129
    v_exp_f32 v130, v130
    v_exp_f32 v131, v131
    v_mfma_f32_32x32x16_bf16 v[192:207], v[248:251], v[136:139], v[192:207]
    v_exp_f32 v132, v132
    v_exp_f32 v133, v133
    v_exp_f32 v134, v134
    v_exp_f32 v135, v135
    v_cvt_pk_bf16_f32 v140, v128, v129
    v_cvt_pk_bf16_f32 v141, v130, v131
    v_cvt_pk_bf16_f32 v142, v132, v133
    v_cvt_pk_bf16_f32 v143, v134, v135
    v_mfma_f32_32x32x16_bf16 v[120:135], v[208:211], v[24:27], 0
    v_exp_f32 v104, v104
    v_exp_f32 v105, v105
    v_exp_f32 v106, v106
    v_exp_f32 v107, v107
    v_mfma_f32_32x32x16_bf16 v[192:207], v[252:255], v[140:143], v[192:207]
    s_cmp_lt_u32 s98, s96
    s_cbranch_scc1 Lgo_main_kernel_352
    s_mov_b32 s70, 2097152
    v_lshlrev_b32 v8, 3, v1
    v_and_b32 v8, 0x780, v8
Lgl_main_kernel_353:
    s_min_u32 s96, s96, 48
    s_lshl_b32 s97, s96, 7
    s_add_u32 s97, s97, 97714176
    s_mov_b64 exec, 0xffff
    buffer_load_dword v9, v8, s[12:15], s97 offen sc1
    s_mov_b64 exec, -1
    s_sub_u32 s70, s70, 1
    s_cbranch_scc1 Lexit_main_kernel
    s_waitcnt vmcnt(0)
    v_cmp_ne_u32 vcc, 4, v9
    s_nop 0
    s_or_b32 s97, vcc_lo, 0x10000
    s_ff1_i32_b32 s97, s97
    s_add_u32 s96, s96, s97
    s_cmp_eq_u32 s97, 16
    s_cselect_b32 s97, 1, 0
    s_cmp_ge_u32 s96, 64
    s_cselect_b32 s96, 0x100, s96
    s_cbranch_scc1 Lgo_main_kernel_352
    s_cmp_eq_u32 s97, 1
    s_cbranch_scc1 Lgl_main_kernel_353
    s_cmp_lt_u32 s98, s96
    s_cbranch_scc1 Lgo_main_kernel_352
    s_add_u32 s97, s96, 1
    s_cmp_gt_u32 s98, s97
    s_cbranch_scc1 Lgf_main_kernel_354
    s_sleep 1
    s_branch Lgl_main_kernel_353
Lgf_main_kernel_354:
    s_sleep 40
    s_branch Lgl_main_kernel_353
Lgo_main_kernel_352:
    s_add_u32 s98, s98, 4
    buffer_load_dwordx4 v[240:243], v1, s[12:15], s67 offen sc1
    buffer_load_dwordx4 v[244:247], v1, s[12:15], s67 offen offset:1024 sc1
    buffer_load_dwordx4 v[248:251], v1, s[12:15], s68 offen sc1
    buffer_load_dwordx4 v[252:255], v1, s[12:15], s68 offen offset:1024 sc1
    s_add_u32 s67, s67, 8192
    s_add_u32 s68, s68, 8192
    v_exp_f32 v108, v108
    v_exp_f32 v109, v109
    v_exp_f32 v110, v110
    v_exp_f32 v111, v111
    v_mfma_f32_32x32x16_bf16 v[120:135], v[212:215], v[28:31], v[120:135]
    v_cvt_pk_bf16_f32 v136, v104, v105
    v_cvt_pk_bf16_f32 v137, v106, v107
    v_cvt_pk_bf16_f32 v138, v108, v109
    v_cvt_pk_bf16_f32 v139, v110, v111
    v_exp_f32 v112, v112
    v_exp_f32 v113, v113
    v_exp_f32 v114, v114
    v_exp_f32 v115, v115
    v_mfma_f32_32x32x16_bf16 v[144:159], v[216:219], v[136:139], v[144:159]
    v_exp_f32 v116, v116
    v_exp_f32 v117, v117
    v_exp_f32 v118, v118
    v_exp_f32 v119, v119
    v_cvt_pk_bf16_f32 v140, v112, v113
    v_cvt_pk_bf16_f32 v141, v114, v115
    v_cvt_pk_bf16_f32 v142, v116, v117
    v_cvt_pk_bf16_f32 v143, v118, v119
    v_mfma_f32_32x32x16_bf16 v[104:119], v[208:211], v[32:35], 0
    v_exp_f32 v120, v120
    v_exp_f32 v121, v121
    v_exp_f32 v122, v122
    v_exp_f32 v123, v123
    v_mfma_f32_32x32x16_bf16 v[144:159], v[220:223], v[140:143], v[144:159]
    v_exp_f32 v124, v124
    v_exp_f32 v125, v125
    v_exp_f32 v126, v126
    v_exp_f32 v127, v127
    v_mfma_f32_32x32x16_bf16 v[104:119], v[212:215], v[36:39], v[104:119]
    v_cvt_pk_bf16_f32 v136, v120, v121
    v_cvt_pk_bf16_f32 v137, v122, v123
    v_cvt_pk_bf16_f32 v138, v124, v125
    v_cvt_pk_bf16_f32 v139, v126, v127
    v_exp_f32 v128, v128
    v_exp_f32 v129, v129
    v_exp_f32 v130, v130
    v_exp_f32 v131, v131
    v_mfma_f32_32x32x16_bf16 v[160:175], v[216:219], v[136:139], v[160:175]
    v_exp_f32 v132, v132
    v_exp_f32 v133, v133
    v_exp_f32 v134, v134
    v_exp_f32 v135, v135
    v_cvt_pk_bf16_f32 v140, v128, v129
    v_cvt_pk_bf16_f32 v141, v130, v131
    v_cvt_pk_bf16_f32 v142, v132, v133
    v_cvt_pk_bf16_f32 v143, v134, v135
    v_mfma_f32_32x32x16_bf16 v[120:135], v[208:211], v[40:43], 0
    v_exp_f32 v104, v104
    v_exp_f32 v105, v105
    v_exp_f32 v106, v106
    v_exp_f32 v107, v107
    v_mfma_f32_32x32x16_bf16 v[160:175], v[220:223], v[140:143], v[160:175]
    v_exp_f32 v108, v108
    v_exp_f32 v109, v109
    v_exp_f32 v110, v110
    v_exp_f32 v111, v111
    v_mfma_f32_32x32x16_bf16 v[120:135], v[212:215], v[44:47], v[120:135]
    v_cvt_pk_bf16_f32 v136, v104, v105
    v_cvt_pk_bf16_f32 v137, v106, v107
    v_cvt_pk_bf16_f32 v138, v108, v109
    v_cvt_pk_bf16_f32 v139, v110, v111
    v_exp_f32 v112, v112
    v_exp_f32 v113, v113
    v_exp_f32 v114, v114
    v_exp_f32 v115, v115
    v_mfma_f32_32x32x16_bf16 v[176:191], v[216:219], v[136:139], v[176:191]
    v_exp_f32 v116, v116
    v_exp_f32 v117, v117
    v_exp_f32 v118, v118
    v_exp_f32 v119, v119
    v_cvt_pk_bf16_f32 v140, v112, v113
    v_cvt_pk_bf16_f32 v141, v114, v115
    v_cvt_pk_bf16_f32 v142, v116, v117
    v_cvt_pk_bf16_f32 v143, v118, v119
    s_waitcnt vmcnt(4)
    v_mfma_f32_32x32x16_bf16 v[104:119], v[224:227], v[16:19], 0
    v_exp_f32 v120, v120
    v_exp_f32 v121, v121
    v_exp_f32 v122, v122
    v_exp_f32 v123, v123
    v_mfma_f32_32x32x16_bf16 v[176:191], v[220:223], v[140:143], v[176:191]
    v_exp_f32 v124, v124
    v_exp_f32 v125, v125
    v_exp_f32 v126, v126
    v_exp_f32 v127, v127
    v_mfma_f32_32x32x16_bf16 v[104:119], v[228:231], v[20:23], v[104:119]
    v_cvt_pk_bf16_f32 v136, v120, v121
    v_cvt_pk_bf16_f32 v137, v122, v123
    v_cvt_pk_bf16_f32 v138, v124, v125
    v_cvt_pk_bf16_f32 v139, v126, v127
    v_exp_f32 v128, v128
    v_exp_f32 v129, v129
    v_exp_f32 v130, v130
    v_exp_f32 v131, v131
    v_mfma_f32_32x32x16_bf16 v[192:207], v[216:219], v[136:139], v[192:207]
    v_exp_f32 v132, v132
    v_exp_f32 v133, v133
    v_exp_f32 v134, v134
    v_exp_f32 v135, v135
    v_cvt_pk_bf16_f32 v140, v128, v129
    v_cvt_pk_bf16_f32 v141, v130, v131
    v_cvt_pk_bf16_f32 v142, v132, v133
    v_cvt_pk_bf16_f32 v143, v134, v135
    v_mfma_f32_32x32x16_bf16 v[120:135], v[224:227], v[24:27], 0
    v_exp_f32 v104, v104
    v_exp_f32 v105, v105
    v_exp_f32 v106, v106
    v_exp_f32 v107, v107
    v_mfma_f32_32x32x16_bf16 v[192:207], v[220:223], v[140:143], v[192:207]
    buffer_load_dwordx4 v[208:211], v1, s[12:15], s67 offen sc1
    buffer_load_dwordx4 v[212:215], v1, s[12:15], s67 offen offset:1024 sc1
    buffer_load_dwordx4 v[216:219], v1, s[12:15], s68 offen sc1
    buffer_load_dwordx4 v[220:223], v1, s[12:15], s68 offen offset:1024 sc1
    v_exp_f32 v108, v108
    v_exp_f32 v109, v109
    v_exp_f32 v110, v110
    v_exp_f32 v111, v111
    v_mfma_f32_32x32x16_bf16 v[120:135], v[228:231], v[28:31], v[120:135]
    v_cvt_pk_bf16_f32 v136, v104, v105
    v_cvt_pk_bf16_f32 v137, v106, v107
    v_cvt_pk_bf16_f32 v138, v108, v109
    v_cvt_pk_bf16_f32 v139, v110, v111
    v_exp_f32 v112, v112
    v_exp_f32 v113, v113
    v_exp_f32 v114, v114
    v_exp_f32 v115, v115
    v_mfma_f32_32x32x16_bf16 v[144:159], v[232:235], v[136:139], v[144:159]
    v_exp_f32 v116, v116
    v_exp_f32 v117, v117
    v_exp_f32 v118, v118
    v_exp_f32 v119, v119
    v_cvt_pk_bf16_f32 v140, v112, v113
    v_cvt_pk_bf16_f32 v141, v114, v115
    v_cvt_pk_bf16_f32 v142, v116, v117
    v_cvt_pk_bf16_f32 v143, v118, v119
    v_mfma_f32_32x32x16_bf16 v[104:119], v[224:227], v[32:35], 0
    v_exp_f32 v120, v120
    v_exp_f32 v121, v121
    v_exp_f32 v122, v122
    v_exp_f32 v123, v123
    v_mfma_f32_32x32x16_bf16 v[144:159], v[236:239], v[140:143], v[144:159]
    v_exp_f32 v124, v124
    v_exp_f32 v125, v125
    v_exp_f32 v126, v126
    v_exp_f32 v127, v127
    v_mfma_f32_32x32x16_bf16 v[104:119], v[228:231], v[36:39], v[104:119]
    v_cvt_pk_bf16_f32 v136, v120, v121
    v_cvt_pk_bf16_f32 v137, v122, v123
    v_cvt_pk_bf16_f32 v138, v124, v125
    v_cvt_pk_bf16_f32 v139, v126, v127
    v_exp_f32 v128, v128
    v_exp_f32 v129, v129
    v_exp_f32 v130, v130
    v_exp_f32 v131, v131
    v_mfma_f32_32x32x16_bf16 v[160:175], v[232:235], v[136:139], v[160:175]
    v_exp_f32 v132, v132
    v_exp_f32 v133, v133
    v_exp_f32 v134, v134
    v_exp_f32 v135, v135
    v_cvt_pk_bf16_f32 v140, v128, v129
    v_cvt_pk_bf16_f32 v141, v130, v131
    v_cvt_pk_bf16_f32 v142, v132, v133
    v_cvt_pk_bf16_f32 v143, v134, v135
    v_mfma_f32_32x32x16_bf16 v[120:135], v[224:227], v[40:43], 0
    v_exp_f32 v104, v104
    v_exp_f32 v105, v105
    v_exp_f32 v106, v106
    v_exp_f32 v107, v107
    v_mfma_f32_32x32x16_bf16 v[160:175], v[236:239], v[140:143], v[160:175]
    v_exp_f32 v108, v108
    v_exp_f32 v109, v109
    v_exp_f32 v110, v110
    v_exp_f32 v111, v111
    v_mfma_f32_32x32x16_bf16 v[120:135], v[228:231], v[44:47], v[120:135]
    v_cvt_pk_bf16_f32 v136, v104, v105
    v_cvt_pk_bf16_f32 v137, v106, v107
    v_cvt_pk_bf16_f32 v138, v108, v109
    v_cvt_pk_bf16_f32 v139, v110, v111
    v_exp_f32 v112, v112
    v_exp_f32 v113, v113
    v_exp_f32 v114, v114
    v_exp_f32 v115, v115
    v_mfma_f32_32x32x16_bf16 v[176:191], v[232:235], v[136:139], v[176:191]
    v_exp_f32 v116, v116
    v_exp_f32 v117, v117
    v_exp_f32 v118, v118
    v_exp_f32 v119, v119
    v_cvt_pk_bf16_f32 v140, v112, v113
    v_cvt_pk_bf16_f32 v141, v114, v115
    v_cvt_pk_bf16_f32 v142, v116, v117
    v_cvt_pk_bf16_f32 v143, v118, v119
    s_waitcnt vmcnt(4)
    v_mfma_f32_32x32x16_bf16 v[104:119], v[240:243], v[16:19], 0
    v_exp_f32 v120, v120
    v_exp_f32 v121, v121
    v_exp_f32 v122, v122
    v_exp_f32 v123, v123
    v_mfma_f32_32x32x16_bf16 v[176:191], v[236:239], v[140:143], v[176:191]
    v_exp_f32 v124, v124
    v_exp_f32 v125, v125
    v_exp_f32 v126, v126
    v_exp_f32 v127, v127
    v_mfma_f32_32x32x16_bf16 v[104:119], v[244:247], v[20:23], v[104:119]
    v_cvt_pk_bf16_f32 v136, v120, v121
    v_cvt_pk_bf16_f32 v137, v122, v123
    v_cvt_pk_bf16_f32 v138, v124, v125
    v_cvt_pk_bf16_f32 v139, v126, v127
    v_exp_f32 v128, v128
    v_exp_f32 v129, v129
    v_exp_f32 v130, v130
    v_exp_f32 v131, v131
    v_mfma_f32_32x32x16_bf16 v[192:207], v[232:235], v[136:139], v[192:207]
    v_exp_f32 v132, v132
    v_exp_f32 v133, v133
    v_exp_f32 v134, v134
    v_exp_f32 v135, v135
    v_cvt_pk_bf16_f32 v140, v128, v129
    v_cvt_pk_bf16_f32 v141, v130, v131
    v_cvt_pk_bf16_f32 v142, v132, v133
    v_cvt_pk_bf16_f32 v143, v134, v135
    v_mfma_f32_32x32x16_bf16 v[120:135], v[240:243], v[24:27], 0
    v_exp_f32 v104, v104
    v_exp_f32 v105, v105
    v_exp_f32 v106, v106
    v_exp_f32 v107, v107
    v_mfma_f32_32x32x16_bf16 v[192:207], v[236:239], v[140:143], v[192:207]
    v_exp_f32 v108, v108
    v_exp_f32 v109, v109
    v_exp_f32 v110, v110
    v_exp_f32 v111, v111
    v_mfma_f32_32x32x16_bf16 v[120:135], v[244:247], v[28:31], v[120:135]
    v_cvt_pk_bf16_f32 v136, v104, v105
    v_cvt_pk_bf16_f32 v137, v106, v107
    v_cvt_pk_bf16_f32 v138, v108, v109
    v_cvt_pk_bf16_f32 v139, v110, v111
    v_exp_f32 v112, v112
    v_exp_f32 v113, v113
    v_exp_f32 v114, v114
    v_exp_f32 v115, v115
    v_mfma_f32_32x32x16_bf16 v[144:159], v[248:251], v[136:139], v[144:159]
    v_exp_f32 v116, v116
    v_exp_f32 v117, v117
    v_exp_f32 v118, v118
    v_exp_f32 v119, v119
    v_cvt_pk_bf16_f32 v140, v112, v113
    v_cvt_pk_bf16_f32 v141, v114, v115
    v_cvt_pk_bf16_f32 v142, v116, v117
    v_cvt_pk_bf16_f32 v143, v118, v119
    v_mfma_f32_32x32x16_bf16 v[104:119], v[240:243], v[32:35], 0
    v_exp_f32 v120, v120
    v_exp_f32 v121, v121
    v_exp_f32 v122, v122
    v_exp_f32 v123, v123
    v_mfma_f32_32x32x16_bf16 v[144:159], v[252:255], v[140:143], v[144:159]
    v_exp_f32 v124, v124
    v_exp_f32 v125, v125
    v_exp_f32 v126, v126
    v_exp_f32 v127, v127
    v_mfma_f32_32x32x16_bf16 v[104:119], v[244:247], v[36:39], v[104:119]
    v_cvt_pk_bf16_f32 v136, v120, v121
    v_cvt_pk_bf16_f32 v137, v122, v123
    v_cvt_pk_bf16_f32 v138, v124, v125
    v_cvt_pk_bf16_f32 v139, v126, v127
    v_exp_f32 v128, v128
    v_exp_f32 v129, v129
    v_exp_f32 v130, v130
    v_exp_f32 v131, v131
    v_mfma_f32_32x32x16_bf16 v[160:175], v[248:251], v[136:139], v[160:175]
    v_exp_f32 v132, v132
    v_exp_f32 v133, v133
    v_exp_f32 v134, v134
    v_exp_f32 v135, v135
    v_cvt_pk_bf16_f32 v140, v128, v129
    v_cvt_pk_bf16_f32 v141, v130, v131
    v_cvt_pk_bf16_f32 v142, v132, v133
    v_cvt_pk_bf16_f32 v143, v134, v135
    v_mfma_f32_32x32x16_bf16 v[120:135], v[240:243], v[40:43], 0
    v_exp_f32 v104, v104
    v_exp_f32 v105, v105
    v_exp_f32 v106, v106
    v_exp_f32 v107, v107
    v_mfma_f32_32x32x16_bf16 v[160:175], v[252:255], v[140:143], v[160:175]
    v_exp_f32 v108, v108
    v_exp_f32 v109, v109
    v_exp_f32 v110, v110
    v_exp_f32 v111, v111
    v_mfma_f32_32x32x16_bf16 v[120:135], v[244:247], v[44:47], v[120:135]
    v_cvt_pk_bf16_f32 v136, v104, v105
    v_cvt_pk_bf16_f32 v137, v106, v107
    v_cvt_pk_bf16_f32 v138, v108, v109
    v_cvt_pk_bf16_f32 v139, v110, v111
    v_exp_f32 v112, v112
    v_exp_f32 v113, v113
    v_exp_f32 v114, v114
    v_exp_f32 v115, v115
    v_mfma_f32_32x32x16_bf16 v[176:191], v[248:251], v[136:139], v[176:191]
    v_exp_f32 v116, v116
    v_exp_f32 v117, v117
    v_exp_f32 v118, v118
    v_exp_f32 v119, v119
    v_cvt_pk_bf16_f32 v140, v112, v113
    v_cvt_pk_bf16_f32 v141, v114, v115
    v_cvt_pk_bf16_f32 v142, v116, v117
    v_cvt_pk_bf16_f32 v143, v118, v119
    s_mov_b32 s70, 2097152
    s_branch Lkc_main_kernel_356
Lkd_main_kernel_355:
    buffer_load_dwordx4 v[208:211], v1, s[12:15], s67 offen offset:0 sc1
    buffer_load_dwordx4 v[212:215], v1, s[12:15], s67 offen offset:1024 sc1
    buffer_load_dwordx4 v[216:219], v1, s[12:15], s68 offen offset:0 sc1
    buffer_load_dwordx4 v[220:223], v1, s[12:15], s68 offen offset:1024 sc1
    s_sub_u32 s70, s70, 1
    s_cbranch_scc1 Lexit_main_kernel
Lkc_main_kernel_356:
    s_waitcnt vmcnt(0)
    v_max3_u32 v8, v208, v209, v210
    v_max3_u32 v8, v8, v211, v212
    v_max3_u32 v8, v8, v213, v214
    v_max3_u32 v8, v8, v215, v216
    v_max3_u32 v8, v8, v217, v218
    v_max3_u32 v8, v8, v219, v220
    v_max3_u32 v8, v8, v221, v222
    v_max_u32 v8, v8, v223
    v_cmp_eq_u32 vcc, -1, v8
    s_cbranch_vccnz Lkd_main_kernel_355
    v_mfma_f32_32x32x16_bf16 v[104:119], v[208:211], v[16:19], 0
    v_exp_f32 v120, v120
    v_exp_f32 v121, v121
    v_exp_f32 v122, v122
    v_exp_f32 v123, v123
    v_mfma_f32_32x32x16_bf16 v[176:191], v[252:255], v[140:143], v[176:191]
    v_exp_f32 v124, v124
    v_exp_f32 v125, v125
    v_exp_f32 v126, v126
    v_exp_f32 v127, v127
    v_mfma_f32_32x32x16_bf16 v[104:119], v[212:215], v[20:23], v[104:119]
    v_cvt_pk_bf16_f32 v136, v120, v121
    v_cvt_pk_bf16_f32 v137, v122, v123
    v_cvt_pk_bf16_f32 v138, v124, v125
    v_cvt_pk_bf16_f32 v139, v126, v127
    v_exp_f32 v128, v128
    v_exp_f32 v129, v129
    v_exp_f32 v130, v130
    v_exp_f32 v131, v131
    v_mfma_f32_32x32x16_bf16 v[192:207], v[248:251], v[136:139], v[192:207]
    v_exp_f32 v132, v132
    v_exp_f32 v133, v133
    v_exp_f32 v134, v134
    v_exp_f32 v135, v135
    v_cvt_pk_bf16_f32 v140, v128, v129
    v_cvt_pk_bf16_f32 v141, v130, v131
    v_cvt_pk_bf16_f32 v142, v132, v133
    v_cvt_pk_bf16_f32 v143, v134, v135
    v_mfma_f32_32x32x16_bf16 v[120:135], v[208:211], v[24:27], 0
    v_exp_f32 v104, v104
    v_exp_f32 v105, v105
    v_exp_f32 v106, v106
    v_exp_f32 v107, v107
    v_mfma_f32_32x32x16_bf16 v[192:207], v[252:255], v[140:143], v[192:207]
    v_exp_f32 v108, v108
    v_exp_f32 v109, v109
    v_exp_f32 v110, v110
    v_exp_f32 v111, v111
    v_mfma_f32_32x32x16_bf16 v[120:135], v[212:215], v[28:31], v[120:135]
    v_cvt_pk_bf16_f32 v136, v104, v105
    v_cvt_pk_bf16_f32 v137, v106, v107
    v_cvt_pk_bf16_f32 v138, v108, v109
    v_cvt_pk_bf16_f32 v139, v110, v111
    v_exp_f32 v112, v112
    v_exp_f32 v113, v113
    v_exp_f32 v114, v114
    v_exp_f32 v115, v115
    v_mfma_f32_32x32x16_bf16 v[144:159], v[216:219], v[136:139], v[144:159]
    v_exp_f32 v116, v116
    v_exp_f32 v117, v117
    v_exp_f32 v118, v118
    v_exp_f32 v119, v119
    v_cvt_pk_bf16_f32 v140, v112, v113
    v_cvt_pk_bf16_f32 v141, v114, v115
    v_cvt_pk_bf16_f32 v142, v116, v117
    v_cvt_pk_bf16_f32 v143, v118, v119
    v_mfma_f32_32x32x16_bf16 v[104:119], v[208:211], v[32:35], 0
    v_exp_f32 v120, v120
    v_exp_f32 v121, v121
    v_exp_f32 v122, v122
    v_exp_f32 v123, v123
    v_mfma_f32_32x32x16_bf16 v[144:159], v[220:223], v[140:143], v[144:159]
    v_exp_f32 v124, v124
    v_exp_f32 v125, v125
    v_exp_f32 v126, v126
    v_exp_f32 v127, v127
    v_mfma_f32_32x32x16_bf16 v[104:119], v[212:215], v[36:39], v[104:119]
    v_cvt_pk_bf16_f32 v136, v120, v121
    v_cvt_pk_bf16_f32 v137, v122, v123
    v_cvt_pk_bf16_f32 v138, v124, v125
    v_cvt_pk_bf16_f32 v139, v126, v127
    v_exp_f32 v128, v128
    v_exp_f32 v129, v129
    v_exp_f32 v130, v130
    v_exp_f32 v131, v131
    v_mfma_f32_32x32x16_bf16 v[160:175], v[216:219], v[136:139], v[160:175]
    v_exp_f32 v132, v132
    v_exp_f32 v133, v133
    v_exp_f32 v134, v134
    v_exp_f32 v135, v135
    v_cvt_pk_bf16_f32 v140, v128, v129
    v_cvt_pk_bf16_f32 v141, v130, v131
    v_cvt_pk_bf16_f32 v142, v132, v133
    v_cvt_pk_bf16_f32 v143, v134, v135
    v_mfma_f32_32x32x16_bf16 v[120:135], v[208:211], v[40:43], 0
    v_exp_f32 v104, v104
    v_exp_f32 v105, v105
    v_exp_f32 v106, v106
    v_exp_f32 v107, v107
    v_mfma_f32_32x32x16_bf16 v[160:175], v[220:223], v[140:143], v[160:175]
    v_exp_f32 v108, v108
    v_exp_f32 v109, v109
    v_exp_f32 v110, v110
    v_exp_f32 v111, v111
    v_mfma_f32_32x32x16_bf16 v[120:135], v[212:215], v[44:47], v[120:135]
    v_cvt_pk_bf16_f32 v136, v104, v105
    v_cvt_pk_bf16_f32 v137, v106, v107
    v_cvt_pk_bf16_f32 v138, v108, v109
    v_cvt_pk_bf16_f32 v139, v110, v111
    v_exp_f32 v112, v112
    v_exp_f32 v113, v113
    v_exp_f32 v114, v114
    v_exp_f32 v115, v115
    v_mfma_f32_32x32x16_bf16 v[176:191], v[216:219], v[136:139], v[176:191]
    v_exp_f32 v116, v116
    v_exp_f32 v117, v117
    v_exp_f32 v118, v118
    v_exp_f32 v119, v119
    v_cvt_pk_bf16_f32 v140, v112, v113
    v_cvt_pk_bf16_f32 v141, v114, v115
    v_cvt_pk_bf16_f32 v142, v116, v117
    v_cvt_pk_bf16_f32 v143, v118, v119
    v_exp_f32 v120, v120
    v_exp_f32 v121, v121
    v_exp_f32 v122, v122
    v_exp_f32 v123, v123
    v_mfma_f32_32x32x16_bf16 v[176:191], v[220:223], v[140:143], v[176:191]
    v_exp_f32 v124, v124
    v_exp_f32 v125, v125
    v_exp_f32 v126, v126
    v_exp_f32 v127, v127
    v_cvt_pk_bf16_f32 v136, v120, v121
    v_cvt_pk_bf16_f32 v137, v122, v123
    v_cvt_pk_bf16_f32 v138, v124, v125
    v_cvt_pk_bf16_f32 v139, v126, v127
    v_exp_f32 v128, v128
    v_exp_f32 v129, v129
    v_exp_f32 v130, v130
    v_exp_f32 v131, v131
    v_mfma_f32_32x32x16_bf16 v[192:207], v[216:219], v[136:139], v[192:207]
    v_exp_f32 v132, v132
    v_exp_f32 v133, v133
    v_exp_f32 v134, v134
    v_exp_f32 v135, v135
    v_cvt_pk_bf16_f32 v140, v128, v129
    v_cvt_pk_bf16_f32 v141, v130, v131
    v_cvt_pk_bf16_f32 v142, v132, v133
    v_cvt_pk_bf16_f32 v143, v134, v135
    s_nop 1
    v_mfma_f32_32x32x16_bf16 v[192:207], v[220:223], v[140:143], v[192:207]
LBr_main_kernel_357:
    s_mul_i32 s46, s3, 16384
    s_add_u32 s46, s46, 36864
    v_add_u32 v7, s46, v1
    ds_write_b128 v7, v[144:147] offset:0
    ds_write_b128 v7, v[148:151] offset:1024
    ds_write_b128 v7, v[152:155] offset:2048
    ds_write_b128 v7, v[156:159] offset:3072
    ds_write_b128 v7, v[160:163] offset:4096
    ds_write_b128 v7, v[164:167] offset:5120
    ds_write_b128 v7, v[168:171] offset:6144
    ds_write_b128 v7, v[172:175] offset:7168
    ds_write_b128 v7, v[176:179] offset:8192
    ds_write_b128 v7, v[180:183] offset:9216
    ds_write_b128 v7, v[184:187] offset:10240
    ds_write_b128 v7, v[188:191] offset:11264
    ds_write_b128 v7, v[192:195] offset:12288
    ds_write_b128 v7, v[196:199] offset:13312
    ds_write_b128 v7, v[200:203] offset:14336
    ds_write_b128 v7, v[204:207] offset:15360
    s_waitcnt lgkmcnt(0)
    s_barrier
    v_lshrrev_b32 v8, 5, v0
    v_bfe_u32 v5, v0, 4, 1
    v_mul_u32_u24 v5, 912, v5
    v_mul_u32_u24 v10, 56, v2
    v_add_u32 v5, v5, v10
    v_lshl_add_u32 v5, v8, 3, v5
    v_mov_b32 v11, 30976
    v_cmp_eq_u32 s[74:75], 1, v8
    s_mov_b32 s46, s3
    s_lshl_b32 s47, s46, 12
    s_add_u32 s47, s47, 36864
    v_add_u32 v7, s47, v1
    ds_read_b128 v[16:19], v7 offset:0
    ds_read_b128 v[20:23], v7 offset:1024
    ds_read_b128 v[24:27], v7 offset:2048
    ds_read_b128 v[28:31], v7 offset:3072
    v_add_u32 v7, 16384, v7
    ds_read_b128 v[32:35], v7 offset:0
    ds_read_b128 v[36:39], v7 offset:1024
    ds_read_b128 v[40:43], v7 offset:2048
    ds_read_b128 v[44:47], v7 offset:3072
    v_add_u32 v7, 16384, v7
    ds_read_b128 v[48:51], v7 offset:0
    ds_read_b128 v[52:55], v7 offset:1024
    ds_read_b128 v[56:59], v7 offset:2048
    ds_read_b128 v[60:63], v7 offset:3072
    s_waitcnt lgkmcnt(4)
    v_add_u32 v7, 16384, v7
    ds_read_b128 v[64:67], v7 offset:0
    ds_read_b128 v[68:71], v7 offset:1024
    ds_read_b128 v[72:75], v7 offset:2048
    ds_read_b128 v[76:79], v7 offset:3072
    v_pk_add_f32 v[16:17], v[16:17], v[32:33]
    v_pk_add_f32 v[18:19], v[18:19], v[34:35]
    v_pk_add_f32 v[20:21], v[20:21], v[36:37]
    v_pk_add_f32 v[22:23], v[22:23], v[38:39]
    v_pk_add_f32 v[24:25], v[24:25], v[40:41]
    v_pk_add_f32 v[26:27], v[26:27], v[42:43]
    v_pk_add_f32 v[28:29], v[28:29], v[44:45]
    v_pk_add_f32 v[30:31], v[30:31], v[46:47]
    s_waitcnt lgkmcnt(0)
    v_pk_add_f32 v[48:49], v[48:49], v[64:65]
    v_pk_add_f32 v[50:51], v[50:51], v[66:67]
    v_pk_add_f32 v[52:53], v[52:53], v[68:69]
    v_pk_add_f32 v[54:55], v[54:55], v[70:71]
    v_pk_add_f32 v[56:57], v[56:57], v[72:73]
    v_pk_add_f32 v[58:59], v[58:59], v[74:75]
    v_pk_add_f32 v[60:61], v[60:61], v[76:77]
    v_pk_add_f32 v[62:63], v[62:63], v[78:79]
    v_pk_add_f32 v[16:17], v[16:17], v[48:49]
    v_pk_add_f32 v[18:19], v[18:19], v[50:51]
    v_pk_add_f32 v[20:21], v[20:21], v[52:53]
    v_pk_add_f32 v[22:23], v[22:23], v[54:55]
    v_pk_add_f32 v[24:25], v[24:25], v[56:57]
    v_pk_add_f32 v[26:27], v[26:27], v[58:59]
    v_pk_add_f32 v[28:29], v[28:29], v[60:61]
    v_pk_add_f32 v[30:31], v[30:31], v[62:63]
    v_mov_b32 v12, v28
    v_mov_b32 v13, v28
    s_nop 1
    v_permlane32_swap_b32 v12, v13
    s_nop 0
    v_cmp_nle_f32 vcc, 0x21800000, v13
    v_mov_b32 v12, 0x5d800000
    v_cmp_nle_f32 s[76:77], v13, v12
    s_nop 0
    s_or_b64 vcc, vcc, s[76:77]
    s_cbranch_vccz L_main_kernel_361
    v_mov_b32 v12, 36608
    v_mov_b32 v15, 1
    ds_write_b32 v12, v15
L_main_kernel_361:
    v_rcp_f32 v13, v13
    s_mul_i32 s47, s46, 1824
    s_add_u32 s47, s47, 16384
    v_add_u32 v10, s47, v5
    v_mul_f32 v16, v16, v13
    v_mul_f32 v17, v17, v13
    v_mul_f32 v18, v18, v13
    v_mul_f32 v19, v19, v13
    v_cvt_pk_bf16_f32 v16, v16, v17
    v_cvt_pk_bf16_f32 v17, v18, v19
    ds_write_b64 v10, v[16:17] offset:0
    v_mul_f32 v20, v20, v13
    v_mul_f32 v21, v21, v13
    v_mul_f32 v22, v22, v13
    v_mul_f32 v23, v23, v13
    v_cvt_pk_bf16_f32 v20, v20, v21
    v_cvt_pk_bf16_f32 v21, v22, v23
    ds_write_b64 v10, v[20:21] offset:16
    v_mul_f32 v24, v24, v13
    v_mul_f32 v25, v25, v13
    v_mul_f32 v26, v26, v13
    v_mul_f32 v27, v27, v13
    v_cvt_pk_bf16_f32 v24, v24, v25
    v_cvt_pk_bf16_f32 v25, v26, v27
    ds_write_b64 v10, v[24:25] offset:32
    v_mul_f32 v28, v28, v13
    v_mul_f32 v29, v29, v13
    v_mul_f32 v30, v30, v13
    v_mul_f32 v31, v31, v13
    v_cvt_pk_bf16_f32 v28, v28, v29
    v_cvt_pk_bf16_f32 v29, v30, v31
    v_add_u32 v10, 48, v10
    v_cndmask_b32 v10, v10, v11, s[74:75]
    ds_write_b64 v10, v[28:29]
L_main_kernel_360:
    s_waitcnt lgkmcnt(0)
    s_barrier
    v_mov_b32 v12, 36608
    ds_read_b32 v12, v12
    s_waitcnt lgkmcnt(0)
    v_readfirstlane_b32 s46, v12
    s_nop 0
    s_andn2_b32 s46, s46, s78
    s_cmp_eq_u32 s46, 1
    s_cbranch_scc1 LBs_main_kernel_358
    s_mul_i32 s46, s3, 912
    s_add_u32 s46, s46, 16384
    v_add_u32 v7, s46, v1
    ds_read_b128 v[16:19], v7 offset:0
    ds_read_b128 v[20:23], v7 offset:3648
    s_sub_u32 s46, s61, 1792
    s_add_u32 s47, s46, s3
    s_mul_i32 s47, s47, 896
    s_add_u32 s47, s47, 97411072
    v_mov_b32 v8, 0x7fffffff
    v_cmp_gt_u32 vcc, 56, v0
    s_nop 1
    v_cndmask_b32 v8, v8, v1, vcc
    s_waitcnt lgkmcnt(0)
    v_min_u32 v16, -2, v16
    v_min_u32 v17, -2, v17
    v_min_u32 v18, -2, v18
    v_min_u32 v19, -2, v19
    v_min_u32 v20, -2, v20
    v_min_u32 v21, -2, v21
    v_min_u32 v22, -2, v22
    v_min_u32 v23, -2, v23
    buffer_store_dwordx4 v[16:19], v8, s[12:15], s47 offen offset:0 sc1
    buffer_store_dwordx4 v[20:23], v8, s[12:15], s47 offen offset:3584 sc1
    s_branch LBf_main_kernel_359
LBs_main_kernel_358:
    s_waitcnt vmcnt(0) lgkmcnt(0)
    s_barrier
    s_mov_b32 s78, 1
    ds_read_b128 v[16:19], v6 offset:0
    ds_read_b128 v[20:23], v6 offset:32
    ds_read_b128 v[24:27], v6 offset:2048
    ds_read_b128 v[28:31], v6 offset:2080
    ds_read_b128 v[32:35], v6 offset:4096
    ds_read_b128 v[36:39], v6 offset:4128
    ds_read_b128 v[40:43], v6 offset:6144
    ds_read_b128 v[44:47], v6 offset:6176
    v_mov_b32 v120, 0xff61b1e6
    v_mov_b32 v121, 0xff61b1e6
    v_mov_b32 v122, 0xff61b1e6
    v_mov_b32 v123, 0xff61b1e6
    s_mov_b32 s67, s65
    s_mov_b32 s68, s66
    s_mov_b32 s70, 16
LM_main_kernel_362:
    buffer_load_dwordx4 v[208:211], v1, s[12:15], s67 offen sc1
    buffer_load_dwordx4 v[212:215], v1, s[12:15], s67 offen offset:1024 sc1
    buffer_load_dwordx4 v[216:219], v1, s[12:15], s68 offen sc1
    buffer_load_dwordx4 v[220:223], v1, s[12:15], s68 offen offset:1024 sc1
    s_add_u32 s67, s67, 8192
    s_add_u32 s68, s68, 8192
    s_waitcnt vmcnt(0) lgkmcnt(0)
    v_mfma_f32_32x32x16_bf16 v[104:119], v[208:211], v[16:19], 0
    v_mfma_f32_32x32x16_bf16 v[104:119], v[212:215], v[20:23], v[104:119]
    s_nop 11
    v_max3_f32 v120, v120, v104, v105
    v_max3_f32 v120, v120, v106, v107
    v_max3_f32 v120, v120, v108, v109
    v_max3_f32 v120, v120, v110, v111
    v_max3_f32 v120, v120, v112, v113
    v_max3_f32 v120, v120, v114, v115
    v_max3_f32 v120, v120, v116, v117
    v_max3_f32 v120, v120, v118, v119
    v_mfma_f32_32x32x16_bf16 v[104:119], v[208:211], v[24:27], 0
    v_mfma_f32_32x32x16_bf16 v[104:119], v[212:215], v[28:31], v[104:119]
    s_nop 11
    v_max3_f32 v121, v121, v104, v105
    v_max3_f32 v121, v121, v106, v107
    v_max3_f32 v121, v121, v108, v109
    v_max3_f32 v121, v121, v110, v111
    v_max3_f32 v121, v121, v112, v113
    v_max3_f32 v121, v121, v114, v115
    v_max3_f32 v121, v121, v116, v117
    v_max3_f32 v121, v121, v118, v119
    v_mfma_f32_32x32x16_bf16 v[104:119], v[208:211], v[32:35], 0
    v_mfma_f32_32x32x16_bf16 v[104:119], v[212:215], v[36:39], v[104:119]
    s_nop 11
    v_max3_f32 v122, v122, v104, v105
    v_max3_f32 v122, v122, v106, v107
    v_max3_f32 v122, v122, v108, v109
    v_max3_f32 v122, v122, v110, v111
    v_max3_f32 v122, v122, v112, v113
    v_max3_f32 v122, v122, v114, v115
    v_max3_f32 v122, v122, v116, v117
    v_max3_f32 v122, v122, v118, v119
    v_mfma_f32_32x32x16_bf16 v[104:119], v[208:211], v[40:43], 0
    v_mfma_f32_32x32x16_bf16 v[104:119], v[212:215], v[44:47], v[104:119]
    s_nop 11
    v_max3_f32 v123, v123, v104, v105
    v_max3_f32 v123, v123, v106, v107
    v_max3_f32 v123, v123, v108, v109
    v_max3_f32 v123, v123, v110, v111
    v_max3_f32 v123, v123, v112, v113
    v_max3_f32 v123, v123, v114, v115
    v_max3_f32 v123, v123, v116, v117
    v_max3_f32 v123, v123, v118, v119
    s_sub_u32 s70, s70, 1
    s_cmp_lg_u32 s70, 0
    s_cbranch_scc1 LM_main_kernel_362
    v_and_b32 v7, 31, v0
    v_lshlrev_b32 v7, 2, v7
    s_lshl_b32 s46, s3, 10
    v_add_u32 v12, s46, v7
    v_mov_b32 v13, v120
    s_nop 1
    v_permlane32_swap_b32 v120, v13
    s_nop 0
    v_max_f32 v120, v120, v13
    ds_write_b32 v12, v120 offset:32512
    v_mov_b32 v13, v121
    s_nop 1
    v_permlane32_swap_b32 v121, v13
    s_nop 0
    v_max_f32 v121, v121, v13
    ds_write_b32 v12, v121 offset:32640
    v_mov_b32 v13, v122
    s_nop 1
    v_permlane32_swap_b32 v122, v13
    s_nop 0
    v_max_f32 v122, v122, v13
    ds_write_b32 v12, v122 offset:32768
    v_mov_b32 v13, v123
    s_nop 1
    v_permlane32_swap_b32 v123, v13
    s_nop 0
    v_max_f32 v123, v123, v13
    ds_write_b32 v12, v123 offset:32896
    s_waitcnt lgkmcnt(0)
    s_barrier
    ds_read_b32 v104, v7 offset:32512
    ds_read_b32 v105, v7 offset:33536
    ds_read_b32 v106, v7 offset:34560
    ds_read_b32 v107, v7 offset:35584
    s_waitcnt lgkmcnt(0)
    v_max3_f32 v120, v104, v105, v106
    v_max_f32 v120, v120, v107
    ds_read_b32 v104, v7 offset:32640
    ds_read_b32 v105, v7 offset:33664
    ds_read_b32 v106, v7 offset:34688
    ds_read_b32 v107, v7 offset:35712
    s_waitcnt lgkmcnt(0)
    v_max3_f32 v121, v104, v105, v106
    v_max_f32 v121, v121, v107
    ds_read_b32 v104, v7 offset:32768
    ds_read_b32 v105, v7 offset:33792
    ds_read_b32 v106, v7 offset:34816
    ds_read_b32 v107, v7 offset:35840
    s_waitcnt lgkmcnt(0)
    v_max3_f32 v122, v104, v105, v106
    v_max_f32 v122, v122, v107
    ds_read_b32 v104, v7 offset:32896
    ds_read_b32 v105, v7 offset:33920
    ds_read_b32 v106, v7 offset:34944
    ds_read_b32 v107, v7 offset:35968
    s_waitcnt lgkmcnt(0)
    v_max3_f32 v123, v104, v105, v106
    v_max_f32 v123, v123, v107
    v_mov_b64 v[144:145], 0
    v_mov_b64 v[146:147], 0
    v_mov_b64 v[148:149], 0
    v_mov_b64 v[150:151], 0
    v_mov_b64 v[152:153], 0
    v_mov_b64 v[154:155], 0
    v_mov_b64 v[156:157], 0
    v_mov_b64 v[158:159], 0
    v_mov_b64 v[160:161], 0
    v_mov_b64 v[162:163], 0
    v_mov_b64 v[164:165], 0
    v_mov_b64 v[166:167], 0
    v_mov_b64 v[168:169], 0
    v_mov_b64 v[170:171], 0
    v_mov_b64 v[172:173], 0
    v_mov_b64 v[174:175], 0
    v_mov_b64 v[176:177], 0
    v_mov_b64 v[178:179], 0
    v_mov_b64 v[180:181], 0
    v_mov_b64 v[182:183], 0
    v_mov_b64 v[184:185], 0
    v_mov_b64 v[186:187], 0
    v_mov_b64 v[188:189], 0
    v_mov_b64 v[190:191], 0
    v_mov_b64 v[192:193], 0
    v_mov_b64 v[194:195], 0
    v_mov_b64 v[196:197], 0
    v_mov_b64 v[198:199], 0
    v_mov_b64 v[200:201], 0
    v_mov_b64 v[202:203], 0
    v_mov_b64 v[204:205], 0
    v_mov_b64 v[206:207], 0
    s_mov_b32 s67, s65
    s_mov_b32 s68, s66
    s_mov_b32 s70, 16
LK_main_kernel_363:
    buffer_load_dwordx4 v[208:211], v1, s[12:15], s67 offen sc1
    buffer_load_dwordx4 v[212:215], v1, s[12:15], s67 offen offset:1024 sc1
    buffer_load_dwordx4 v[216:219], v1, s[12:15], s68 offen sc1
    buffer_load_dwordx4 v[220:223], v1, s[12:15], s68 offen offset:1024 sc1
    s_add_u32 s67, s67, 8192
    s_add_u32 s68, s68, 8192
    s_waitcnt vmcnt(0)
    v_sub_f32 v104, 0, v120
    v_sub_f32 v105, 0, v120
    v_sub_f32 v106, 0, v120
    v_sub_f32 v107, 0, v120
    v_sub_f32 v108, 0, v120
    v_sub_f32 v109, 0, v120
    v_sub_f32 v110, 0, v120
    v_sub_f32 v111, 0, v120
    v_sub_f32 v112, 0, v120
    v_sub_f32 v113, 0, v120
    v_sub_f32 v114, 0, v120
    v_sub_f32 v115, 0, v120
    v_sub_f32 v116, 0, v120
    v_sub_f32 v117, 0, v120
    v_sub_f32 v118, 0, v120
    v_sub_f32 v119, 0, v120
    s_nop 1
    v_mfma_f32_32x32x16_bf16 v[104:119], v[208:211], v[16:19], v[104:119]
    v_mfma_f32_32x32x16_bf16 v[104:119], v[212:215], v[20:23], v[104:119]
    s_nop 11
    v_exp_f32 v104, v104
    v_exp_f32 v105, v105
    v_exp_f32 v106, v106
    v_exp_f32 v107, v107
    v_exp_f32 v108, v108
    v_exp_f32 v109, v109
    v_exp_f32 v110, v110
    v_exp_f32 v111, v111
    v_cvt_pk_bf16_f32 v136, v104, v105
    v_cvt_pk_bf16_f32 v137, v106, v107
    v_cvt_pk_bf16_f32 v138, v108, v109
    v_cvt_pk_bf16_f32 v139, v110, v111
    s_nop 1
    v_mfma_f32_32x32x16_bf16 v[144:159], v[216:219], v[136:139], v[144:159]
    v_exp_f32 v112, v112
    v_exp_f32 v113, v113
    v_exp_f32 v114, v114
    v_exp_f32 v115, v115
    v_exp_f32 v116, v116
    v_exp_f32 v117, v117
    v_exp_f32 v118, v118
    v_exp_f32 v119, v119
    v_cvt_pk_bf16_f32 v140, v112, v113
    v_cvt_pk_bf16_f32 v141, v114, v115
    v_cvt_pk_bf16_f32 v142, v116, v117
    v_cvt_pk_bf16_f32 v143, v118, v119
    s_nop 1
    v_mfma_f32_32x32x16_bf16 v[144:159], v[220:223], v[140:143], v[144:159]
    v_sub_f32 v104, 0, v121
    v_sub_f32 v105, 0, v121
    v_sub_f32 v106, 0, v121
    v_sub_f32 v107, 0, v121
    v_sub_f32 v108, 0, v121
    v_sub_f32 v109, 0, v121
    v_sub_f32 v110, 0, v121
    v_sub_f32 v111, 0, v121
    v_sub_f32 v112, 0, v121
    v_sub_f32 v113, 0, v121
    v_sub_f32 v114, 0, v121
    v_sub_f32 v115, 0, v121
    v_sub_f32 v116, 0, v121
    v_sub_f32 v117, 0, v121
    v_sub_f32 v118, 0, v121
    v_sub_f32 v119, 0, v121
    s_nop 1
    v_mfma_f32_32x32x16_bf16 v[104:119], v[208:211], v[24:27], v[104:119]
    v_mfma_f32_32x32x16_bf16 v[104:119], v[212:215], v[28:31], v[104:119]
    s_nop 11
    v_exp_f32 v104, v104
    v_exp_f32 v105, v105
    v_exp_f32 v106, v106
    v_exp_f32 v107, v107
    v_exp_f32 v108, v108
    v_exp_f32 v109, v109
    v_exp_f32 v110, v110
    v_exp_f32 v111, v111
    v_cvt_pk_bf16_f32 v136, v104, v105
    v_cvt_pk_bf16_f32 v137, v106, v107
    v_cvt_pk_bf16_f32 v138, v108, v109
    v_cvt_pk_bf16_f32 v139, v110, v111
    s_nop 1
    v_mfma_f32_32x32x16_bf16 v[160:175], v[216:219], v[136:139], v[160:175]
    v_exp_f32 v112, v112
    v_exp_f32 v113, v113
    v_exp_f32 v114, v114
    v_exp_f32 v115, v115
    v_exp_f32 v116, v116
    v_exp_f32 v117, v117
    v_exp_f32 v118, v118
    v_exp_f32 v119, v119
    v_cvt_pk_bf16_f32 v140, v112, v113
    v_cvt_pk_bf16_f32 v141, v114, v115
    v_cvt_pk_bf16_f32 v142, v116, v117
    v_cvt_pk_bf16_f32 v143, v118, v119
    s_nop 1
    v_mfma_f32_32x32x16_bf16 v[160:175], v[220:223], v[140:143], v[160:175]
    v_sub_f32 v104, 0, v122
    v_sub_f32 v105, 0, v122
    v_sub_f32 v106, 0, v122
    v_sub_f32 v107, 0, v122
    v_sub_f32 v108, 0, v122
    v_sub_f32 v109, 0, v122
    v_sub_f32 v110, 0, v122
    v_sub_f32 v111, 0, v122
    v_sub_f32 v112, 0, v122
    v_sub_f32 v113, 0, v122
    v_sub_f32 v114, 0, v122
    v_sub_f32 v115, 0, v122
    v_sub_f32 v116, 0, v122
    v_sub_f32 v117, 0, v122
    v_sub_f32 v118, 0, v122
    v_sub_f32 v119, 0, v122
    s_nop 1
    v_mfma_f32_32x32x16_bf16 v[104:119], v[208:211], v[32:35], v[104:119]
    v_mfma_f32_32x32x16_bf16 v[104:119], v[212:215], v[36:39], v[104:119]
    s_nop 11
    v_exp_f32 v104, v104
    v_exp_f32 v105, v105
    v_exp_f32 v106, v106
    v_exp_f32 v107, v107
    v_exp_f32 v108, v108
    v_exp_f32 v109, v109
    v_exp_f32 v110, v110
    v_exp_f32 v111, v111
    v_cvt_pk_bf16_f32 v136, v104, v105
    v_cvt_pk_bf16_f32 v137, v106, v107
    v_cvt_pk_bf16_f32 v138, v108, v109
    v_cvt_pk_bf16_f32 v139, v110, v111
    s_nop 1
    v_mfma_f32_32x32x16_bf16 v[176:191], v[216:219], v[136:139], v[176:191]
    v_exp_f32 v112, v112
    v_exp_f32 v113, v113
    v_exp_f32 v114, v114
    v_exp_f32 v115, v115
    v_exp_f32 v116, v116
    v_exp_f32 v117, v117
    v_exp_f32 v118, v118
    v_exp_f32 v119, v119
    v_cvt_pk_bf16_f32 v140, v112, v113
    v_cvt_pk_bf16_f32 v141, v114, v115
    v_cvt_pk_bf16_f32 v142, v116, v117
    v_cvt_pk_bf16_f32 v143, v118, v119
    s_nop 1
    v_mfma_f32_32x32x16_bf16 v[176:191], v[220:223], v[140:143], v[176:191]
    v_sub_f32 v104, 0, v123
    v_sub_f32 v105, 0, v123
    v_sub_f32 v106, 0, v123
    v_sub_f32 v107, 0, v123
    v_sub_f32 v108, 0, v123
    v_sub_f32 v109, 0, v123
    v_sub_f32 v110, 0, v123
    v_sub_f32 v111, 0, v123
    v_sub_f32 v112, 0, v123
    v_sub_f32 v113, 0, v123
    v_sub_f32 v114, 0, v123
    v_sub_f32 v115, 0, v123
    v_sub_f32 v116, 0, v123
    v_sub_f32 v117, 0, v123
    v_sub_f32 v118, 0, v123
    v_sub_f32 v119, 0, v123
    s_nop 1
    v_mfma_f32_32x32x16_bf16 v[104:119], v[208:211], v[40:43], v[104:119]
    v_mfma_f32_32x32x16_bf16 v[104:119], v[212:215], v[44:47], v[104:119]
    s_nop 11
    v_exp_f32 v104, v104
    v_exp_f32 v105, v105
    v_exp_f32 v106, v106
    v_exp_f32 v107, v107
    v_exp_f32 v108, v108
    v_exp_f32 v109, v109
    v_exp_f32 v110, v110
    v_exp_f32 v111, v111
    v_cvt_pk_bf16_f32 v136, v104, v105
    v_cvt_pk_bf16_f32 v137, v106, v107
    v_cvt_pk_bf16_f32 v138, v108, v109
    v_cvt_pk_bf16_f32 v139, v110, v111
    s_nop 1
    v_mfma_f32_32x32x16_bf16 v[192:207], v[216:219], v[136:139], v[192:207]
    v_exp_f32 v112, v112
    v_exp_f32 v113, v113
    v_exp_f32 v114, v114
    v_exp_f32 v115, v115
    v_exp_f32 v116, v116
    v_exp_f32 v117, v117
    v_exp_f32 v118, v118
    v_exp_f32 v119, v119
    v_cvt_pk_bf16_f32 v140, v112, v113
    v_cvt_pk_bf16_f32 v141, v114, v115
    v_cvt_pk_bf16_f32 v142, v116, v117
    v_cvt_pk_bf16_f32 v143, v118, v119
    s_nop 1
    v_mfma_f32_32x32x16_bf16 v[192:207], v[220:223], v[140:143], v[192:207]
    s_sub_u32 s70, s70, 1
    s_cmp_lg_u32 s70, 0
    s_cbranch_scc1 LK_main_kernel_363
    s_branch LBr_main_kernel_357
LBf_main_kernel_359:
    s_cmp_eq_u32 s0, 1
    s_cbranch_scc1 L_main_kernel_364
    s_mul_i32 s53, s100, 9363
    s_lshr_b32 s53, s53, 16
    s_mul_i32 s54, s53, 7
    s_sub_u32 s54, s100, s54
    s_and_b32 s55, s53, 15
    s_lshr_b32 s53, s53, 4
    s_cmp_eq_u32 s53, 0
    s_cselect_b32 s57, 0, 6422528
    s_mul_i32 s58, s55, 28
    s_lshl_b32 s59, s54, 2
    s_add_u32 s58, s58, s59
    s_add_u32 s58, s58, s3
    s_mul_i32 s58, s58, 14336
    s_add_u32 s57, s57, s58
    buffer_load_dwordx4 v[128:131], v1, s[4:7], s57 offen offset:0 sc1
    buffer_load_dwordx4 v[132:135], v1, s[4:7], s57 offen offset:1024 sc1
    buffer_load_dwordx4 v[136:139], v1, s[4:7], s57 offen offset:2048 sc1
    buffer_load_dwordx4 v[140:143], v1, s[4:7], s57 offen offset:3072 sc1
    s_add_u32 s57, s57, 4096
    buffer_load_dwordx4 v[144:147], v1, s[4:7], s57 offen offset:0 sc1
    buffer_load_dwordx4 v[148:151], v1, s[4:7], s57 offen offset:1024 sc1
    buffer_load_dwordx4 v[152:155], v1, s[4:7], s57 offen offset:2048 sc1
    buffer_load_dwordx4 v[156:159], v1, s[4:7], s57 offen offset:3072 sc1
    s_add_u32 s57, s57, 4096
    buffer_load_dwordx4 v[160:163], v1, s[4:7], s57 offen offset:0 sc1
    buffer_load_dwordx4 v[164:167], v1, s[4:7], s57 offen offset:1024 sc1
    buffer_load_dwordx4 v[168:171], v1, s[4:7], s57 offen offset:2048 sc1
    buffer_load_dwordx4 v[172:175], v1, s[4:7], s57 offen offset:3072 sc1
    s_add_u32 s57, s57, 4096
    buffer_load_dwordx4 v[176:179], v1, s[4:7], s57 offen offset:0 sc1
    buffer_load_dwordx4 v[180:183], v1, s[4:7], s57 offen offset:1024 sc1
L_main_kernel_364:
    s_cmp_eq_u32 s0, 1
    s_cbranch_scc1 L_main_kernel_365
    s_mul_i32 s58, s3, 14336
    s_add_u32 s58, s58, 32768
    v_add_u32 v2, s58, v1
    s_waitcnt vmcnt(0)
    s_barrier
    ds_write_b128 v2, v[128:131] offset:0
    ds_write_b128 v2, v[132:135] offset:1024
    ds_write_b128 v2, v[136:139] offset:2048
    ds_write_b128 v2, v[140:143] offset:3072
    ds_write_b128 v2, v[144:147] offset:4096
    ds_write_b128 v2, v[148:151] offset:5120
    ds_write_b128 v2, v[152:155] offset:6144
    ds_write_b128 v2, v[156:159] offset:7168
    ds_write_b128 v2, v[160:163] offset:8192
    ds_write_b128 v2, v[164:167] offset:9216
    ds_write_b128 v2, v[168:171] offset:10240
    ds_write_b128 v2, v[172:175] offset:11264
    ds_write_b128 v2, v[176:179] offset:12288
    ds_write_b128 v2, v[180:183] offset:13312
    s_nop 0
    v_add_u32 v2, 32768, v1
    s_waitcnt lgkmcnt(0)
    s_barrier
    ds_read_b128 a[0:3], v2 offset:0
    ds_read_b128 a[4:7], v2 offset:1024
    ds_read_b128 a[8:11], v2 offset:2048
    ds_read_b128 a[12:15], v2 offset:3072
    ds_read_b128 a[16:19], v2 offset:4096
    ds_read_b128 a[20:23], v2 offset:5120
    ds_read_b128 a[24:27], v2 offset:6144
    ds_read_b128 a[28:31], v2 offset:7168
    ds_read_b128 a[32:35], v2 offset:8192
    ds_read_b128 a[36:39], v2 offset:9216
    ds_read_b128 a[40:43], v2 offset:10240
    ds_read_b128 a[44:47], v2 offset:11264
    s_waitcnt lgkmcnt(4)
    ds_read_b128 a[48:51], v2 offset:12288
    ds_read_b128 a[52:55], v2 offset:13312
    ds_read_b128 a[56:59], v2 offset:14336
    ds_read_b128 a[60:63], v2 offset:15360
    ds_read_b128 a[64:67], v2 offset:16384
    ds_read_b128 a[68:71], v2 offset:17408
    ds_read_b128 a[72:75], v2 offset:18432
    ds_read_b128 a[76:79], v2 offset:19456
    ds_read_b128 a[80:83], v2 offset:20480
    ds_read_b128 a[84:87], v2 offset:21504
    ds_read_b128 a[88:91], v2 offset:22528
    ds_read_b128 a[92:95], v2 offset:23552
    s_waitcnt lgkmcnt(4)
    ds_read_b128 a[96:99], v2 offset:24576
    ds_read_b128 a[100:103], v2 offset:25600
    ds_read_b128 a[104:107], v2 offset:26624
    ds_read_b128 a[108:111], v2 offset:27648
    ds_read_b128 a[112:115], v2 offset:28672
    ds_read_b128 a[116:119], v2 offset:29696
    ds_read_b128 a[120:123], v2 offset:30720
    ds_read_b128 a[124:127], v2 offset:31744
    ds_read_b128 a[128:131], v2 offset:32768
    ds_read_b128 a[132:135], v2 offset:33792
    ds_read_b128 a[136:139], v2 offset:34816
    ds_read_b128 a[140:143], v2 offset:35840
    s_waitcnt lgkmcnt(4)
    ds_read_b128 a[144:147], v2 offset:36864
    ds_read_b128 a[148:151], v2 offset:37888
    ds_read_b128 a[152:155], v2 offset:38912
    ds_read_b128 a[156:159], v2 offset:39936
    ds_read_b128 a[160:163], v2 offset:40960
    ds_read_b128 a[164:167], v2 offset:41984
    ds_read_b128 a[168:171], v2 offset:43008
    ds_read_b128 a[172:175], v2 offset:44032
    ds_read_b128 a[176:179], v2 offset:45056
    ds_read_b128 a[180:183], v2 offset:46080
    ds_read_b128 a[184:187], v2 offset:47104
    ds_read_b128 a[188:191], v2 offset:48128
    s_waitcnt lgkmcnt(4)
    ds_read_b128 a[192:195], v2 offset:49152
    ds_read_b128 a[196:199], v2 offset:50176
    ds_read_b128 a[200:203], v2 offset:51200
    ds_read_b128 a[204:207], v2 offset:52224
    ds_read_b128 a[208:211], v2 offset:53248
    ds_read_b128 a[212:215], v2 offset:54272
    ds_read_b128 a[216:219], v2 offset:55296
    ds_read_b128 a[220:223], v2 offset:56320
L_main_kernel_365:
    s_branch Lnx_main_kernel_187
L2_main_kernel_192:
    s_sub_u32 s60, s100, 80
    v_lshlrev_b32 v1, 4, v0
    v_and_b32 v2, 15, v0
    v_lshrrev_b32 v3, 4, v0
    s_mul_i32 s46, s3, 100352
    s_add_u32 s46, s46, 12845056
    buffer_load_dwordx4 a[0:3], v1, s[4:7], s46 offen offset:0 sc1
    buffer_load_dwordx4 a[4:7], v1, s[4:7], s46 offen offset:1024 sc1
    buffer_load_dwordx4 a[8:11], v1, s[4:7], s46 offen offset:2048 sc1
    buffer_load_dwordx4 a[12:15], v1, s[4:7], s46 offen offset:3072 sc1
    s_add_u32 s46, s46, 4096
    buffer_load_dwordx4 a[16:19], v1, s[4:7], s46 offen offset:0 sc1
    buffer_load_dwordx4 a[20:23], v1, s[4:7], s46 offen offset:1024 sc1
    buffer_load_dwordx4 a[24:27], v1, s[4:7], s46 offen offset:2048 sc1
    buffer_load_dwordx4 a[28:31], v1, s[4:7], s46 offen offset:3072 sc1
    s_add_u32 s46, s46, 4096
    buffer_load_dwordx4 a[32:35], v1, s[4:7], s46 offen offset:0 sc1
    buffer_load_dwordx4 a[36:39], v1, s[4:7], s46 offen offset:1024 sc1
    buffer_load_dwordx4 a[40:43], v1, s[4:7], s46 offen offset:2048 sc1
    buffer_load_dwordx4 a[44:47], v1, s[4:7], s46 offen offset:3072 sc1
    s_add_u32 s46, s46, 4096
    buffer_load_dwordx4 a[48:51], v1, s[4:7], s46 offen offset:0 sc1
    buffer_load_dwordx4 a[52:55], v1, s[4:7], s46 offen offset:1024 sc1
    buffer_load_dwordx4 a[56:59], v1, s[4:7], s46 offen offset:2048 sc1
    buffer_load_dwordx4 a[60:63], v1, s[4:7], s46 offen offset:3072 sc1
    s_add_u32 s46, s46, 4096
    buffer_load_dwordx4 a[64:67], v1, s[4:7], s46 offen offset:0 sc1
    buffer_load_dwordx4 a[68:71], v1, s[4:7], s46 offen offset:1024 sc1
    buffer_load_dwordx4 a[72:75], v1, s[4:7], s46 offen offset:2048 sc1
    buffer_load_dwordx4 a[76:79], v1, s[4:7], s46 offen offset:3072 sc1
    s_add_u32 s46, s46, 4096
    buffer_load_dwordx4 a[80:83], v1, s[4:7], s46 offen offset:0 sc1
    buffer_load_dwordx4 a[84:87], v1, s[4:7], s46 offen offset:1024 sc1
    buffer_load_dwordx4 a[88:91], v1, s[4:7], s46 offen offset:2048 sc1
    buffer_load_dwordx4 a[92:95], v1, s[4:7], s46 offen offset:3072 sc1
    s_add_u32 s46, s46, 4096
    buffer_load_dwordx4 a[96:99], v1, s[4:7], s46 offen offset:0 sc1
    buffer_load_dwordx4 a[100:103], v1, s[4:7], s46 offen offset:1024 sc1
    buffer_load_dwordx4 a[104:107], v1, s[4:7], s46 offen offset:2048 sc1
    buffer_load_dwordx4 a[108:111], v1, s[4:7], s46 offen offset:3072 sc1
    s_add_u32 s46, s46, 4096
    buffer_load_dwordx4 a[112:115], v1, s[4:7], s46 offen offset:0 sc1
    buffer_load_dwordx4 a[116:119], v1, s[4:7], s46 offen offset:1024 sc1
    buffer_load_dwordx4 a[120:123], v1, s[4:7], s46 offen offset:2048 sc1
    buffer_load_dwordx4 a[124:127], v1, s[4:7], s46 offen offset:3072 sc1
    s_add_u32 s46, s46, 4096
    buffer_load_dwordx4 a[128:131], v1, s[4:7], s46 offen offset:0 sc1
    buffer_load_dwordx4 a[132:135], v1, s[4:7], s46 offen offset:1024 sc1
    buffer_load_dwordx4 a[136:139], v1, s[4:7], s46 offen offset:2048 sc1
    buffer_load_dwordx4 a[140:143], v1, s[4:7], s46 offen offset:3072 sc1
    s_add_u32 s46, s46, 4096
    buffer_load_dwordx4 a[144:147], v1, s[4:7], s46 offen offset:0 sc1
    buffer_load_dwordx4 a[148:151], v1, s[4:7], s46 offen offset:1024 sc1
    buffer_load_dwordx4 a[152:155], v1, s[4:7], s46 offen offset:2048 sc1
    buffer_load_dwordx4 a[156:159], v1, s[4:7], s46 offen offset:3072 sc1
    s_add_u32 s46, s46, 4096
    buffer_load_dwordx4 a[160:163], v1, s[4:7], s46 offen offset:0 sc1
    buffer_load_dwordx4 a[164:167], v1, s[4:7], s46 offen offset:1024 sc1
    buffer_load_dwordx4 a[168:171], v1, s[4:7], s46 offen offset:2048 sc1
    buffer_load_dwordx4 a[172:175], v1, s[4:7], s46 offen offset:3072 sc1
    s_add_u32 s46, s46, 4096
    buffer_load_dwordx4 a[176:179], v1, s[4:7], s46 offen offset:0 sc1
    buffer_load_dwordx4 a[180:183], v1, s[4:7], s46 offen offset:1024 sc1
    buffer_load_dwordx4 a[184:187], v1, s[4:7], s46 offen offset:2048 sc1
    buffer_load_dwordx4 a[188:191], v1, s[4:7], s46 offen offset:3072 sc1
    s_add_u32 s46, s46, 4096
    buffer_load_dwordx4 a[192:195], v1, s[4:7], s46 offen offset:0 sc1
    buffer_load_dwordx4 a[196:199], v1, s[4:7], s46 offen offset:1024 sc1
    buffer_load_dwordx4 a[200:203], v1, s[4:7], s46 offen offset:2048 sc1
    buffer_load_dwordx4 a[204:207], v1, s[4:7], s46 offen offset:3072 sc1
    s_add_u32 s46, s46, 4096
    buffer_load_dwordx4 a[208:211], v1, s[4:7], s46 offen offset:0 sc1
    buffer_load_dwordx4 a[212:215], v1, s[4:7], s46 offen offset:1024 sc1
    buffer_load_dwordx4 a[216:219], v1, s[4:7], s46 offen offset:2048 sc1
    buffer_load_dwordx4 a[220:223], v1, s[4:7], s46 offen offset:3072 sc1
    s_add_u32 s46, s46, 4096
    buffer_load_dwordx4 a[224:227], v1, s[4:7], s46 offen offset:0 sc1
    buffer_load_dwordx4 a[228:231], v1, s[4:7], s46 offen offset:1024 sc1
    buffer_load_dwordx4 a[232:235], v1, s[4:7], s46 offen offset:2048 sc1
    buffer_load_dwordx4 a[236:239], v1, s[4:7], s46 offen offset:3072 sc1
    s_add_u32 s46, s46, 4096
    buffer_load_dwordx4 a[240:243], v1, s[4:7], s46 offen offset:0 sc1
    buffer_load_dwordx4 a[244:247], v1, s[4:7], s46 offen offset:1024 sc1
    buffer_load_dwordx4 a[248:251], v1, s[4:7], s46 offen offset:2048 sc1
    buffer_load_dwordx4 a[252:255], v1, s[4:7], s46 offen offset:3072 sc1
    s_add_u32 s46, s46, 4096
    buffer_load_dwordx4 v[120:123], v1, s[4:7], s46 offen offset:0 sc1
    buffer_load_dwordx4 v[124:127], v1, s[4:7], s46 offen offset:1024 sc1
    buffer_load_dwordx4 v[128:131], v1, s[4:7], s46 offen offset:2048 sc1
    buffer_load_dwordx4 v[132:135], v1, s[4:7], s46 offen offset:3072 sc1
    s_add_u32 s46, s46, 4096
    buffer_load_dwordx4 v[136:139], v1, s[4:7], s46 offen offset:0 sc1
    buffer_load_dwordx4 v[140:143], v1, s[4:7], s46 offen offset:1024 sc1
    buffer_load_dwordx4 v[144:147], v1, s[4:7], s46 offen offset:2048 sc1
    buffer_load_dwordx4 v[148:151], v1, s[4:7], s46 offen offset:3072 sc1
    s_add_u32 s46, s46, 4096
    buffer_load_dwordx4 v[152:155], v1, s[4:7], s46 offen offset:0 sc1
    buffer_load_dwordx4 v[156:159], v1, s[4:7], s46 offen offset:1024 sc1
    buffer_load_dwordx4 v[160:163], v1, s[4:7], s46 offen offset:2048 sc1
    buffer_load_dwordx4 v[164:167], v1, s[4:7], s46 offen offset:3072 sc1
    s_add_u32 s46, s46, 4096
    buffer_load_dwordx4 v[168:171], v1, s[4:7], s46 offen offset:0 sc1
    buffer_load_dwordx4 v[172:175], v1, s[4:7], s46 offen offset:1024 sc1
    buffer_load_dwordx4 v[176:179], v1, s[4:7], s46 offen offset:2048 sc1
    buffer_load_dwordx4 v[180:183], v1, s[4:7], s46 offen offset:3072 sc1
    s_add_u32 s46, s46, 4096
    buffer_load_dwordx4 v[184:187], v1, s[4:7], s46 offen offset:0 sc1
    buffer_load_dwordx4 v[188:191], v1, s[4:7], s46 offen offset:1024 sc1
    buffer_load_dwordx4 v[192:195], v1, s[4:7], s46 offen offset:2048 sc1
    buffer_load_dwordx4 v[196:199], v1, s[4:7], s46 offen offset:3072 sc1
    s_add_u32 s46, s46, 4096
    buffer_load_dwordx4 v[200:203], v1, s[4:7], s46 offen offset:0 sc1
    buffer_load_dwordx4 v[204:207], v1, s[4:7], s46 offen offset:1024 sc1
    buffer_load_dwordx4 v[208:211], v1, s[4:7], s46 offen offset:2048 sc1
    buffer_load_dwordx4 v[212:215], v1, s[4:7], s46 offen offset:3072 sc1
    s_add_u32 s46, s46, 4096
    buffer_load_dwordx4 v[216:219], v1, s[4:7], s46 offen offset:0 sc1
    buffer_load_dwordx4 v[220:223], v1, s[4:7], s46 offen offset:1024 sc1
    buffer_load_dwordx4 v[224:227], v1, s[4:7], s46 offen offset:2048 sc1
    buffer_load_dwordx4 v[228:231], v1, s[4:7], s46 offen offset:3072 sc1
    s_add_u32 s46, s46, 4096
    buffer_load_dwordx4 v[232:235], v1, s[4:7], s46 offen offset:0 sc1
    buffer_load_dwordx4 v[236:239], v1, s[4:7], s46 offen offset:1024 sc1
    buffer_load_dwordx4 v[240:243], v1, s[4:7], s46 offen offset:2048 sc1
    buffer_load_dwordx4 v[244:247], v1, s[4:7], s46 offen offset:3072 sc1
    s_add_u32 s46, s46, 4096
    buffer_load_dwordx4 v[248:251], v1, s[4:7], s46 offen offset:0 sc1
    buffer_load_dwordx4 v[252:255], v1, s[4:7], s46 offen offset:1024 sc1
    s_mul_i32 s61, s60, 4
    s_add_u32 s61, s61, 1920
    v_min_u32 v4, 3, v2
    v_add_u32 v4, s61, v4
    v_lshrrev_b32 v5, 4, v4
    v_mul_u32_u24 v5, 14336, v5
    v_and_b32 v6, 15, v4
    v_lshl_add_u32 v5, v6, 4, v5
    v_lshl_add_u32 v5, v3, 8, v5
    v_mov_b64 v[8:9], 0
    v_mov_b64 v[10:11], 0
    s_lshl_b32 s46, s3, 12
    v_add_u32 v7, s46, v1
    ds_write_b128 v7, v[8:11] offset:0
    ds_write_b128 v7, v[8:11] offset:1024
    ds_write_b128 v7, v[8:11] offset:2048
    ds_write_b128 v7, v[8:11] offset:3072
    s_nop 0
    v_mov_b32 v7, 36608
    ds_write_b32 v7, v8
    v_lshrrev_b32 v12, 5, v4
    v_lshlrev_b32 v12, 7, v12
    s_mov_b32 s49, 97714176
    s_lshr_b32 s50, s61, 5
    s_min_u32 s50, s50, 61
    s_waitcnt vmcnt(0)
    s_mov_b32 s49, 97768448
    v_mov_b32 v12, 0
    s_cmp_lg_u32 s3, 0
    s_cbranch_scc1 Lwo_main_kernel_367
    s_mov_b32 s47, 2097152
Lwc_main_kernel_366:
    buffer_load_dword v13, v12, s[12:15], s49 offen sc1
    s_sub_u32 s47, s47, 1
    s_cbranch_scc1 Lexit_main_kernel
    s_waitcnt vmcnt(0)
    v_cmp_gt_u32 vcc, s50, v13
    s_cbranch_vccz Lwo_main_kernel_367
    s_sleep 24
    s_branch Lwc_main_kernel_366
Lwo_main_kernel_367:
    s_barrier
    s_mov_b32 s96, 0
    s_lshr_b32 s98, s61, 5
    s_sub_u32 s98, s98, 1
    s_cmp_lt_u32 s98, s96
    s_cbranch_scc1 Lgo_main_kernel_368
    s_mov_b32 s70, 2097152
    v_lshlrev_b32 v8, 3, v1
    v_and_b32 v8, 0x780, v8
Lgl_main_kernel_369:
    s_min_u32 s96, s96, 48
    s_lshl_b32 s97, s96, 7
    s_add_u32 s97, s97, 97714176
    s_mov_b64 exec, 0xffff
    buffer_load_dword v9, v8, s[12:15], s97 offen sc1
    s_mov_b64 exec, -1
    s_sub_u32 s70, s70, 1
    s_cbranch_scc1 Lexit_main_kernel
    s_waitcnt vmcnt(0)
    v_cmp_ne_u32 vcc, 4, v9
    s_nop 0
    s_or_b32 s97, vcc_lo, 0x10000
    s_ff1_i32_b32 s97, s97
    s_add_u32 s96, s96, s97
    s_cmp_eq_u32 s97, 16
    s_cselect_b32 s97, 1, 0
    s_cmp_ge_u32 s96, 64
    s_cselect_b32 s96, 0x100, s96
    s_cbranch_scc1 Lgo_main_kernel_368
    s_cmp_eq_u32 s97, 1
    s_cbranch_scc1 Lgl_main_kernel_369
    s_cmp_lt_u32 s98, s96
    s_cbranch_scc1 Lgo_main_kernel_368
    s_add_u32 s97, s96, 1
    s_cmp_gt_u32 s98, s97
    s_cbranch_scc1 Lgf_main_kernel_370
    s_sleep 1
    s_branch Lgl_main_kernel_369
Lgf_main_kernel_370:
    s_sleep 8
    s_branch Lgl_main_kernel_369
Lgo_main_kernel_368:
    s_mov_b32 s48, 17432576
    s_mov_b32 s70, 2097152
    s_waitcnt lgkmcnt(0)
    s_barrier
    s_mul_i32 s63, s3, 112
    v_lshlrev_b32 v6, 2, v3
    v_add_u32 v6, s63, v6
    v_lshlrev_b32 v7, 10, v2
    v_add_u32 v8, 0, v6
    v_mul_u32_u24 v9, 2341, v8
    v_lshrrev_b32 v9, 16, v9
    v_lshl_add_u32 v8, v8, 1, v7
    v_lshl_add_u32 v100, v9, 3, v8
    v_add_u32 v8, 16, v6
    v_mul_u32_u24 v9, 2341, v8
    v_lshrrev_b32 v9, 16, v9
    v_lshl_add_u32 v8, v8, 1, v7
    v_lshl_add_u32 v101, v9, 3, v8
    v_add_u32 v8, 32, v6
    v_mul_u32_u24 v9, 2341, v8
    v_lshrrev_b32 v9, 16, v9
    v_lshl_add_u32 v8, v8, 1, v7
    v_lshl_add_u32 v102, v9, 3, v8
    v_add_u32 v8, 48, v6
    v_mul_u32_u24 v9, 2341, v8
    v_lshrrev_b32 v9, 16, v9
    v_lshl_add_u32 v8, v8, 1, v7
    v_lshl_add_u32 v103, v9, 3, v8
    v_add_u32 v8, 64, v6
    v_mul_u32_u24 v9, 2341, v8
    v_lshrrev_b32 v9, 16, v9
    v_lshl_add_u32 v8, v8, 1, v7
    v_lshl_add_u32 v104, v9, 3, v8
    v_add_u32 v8, 80, v6
    v_mul_u32_u24 v9, 2341, v8
    v_lshrrev_b32 v9, 16, v9
    v_lshl_add_u32 v8, v8, 1, v7
    v_lshl_add_u32 v105, v9, 3, v8
    v_add_u32 v8, 96, v6
    v_mul_u32_u24 v9, 2341, v8
    v_lshrrev_b32 v9, 16, v9
    v_lshl_add_u32 v8, v8, 1, v7
    v_lshl_add_u32 v106, v9, 3, v8
    s_mov_b32 s64, 0x3e8b97f6
Lx_main_kernel_371:
Lx_main_kernel_372:
    s_add_u32 s47, s48, 13312
    buffer_load_dword v8, v5, s[12:15], s47 offen sc1
    s_sub_u32 s70, s70, 1
    s_cbranch_scc1 Lexit_main_kernel
    s_waitcnt vmcnt(0)
    v_cmp_eq_u32 vcc, -1, v8
    s_cbranch_vccnz Lx_main_kernel_372
    buffer_load_dwordx4 v[16:19], v5, s[12:15], s48 offen offset:0 sc1
    buffer_load_dwordx4 v[20:23], v5, s[12:15], s48 offen offset:1024 sc1
    buffer_load_dwordx4 v[24:27], v5, s[12:15], s48 offen offset:2048 sc1
    buffer_load_dwordx4 v[28:31], v5, s[12:15], s48 offen offset:3072 sc1
    s_add_u32 s47, s48, 4096
    buffer_load_dwordx4 v[32:35], v5, s[12:15], s47 offen offset:0 sc1
    buffer_load_dwordx4 v[36:39], v5, s[12:15], s47 offen offset:1024 sc1
    buffer_load_dwordx4 v[40:43], v5, s[12:15], s47 offen offset:2048 sc1
    buffer_load_dwordx4 v[44:47], v5, s[12:15], s47 offen offset:3072 sc1
    s_add_u32 s47, s47, 4096
    buffer_load_dwordx4 v[48:51], v5, s[12:15], s47 offen offset:0 sc1
    buffer_load_dwordx4 v[52:55], v5, s[12:15], s47 offen offset:1024 sc1
    buffer_load_dwordx4 v[56:59], v5, s[12:15], s47 offen offset:2048 sc1
    buffer_load_dwordx4 v[60:63], v5, s[12:15], s47 offen offset:3072 sc1
    s_add_u32 s47, s47, 4096
    buffer_load_dwordx4 v[64:67], v5, s[12:15], s47 offen offset:0 sc1
    buffer_load_dwordx4 v[68:71], v5, s[12:15], s47 offen offset:1024 sc1
    s_waitcnt vmcnt(13)
    v_mfma_f32_16x16x32_bf16 v[72:75], a[0:3], v[16:19], 0
    v_max3_u32 v8, v16, v17, v16
    v_mfma_f32_16x16x32_bf16 v[76:79], a[56:59], v[16:19], 0
    v_max3_u32 v8, v18, v19, v8
    v_mfma_f32_16x16x32_bf16 v[80:83], a[112:115], v[16:19], 0
    v_mfma_f32_16x16x32_bf16 v[84:87], a[168:171], v[16:19], 0
    v_mfma_f32_16x16x32_bf16 v[88:91], a[224:227], v[16:19], 0
    v_mfma_f32_16x16x32_bf16 v[92:95], v[144:147], v[16:19], 0
    v_mfma_f32_16x16x32_bf16 v[96:99], v[200:203], v[16:19], 0
    s_waitcnt vmcnt(12)
    v_mfma_f32_16x16x32_bf16 v[72:75], a[4:7], v[20:23], v[72:75]
    v_max3_u32 v8, v20, v21, v8
    v_mfma_f32_16x16x32_bf16 v[76:79], a[60:63], v[20:23], v[76:79]
    v_max3_u32 v8, v22, v23, v8
    v_mfma_f32_16x16x32_bf16 v[80:83], a[116:119], v[20:23], v[80:83]
    v_mfma_f32_16x16x32_bf16 v[84:87], a[172:175], v[20:23], v[84:87]
    v_mfma_f32_16x16x32_bf16 v[88:91], a[228:231], v[20:23], v[88:91]
    v_mfma_f32_16x16x32_bf16 v[92:95], v[148:151], v[20:23], v[92:95]
    v_mfma_f32_16x16x32_bf16 v[96:99], v[204:207], v[20:23], v[96:99]
    s_waitcnt vmcnt(11)
    v_mfma_f32_16x16x32_bf16 v[72:75], a[8:11], v[24:27], v[72:75]
    v_max3_u32 v8, v24, v25, v8
    v_mfma_f32_16x16x32_bf16 v[76:79], a[64:67], v[24:27], v[76:79]
    v_max3_u32 v8, v26, v27, v8
    v_mfma_f32_16x16x32_bf16 v[80:83], a[120:123], v[24:27], v[80:83]
    v_mfma_f32_16x16x32_bf16 v[84:87], a[176:179], v[24:27], v[84:87]
    v_mfma_f32_16x16x32_bf16 v[88:91], a[232:235], v[24:27], v[88:91]
    v_mfma_f32_16x16x32_bf16 v[92:95], v[152:155], v[24:27], v[92:95]
    v_mfma_f32_16x16x32_bf16 v[96:99], v[208:211], v[24:27], v[96:99]
    s_waitcnt vmcnt(10)
    v_mfma_f32_16x16x32_bf16 v[72:75], a[12:15], v[28:31], v[72:75]
    v_max3_u32 v8, v28, v29, v8
    v_mfma_f32_16x16x32_bf16 v[76:79], a[68:71], v[28:31], v[76:79]
    v_max3_u32 v8, v30, v31, v8
    v_mfma_f32_16x16x32_bf16 v[80:83], a[124:127], v[28:31], v[80:83]
    v_mfma_f32_16x16x32_bf16 v[84:87], a[180:183], v[28:31], v[84:87]
    v_mfma_f32_16x16x32_bf16 v[88:91], a[236:239], v[28:31], v[88:91]
    v_mfma_f32_16x16x32_bf16 v[92:95], v[156:159], v[28:31], v[92:95]
    v_mfma_f32_16x16x32_bf16 v[96:99], v[212:215], v[28:31], v[96:99]
    s_waitcnt vmcnt(9)
    v_mfma_f32_16x16x32_bf16 v[72:75], a[16:19], v[32:35], v[72:75]
    v_max3_u32 v8, v32, v33, v8
    v_mfma_f32_16x16x32_bf16 v[76:79], a[72:75], v[32:35], v[76:79]
    v_max3_u32 v8, v34, v35, v8
    v_mfma_f32_16x16x32_bf16 v[80:83], a[128:131], v[32:35], v[80:83]
    v_mfma_f32_16x16x32_bf16 v[84:87], a[184:187], v[32:35], v[84:87]
    v_mfma_f32_16x16x32_bf16 v[88:91], a[240:243], v[32:35], v[88:91]
    v_mfma_f32_16x16x32_bf16 v[92:95], v[160:163], v[32:35], v[92:95]
    v_mfma_f32_16x16x32_bf16 v[96:99], v[216:219], v[32:35], v[96:99]
    s_waitcnt vmcnt(8)
    v_mfma_f32_16x16x32_bf16 v[72:75], a[20:23], v[36:39], v[72:75]
    v_max3_u32 v8, v36, v37, v8
    v_mfma_f32_16x16x32_bf16 v[76:79], a[76:79], v[36:39], v[76:79]
    v_max3_u32 v8, v38, v39, v8
    v_mfma_f32_16x16x32_bf16 v[80:83], a[132:135], v[36:39], v[80:83]
    v_mfma_f32_16x16x32_bf16 v[84:87], a[188:191], v[36:39], v[84:87]
    v_mfma_f32_16x16x32_bf16 v[88:91], a[244:247], v[36:39], v[88:91]
    v_mfma_f32_16x16x32_bf16 v[92:95], v[164:167], v[36:39], v[92:95]
    v_mfma_f32_16x16x32_bf16 v[96:99], v[220:223], v[36:39], v[96:99]
    s_waitcnt vmcnt(7)
    v_mfma_f32_16x16x32_bf16 v[72:75], a[24:27], v[40:43], v[72:75]
    v_max3_u32 v8, v40, v41, v8
    v_mfma_f32_16x16x32_bf16 v[76:79], a[80:83], v[40:43], v[76:79]
    v_max3_u32 v8, v42, v43, v8
    v_mfma_f32_16x16x32_bf16 v[80:83], a[136:139], v[40:43], v[80:83]
    v_mfma_f32_16x16x32_bf16 v[84:87], a[192:195], v[40:43], v[84:87]
    v_mfma_f32_16x16x32_bf16 v[88:91], a[248:251], v[40:43], v[88:91]
    v_mfma_f32_16x16x32_bf16 v[92:95], v[168:171], v[40:43], v[92:95]
    v_mfma_f32_16x16x32_bf16 v[96:99], v[224:227], v[40:43], v[96:99]
    s_waitcnt vmcnt(6)
    v_mfma_f32_16x16x32_bf16 v[72:75], a[28:31], v[44:47], v[72:75]
    v_max3_u32 v8, v44, v45, v8
    v_mfma_f32_16x16x32_bf16 v[76:79], a[84:87], v[44:47], v[76:79]
    v_max3_u32 v8, v46, v47, v8
    v_mfma_f32_16x16x32_bf16 v[80:83], a[140:143], v[44:47], v[80:83]
    v_mfma_f32_16x16x32_bf16 v[84:87], a[196:199], v[44:47], v[84:87]
    v_mfma_f32_16x16x32_bf16 v[88:91], a[252:255], v[44:47], v[88:91]
    v_mfma_f32_16x16x32_bf16 v[92:95], v[172:175], v[44:47], v[92:95]
    v_mfma_f32_16x16x32_bf16 v[96:99], v[228:231], v[44:47], v[96:99]
    s_waitcnt vmcnt(5)
    v_mfma_f32_16x16x32_bf16 v[72:75], a[32:35], v[48:51], v[72:75]
    v_max3_u32 v8, v48, v49, v8
    v_mfma_f32_16x16x32_bf16 v[76:79], a[88:91], v[48:51], v[76:79]
    v_max3_u32 v8, v50, v51, v8
    v_mfma_f32_16x16x32_bf16 v[80:83], a[144:147], v[48:51], v[80:83]
    v_mfma_f32_16x16x32_bf16 v[84:87], a[200:203], v[48:51], v[84:87]
    v_mfma_f32_16x16x32_bf16 v[88:91], v[120:123], v[48:51], v[88:91]
    v_mfma_f32_16x16x32_bf16 v[92:95], v[176:179], v[48:51], v[92:95]
    v_mfma_f32_16x16x32_bf16 v[96:99], v[232:235], v[48:51], v[96:99]
    s_waitcnt vmcnt(4)
    v_mfma_f32_16x16x32_bf16 v[72:75], a[36:39], v[52:55], v[72:75]
    v_max3_u32 v8, v52, v53, v8
    v_mfma_f32_16x16x32_bf16 v[76:79], a[92:95], v[52:55], v[76:79]
    v_max3_u32 v8, v54, v55, v8
    v_mfma_f32_16x16x32_bf16 v[80:83], a[148:151], v[52:55], v[80:83]
    v_mfma_f32_16x16x32_bf16 v[84:87], a[204:207], v[52:55], v[84:87]
    v_mfma_f32_16x16x32_bf16 v[88:91], v[124:127], v[52:55], v[88:91]
    v_mfma_f32_16x16x32_bf16 v[92:95], v[180:183], v[52:55], v[92:95]
    v_mfma_f32_16x16x32_bf16 v[96:99], v[236:239], v[52:55], v[96:99]
    s_waitcnt vmcnt(3)
    v_mfma_f32_16x16x32_bf16 v[72:75], a[40:43], v[56:59], v[72:75]
    v_max3_u32 v8, v56, v57, v8
    v_mfma_f32_16x16x32_bf16 v[76:79], a[96:99], v[56:59], v[76:79]
    v_max3_u32 v8, v58, v59, v8
    v_mfma_f32_16x16x32_bf16 v[80:83], a[152:155], v[56:59], v[80:83]
    v_mfma_f32_16x16x32_bf16 v[84:87], a[208:211], v[56:59], v[84:87]
    v_mfma_f32_16x16x32_bf16 v[88:91], v[128:131], v[56:59], v[88:91]
    v_mfma_f32_16x16x32_bf16 v[92:95], v[184:187], v[56:59], v[92:95]
    v_mfma_f32_16x16x32_bf16 v[96:99], v[240:243], v[56:59], v[96:99]
    s_waitcnt vmcnt(2)
    v_mfma_f32_16x16x32_bf16 v[72:75], a[44:47], v[60:63], v[72:75]
    v_max3_u32 v8, v60, v61, v8
    v_mfma_f32_16x16x32_bf16 v[76:79], a[100:103], v[60:63], v[76:79]
    v_max3_u32 v8, v62, v63, v8
    v_mfma_f32_16x16x32_bf16 v[80:83], a[156:159], v[60:63], v[80:83]
    v_mfma_f32_16x16x32_bf16 v[84:87], a[212:215], v[60:63], v[84:87]
    v_mfma_f32_16x16x32_bf16 v[88:91], v[132:135], v[60:63], v[88:91]
    v_mfma_f32_16x16x32_bf16 v[92:95], v[188:191], v[60:63], v[92:95]
    v_mfma_f32_16x16x32_bf16 v[96:99], v[244:247], v[60:63], v[96:99]
    s_waitcnt vmcnt(1)
    v_mfma_f32_16x16x32_bf16 v[72:75], a[48:51], v[64:67], v[72:75]
    v_max3_u32 v8, v64, v65, v8
    v_mfma_f32_16x16x32_bf16 v[76:79], a[104:107], v[64:67], v[76:79]
    v_max3_u32 v8, v66, v67, v8
    v_mfma_f32_16x16x32_bf16 v[80:83], a[160:163], v[64:67], v[80:83]
    v_mfma_f32_16x16x32_bf16 v[84:87], a[216:219], v[64:67], v[84:87]
    v_mfma_f32_16x16x32_bf16 v[88:91], v[136:139], v[64:67], v[88:91]
    v_mfma_f32_16x16x32_bf16 v[92:95], v[192:195], v[64:67], v[92:95]
    v_mfma_f32_16x16x32_bf16 v[96:99], v[248:251], v[64:67], v[96:99]
    s_waitcnt vmcnt(0)
    v_mfma_f32_16x16x32_bf16 v[72:75], a[52:55], v[68:71], v[72:75]
    v_max3_u32 v8, v68, v69, v8
    v_mfma_f32_16x16x32_bf16 v[76:79], a[108:111], v[68:71], v[76:79]
    v_max3_u32 v8, v70, v71, v8
    v_mfma_f32_16x16x32_bf16 v[80:83], a[164:167], v[68:71], v[80:83]
    v_mfma_f32_16x16x32_bf16 v[84:87], a[220:223], v[68:71], v[84:87]
    v_mfma_f32_16x16x32_bf16 v[88:91], v[140:143], v[68:71], v[88:91]
    v_mfma_f32_16x16x32_bf16 v[92:95], v[196:199], v[68:71], v[92:95]
    v_mfma_f32_16x16x32_bf16 v[96:99], v[252:255], v[68:71], v[96:99]
    v_cmp_eq_u32 vcc, -1, v8
    s_cbranch_vccnz Lx_main_kernel_371
    s_lshl_b32 s65, s3, 11
    s_add_u32 s66, s65, 88879104
    s_add_u32 s65, s65, 88743936
    s_mov_b32 s67, s65
    s_mov_b32 s68, s66
    s_mov_b32 s78, 0
    s_add_u32 s98, s3, 48
    buffer_load_dwordx4 v[208:211], v1, s[12:15], s67 offen sc1
    buffer_load_dwordx4 v[212:215], v1, s[12:15], s67 offen offset:1024 sc1
    buffer_load_dwordx4 v[216:219], v1, s[12:15], s68 offen sc1
    buffer_load_dwordx4 v[220:223], v1, s[12:15], s68 offen offset:1024 sc1
    s_add_u32 s67, s67, 8192
    s_add_u32 s68, s68, 8192
    buffer_load_dwordx4 v[224:227], v1, s[12:15], s67 offen sc1
    buffer_load_dwordx4 v[228:231], v1, s[12:15], s67 offen offset:1024 sc1
    buffer_load_dwordx4 v[232:235], v1, s[12:15], s68 offen sc1
    buffer_load_dwordx4 v[236:239], v1, s[12:15], s68 offen offset:1024 sc1
    s_add_u32 s67, s67, 8192
    s_add_u32 s68, s68, 8192
    buffer_load_dwordx4 v[240:243], v1, s[12:15], s67 offen sc1
    buffer_load_dwordx4 v[244:247], v1, s[12:15], s67 offen offset:1024 sc1
    buffer_load_dwordx4 v[248:251], v1, s[12:15], s68 offen sc1
    buffer_load_dwordx4 v[252:255], v1, s[12:15], s68 offen offset:1024 sc1
    s_add_u32 s67, s67, 8192
    s_add_u32 s68, s68, 8192
    v_mul_f32 v72, s64, v72
    v_mul_f32 v73, s64, v73
    v_mul_f32 v74, s64, v74
    v_mul_f32 v75, s64, v75
    v_cvt_pk_bf16_f32 v72, v72, v73
    v_cvt_pk_bf16_f32 v73, v74, v75
    ds_write_b64 v100, v[72:73] offset:0
    v_mul_f32 v76, s64, v76
    v_mul_f32 v77, s64, v77
    v_mul_f32 v78, s64, v78
    v_mul_f32 v79, s64, v79
    v_cvt_pk_bf16_f32 v76, v76, v77
    v_cvt_pk_bf16_f32 v77, v78, v79
    ds_write_b64 v101, v[76:77] offset:0
    v_mul_f32 v80, s64, v80
    v_mul_f32 v81, s64, v81
    v_mul_f32 v82, s64, v82
    v_mul_f32 v83, s64, v83
    v_cvt_pk_bf16_f32 v80, v80, v81
    v_cvt_pk_bf16_f32 v81, v82, v83
    ds_write_b64 v102, v[80:81] offset:0
    v_mul_f32 v84, s64, v84
    v_mul_f32 v85, s64, v85
    v_mul_f32 v86, s64, v86
    v_mul_f32 v87, s64, v87
    v_cvt_pk_bf16_f32 v84, v84, v85
    v_cvt_pk_bf16_f32 v85, v86, v87
    ds_write_b64 v103, v[84:85] offset:0
    v_mul_f32 v88, s64, v88
    v_mul_f32 v89, s64, v89
    v_mul_f32 v90, s64, v90
    v_mul_f32 v91, s64, v91
    v_cvt_pk_bf16_f32 v88, v88, v89
    v_cvt_pk_bf16_f32 v89, v90, v91
    ds_write_b64 v104, v[88:89] offset:0
    v_mul_f32 v92, s64, v92
    v_mul_f32 v93, s64, v93
    v_mul_f32 v94, s64, v94
    v_mul_f32 v95, s64, v95
    v_cvt_pk_bf16_f32 v92, v92, v93
    v_cvt_pk_bf16_f32 v93, v94, v95
    ds_write_b64 v105, v[92:93] offset:0
    v_mul_f32 v96, s64, v96
    v_mul_f32 v97, s64, v97
    v_mul_f32 v98, s64, v98
    v_mul_f32 v99, s64, v99
    v_cvt_pk_bf16_f32 v96, v96, v97
    v_cvt_pk_bf16_f32 v97, v98, v99
    ds_write_b64 v106, v[96:97] offset:0
    s_waitcnt lgkmcnt(0)
    s_barrier
    v_bfe_u32 v6, v0, 4, 1
    v_lshlrev_b32 v6, 10, v6
    v_lshl_add_u32 v6, v2, 6, v6
    v_lshrrev_b32 v7, 5, v0
    v_lshl_add_u32 v6, v7, 4, v6
    ds_read_b128 v[16:19], v6 offset:0
    ds_read_b128 v[20:23], v6 offset:32
    ds_read_b128 v[24:27], v6 offset:2048
    ds_read_b128 v[28:31], v6 offset:2080
    v_mov_b64 v[144:145], 0
    v_mov_b64 v[146:147], 0
    v_mov_b64 v[148:149], 0
    v_mov_b64 v[150:151], 0
    v_mov_b64 v[152:153], 0
    v_mov_b64 v[154:155], 0
    v_mov_b64 v[156:157], 0
    v_mov_b64 v[158:159], 0
    v_mov_b64 v[160:161], 0
    v_mov_b64 v[162:163], 0
    v_mov_b64 v[164:165], 0
    v_mov_b64 v[166:167], 0
    v_mov_b64 v[168:169], 0
    v_mov_b64 v[170:171], 0
    v_mov_b64 v[172:173], 0
    v_mov_b64 v[174:175], 0
    s_waitcnt vmcnt(8) lgkmcnt(0)
    v_mfma_f32_32x32x16_bf16 v[104:119], v[208:211], v[16:19], 0
    v_mfma_f32_32x32x16_bf16 v[104:119], v[212:215], v[20:23], v[104:119]
    v_mfma_f32_32x32x16_bf16 v[120:135], v[208:211], v[24:27], 0
    s_nop 4
    v_exp_f32 v104, v104
    v_exp_f32 v105, v105
    v_exp_f32 v106, v106
    v_exp_f32 v107, v107
    v_exp_f32 v108, v108
    v_exp_f32 v109, v109
    v_exp_f32 v110, v110
    v_exp_f32 v111, v111
    v_mfma_f32_32x32x16_bf16 v[120:135], v[212:215], v[28:31], v[120:135]
    v_cvt_pk_bf16_f32 v136, v104, v105
    v_cvt_pk_bf16_f32 v137, v106, v107
    v_cvt_pk_bf16_f32 v138, v108, v109
    v_cvt_pk_bf16_f32 v139, v110, v111
    v_exp_f32 v112, v112
    v_exp_f32 v113, v113
    v_exp_f32 v114, v114
    v_exp_f32 v115, v115
    v_mfma_f32_32x32x16_bf16 v[144:159], v[216:219], v[136:139], v[144:159]
    v_exp_f32 v116, v116
    v_exp_f32 v117, v117
    v_exp_f32 v118, v118
    v_exp_f32 v119, v119
    v_cvt_pk_bf16_f32 v140, v112, v113
    v_cvt_pk_bf16_f32 v141, v114, v115
    v_cvt_pk_bf16_f32 v142, v116, v117
    v_cvt_pk_bf16_f32 v143, v118, v119
    s_waitcnt vmcnt(4)
    v_mfma_f32_32x32x16_bf16 v[104:119], v[224:227], v[16:19], 0
    v_exp_f32 v120, v120
    v_exp_f32 v121, v121
    v_exp_f32 v122, v122
    v_exp_f32 v123, v123
    v_mfma_f32_32x32x16_bf16 v[144:159], v[220:223], v[140:143], v[144:159]
    v_exp_f32 v124, v124
    v_exp_f32 v125, v125
    v_exp_f32 v126, v126
    v_exp_f32 v127, v127
    v_mfma_f32_32x32x16_bf16 v[104:119], v[228:231], v[20:23], v[104:119]
    v_cvt_pk_bf16_f32 v136, v120, v121
    v_cvt_pk_bf16_f32 v137, v122, v123
    v_cvt_pk_bf16_f32 v138, v124, v125
    v_cvt_pk_bf16_f32 v139, v126, v127
    v_exp_f32 v128, v128
    v_exp_f32 v129, v129
    v_exp_f32 v130, v130
    v_exp_f32 v131, v131
    v_mfma_f32_32x32x16_bf16 v[160:175], v[216:219], v[136:139], v[160:175]
    v_exp_f32 v132, v132
    v_exp_f32 v133, v133
    v_exp_f32 v134, v134
    v_exp_f32 v135, v135
    v_cvt_pk_bf16_f32 v140, v128, v129
    v_cvt_pk_bf16_f32 v141, v130, v131
    v_cvt_pk_bf16_f32 v142, v132, v133
    v_cvt_pk_bf16_f32 v143, v134, v135
    v_mfma_f32_32x32x16_bf16 v[120:135], v[224:227], v[24:27], 0
    v_exp_f32 v104, v104
    v_exp_f32 v105, v105
    v_exp_f32 v106, v106
    v_exp_f32 v107, v107
    v_mfma_f32_32x32x16_bf16 v[160:175], v[220:223], v[140:143], v[160:175]
    buffer_load_dwordx4 v[208:211], v1, s[12:15], s67 offen sc1
    buffer_load_dwordx4 v[212:215], v1, s[12:15], s67 offen offset:1024 sc1
    buffer_load_dwordx4 v[216:219], v1, s[12:15], s68 offen sc1
    buffer_load_dwordx4 v[220:223], v1, s[12:15], s68 offen offset:1024 sc1
    s_add_u32 s67, s67, 8192
    s_add_u32 s68, s68, 8192
    v_exp_f32 v108, v108
    v_exp_f32 v109, v109
    v_exp_f32 v110, v110
    v_exp_f32 v111, v111
    v_mfma_f32_32x32x16_bf16 v[120:135], v[228:231], v[28:31], v[120:135]
    v_cvt_pk_bf16_f32 v136, v104, v105
    v_cvt_pk_bf16_f32 v137, v106, v107
    v_cvt_pk_bf16_f32 v138, v108, v109
    v_cvt_pk_bf16_f32 v139, v110, v111
    v_exp_f32 v112, v112
    v_exp_f32 v113, v113
    v_exp_f32 v114, v114
    v_exp_f32 v115, v115
    v_mfma_f32_32x32x16_bf16 v[144:159], v[232:235], v[136:139], v[144:159]
    v_exp_f32 v116, v116
    v_exp_f32 v117, v117
    v_exp_f32 v118, v118
    v_exp_f32 v119, v119
    v_cvt_pk_bf16_f32 v140, v112, v113
    v_cvt_pk_bf16_f32 v141, v114, v115
    v_cvt_pk_bf16_f32 v142, v116, v117
    v_cvt_pk_bf16_f32 v143, v118, v119
    s_waitcnt vmcnt(4)
    v_mfma_f32_32x32x16_bf16 v[104:119], v[240:243], v[16:19], 0
    v_exp_f32 v120, v120
    v_exp_f32 v121, v121
    v_exp_f32 v122, v122
    v_exp_f32 v123, v123
    v_mfma_f32_32x32x16_bf16 v[144:159], v[236:239], v[140:143], v[144:159]
    v_exp_f32 v124, v124
    v_exp_f32 v125, v125
    v_exp_f32 v126, v126
    v_exp_f32 v127, v127
    v_mfma_f32_32x32x16_bf16 v[104:119], v[244:247], v[20:23], v[104:119]
    v_cvt_pk_bf16_f32 v136, v120, v121
    v_cvt_pk_bf16_f32 v137, v122, v123
    v_cvt_pk_bf16_f32 v138, v124, v125
    v_cvt_pk_bf16_f32 v139, v126, v127
    v_exp_f32 v128, v128
    v_exp_f32 v129, v129
    v_exp_f32 v130, v130
    v_exp_f32 v131, v131
    v_mfma_f32_32x32x16_bf16 v[160:175], v[232:235], v[136:139], v[160:175]
    v_exp_f32 v132, v132
    v_exp_f32 v133, v133
    v_exp_f32 v134, v134
    v_exp_f32 v135, v135
    v_cvt_pk_bf16_f32 v140, v128, v129
    v_cvt_pk_bf16_f32 v141, v130, v131
    v_cvt_pk_bf16_f32 v142, v132, v133
    v_cvt_pk_bf16_f32 v143, v134, v135
    v_mfma_f32_32x32x16_bf16 v[120:135], v[240:243], v[24:27], 0
    v_exp_f32 v104, v104
    v_exp_f32 v105, v105
    v_exp_f32 v106, v106
    v_exp_f32 v107, v107
    v_mfma_f32_32x32x16_bf16 v[160:175], v[236:239], v[140:143], v[160:175]
    buffer_load_dwordx4 v[224:227], v1, s[12:15], s67 offen sc1
    buffer_load_dwordx4 v[228:231], v1, s[12:15], s67 offen offset:1024 sc1
    buffer_load_dwordx4 v[232:235], v1, s[12:15], s68 offen sc1
    buffer_load_dwordx4 v[236:239], v1, s[12:15], s68 offen offset:1024 sc1
    s_add_u32 s67, s67, 8192
    s_add_u32 s68, s68, 8192
    v_exp_f32 v108, v108
    v_exp_f32 v109, v109
    v_exp_f32 v110, v110
    v_exp_f32 v111, v111
    v_mfma_f32_32x32x16_bf16 v[120:135], v[244:247], v[28:31], v[120:135]
    v_cvt_pk_bf16_f32 v136, v104, v105
    v_cvt_pk_bf16_f32 v137, v106, v107
    v_cvt_pk_bf16_f32 v138, v108, v109
    v_cvt_pk_bf16_f32 v139, v110, v111
    v_exp_f32 v112, v112
    v_exp_f32 v113, v113
    v_exp_f32 v114, v114
    v_exp_f32 v115, v115
    v_mfma_f32_32x32x16_bf16 v[144:159], v[248:251], v[136:139], v[144:159]
    v_exp_f32 v116, v116
    v_exp_f32 v117, v117
    v_exp_f32 v118, v118
    v_exp_f32 v119, v119
    v_cvt_pk_bf16_f32 v140, v112, v113
    v_cvt_pk_bf16_f32 v141, v114, v115
    v_cvt_pk_bf16_f32 v142, v116, v117
    v_cvt_pk_bf16_f32 v143, v118, v119
    s_waitcnt vmcnt(4)
    v_mfma_f32_32x32x16_bf16 v[104:119], v[208:211], v[16:19], 0
    v_exp_f32 v120, v120
    v_exp_f32 v121, v121
    v_exp_f32 v122, v122
    v_exp_f32 v123, v123
    v_mfma_f32_32x32x16_bf16 v[144:159], v[252:255], v[140:143], v[144:159]
    v_exp_f32 v124, v124
    v_exp_f32 v125, v125
    v_exp_f32 v126, v126
    v_exp_f32 v127, v127
    v_mfma_f32_32x32x16_bf16 v[104:119], v[212:215], v[20:23], v[104:119]
    v_cvt_pk_bf16_f32 v136, v120, v121
    v_cvt_pk_bf16_f32 v137, v122, v123
    v_cvt_pk_bf16_f32 v138, v124, v125
    v_cvt_pk_bf16_f32 v139, v126, v127
    v_exp_f32 v128, v128
    v_exp_f32 v129, v129
    v_exp_f32 v130, v130
    v_exp_f32 v131, v131
    v_mfma_f32_32x32x16_bf16 v[160:175], v[248:251], v[136:139], v[160:175]
    v_exp_f32 v132, v132
    v_exp_f32 v133, v133
    v_exp_f32 v134, v134
    v_exp_f32 v135, v135
    v_cvt_pk_bf16_f32 v140, v128, v129
    v_cvt_pk_bf16_f32 v141, v130, v131
    v_cvt_pk_bf16_f32 v142, v132, v133
    v_cvt_pk_bf16_f32 v143, v134, v135
    v_mfma_f32_32x32x16_bf16 v[120:135], v[208:211], v[24:27], 0
    v_exp_f32 v104, v104
    v_exp_f32 v105, v105
    v_exp_f32 v106, v106
    v_exp_f32 v107, v107
    v_mfma_f32_32x32x16_bf16 v[160:175], v[252:255], v[140:143], v[160:175]
    buffer_load_dwordx4 v[240:243], v1, s[12:15], s67 offen sc1
    buffer_load_dwordx4 v[244:247], v1, s[12:15], s67 offen offset:1024 sc1
    buffer_load_dwordx4 v[248:251], v1, s[12:15], s68 offen sc1
    buffer_load_dwordx4 v[252:255], v1, s[12:15], s68 offen offset:1024 sc1
    s_add_u32 s67, s67, 8192
    s_add_u32 s68, s68, 8192
    v_exp_f32 v108, v108
    v_exp_f32 v109, v109
    v_exp_f32 v110, v110
    v_exp_f32 v111, v111
    v_mfma_f32_32x32x16_bf16 v[120:135], v[212:215], v[28:31], v[120:135]
    v_cvt_pk_bf16_f32 v136, v104, v105
    v_cvt_pk_bf16_f32 v137, v106, v107
    v_cvt_pk_bf16_f32 v138, v108, v109
    v_cvt_pk_bf16_f32 v139, v110, v111
    v_exp_f32 v112, v112
    v_exp_f32 v113, v113
    v_exp_f32 v114, v114
    v_exp_f32 v115, v115
    v_mfma_f32_32x32x16_bf16 v[144:159], v[216:219], v[136:139], v[144:159]
    v_exp_f32 v116, v116
    v_exp_f32 v117, v117
    v_exp_f32 v118, v118
    v_exp_f32 v119, v119
    v_cvt_pk_bf16_f32 v140, v112, v113
    v_cvt_pk_bf16_f32 v141, v114, v115
    v_cvt_pk_bf16_f32 v142, v116, v117
    v_cvt_pk_bf16_f32 v143, v118, v119
    s_waitcnt vmcnt(4)
    v_mfma_f32_32x32x16_bf16 v[104:119], v[224:227], v[16:19], 0
    v_exp_f32 v120, v120
    v_exp_f32 v121, v121
    v_exp_f32 v122, v122
    v_exp_f32 v123, v123
    v_mfma_f32_32x32x16_bf16 v[144:159], v[220:223], v[140:143], v[144:159]
    v_exp_f32 v124, v124
    v_exp_f32 v125, v125
    v_exp_f32 v126, v126
    v_exp_f32 v127, v127
    v_mfma_f32_32x32x16_bf16 v[104:119], v[228:231], v[20:23], v[104:119]
    v_cvt_pk_bf16_f32 v136, v120, v121
    v_cvt_pk_bf16_f32 v137, v122, v123
    v_cvt_pk_bf16_f32 v138, v124, v125
    v_cvt_pk_bf16_f32 v139, v126, v127
    v_exp_f32 v128, v128
    v_exp_f32 v129, v129
    v_exp_f32 v130, v130
    v_exp_f32 v131, v131
    v_mfma_f32_32x32x16_bf16 v[160:175], v[216:219], v[136:139], v[160:175]
    v_exp_f32 v132, v132
    v_exp_f32 v133, v133
    v_exp_f32 v134, v134
    v_exp_f32 v135, v135
    v_cvt_pk_bf16_f32 v140, v128, v129
    v_cvt_pk_bf16_f32 v141, v130, v131
    v_cvt_pk_bf16_f32 v142, v132, v133
    v_cvt_pk_bf16_f32 v143, v134, v135
    v_mfma_f32_32x32x16_bf16 v[120:135], v[224:227], v[24:27], 0
    v_exp_f32 v104, v104
    v_exp_f32 v105, v105
    v_exp_f32 v106, v106
    v_exp_f32 v107, v107
    v_mfma_f32_32x32x16_bf16 v[160:175], v[220:223], v[140:143], v[160:175]
    buffer_load_dwordx4 v[208:211], v1, s[12:15], s67 offen sc1
    buffer_load_dwordx4 v[212:215], v1, s[12:15], s67 offen offset:1024 sc1
    buffer_load_dwordx4 v[216:219], v1, s[12:15], s68 offen sc1
    buffer_load_dwordx4 v[220:223], v1, s[12:15], s68 offen offset:1024 sc1
    s_add_u32 s67, s67, 8192
    s_add_u32 s68, s68, 8192
    v_exp_f32 v108, v108
    v_exp_f32 v109, v109
    v_exp_f32 v110, v110
    v_exp_f32 v111, v111
    v_mfma_f32_32x32x16_bf16 v[120:135], v[228:231], v[28:31], v[120:135]
    v_cvt_pk_bf16_f32 v136, v104, v105
    v_cvt_pk_bf16_f32 v137, v106, v107
    v_cvt_pk_bf16_f32 v138, v108, v109
    v_cvt_pk_bf16_f32 v139, v110, v111
    v_exp_f32 v112, v112
    v_exp_f32 v113, v113
    v_exp_f32 v114, v114
    v_exp_f32 v115, v115
    v_mfma_f32_32x32x16_bf16 v[144:159], v[232:235], v[136:139], v[144:159]
    v_exp_f32 v116, v116
    v_exp_f32 v117, v117
    v_exp_f32 v118, v118
    v_exp_f32 v119, v119
    v_cvt_pk_bf16_f32 v140, v112, v113
    v_cvt_pk_bf16_f32 v141, v114, v115
    v_cvt_pk_bf16_f32 v142, v116, v117
    v_cvt_pk_bf16_f32 v143, v118, v119
    s_waitcnt vmcnt(4)
    v_mfma_f32_32x32x16_bf16 v[104:119], v[240:243], v[16:19], 0
    v_exp_f32 v120, v120
    v_exp_f32 v121, v121
    v_exp_f32 v122, v122
    v_exp_f32 v123, v123
    v_mfma_f32_32x32x16_bf16 v[144:159], v[236:239], v[140:143], v[144:159]
    v_exp_f32 v124, v124
    v_exp_f32 v125, v125
    v_exp_f32 v126, v126
    v_exp_f32 v127, v127
    v_mfma_f32_32x32x16_bf16 v[104:119], v[244:247], v[20:23], v[104:119]
    v_cvt_pk_bf16_f32 v136, v120, v121
    v_cvt_pk_bf16_f32 v137, v122, v123
    v_cvt_pk_bf16_f32 v138, v124, v125
    v_cvt_pk_bf16_f32 v139, v126, v127
    v_exp_f32 v128, v128
    v_exp_f32 v129, v129
    v_exp_f32 v130, v130
    v_exp_f32 v131, v131
    v_mfma_f32_32x32x16_bf16 v[160:175], v[232:235], v[136:139], v[160:175]
    v_exp_f32 v132, v132
    v_exp_f32 v133, v133
    v_exp_f32 v134, v134
    v_exp_f32 v135, v135
    v_cvt_pk_bf16_f32 v140, v128, v129
    v_cvt_pk_bf16_f32 v141, v130, v131
    v_cvt_pk_bf16_f32 v142, v132, v133
    v_cvt_pk_bf16_f32 v143, v134, v135
    v_mfma_f32_32x32x16_bf16 v[120:135], v[240:243], v[24:27], 0
    v_exp_f32 v104, v104
    v_exp_f32 v105, v105
    v_exp_f32 v106, v106
    v_exp_f32 v107, v107
    v_mfma_f32_32x32x16_bf16 v[160:175], v[236:239], v[140:143], v[160:175]
    buffer_load_dwordx4 v[224:227], v1, s[12:15], s67 offen sc1
    buffer_load_dwordx4 v[228:231], v1, s[12:15], s67 offen offset:1024 sc1
    buffer_load_dwordx4 v[232:235], v1, s[12:15], s68 offen sc1
    buffer_load_dwordx4 v[236:239], v1, s[12:15], s68 offen offset:1024 sc1
    s_add_u32 s67, s67, 8192
    s_add_u32 s68, s68, 8192
    v_exp_f32 v108, v108
    v_exp_f32 v109, v109
    v_exp_f32 v110, v110
    v_exp_f32 v111, v111
    v_mfma_f32_32x32x16_bf16 v[120:135], v[244:247], v[28:31], v[120:135]
    v_cvt_pk_bf16_f32 v136, v104, v105
    v_cvt_pk_bf16_f32 v137, v106, v107
    v_cvt_pk_bf16_f32 v138, v108, v109
    v_cvt_pk_bf16_f32 v139, v110, v111
    v_exp_f32 v112, v112
    v_exp_f32 v113, v113
    v_exp_f32 v114, v114
    v_exp_f32 v115, v115
    v_mfma_f32_32x32x16_bf16 v[144:159], v[248:251], v[136:139], v[144:159]
    v_exp_f32 v116, v116
    v_exp_f32 v117, v117
    v_exp_f32 v118, v118
    v_exp_f32 v119, v119
    v_cvt_pk_bf16_f32 v140, v112, v113
    v_cvt_pk_bf16_f32 v141, v114, v115
    v_cvt_pk_bf16_f32 v142, v116, v117
    v_cvt_pk_bf16_f32 v143, v118, v119
    s_waitcnt vmcnt(4)
    v_mfma_f32_32x32x16_bf16 v[104:119], v[208:211], v[16:19], 0
    v_exp_f32 v120, v120
    v_exp_f32 v121, v121
    v_exp_f32 v122, v122
    v_exp_f32 v123, v123
    v_mfma_f32_32x32x16_bf16 v[144:159], v[252:255], v[140:143], v[144:159]
    v_exp_f32 v124, v124
    v_exp_f32 v125, v125
    v_exp_f32 v126, v126
    v_exp_f32 v127, v127
    v_mfma_f32_32x32x16_bf16 v[104:119], v[212:215], v[20:23], v[104:119]
    v_cvt_pk_bf16_f32 v136, v120, v121
    v_cvt_pk_bf16_f32 v137, v122, v123
    v_cvt_pk_bf16_f32 v138, v124, v125
    v_cvt_pk_bf16_f32 v139, v126, v127
    v_exp_f32 v128, v128
    v_exp_f32 v129, v129
    v_exp_f32 v130, v130
    v_exp_f32 v131, v131
    v_mfma_f32_32x32x16_bf16 v[160:175], v[248:251], v[136:139], v[160:175]
    v_exp_f32 v132, v132
    v_exp_f32 v133, v133
    v_exp_f32 v134, v134
    v_exp_f32 v135, v135
    v_cvt_pk_bf16_f32 v140, v128, v129
    v_cvt_pk_bf16_f32 v141, v130, v131
    v_cvt_pk_bf16_f32 v142, v132, v133
    v_cvt_pk_bf16_f32 v143, v134, v135
    v_mfma_f32_32x32x16_bf16 v[120:135], v[208:211], v[24:27], 0
    v_exp_f32 v104, v104
    v_exp_f32 v105, v105
    v_exp_f32 v106, v106
    v_exp_f32 v107, v107
    v_mfma_f32_32x32x16_bf16 v[160:175], v[252:255], v[140:143], v[160:175]
    buffer_load_dwordx4 v[240:243], v1, s[12:15], s67 offen sc1
    buffer_load_dwordx4 v[244:247], v1, s[12:15], s67 offen offset:1024 sc1
    buffer_load_dwordx4 v[248:251], v1, s[12:15], s68 offen sc1
    buffer_load_dwordx4 v[252:255], v1, s[12:15], s68 offen offset:1024 sc1
    s_add_u32 s67, s67, 8192
    s_add_u32 s68, s68, 8192
    v_exp_f32 v108, v108
    v_exp_f32 v109, v109
    v_exp_f32 v110, v110
    v_exp_f32 v111, v111
    v_mfma_f32_32x32x16_bf16 v[120:135], v[212:215], v[28:31], v[120:135]
    v_cvt_pk_bf16_f32 v136, v104, v105
    v_cvt_pk_bf16_f32 v137, v106, v107
    v_cvt_pk_bf16_f32 v138, v108, v109
    v_cvt_pk_bf16_f32 v139, v110, v111
    v_exp_f32 v112, v112
    v_exp_f32 v113, v113
    v_exp_f32 v114, v114
    v_exp_f32 v115, v115
    v_mfma_f32_32x32x16_bf16 v[144:159], v[216:219], v[136:139], v[144:159]
    v_exp_f32 v116, v116
    v_exp_f32 v117, v117
    v_exp_f32 v118, v118
    v_exp_f32 v119, v119
    v_cvt_pk_bf16_f32 v140, v112, v113
    v_cvt_pk_bf16_f32 v141, v114, v115
    v_cvt_pk_bf16_f32 v142, v116, v117
    v_cvt_pk_bf16_f32 v143, v118, v119
    s_waitcnt vmcnt(4)
    v_mfma_f32_32x32x16_bf16 v[104:119], v[224:227], v[16:19], 0
    v_exp_f32 v120, v120
    v_exp_f32 v121, v121
    v_exp_f32 v122, v122
    v_exp_f32 v123, v123
    v_mfma_f32_32x32x16_bf16 v[144:159], v[220:223], v[140:143], v[144:159]
    v_exp_f32 v124, v124
    v_exp_f32 v125, v125
    v_exp_f32 v126, v126
    v_exp_f32 v127, v127
    v_mfma_f32_32x32x16_bf16 v[104:119], v[228:231], v[20:23], v[104:119]
    v_cvt_pk_bf16_f32 v136, v120, v121
    v_cvt_pk_bf16_f32 v137, v122, v123
    v_cvt_pk_bf16_f32 v138, v124, v125
    v_cvt_pk_bf16_f32 v139, v126, v127
    v_exp_f32 v128, v128
    v_exp_f32 v129, v129
    v_exp_f32 v130, v130
    v_exp_f32 v131, v131
    v_mfma_f32_32x32x16_bf16 v[160:175], v[216:219], v[136:139], v[160:175]
    v_exp_f32 v132, v132
    v_exp_f32 v133, v133
    v_exp_f32 v134, v134
    v_exp_f32 v135, v135
    v_cvt_pk_bf16_f32 v140, v128, v129
    v_cvt_pk_bf16_f32 v141, v130, v131
    v_cvt_pk_bf16_f32 v142, v132, v133
    v_cvt_pk_bf16_f32 v143, v134, v135
    v_mfma_f32_32x32x16_bf16 v[120:135], v[224:227], v[24:27], 0
    v_exp_f32 v104, v104
    v_exp_f32 v105, v105
    v_exp_f32 v106, v106
    v_exp_f32 v107, v107
    v_mfma_f32_32x32x16_bf16 v[160:175], v[220:223], v[140:143], v[160:175]
    buffer_load_dwordx4 v[208:211], v1, s[12:15], s67 offen sc1
    buffer_load_dwordx4 v[212:215], v1, s[12:15], s67 offen offset:1024 sc1
    buffer_load_dwordx4 v[216:219], v1, s[12:15], s68 offen sc1
    buffer_load_dwordx4 v[220:223], v1, s[12:15], s68 offen offset:1024 sc1
    s_add_u32 s67, s67, 8192
    s_add_u32 s68, s68, 8192
    v_exp_f32 v108, v108
    v_exp_f32 v109, v109
    v_exp_f32 v110, v110
    v_exp_f32 v111, v111
    v_mfma_f32_32x32x16_bf16 v[120:135], v[228:231], v[28:31], v[120:135]
    v_cvt_pk_bf16_f32 v136, v104, v105
    v_cvt_pk_bf16_f32 v137, v106, v107
    v_cvt_pk_bf16_f32 v138, v108, v109
    v_cvt_pk_bf16_f32 v139, v110, v111
    v_exp_f32 v112, v112
    v_exp_f32 v113, v113
    v_exp_f32 v114, v114
    v_exp_f32 v115, v115
    v_mfma_f32_32x32x16_bf16 v[144:159], v[232:235], v[136:139], v[144:159]
    v_exp_f32 v116, v116
    v_exp_f32 v117, v117
    v_exp_f32 v118, v118
    v_exp_f32 v119, v119
    v_cvt_pk_bf16_f32 v140, v112, v113
    v_cvt_pk_bf16_f32 v141, v114, v115
    v_cvt_pk_bf16_f32 v142, v116, v117
    v_cvt_pk_bf16_f32 v143, v118, v119
    s_waitcnt vmcnt(4)
    v_mfma_f32_32x32x16_bf16 v[104:119], v[240:243], v[16:19], 0
    v_exp_f32 v120, v120
    v_exp_f32 v121, v121
    v_exp_f32 v122, v122
    v_exp_f32 v123, v123
    v_mfma_f32_32x32x16_bf16 v[144:159], v[236:239], v[140:143], v[144:159]
    v_exp_f32 v124, v124
    v_exp_f32 v125, v125
    v_exp_f32 v126, v126
    v_exp_f32 v127, v127
    v_mfma_f32_32x32x16_bf16 v[104:119], v[244:247], v[20:23], v[104:119]
    v_cvt_pk_bf16_f32 v136, v120, v121
    v_cvt_pk_bf16_f32 v137, v122, v123
    v_cvt_pk_bf16_f32 v138, v124, v125
    v_cvt_pk_bf16_f32 v139, v126, v127
    v_exp_f32 v128, v128
    v_exp_f32 v129, v129
    v_exp_f32 v130, v130
    v_exp_f32 v131, v131
    v_mfma_f32_32x32x16_bf16 v[160:175], v[232:235], v[136:139], v[160:175]
    v_exp_f32 v132, v132
    v_exp_f32 v133, v133
    v_exp_f32 v134, v134
    v_exp_f32 v135, v135
    v_cvt_pk_bf16_f32 v140, v128, v129
    v_cvt_pk_bf16_f32 v141, v130, v131
    v_cvt_pk_bf16_f32 v142, v132, v133
    v_cvt_pk_bf16_f32 v143, v134, v135
    v_mfma_f32_32x32x16_bf16 v[120:135], v[240:243], v[24:27], 0
    v_exp_f32 v104, v104
    v_exp_f32 v105, v105
    v_exp_f32 v106, v106
    v_exp_f32 v107, v107
    v_mfma_f32_32x32x16_bf16 v[160:175], v[236:239], v[140:143], v[160:175]
    buffer_load_dwordx4 v[224:227], v1, s[12:15], s67 offen sc1
    buffer_load_dwordx4 v[228:231], v1, s[12:15], s67 offen offset:1024 sc1
    buffer_load_dwordx4 v[232:235], v1, s[12:15], s68 offen sc1
    buffer_load_dwordx4 v[236:239], v1, s[12:15], s68 offen offset:1024 sc1
    s_add_u32 s67, s67, 8192
    s_add_u32 s68, s68, 8192
    v_exp_f32 v108, v108
    v_exp_f32 v109, v109
    v_exp_f32 v110, v110
    v_exp_f32 v111, v111
    v_mfma_f32_32x32x16_bf16 v[120:135], v[244:247], v[28:31], v[120:135]
    v_cvt_pk_bf16_f32 v136, v104, v105
    v_cvt_pk_bf16_f32 v137, v106, v107
    v_cvt_pk_bf16_f32 v138, v108, v109
    v_cvt_pk_bf16_f32 v139, v110, v111
    v_exp_f32 v112, v112
    v_exp_f32 v113, v113
    v_exp_f32 v114, v114
    v_exp_f32 v115, v115
    v_mfma_f32_32x32x16_bf16 v[144:159], v[248:251], v[136:139], v[144:159]
    v_exp_f32 v116, v116
    v_exp_f32 v117, v117
    v_exp_f32 v118, v118
    v_exp_f32 v119, v119
    v_cvt_pk_bf16_f32 v140, v112, v113
    v_cvt_pk_bf16_f32 v141, v114, v115
    v_cvt_pk_bf16_f32 v142, v116, v117
    v_cvt_pk_bf16_f32 v143, v118, v119
    s_waitcnt vmcnt(4)
    v_mfma_f32_32x32x16_bf16 v[104:119], v[208:211], v[16:19], 0
    v_exp_f32 v120, v120
    v_exp_f32 v121, v121
    v_exp_f32 v122, v122
    v_exp_f32 v123, v123
    v_mfma_f32_32x32x16_bf16 v[144:159], v[252:255], v[140:143], v[144:159]
    v_exp_f32 v124, v124
    v_exp_f32 v125, v125
    v_exp_f32 v126, v126
    v_exp_f32 v127, v127
    v_mfma_f32_32x32x16_bf16 v[104:119], v[212:215], v[20:23], v[104:119]
    v_cvt_pk_bf16_f32 v136, v120, v121
    v_cvt_pk_bf16_f32 v137, v122, v123
    v_cvt_pk_bf16_f32 v138, v124, v125
    v_cvt_pk_bf16_f32 v139, v126, v127
    v_exp_f32 v128, v128
    v_exp_f32 v129, v129
    v_exp_f32 v130, v130
    v_exp_f32 v131, v131
    v_mfma_f32_32x32x16_bf16 v[160:175], v[248:251], v[136:139], v[160:175]
    v_exp_f32 v132, v132
    v_exp_f32 v133, v133
    v_exp_f32 v134, v134
    v_exp_f32 v135, v135
    v_cvt_pk_bf16_f32 v140, v128, v129
    v_cvt_pk_bf16_f32 v141, v130, v131
    v_cvt_pk_bf16_f32 v142, v132, v133
    v_cvt_pk_bf16_f32 v143, v134, v135
    v_mfma_f32_32x32x16_bf16 v[120:135], v[208:211], v[24:27], 0
    v_exp_f32 v104, v104
    v_exp_f32 v105, v105
    v_exp_f32 v106, v106
    v_exp_f32 v107, v107
    v_mfma_f32_32x32x16_bf16 v[160:175], v[252:255], v[140:143], v[160:175]
    buffer_load_dwordx4 v[240:243], v1, s[12:15], s67 offen sc1
    buffer_load_dwordx4 v[244:247], v1, s[12:15], s67 offen offset:1024 sc1
    buffer_load_dwordx4 v[248:251], v1, s[12:15], s68 offen sc1
    buffer_load_dwordx4 v[252:255], v1, s[12:15], s68 offen offset:1024 sc1
    s_add_u32 s67, s67, 8192
    s_add_u32 s68, s68, 8192
    v_exp_f32 v108, v108
    v_exp_f32 v109, v109
    v_exp_f32 v110, v110
    v_exp_f32 v111, v111
    v_mfma_f32_32x32x16_bf16 v[120:135], v[212:215], v[28:31], v[120:135]
    v_cvt_pk_bf16_f32 v136, v104, v105
    v_cvt_pk_bf16_f32 v137, v106, v107
    v_cvt_pk_bf16_f32 v138, v108, v109
    v_cvt_pk_bf16_f32 v139, v110, v111
    v_exp_f32 v112, v112
    v_exp_f32 v113, v113
    v_exp_f32 v114, v114
    v_exp_f32 v115, v115
    v_mfma_f32_32x32x16_bf16 v[144:159], v[216:219], v[136:139], v[144:159]
    v_exp_f32 v116, v116
    v_exp_f32 v117, v117
    v_exp_f32 v118, v118
    v_exp_f32 v119, v119
    v_cvt_pk_bf16_f32 v140, v112, v113
    v_cvt_pk_bf16_f32 v141, v114, v115
    v_cvt_pk_bf16_f32 v142, v116, v117
    v_cvt_pk_bf16_f32 v143, v118, v119
    s_waitcnt vmcnt(4)
    v_mfma_f32_32x32x16_bf16 v[104:119], v[224:227], v[16:19], 0
    v_exp_f32 v120, v120
    v_exp_f32 v121, v121
    v_exp_f32 v122, v122
    v_exp_f32 v123, v123
    v_mfma_f32_32x32x16_bf16 v[144:159], v[220:223], v[140:143], v[144:159]
    v_exp_f32 v124, v124
    v_exp_f32 v125, v125
    v_exp_f32 v126, v126
    v_exp_f32 v127, v127
    v_mfma_f32_32x32x16_bf16 v[104:119], v[228:231], v[20:23], v[104:119]
    v_cvt_pk_bf16_f32 v136, v120, v121
    v_cvt_pk_bf16_f32 v137, v122, v123
    v_cvt_pk_bf16_f32 v138, v124, v125
    v_cvt_pk_bf16_f32 v139, v126, v127
    v_exp_f32 v128, v128
    v_exp_f32 v129, v129
    v_exp_f32 v130, v130
    v_exp_f32 v131, v131
    v_mfma_f32_32x32x16_bf16 v[160:175], v[216:219], v[136:139], v[160:175]
    v_exp_f32 v132, v132
    v_exp_f32 v133, v133
    v_exp_f32 v134, v134
    v_exp_f32 v135, v135
    v_cvt_pk_bf16_f32 v140, v128, v129
    v_cvt_pk_bf16_f32 v141, v130, v131
    v_cvt_pk_bf16_f32 v142, v132, v133
    v_cvt_pk_bf16_f32 v143, v134, v135
    v_mfma_f32_32x32x16_bf16 v[120:135], v[224:227], v[24:27], 0
    v_exp_f32 v104, v104
    v_exp_f32 v105, v105
    v_exp_f32 v106, v106
    v_exp_f32 v107, v107
    v_mfma_f32_32x32x16_bf16 v[160:175], v[220:223], v[140:143], v[160:175]
    s_cmp_lt_u32 s98, s96
    s_cbranch_scc1 Lgo_main_kernel_373
    s_mov_b32 s70, 2097152
    v_lshlrev_b32 v8, 3, v1
    v_and_b32 v8, 0x780, v8
Lgl_main_kernel_374:
    s_min_u32 s96, s96, 48
    s_lshl_b32 s97, s96, 7
    s_add_u32 s97, s97, 97714176
    s_mov_b64 exec, 0xffff
    buffer_load_dword v9, v8, s[12:15], s97 offen sc1
    s_mov_b64 exec, -1
    s_sub_u32 s70, s70, 1
    s_cbranch_scc1 Lexit_main_kernel
    s_waitcnt vmcnt(0)
    v_cmp_ne_u32 vcc, 4, v9
    s_nop 0
    s_or_b32 s97, vcc_lo, 0x10000
    s_ff1_i32_b32 s97, s97
    s_add_u32 s96, s96, s97
    s_cmp_eq_u32 s97, 16
    s_cselect_b32 s97, 1, 0
    s_cmp_ge_u32 s96, 64
    s_cselect_b32 s96, 0x100, s96
    s_cbranch_scc1 Lgo_main_kernel_373
    s_cmp_eq_u32 s97, 1
    s_cbranch_scc1 Lgl_main_kernel_374
    s_cmp_lt_u32 s98, s96
    s_cbranch_scc1 Lgo_main_kernel_373
    s_add_u32 s97, s96, 1
    s_cmp_gt_u32 s98, s97
    s_cbranch_scc1 Lgf_main_kernel_375
    s_sleep 1
    s_branch Lgl_main_kernel_374
Lgf_main_kernel_375:
    s_sleep 40
    s_branch Lgl_main_kernel_374
Lgo_main_kernel_373:
    s_add_u32 s98, s98, 4
    buffer_load_dwordx4 v[208:211], v1, s[12:15], s67 offen sc1
    buffer_load_dwordx4 v[212:215], v1, s[12:15], s67 offen offset:1024 sc1
    buffer_load_dwordx4 v[216:219], v1, s[12:15], s68 offen sc1
    buffer_load_dwordx4 v[220:223], v1, s[12:15], s68 offen offset:1024 sc1
    s_add_u32 s67, s67, 8192
    s_add_u32 s68, s68, 8192
    v_exp_f32 v108, v108
    v_exp_f32 v109, v109
    v_exp_f32 v110, v110
    v_exp_f32 v111, v111
    v_mfma_f32_32x32x16_bf16 v[120:135], v[228:231], v[28:31], v[120:135]
    v_cvt_pk_bf16_f32 v136, v104, v105
    v_cvt_pk_bf16_f32 v137, v106, v107
    v_cvt_pk_bf16_f32 v138, v108, v109
    v_cvt_pk_bf16_f32 v139, v110, v111
    v_exp_f32 v112, v112
    v_exp_f32 v113, v113
    v_exp_f32 v114, v114
    v_exp_f32 v115, v115
    v_mfma_f32_32x32x16_bf16 v[144:159], v[232:235], v[136:139], v[144:159]
    v_exp_f32 v116, v116
    v_exp_f32 v117, v117
    v_exp_f32 v118, v118
    v_exp_f32 v119, v119
    v_cvt_pk_bf16_f32 v140, v112, v113
    v_cvt_pk_bf16_f32 v141, v114, v115
    v_cvt_pk_bf16_f32 v142, v116, v117
    v_cvt_pk_bf16_f32 v143, v118, v119
    s_waitcnt vmcnt(4)
    v_mfma_f32_32x32x16_bf16 v[104:119], v[240:243], v[16:19], 0
    v_exp_f32 v120, v120
    v_exp_f32 v121, v121
    v_exp_f32 v122, v122
    v_exp_f32 v123, v123
    v_mfma_f32_32x32x16_bf16 v[144:159], v[236:239], v[140:143], v[144:159]
    v_exp_f32 v124, v124
    v_exp_f32 v125, v125
    v_exp_f32 v126, v126
    v_exp_f32 v127, v127
    v_mfma_f32_32x32x16_bf16 v[104:119], v[244:247], v[20:23], v[104:119]
    v_cvt_pk_bf16_f32 v136, v120, v121
    v_cvt_pk_bf16_f32 v137, v122, v123
    v_cvt_pk_bf16_f32 v138, v124, v125
    v_cvt_pk_bf16_f32 v139, v126, v127
    v_exp_f32 v128, v128
    v_exp_f32 v129, v129
    v_exp_f32 v130, v130
    v_exp_f32 v131, v131
    v_mfma_f32_32x32x16_bf16 v[160:175], v[232:235], v[136:139], v[160:175]
    v_exp_f32 v132, v132
    v_exp_f32 v133, v133
    v_exp_f32 v134, v134
    v_exp_f32 v135, v135
    v_cvt_pk_bf16_f32 v140, v128, v129
    v_cvt_pk_bf16_f32 v141, v130, v131
    v_cvt_pk_bf16_f32 v142, v132, v133
    v_cvt_pk_bf16_f32 v143, v134, v135
    v_mfma_f32_32x32x16_bf16 v[120:135], v[240:243], v[24:27], 0
    v_exp_f32 v104, v104
    v_exp_f32 v105, v105
    v_exp_f32 v106, v106
    v_exp_f32 v107, v107
    v_mfma_f32_32x32x16_bf16 v[160:175], v[236:239], v[140:143], v[160:175]
    s_cmp_lt_u32 s98, s96
    s_cbranch_scc1 Lgo_main_kernel_376
    s_mov_b32 s70, 2097152
    v_lshlrev_b32 v8, 3, v1
    v_and_b32 v8, 0x780, v8
Lgl_main_kernel_377:
    s_min_u32 s96, s96, 48
    s_lshl_b32 s97, s96, 7
    s_add_u32 s97, s97, 97714176
    s_mov_b64 exec, 0xffff
    buffer_load_dword v9, v8, s[12:15], s97 offen sc1
    s_mov_b64 exec, -1
    s_sub_u32 s70, s70, 1
    s_cbranch_scc1 Lexit_main_kernel
    s_waitcnt vmcnt(0)
    v_cmp_ne_u32 vcc, 4, v9
    s_nop 0
    s_or_b32 s97, vcc_lo, 0x10000
    s_ff1_i32_b32 s97, s97
    s_add_u32 s96, s96, s97
    s_cmp_eq_u32 s97, 16
    s_cselect_b32 s97, 1, 0
    s_cmp_ge_u32 s96, 64
    s_cselect_b32 s96, 0x100, s96
    s_cbranch_scc1 Lgo_main_kernel_376
    s_cmp_eq_u32 s97, 1
    s_cbranch_scc1 Lgl_main_kernel_377
    s_cmp_lt_u32 s98, s96
    s_cbranch_scc1 Lgo_main_kernel_376
    s_add_u32 s97, s96, 1
    s_cmp_gt_u32 s98, s97
    s_cbranch_scc1 Lgf_main_kernel_378
    s_sleep 1
    s_branch Lgl_main_kernel_377
Lgf_main_kernel_378:
    s_sleep 40
    s_branch Lgl_main_kernel_377
Lgo_main_kernel_376:
    s_add_u32 s98, s98, 4
    buffer_load_dwordx4 v[224:227], v1, s[12:15], s67 offen sc1
    buffer_load_dwordx4 v[228:231], v1, s[12:15], s67 offen offset:1024 sc1
    buffer_load_dwordx4 v[232:235], v1, s[12:15], s68 offen sc1
    buffer_load_dwordx4 v[236:239], v1, s[12:15], s68 offen offset:1024 sc1
    s_add_u32 s67, s67, 8192
    s_add_u32 s68, s68, 8192
    v_exp_f32 v108, v108
    v_exp_f32 v109, v109
    v_exp_f32 v110, v110
    v_exp_f32 v111, v111
    v_mfma_f32_32x32x16_bf16 v[120:135], v[244:247], v[28:31], v[120:135]
    v_cvt_pk_bf16_f32 v136, v104, v105
    v_cvt_pk_bf16_f32 v137, v106, v107
    v_cvt_pk_bf16_f32 v138, v108, v109
    v_cvt_pk_bf16_f32 v139, v110, v111
    v_exp_f32 v112, v112
    v_exp_f32 v113, v113
    v_exp_f32 v114, v114
    v_exp_f32 v115, v115
    v_mfma_f32_32x32x16_bf16 v[144:159], v[248:251], v[136:139], v[144:159]
    v_exp_f32 v116, v116
    v_exp_f32 v117, v117
    v_exp_f32 v118, v118
    v_exp_f32 v119, v119
    v_cvt_pk_bf16_f32 v140, v112, v113
    v_cvt_pk_bf16_f32 v141, v114, v115
    v_cvt_pk_bf16_f32 v142, v116, v117
    v_cvt_pk_bf16_f32 v143, v118, v119
    s_waitcnt vmcnt(4)
    v_mfma_f32_32x32x16_bf16 v[104:119], v[208:211], v[16:19], 0
    v_exp_f32 v120, v120
    v_exp_f32 v121, v121
    v_exp_f32 v122, v122
    v_exp_f32 v123, v123
    v_mfma_f32_32x32x16_bf16 v[144:159], v[252:255], v[140:143], v[144:159]
    v_exp_f32 v124, v124
    v_exp_f32 v125, v125
    v_exp_f32 v126, v126
    v_exp_f32 v127, v127
    v_mfma_f32_32x32x16_bf16 v[104:119], v[212:215], v[20:23], v[104:119]
    v_cvt_pk_bf16_f32 v136, v120, v121
    v_cvt_pk_bf16_f32 v137, v122, v123
    v_cvt_pk_bf16_f32 v138, v124, v125
    v_cvt_pk_bf16_f32 v139, v126, v127
    v_exp_f32 v128, v128
    v_exp_f32 v129, v129
    v_exp_f32 v130, v130
    v_exp_f32 v131, v131
    v_mfma_f32_32x32x16_bf16 v[160:175], v[248:251], v[136:139], v[160:175]
    v_exp_f32 v132, v132
    v_exp_f32 v133, v133
    v_exp_f32 v134, v134
    v_exp_f32 v135, v135
    v_cvt_pk_bf16_f32 v140, v128, v129
    v_cvt_pk_bf16_f32 v141, v130, v131
    v_cvt_pk_bf16_f32 v142, v132, v133
    v_cvt_pk_bf16_f32 v143, v134, v135
    v_mfma_f32_32x32x16_bf16 v[120:135], v[208:211], v[24:27], 0
    v_exp_f32 v104, v104
    v_exp_f32 v105, v105
    v_exp_f32 v106, v106
    v_exp_f32 v107, v107
    v_mfma_f32_32x32x16_bf16 v[160:175], v[252:255], v[140:143], v[160:175]
    s_cmp_lt_u32 s98, s96
    s_cbranch_scc1 Lgo_main_kernel_379
    s_mov_b32 s70, 2097152
    v_lshlrev_b32 v8, 3, v1
    v_and_b32 v8, 0x780, v8
Lgl_main_kernel_380:
    s_min_u32 s96, s96, 48
    s_lshl_b32 s97, s96, 7
    s_add_u32 s97, s97, 97714176
    s_mov_b64 exec, 0xffff
    buffer_load_dword v9, v8, s[12:15], s97 offen sc1
    s_mov_b64 exec, -1
    s_sub_u32 s70, s70, 1
    s_cbranch_scc1 Lexit_main_kernel
    s_waitcnt vmcnt(0)
    v_cmp_ne_u32 vcc, 4, v9
    s_nop 0
    s_or_b32 s97, vcc_lo, 0x10000
    s_ff1_i32_b32 s97, s97
    s_add_u32 s96, s96, s97
    s_cmp_eq_u32 s97, 16
    s_cselect_b32 s97, 1, 0
    s_cmp_ge_u32 s96, 64
    s_cselect_b32 s96, 0x100, s96
    s_cbranch_scc1 Lgo_main_kernel_379
    s_cmp_eq_u32 s97, 1
    s_cbranch_scc1 Lgl_main_kernel_380
    s_cmp_lt_u32 s98, s96
    s_cbranch_scc1 Lgo_main_kernel_379
    s_add_u32 s97, s96, 1
    s_cmp_gt_u32 s98, s97
    s_cbranch_scc1 Lgf_main_kernel_381
    s_sleep 1
    s_branch Lgl_main_kernel_380
Lgf_main_kernel_381:
    s_sleep 40
    s_branch Lgl_main_kernel_380
Lgo_main_kernel_379:
    s_add_u32 s98, s98, 4
    buffer_load_dwordx4 v[240:243], v1, s[12:15], s67 offen sc1
    buffer_load_dwordx4 v[244:247], v1, s[12:15], s67 offen offset:1024 sc1
    buffer_load_dwordx4 v[248:251], v1, s[12:15], s68 offen sc1
    buffer_load_dwordx4 v[252:255], v1, s[12:15], s68 offen offset:1024 sc1
    s_add_u32 s67, s67, 8192
    s_add_u32 s68, s68, 8192
    v_exp_f32 v108, v108
    v_exp_f32 v109, v109
    v_exp_f32 v110, v110
    v_exp_f32 v111, v111
    v_mfma_f32_32x32x16_bf16 v[120:135], v[212:215], v[28:31], v[120:135]
    v_cvt_pk_bf16_f32 v136, v104, v105
    v_cvt_pk_bf16_f32 v137, v106, v107
    v_cvt_pk_bf16_f32 v138, v108, v109
    v_cvt_pk_bf16_f32 v139, v110, v111
    v_exp_f32 v112, v112
    v_exp_f32 v113, v113
    v_exp_f32 v114, v114
    v_exp_f32 v115, v115
    v_mfma_f32_32x32x16_bf16 v[144:159], v[216:219], v[136:139], v[144:159]
    v_exp_f32 v116, v116
    v_exp_f32 v117, v117
    v_exp_f32 v118, v118
    v_exp_f32 v119, v119
    v_cvt_pk_bf16_f32 v140, v112, v113
    v_cvt_pk_bf16_f32 v141, v114, v115
    v_cvt_pk_bf16_f32 v142, v116, v117
    v_cvt_pk_bf16_f32 v143, v118, v119
    s_waitcnt vmcnt(4)
    v_mfma_f32_32x32x16_bf16 v[104:119], v[224:227], v[16:19], 0
    v_exp_f32 v120, v120
    v_exp_f32 v121, v121
    v_exp_f32 v122, v122
    v_exp_f32 v123, v123
    v_mfma_f32_32x32x16_bf16 v[144:159], v[220:223], v[140:143], v[144:159]
    v_exp_f32 v124, v124
    v_exp_f32 v125, v125
    v_exp_f32 v126, v126
    v_exp_f32 v127, v127
    v_mfma_f32_32x32x16_bf16 v[104:119], v[228:231], v[20:23], v[104:119]
    v_cvt_pk_bf16_f32 v136, v120, v121
    v_cvt_pk_bf16_f32 v137, v122, v123
    v_cvt_pk_bf16_f32 v138, v124, v125
    v_cvt_pk_bf16_f32 v139, v126, v127
    v_exp_f32 v128, v128
    v_exp_f32 v129, v129
    v_exp_f32 v130, v130
    v_exp_f32 v131, v131
    v_mfma_f32_32x32x16_bf16 v[160:175], v[216:219], v[136:139], v[160:175]
    v_exp_f32 v132, v132
    v_exp_f32 v133, v133
    v_exp_f32 v134, v134
    v_exp_f32 v135, v135
    v_cvt_pk_bf16_f32 v140, v128, v129
    v_cvt_pk_bf16_f32 v141, v130, v131
    v_cvt_pk_bf16_f32 v142, v132, v133
    v_cvt_pk_bf16_f32 v143, v134, v135
    v_mfma_f32_32x32x16_bf16 v[120:135], v[224:227], v[24:27], 0
    v_exp_f32 v104, v104
    v_exp_f32 v105, v105
    v_exp_f32 v106, v106
    v_exp_f32 v107, v107
    v_mfma_f32_32x32x16_bf16 v[160:175], v[220:223], v[140:143], v[160:175]
    buffer_load_dwordx4 v[208:211], v1, s[12:15], s67 offen sc1
    buffer_load_dwordx4 v[212:215], v1, s[12:15], s67 offen offset:1024 sc1
    buffer_load_dwordx4 v[216:219], v1, s[12:15], s68 offen sc1
    buffer_load_dwordx4 v[220:223], v1, s[12:15], s68 offen offset:1024 sc1
    v_exp_f32 v108, v108
    v_exp_f32 v109, v109
    v_exp_f32 v110, v110
    v_exp_f32 v111, v111
    v_mfma_f32_32x32x16_bf16 v[120:135], v[228:231], v[28:31], v[120:135]
    v_cvt_pk_bf16_f32 v136, v104, v105
    v_cvt_pk_bf16_f32 v137, v106, v107
    v_cvt_pk_bf16_f32 v138, v108, v109
    v_cvt_pk_bf16_f32 v139, v110, v111
    v_exp_f32 v112, v112
    v_exp_f32 v113, v113
    v_exp_f32 v114, v114
    v_exp_f32 v115, v115
    v_mfma_f32_32x32x16_bf16 v[144:159], v[232:235], v[136:139], v[144:159]
    v_exp_f32 v116, v116
    v_exp_f32 v117, v117
    v_exp_f32 v118, v118
    v_exp_f32 v119, v119
    v_cvt_pk_bf16_f32 v140, v112, v113
    v_cvt_pk_bf16_f32 v141, v114, v115
    v_cvt_pk_bf16_f32 v142, v116, v117
    v_cvt_pk_bf16_f32 v143, v118, v119
    s_waitcnt vmcnt(4)
    v_mfma_f32_32x32x16_bf16 v[104:119], v[240:243], v[16:19], 0
    v_exp_f32 v120, v120
    v_exp_f32 v121, v121
    v_exp_f32 v122, v122
    v_exp_f32 v123, v123
    v_mfma_f32_32x32x16_bf16 v[144:159], v[236:239], v[140:143], v[144:159]
    v_exp_f32 v124, v124
    v_exp_f32 v125, v125
    v_exp_f32 v126, v126
    v_exp_f32 v127, v127
    v_mfma_f32_32x32x16_bf16 v[104:119], v[244:247], v[20:23], v[104:119]
    v_cvt_pk_bf16_f32 v136, v120, v121
    v_cvt_pk_bf16_f32 v137, v122, v123
    v_cvt_pk_bf16_f32 v138, v124, v125
    v_cvt_pk_bf16_f32 v139, v126, v127
    v_exp_f32 v128, v128
    v_exp_f32 v129, v129
    v_exp_f32 v130, v130
    v_exp_f32 v131, v131
    v_mfma_f32_32x32x16_bf16 v[160:175], v[232:235], v[136:139], v[160:175]
    v_exp_f32 v132, v132
    v_exp_f32 v133, v133
    v_exp_f32 v134, v134
    v_exp_f32 v135, v135
    v_cvt_pk_bf16_f32 v140, v128, v129
    v_cvt_pk_bf16_f32 v141, v130, v131
    v_cvt_pk_bf16_f32 v142, v132, v133
    v_cvt_pk_bf16_f32 v143, v134, v135
    v_mfma_f32_32x32x16_bf16 v[120:135], v[240:243], v[24:27], 0
    v_exp_f32 v104, v104
    v_exp_f32 v105, v105
    v_exp_f32 v106, v106
    v_exp_f32 v107, v107
    v_mfma_f32_32x32x16_bf16 v[160:175], v[236:239], v[140:143], v[160:175]
    v_exp_f32 v108, v108
    v_exp_f32 v109, v109
    v_exp_f32 v110, v110
    v_exp_f32 v111, v111
    v_mfma_f32_32x32x16_bf16 v[120:135], v[244:247], v[28:31], v[120:135]
    v_cvt_pk_bf16_f32 v136, v104, v105
    v_cvt_pk_bf16_f32 v137, v106, v107
    v_cvt_pk_bf16_f32 v138, v108, v109
    v_cvt_pk_bf16_f32 v139, v110, v111
    v_exp_f32 v112, v112
    v_exp_f32 v113, v113
    v_exp_f32 v114, v114
    v_exp_f32 v115, v115
    v_mfma_f32_32x32x16_bf16 v[144:159], v[248:251], v[136:139], v[144:159]
    v_exp_f32 v116, v116
    v_exp_f32 v117, v117
    v_exp_f32 v118, v118
    v_exp_f32 v119, v119
    v_cvt_pk_bf16_f32 v140, v112, v113
    v_cvt_pk_bf16_f32 v141, v114, v115
    v_cvt_pk_bf16_f32 v142, v116, v117
    v_cvt_pk_bf16_f32 v143, v118, v119
    s_mov_b32 s70, 2097152
    s_branch Lkc_main_kernel_383
Lkd_main_kernel_382:
    buffer_load_dwordx4 v[208:211], v1, s[12:15], s67 offen offset:0 sc1
    buffer_load_dwordx4 v[212:215], v1, s[12:15], s67 offen offset:1024 sc1
    buffer_load_dwordx4 v[216:219], v1, s[12:15], s68 offen offset:0 sc1
    buffer_load_dwordx4 v[220:223], v1, s[12:15], s68 offen offset:1024 sc1
    s_sub_u32 s70, s70, 1
    s_cbranch_scc1 Lexit_main_kernel
Lkc_main_kernel_383:
    s_waitcnt vmcnt(0)
    v_max3_u32 v8, v208, v209, v210
    v_max3_u32 v8, v8, v211, v212
    v_max3_u32 v8, v8, v213, v214
    v_max3_u32 v8, v8, v215, v216
    v_max3_u32 v8, v8, v217, v218
    v_max3_u32 v8, v8, v219, v220
    v_max3_u32 v8, v8, v221, v222
    v_max_u32 v8, v8, v223
    v_cmp_eq_u32 vcc, -1, v8
    s_cbranch_vccnz Lkd_main_kernel_382
    v_mfma_f32_32x32x16_bf16 v[104:119], v[208:211], v[16:19], 0
    v_exp_f32 v120, v120
    v_exp_f32 v121, v121
    v_exp_f32 v122, v122
    v_exp_f32 v123, v123
    v_mfma_f32_32x32x16_bf16 v[144:159], v[252:255], v[140:143], v[144:159]
    v_exp_f32 v124, v124
    v_exp_f32 v125, v125
    v_exp_f32 v126, v126
    v_exp_f32 v127, v127
    v_mfma_f32_32x32x16_bf16 v[104:119], v[212:215], v[20:23], v[104:119]
    v_cvt_pk_bf16_f32 v136, v120, v121
    v_cvt_pk_bf16_f32 v137, v122, v123
    v_cvt_pk_bf16_f32 v138, v124, v125
    v_cvt_pk_bf16_f32 v139, v126, v127
    v_exp_f32 v128, v128
    v_exp_f32 v129, v129
    v_exp_f32 v130, v130
    v_exp_f32 v131, v131
    v_mfma_f32_32x32x16_bf16 v[160:175], v[248:251], v[136:139], v[160:175]
    v_exp_f32 v132, v132
    v_exp_f32 v133, v133
    v_exp_f32 v134, v134
    v_exp_f32 v135, v135
    v_cvt_pk_bf16_f32 v140, v128, v129
    v_cvt_pk_bf16_f32 v141, v130, v131
    v_cvt_pk_bf16_f32 v142, v132, v133
    v_cvt_pk_bf16_f32 v143, v134, v135
    v_mfma_f32_32x32x16_bf16 v[120:135], v[208:211], v[24:27], 0
    v_exp_f32 v104, v104
    v_exp_f32 v105, v105
    v_exp_f32 v106, v106
    v_exp_f32 v107, v107
    v_mfma_f32_32x32x16_bf16 v[160:175], v[252:255], v[140:143], v[160:175]
    v_exp_f32 v108, v108
    v_exp_f32 v109, v109
    v_exp_f32 v110, v110
    v_exp_f32 v111, v111
    v_mfma_f32_32x32x16_bf16 v[120:135], v[212:215], v[28:31], v[120:135]
    v_cvt_pk_bf16_f32 v136, v104, v105
    v_cvt_pk_bf16_f32 v137, v106, v107
    v_cvt_pk_bf16_f32 v138, v108, v109
    v_cvt_pk_bf16_f32 v139, v110, v111
    v_exp_f32 v112, v112
    v_exp_f32 v113, v113
    v_exp_f32 v114, v114
    v_exp_f32 v115, v115
    v_mfma_f32_32x32x16_bf16 v[144:159], v[216:219], v[136:139], v[144:159]
    v_exp_f32 v116, v116
    v_exp_f32 v117, v117
    v_exp_f32 v118, v118
    v_exp_f32 v119, v119
    v_cvt_pk_bf16_f32 v140, v112, v113
    v_cvt_pk_bf16_f32 v141, v114, v115
    v_cvt_pk_bf16_f32 v142, v116, v117
    v_cvt_pk_bf16_f32 v143, v118, v119
    v_exp_f32 v120, v120
    v_exp_f32 v121, v121
    v_exp_f32 v122, v122
    v_exp_f32 v123, v123
    v_mfma_f32_32x32x16_bf16 v[144:159], v[220:223], v[140:143], v[144:159]
    v_exp_f32 v124, v124
    v_exp_f32 v125, v125
    v_exp_f32 v126, v126
    v_exp_f32 v127, v127
    v_cvt_pk_bf16_f32 v136, v120, v121
    v_cvt_pk_bf16_f32 v137, v122, v123
    v_cvt_pk_bf16_f32 v138, v124, v125
    v_cvt_pk_bf16_f32 v139, v126, v127
    v_exp_f32 v128, v128
    v_exp_f32 v129, v129
    v_exp_f32 v130, v130
    v_exp_f32 v131, v131
    v_mfma_f32_32x32x16_bf16 v[160:175], v[216:219], v[136:139], v[160:175]
    v_exp_f32 v132, v132
    v_exp_f32 v133, v133
    v_exp_f32 v134, v134
    v_exp_f32 v135, v135
    v_cvt_pk_bf16_f32 v140, v128, v129
    v_cvt_pk_bf16_f32 v141, v130, v131
    v_cvt_pk_bf16_f32 v142, v132, v133
    v_cvt_pk_bf16_f32 v143, v134, v135
    s_nop 1
    v_mfma_f32_32x32x16_bf16 v[160:175], v[220:223], v[140:143], v[160:175]
LBr_main_kernel_384:
    s_mul_i32 s46, s3, 8192
    s_add_u32 s46, s46, 36864
    v_add_u32 v7, s46, v1
    ds_write_b128 v7, v[144:147] offset:0
    ds_write_b128 v7, v[148:151] offset:1024
    ds_write_b128 v7, v[152:155] offset:2048
    ds_write_b128 v7, v[156:159] offset:3072
    s_nop 4
    ds_write_b128 v7, v[160:163] offset:4096
    ds_write_b128 v7, v[164:167] offset:5120
    ds_write_b128 v7, v[168:171] offset:6144
    ds_write_b128 v7, v[172:175] offset:7168
    s_waitcnt lgkmcnt(0)
    s_barrier
    v_lshrrev_b32 v8, 5, v0
    v_bfe_u32 v5, v0, 4, 1
    v_mul_u32_u24 v5, 912, v5
    v_mul_u32_u24 v10, 56, v2
    v_add_u32 v5, v5, v10
    v_lshl_add_u32 v5, v8, 3, v5
    v_mov_b32 v11, 30976
    v_cmp_eq_u32 s[74:75], 1, v8
    s_mov_b32 s46, s3
    s_cmp_ge_u32 s46, 2
    s_cbranch_scc1 L_main_kernel_387
    s_lshl_b32 s47, s46, 12
    s_add_u32 s47, s47, 36864
    v_add_u32 v7, s47, v1
    ds_read_b128 v[16:19], v7 offset:0
    ds_read_b128 v[20:23], v7 offset:1024
    ds_read_b128 v[24:27], v7 offset:2048
    ds_read_b128 v[28:31], v7 offset:3072
    v_add_u32 v7, 8192, v7
    ds_read_b128 v[32:35], v7 offset:0
    ds_read_b128 v[36:39], v7 offset:1024
    ds_read_b128 v[40:43], v7 offset:2048
    ds_read_b128 v[44:47], v7 offset:3072
    v_add_u32 v7, 8192, v7
    ds_read_b128 v[48:51], v7 offset:0
    ds_read_b128 v[52:55], v7 offset:1024
    ds_read_b128 v[56:59], v7 offset:2048
    ds_read_b128 v[60:63], v7 offset:3072
    s_waitcnt lgkmcnt(4)
    v_add_u32 v7, 8192, v7
    ds_read_b128 v[64:67], v7 offset:0
    ds_read_b128 v[68:71], v7 offset:1024
    ds_read_b128 v[72:75], v7 offset:2048
    ds_read_b128 v[76:79], v7 offset:3072
    v_pk_add_f32 v[16:17], v[16:17], v[32:33]
    v_pk_add_f32 v[18:19], v[18:19], v[34:35]
    v_pk_add_f32 v[20:21], v[20:21], v[36:37]
    v_pk_add_f32 v[22:23], v[22:23], v[38:39]
    v_pk_add_f32 v[24:25], v[24:25], v[40:41]
    v_pk_add_f32 v[26:27], v[26:27], v[42:43]
    v_pk_add_f32 v[28:29], v[28:29], v[44:45]
    v_pk_add_f32 v[30:31], v[30:31], v[46:47]
    s_waitcnt lgkmcnt(0)
    v_pk_add_f32 v[48:49], v[48:49], v[64:65]
    v_pk_add_f32 v[50:51], v[50:51], v[66:67]
    v_pk_add_f32 v[52:53], v[52:53], v[68:69]
    v_pk_add_f32 v[54:55], v[54:55], v[70:71]
    v_pk_add_f32 v[56:57], v[56:57], v[72:73]
    v_pk_add_f32 v[58:59], v[58:59], v[74:75]
    v_pk_add_f32 v[60:61], v[60:61], v[76:77]
    v_pk_add_f32 v[62:63], v[62:63], v[78:79]
    v_pk_add_f32 v[16:17], v[16:17], v[48:49]
    v_pk_add_f32 v[18:19], v[18:19], v[50:51]
    v_pk_add_f32 v[20:21], v[20:21], v[52:53]
    v_pk_add_f32 v[22:23], v[22:23], v[54:55]
    v_pk_add_f32 v[24:25], v[24:25], v[56:57]
    v_pk_add_f32 v[26:27], v[26:27], v[58:59]
    v_pk_add_f32 v[28:29], v[28:29], v[60:61]
    v_pk_add_f32 v[30:31], v[30:31], v[62:63]
    v_mov_b32 v12, v28
    v_mov_b32 v13, v28
    s_nop 1
    v_permlane32_swap_b32 v12, v13
    s_nop 0
    v_cmp_nle_f32 vcc, 0x21800000, v13
    v_mov_b32 v12, 0x5d800000
    v_cmp_nle_f32 s[76:77], v13, v12
    s_nop 0
    s_or_b64 vcc, vcc, s[76:77]
    s_cbranch_vccz L_main_kernel_388
    v_mov_b32 v12, 36608
    v_mov_b32 v15, 1
    ds_write_b32 v12, v15
L_main_kernel_388:
    v_rcp_f32 v13, v13
    s_mul_i32 s47, s46, 1824
    s_add_u32 s47, s47, 16384
    v_add_u32 v10, s47, v5
    v_mul_f32 v16, v16, v13
    v_mul_f32 v17, v17, v13
    v_mul_f32 v18, v18, v13
    v_mul_f32 v19, v19, v13
    v_cvt_pk_bf16_f32 v16, v16, v17
    v_cvt_pk_bf16_f32 v17, v18, v19
    ds_write_b64 v10, v[16:17] offset:0
    v_mul_f32 v20, v20, v13
    v_mul_f32 v21, v21, v13
    v_mul_f32 v22, v22, v13
    v_mul_f32 v23, v23, v13
    v_cvt_pk_bf16_f32 v20, v20, v21
    v_cvt_pk_bf16_f32 v21, v22, v23
    ds_write_b64 v10, v[20:21] offset:16
    v_mul_f32 v24, v24, v13
    v_mul_f32 v25, v25, v13
    v_mul_f32 v26, v26, v13
    v_mul_f32 v27, v27, v13
    v_cvt_pk_bf16_f32 v24, v24, v25
    v_cvt_pk_bf16_f32 v25, v26, v27
    ds_write_b64 v10, v[24:25] offset:32
    v_mul_f32 v28, v28, v13
    v_mul_f32 v29, v29, v13
    v_mul_f32 v30, v30, v13
    v_mul_f32 v31, v31, v13
    v_cvt_pk_bf16_f32 v28, v28, v29
    v_cvt_pk_bf16_f32 v29, v30, v31
    v_add_u32 v10, 48, v10
    v_cndmask_b32 v10, v10, v11, s[74:75]
    ds_write_b64 v10, v[28:29]
L_main_kernel_387:
    s_waitcnt lgkmcnt(0)
    s_barrier
    v_mov_b32 v12, 36608
    ds_read_b32 v12, v12
    s_waitcnt lgkmcnt(0)
    v_readfirstlane_b32 s46, v12
    s_nop 0
    s_andn2_b32 s46, s46, s78
    s_cmp_eq_u32 s46, 1
    s_cbranch_scc1 LBs_main_kernel_385
    s_mul_i32 s46, s3, 912
    s_add_u32 s46, s46, 16384
    v_add_u32 v7, s46, v1
    ds_read_b128 v[16:19], v7 offset:0
    s_sub_u32 s46, s61, 1792
    s_add_u32 s47, s46, s3
    s_mul_i32 s47, s47, 896
    s_add_u32 s47, s47, 97411072
    v_mov_b32 v8, 0x7fffffff
    v_cmp_gt_u32 vcc, 56, v0
    s_nop 1
    v_cndmask_b32 v8, v8, v1, vcc
    s_waitcnt lgkmcnt(0)
    v_min_u32 v16, -2, v16
    v_min_u32 v17, -2, v17
    v_min_u32 v18, -2, v18
    v_min_u32 v19, -2, v19
    buffer_store_dwordx4 v[16:19], v8, s[12:15], s47 offen offset:0 sc1
    s_branch LBf_main_kernel_386
LBs_main_kernel_385:
    s_waitcnt vmcnt(0) lgkmcnt(0)
    s_barrier
    s_mov_b32 s78, 1
    ds_read_b128 v[16:19], v6 offset:0
    ds_read_b128 v[20:23], v6 offset:32
    ds_read_b128 v[24:27], v6 offset:2048
    ds_read_b128 v[28:31], v6 offset:2080
    v_mov_b32 v120, 0xff61b1e6
    v_mov_b32 v121, 0xff61b1e6
    s_mov_b32 s67, s65
    s_mov_b32 s68, s66
    s_mov_b32 s70, 16
LM_main_kernel_389:
    buffer_load_dwordx4 v[208:211], v1, s[12:15], s67 offen sc1
    buffer_load_dwordx4 v[212:215], v1, s[12:15], s67 offen offset:1024 sc1
    buffer_load_dwordx4 v[216:219], v1, s[12:15], s68 offen sc1
    buffer_load_dwordx4 v[220:223], v1, s[12:15], s68 offen offset:1024 sc1
    s_add_u32 s67, s67, 8192
    s_add_u32 s68, s68, 8192
    s_waitcnt vmcnt(0) lgkmcnt(0)
    v_mfma_f32_32x32x16_bf16 v[104:119], v[208:211], v[16:19], 0
    v_mfma_f32_32x32x16_bf16 v[104:119], v[212:215], v[20:23], v[104:119]
    s_nop 11
    v_max3_f32 v120, v120, v104, v105
    v_max3_f32 v120, v120, v106, v107
    v_max3_f32 v120, v120, v108, v109
    v_max3_f32 v120, v120, v110, v111
    v_max3_f32 v120, v120, v112, v113
    v_max3_f32 v120, v120, v114, v115
    v_max3_f32 v120, v120, v116, v117
    v_max3_f32 v120, v120, v118, v119
    v_mfma_f32_32x32x16_bf16 v[104:119], v[208:211], v[24:27], 0
    v_mfma_f32_32x32x16_bf16 v[104:119], v[212:215], v[28:31], v[104:119]
    s_nop 11
    v_max3_f32 v121, v121, v104, v105
    v_max3_f32 v121, v121, v106, v107
    v_max3_f32 v121, v121, v108, v109
    v_max3_f32 v121, v121, v110, v111
    v_max3_f32 v121, v121, v112, v113
    v_max3_f32 v121, v121, v114, v115
    v_max3_f32 v121, v121, v116, v117
    v_max3_f32 v121, v121, v118, v119
    s_sub_u32 s70, s70, 1
    s_cmp_lg_u32 s70, 0
    s_cbranch_scc1 LM_main_kernel_389
    v_and_b32 v7, 31, v0
    v_lshlrev_b32 v7, 2, v7
    s_lshl_b32 s46, s3, 10
    v_add_u32 v12, s46, v7
    v_mov_b32 v13, v120
    s_nop 1
    v_permlane32_swap_b32 v120, v13
    s_nop 0
    v_max_f32 v120, v120, v13
    ds_write_b32 v12, v120 offset:32512
    v_mov_b32 v13, v121
    s_nop 1
    v_permlane32_swap_b32 v121, v13
    s_nop 0
    v_max_f32 v121, v121, v13
    ds_write_b32 v12, v121 offset:32640
    s_waitcnt lgkmcnt(0)
    s_barrier
    ds_read_b32 v104, v7 offset:32512
    ds_read_b32 v105, v7 offset:33536
    ds_read_b32 v106, v7 offset:34560
    ds_read_b32 v107, v7 offset:35584
    s_waitcnt lgkmcnt(0)
    v_max3_f32 v120, v104, v105, v106
    v_max_f32 v120, v120, v107
    ds_read_b32 v104, v7 offset:32640
    ds_read_b32 v105, v7 offset:33664
    ds_read_b32 v106, v7 offset:34688
    ds_read_b32 v107, v7 offset:35712
    s_waitcnt lgkmcnt(0)
    v_max3_f32 v121, v104, v105, v106
    v_max_f32 v121, v121, v107
    v_mov_b64 v[144:145], 0
    v_mov_b64 v[146:147], 0
    v_mov_b64 v[148:149], 0
    v_mov_b64 v[150:151], 0
    v_mov_b64 v[152:153], 0
    v_mov_b64 v[154:155], 0
    v_mov_b64 v[156:157], 0
    v_mov_b64 v[158:159], 0
    v_mov_b64 v[160:161], 0
    v_mov_b64 v[162:163], 0
    v_mov_b64 v[164:165], 0
    v_mov_b64 v[166:167], 0
    v_mov_b64 v[168:169], 0
    v_mov_b64 v[170:171], 0
    v_mov_b64 v[172:173], 0
    v_mov_b64 v[174:175], 0
    s_mov_b32 s67, s65
    s_mov_b32 s68, s66
    s_mov_b32 s70, 16
LK_main_kernel_390:
    buffer_load_dwordx4 v[208:211], v1, s[12:15], s67 offen sc1
    buffer_load_dwordx4 v[212:215], v1, s[12:15], s67 offen offset:1024 sc1
    buffer_load_dwordx4 v[216:219], v1, s[12:15], s68 offen sc1
    buffer_load_dwordx4 v[220:223], v1, s[12:15], s68 offen offset:1024 sc1
    s_add_u32 s67, s67, 8192
    s_add_u32 s68, s68, 8192
    s_waitcnt vmcnt(0)
    v_sub_f32 v104, 0, v120
    v_sub_f32 v105, 0, v120
    v_sub_f32 v106, 0, v120
    v_sub_f32 v107, 0, v120
    v_sub_f32 v108, 0, v120
    v_sub_f32 v109, 0, v120
    v_sub_f32 v110, 0, v120
    v_sub_f32 v111, 0, v120
    v_sub_f32 v112, 0, v120
    v_sub_f32 v113, 0, v120
    v_sub_f32 v114, 0, v120
    v_sub_f32 v115, 0, v120
    v_sub_f32 v116, 0, v120
    v_sub_f32 v117, 0, v120
    v_sub_f32 v118, 0, v120
    v_sub_f32 v119, 0, v120
    s_nop 1
    v_mfma_f32_32x32x16_bf16 v[104:119], v[208:211], v[16:19], v[104:119]
    v_mfma_f32_32x32x16_bf16 v[104:119], v[212:215], v[20:23], v[104:119]
    s_nop 11
    v_exp_f32 v104, v104
    v_exp_f32 v105, v105
    v_exp_f32 v106, v106
    v_exp_f32 v107, v107
    v_exp_f32 v108, v108
    v_exp_f32 v109, v109
    v_exp_f32 v110, v110
    v_exp_f32 v111, v111
    v_cvt_pk_bf16_f32 v136, v104, v105
    v_cvt_pk_bf16_f32 v137, v106, v107
    v_cvt_pk_bf16_f32 v138, v108, v109
    v_cvt_pk_bf16_f32 v139, v110, v111
    s_nop 1
    v_mfma_f32_32x32x16_bf16 v[144:159], v[216:219], v[136:139], v[144:159]
    v_exp_f32 v112, v112
    v_exp_f32 v113, v113
    v_exp_f32 v114, v114
    v_exp_f32 v115, v115
    v_exp_f32 v116, v116
    v_exp_f32 v117, v117
    v_exp_f32 v118, v118
    v_exp_f32 v119, v119
    v_cvt_pk_bf16_f32 v140, v112, v113
    v_cvt_pk_bf16_f32 v141, v114, v115
    v_cvt_pk_bf16_f32 v142, v116, v117
    v_cvt_pk_bf16_f32 v143, v118, v119
    s_nop 1
    v_mfma_f32_32x32x16_bf16 v[144:159], v[220:223], v[140:143], v[144:159]
    v_sub_f32 v104, 0, v121
    v_sub_f32 v105, 0, v121
    v_sub_f32 v106, 0, v121
    v_sub_f32 v107, 0, v121
    v_sub_f32 v108, 0, v121
    v_sub_f32 v109, 0, v121
    v_sub_f32 v110, 0, v121
    v_sub_f32 v111, 0, v121
    v_sub_f32 v112, 0, v121
    v_sub_f32 v113, 0, v121
    v_sub_f32 v114, 0, v121
    v_sub_f32 v115, 0, v121
    v_sub_f32 v116, 0, v121
    v_sub_f32 v117, 0, v121
    v_sub_f32 v118, 0, v121
    v_sub_f32 v119, 0, v121
    s_nop 1
    v_mfma_f32_32x32x16_bf16 v[104:119], v[208:211], v[24:27], v[104:119]
    v_mfma_f32_32x32x16_bf16 v[104:119], v[212:215], v[28:31], v[104:119]
    s_nop 11
    v_exp_f32 v104, v104
    v_exp_f32 v105, v105
    v_exp_f32 v106, v106
    v_exp_f32 v107, v107
    v_exp_f32 v108, v108
    v_exp_f32 v109, v109
    v_exp_f32 v110, v110
    v_exp_f32 v111, v111
    v_cvt_pk_bf16_f32 v136, v104, v105
    v_cvt_pk_bf16_f32 v137, v106, v107
    v_cvt_pk_bf16_f32 v138, v108, v109
    v_cvt_pk_bf16_f32 v139, v110, v111
    s_nop 1
    v_mfma_f32_32x32x16_bf16 v[160:175], v[216:219], v[136:139], v[160:175]
    v_exp_f32 v112, v112
    v_exp_f32 v113, v113
    v_exp_f32 v114, v114
    v_exp_f32 v115, v115
    v_exp_f32 v116, v116
    v_exp_f32 v117, v117
    v_exp_f32 v118, v118
    v_exp_f32 v119, v119
    v_cvt_pk_bf16_f32 v140, v112, v113
    v_cvt_pk_bf16_f32 v141, v114, v115
    v_cvt_pk_bf16_f32 v142, v116, v117
    v_cvt_pk_bf16_f32 v143, v118, v119
    s_nop 1
    v_mfma_f32_32x32x16_bf16 v[160:175], v[220:223], v[140:143], v[160:175]
    s_sub_u32 s70, s70, 1
    s_cmp_lg_u32 s70, 0
    s_cbranch_scc1 LK_main_kernel_390
    s_branch LBr_main_kernel_384
LBf_main_kernel_386:
    s_cmp_eq_u32 s0, 1
    s_cbranch_scc1 L_main_kernel_391
    s_mul_i32 s53, s100, 9363
    s_lshr_b32 s53, s53, 16
    s_mul_i32 s54, s53, 7
    s_sub_u32 s54, s100, s54
    s_and_b32 s55, s53, 15
    s_lshr_b32 s53, s53, 4
    s_cmp_eq_u32 s53, 0
    s_cselect_b32 s57, 0, 6422528
    s_mul_i32 s58, s55, 28
    s_lshl_b32 s59, s54, 2
    s_add_u32 s58, s58, s59
    s_add_u32 s58, s58, s3
    s_mul_i32 s58, s58, 14336
    s_add_u32 s57, s57, s58
    buffer_load_dwordx4 v[128:131], v1, s[4:7], s57 offen offset:0 sc1
    buffer_load_dwordx4 v[132:135], v1, s[4:7], s57 offen offset:1024 sc1
    buffer_load_dwordx4 v[136:139], v1, s[4:7], s57 offen offset:2048 sc1
    buffer_load_dwordx4 v[140:143], v1, s[4:7], s57 offen offset:3072 sc1
    s_add_u32 s57, s57, 4096
    buffer_load_dwordx4 v[144:147], v1, s[4:7], s57 offen offset:0 sc1
    buffer_load_dwordx4 v[148:151], v1, s[4:7], s57 offen offset:1024 sc1
    buffer_load_dwordx4 v[152:155], v1, s[4:7], s57 offen offset:2048 sc1
    buffer_load_dwordx4 v[156:159], v1, s[4:7], s57 offen offset:3072 sc1
    s_add_u32 s57, s57, 4096
    buffer_load_dwordx4 v[160:163], v1, s[4:7], s57 offen offset:0 sc1
    buffer_load_dwordx4 v[164:167], v1, s[4:7], s57 offen offset:1024 sc1
    buffer_load_dwordx4 v[168:171], v1, s[4:7], s57 offen offset:2048 sc1
    buffer_load_dwordx4 v[172:175], v1, s[4:7], s57 offen offset:3072 sc1
    s_add_u32 s57, s57, 4096
    buffer_load_dwordx4 v[176:179], v1, s[4:7], s57 offen offset:0 sc1
    buffer_load_dwordx4 v[180:183], v1, s[4:7], s57 offen offset:1024 sc1
L_main_kernel_391:
    s_cmp_eq_u32 s0, 1
    s_cbranch_scc1 L_main_kernel_392
    s_mul_i32 s58, s3, 14336
    s_add_u32 s58, s58, 32768
    v_add_u32 v2, s58, v1
    s_waitcnt vmcnt(0)
    s_barrier
    ds_write_b128 v2, v[128:131] offset:0
    ds_write_b128 v2, v[132:135] offset:1024
    ds_write_b128 v2, v[136:139] offset:2048
    ds_write_b128 v2, v[140:143] offset:3072
    ds_write_b128 v2, v[144:147] offset:4096
    ds_write_b128 v2, v[148:151] offset:5120
    ds_write_b128 v2, v[152:155] offset:6144
    ds_write_b128 v2, v[156:159] offset:7168
    ds_write_b128 v2, v[160:163] offset:8192
    ds_write_b128 v2, v[164:167] offset:9216
    ds_write_b128 v2, v[168:171] offset:10240
    ds_write_b128 v2, v[172:175] offset:11264
    ds_write_b128 v2, v[176:179] offset:12288
    ds_write_b128 v2, v[180:183] offset:13312
    s_nop 0
    v_add_u32 v2, 32768, v1
    s_waitcnt lgkmcnt(0)
    s_barrier
    ds_read_b128 a[0:3], v2 offset:0
    ds_read_b128 a[4:7], v2 offset:1024
    ds_read_b128 a[8:11], v2 offset:2048
    ds_read_b128 a[12:15], v2 offset:3072
    ds_read_b128 a[16:19], v2 offset:4096
    ds_read_b128 a[20:23], v2 offset:5120
    ds_read_b128 a[24:27], v2 offset:6144
    ds_read_b128 a[28:31], v2 offset:7168
    ds_read_b128 a[32:35], v2 offset:8192
    ds_read_b128 a[36:39], v2 offset:9216
    ds_read_b128 a[40:43], v2 offset:10240
    ds_read_b128 a[44:47], v2 offset:11264
    s_waitcnt lgkmcnt(4)
    ds_read_b128 a[48:51], v2 offset:12288
    ds_read_b128 a[52:55], v2 offset:13312
    ds_read_b128 a[56:59], v2 offset:14336
    ds_read_b128 a[60:63], v2 offset:15360
    ds_read_b128 a[64:67], v2 offset:16384
    ds_read_b128 a[68:71], v2 offset:17408
    ds_read_b128 a[72:75], v2 offset:18432
    ds_read_b128 a[76:79], v2 offset:19456
    ds_read_b128 a[80:83], v2 offset:20480
    ds_read_b128 a[84:87], v2 offset:21504
    ds_read_b128 a[88:91], v2 offset:22528
    ds_read_b128 a[92:95], v2 offset:23552
    s_waitcnt lgkmcnt(4)
    ds_read_b128 a[96:99], v2 offset:24576
    ds_read_b128 a[100:103], v2 offset:25600
    ds_read_b128 a[104:107], v2 offset:26624
    ds_read_b128 a[108:111], v2 offset:27648
    ds_read_b128 a[112:115], v2 offset:28672
    ds_read_b128 a[116:119], v2 offset:29696
    ds_read_b128 a[120:123], v2 offset:30720
    ds_read_b128 a[124:127], v2 offset:31744
    ds_read_b128 a[128:131], v2 offset:32768
    ds_read_b128 a[132:135], v2 offset:33792
    ds_read_b128 a[136:139], v2 offset:34816
    ds_read_b128 a[140:143], v2 offset:35840
    s_waitcnt lgkmcnt(4)
    ds_read_b128 a[144:147], v2 offset:36864
    ds_read_b128 a[148:151], v2 offset:37888
    ds_read_b128 a[152:155], v2 offset:38912
    ds_read_b128 a[156:159], v2 offset:39936
    ds_read_b128 a[160:163], v2 offset:40960
    ds_read_b128 a[164:167], v2 offset:41984
    ds_read_b128 a[168:171], v2 offset:43008
    ds_read_b128 a[172:175], v2 offset:44032
    ds_read_b128 a[176:179], v2 offset:45056
    ds_read_b128 a[180:183], v2 offset:46080
    ds_read_b128 a[184:187], v2 offset:47104
    ds_read_b128 a[188:191], v2 offset:48128
    s_waitcnt lgkmcnt(4)
    ds_read_b128 a[192:195], v2 offset:49152
    ds_read_b128 a[196:199], v2 offset:50176
    ds_read_b128 a[200:203], v2 offset:51200
    ds_read_b128 a[204:207], v2 offset:52224
    ds_read_b128 a[208:211], v2 offset:53248
    ds_read_b128 a[212:215], v2 offset:54272
    ds_read_b128 a[216:219], v2 offset:55296
    ds_read_b128 a[220:223], v2 offset:56320
L_main_kernel_392:
Lnx_main_kernel_187:
    s_add_u32 s12, s44, 82182144
    s_addc_u32 s13, s45, 0
    s_and_b32 s13, s13, 0xffff
    s_mov_b32 s14, 186253312
    s_add_u32 s0, s0, 1
    s_cmp_lt_u32 s0, 2
    s_cbranch_scc1 Ltop_main_kernel_167
Lexit_main_kernel:
    s_endpgm
.section .rodata,"a"
.p2align 6
.amdhsa_kernel main_kernel
  .amdhsa_next_free_vgpr 512
  .amdhsa_next_free_sgpr 102
  .amdhsa_accum_offset 256
  .amdhsa_group_segment_fixed_size 0
  .amdhsa_kernarg_size 120
  .amdhsa_user_sgpr_count 2
  .amdhsa_user_sgpr_kernarg_segment_ptr 1
  .amdhsa_system_sgpr_workgroup_id_x 1
  .amdhsa_float_denorm_mode_32 3
  .amdhsa_float_denorm_mode_16_64 3
.end_amdhsa_kernel
```
